```python
import torch

def _softmax(x, axis=-1):
    return torch.softmax(x, dim=axis)
def _gelu(x):
    return torch.nn.functional.gelu(x, approximate="tanh")
def _silu(x):
    return torch.nn.functional.silu(x)
def _sigmoid(x):
    return torch.sigmoid(x)
def _layernorm(x, axis=-1, eps=1e-5):
    m = x.mean(dim=axis, keepdim=True)
    v = x.var(dim=axis, keepdim=True, unbiased=False)
    return (x - m) / torch.sqrt(v + eps)
def _scatter_add(tgt, idx, src, axis=0):
    return tgt.clone().index_add_(axis, idx, src)
def _segment_sum(src, seg, n):
    out = torch.zeros((n,) + src.shape[1:], dtype=src.dtype)
    return out.index_add_(0, seg, src)
def _pad(x, pw):
    flat = tuple(v for pair in reversed(pw) for v in pair)
    return torch.nn.functional.pad(x, flat)

kernel_name = 'parallel_sum__spectral_fnet__moe_arch_mod__prompt'

def setup_inputs():

    _w = (lambda a: (lambda t: t.to(torch.bfloat16) if t.is_floating_point() else t)(torch.as_tensor(a)))
    def _A_setup():
        B, S, D = 1, 2048, 1024
        ns = torch.arange(S)[:, None] * torch.arange(S)[None, :]
        nd = torch.arange(D)[:, None] * torch.arange(D)[None, :]
        Ws_re = torch.cos(-2.0 * torch.pi * ns / S).to(float)
        Ws_im = torch.sin(-2.0 * torch.pi * ns / S).to(float)
        Wd_re = torch.cos(-2.0 * torch.pi * nd / D).to(float)
        Wd_im = torch.sin(-2.0 * torch.pi * nd / D).to(float)
        return {
            "x": _w((lambda *s: torch.randn(*s, dtype=torch.bfloat16) * 0.05)(B, S, D)),
            "dft_seq_re": _w(Ws_re),
            "dft_seq_im": _w(Ws_im),
            "dft_hid_re": _w(Wd_re),
            "dft_hid_im": _w(Wd_im),
        }
    _A_in = _A_setup()

    def _B_setup():
        B, S, D, F, C = 1, 2048, 1024, 3584, 2
        return {
            "x": _w((lambda *s: torch.randn(*s, dtype=torch.bfloat16) * 0.05)(B, S, D)),
            "w_r": _w((lambda *s: torch.randn(*s, dtype=torch.bfloat16) * 1.6)(D)),
            "w_gate": _w((lambda *s: torch.randn(*s, dtype=torch.bfloat16) * 0.4)(D, F)),
            "w_up": _w((lambda *s: torch.randn(*s, dtype=torch.bfloat16) * 0.4)(D, F)),
            "w_down": _w((lambda *s: torch.randn(*s, dtype=torch.bfloat16) * 0.4)(F, D)),
        }
    _B_in = _B_setup()

    return {
        "A_x": _A_in["x"],
        "A_dft_seq_re": _A_in["dft_seq_re"],
        "A_dft_seq_im": _A_in["dft_seq_im"],
        "A_dft_hid_re": _A_in["dft_hid_re"],
        "A_dft_hid_im": _A_in["dft_hid_im"],
        "B_x": _B_in["x"],
        "B_w_r": _B_in["w_r"],
        "B_w_gate": _B_in["w_gate"],
        "B_w_up": _B_in["w_up"],
        "B_w_down": _B_in["w_down"],
    }

def reference(A_x, A_dft_seq_re, A_dft_seq_im, A_dft_hid_re, A_dft_hid_im, B_x, B_w_r, B_w_gate, B_w_up, B_w_down):
    def _A_ref(x, dft_seq_re, dft_seq_im, dft_hid_re, dft_hid_im):
        a = torch.einsum("bsd,ed->bse", x, dft_hid_re)
        b = torch.einsum("bsd,ed->bse", x, dft_hid_im)
        y = torch.einsum("ts,bse->bte", dft_seq_re, a) - torch.einsum("ts,bse->bte", dft_seq_im, b)
        return y

    def _B_ref(x, w_r, w_gate, w_up, w_down):
        B, S, D = x.shape
        C = 2
        r = x @ w_r
        idx = torch.argsort(-r, axis=-1)[:, :C]
        idx_e = (lambda x, n, axis: torch.repeat_interleave(x, n, dim=axis))(idx.reshape(B, C, 1), D, axis=2)
        x_sel = (lambda x, i, axis: torch.take_along_dim(x, i, dim=axis))(x, idx_e, axis=1)
        g = _silu(x_sel @ w_gate)
        u = x_sel @ w_up
        y = (g * u) @ w_down
        r_sel = _sigmoid((lambda x, i, axis: torch.take_along_dim(x, i, dim=axis))(r, idx, axis=1))
        y = y * r_sel.reshape(B, C, 1)
        b_off = (torch.arange(B) * S).reshape(B, 1)
        flat_idx = (idx + b_off).reshape(B * C)
        zero = (x * 0.0).reshape(B * S, D)
        upd = _scatter_add(zero, flat_idx, y.reshape(B * C, D), axis=0)
        return x + upd.reshape(B, S, D)

    x = A_x
    xn = _layernorm(x, axis=-1)
    return x + _A_ref(xn, A_dft_seq_re, A_dft_seq_im, A_dft_hid_re, A_dft_hid_im) + _B_ref(xn, B_w_r, B_w_gate, B_w_up, B_w_down)
```

```asm
; @launch kernel=ln_kernel grid=(512,1,1) block=(256,1,1) lds=0
; @launch kernel=gemm1_kernel grid=(256,1,1) block=(256,1,1) lds=0
; @launch kernel=gateup_kernel grid=(56,1,1) block=(256,1,1) lds=32768
; @launch kernel=down_kernel grid=(16,1,1) block=(256,1,1) lds=49152
; @launch kernel=gemm2_kernel grid=(128,1,1) block=(256,1,1) lds=0
.amdgcn_target "amdgcn-amd-amdhsa--gfx950"
.text
.globl ln_kernel
.p2align 8
.type ln_kernel,@function
ln_kernel:
    s_cmp_ge_u32 s2, 512
    s_cbranch_scc1 ln_kernel_end1
    s_load_dwordx2 s[4:5], s[0:1], 0
    s_load_dwordx2 s[8:9], s[0:1], 48
    s_load_dwordx2 s[12:13], s[0:1], 96
    s_waitcnt lgkmcnt(0)
    s_mov_b32 s6, 4194304
    s_mov_b32 s7, 0x00020000
    s_mov_b32 s10, 2048
    s_mov_b32 s11, 0x00020000
    s_mov_b32 s14, 268435456
    s_mov_b32 s15, 0x00020000
    v_lshrrev_b32 v1, 6, v0
    v_and_b32 v2, 63, v0
    s_lshl_b32 s3, s2, 2
    v_add_u32 v1, s3, v1
    v_lshlrev_b32 v3, 4, v2
    v_lshl_add_u32 v4, v1, 11, v3
    buffer_load_dwordx4 v[8:11], v4, s[4:7], 0 offen
    buffer_load_dwordx4 v[12:15], v4, s[4:7], 0 offen offset:1024
    buffer_load_dwordx4 v[16:19], v3, s[8:11], 0 offen
    buffer_load_dwordx4 v[20:23], v3, s[8:11], 0 offen offset:1024
    s_waitcnt vmcnt(0)
    v_lshlrev_b32 v24, 16, v8
    v_and_b32 v25, 0xffff0000, v8
    v_lshlrev_b32 v26, 16, v9
    v_and_b32 v27, 0xffff0000, v9
    v_lshlrev_b32 v28, 16, v10
    v_and_b32 v29, 0xffff0000, v10
    v_lshlrev_b32 v30, 16, v11
    v_and_b32 v31, 0xffff0000, v11
    v_lshlrev_b32 v32, 16, v12
    v_and_b32 v33, 0xffff0000, v12
    v_lshlrev_b32 v34, 16, v13
    v_and_b32 v35, 0xffff0000, v13
    v_lshlrev_b32 v36, 16, v14
    v_and_b32 v37, 0xffff0000, v14
    v_lshlrev_b32 v38, 16, v15
    v_and_b32 v39, 0xffff0000, v15
    v_mov_b32 v5, 0
    v_add_f32 v5, v5, v24
    v_add_f32 v5, v5, v25
    v_add_f32 v5, v5, v26
    v_add_f32 v5, v5, v27
    v_add_f32 v5, v5, v28
    v_add_f32 v5, v5, v29
    v_add_f32 v5, v5, v30
    v_add_f32 v5, v5, v31
    v_add_f32 v5, v5, v32
    v_add_f32 v5, v5, v33
    v_add_f32 v5, v5, v34
    v_add_f32 v5, v5, v35
    v_add_f32 v5, v5, v36
    v_add_f32 v5, v5, v37
    v_add_f32 v5, v5, v38
    v_add_f32 v5, v5, v39
    ds_swizzle_b32 v6, v5 offset:0x41f
    s_waitcnt lgkmcnt(0)
    v_add_f32 v5, v5, v6
    ds_swizzle_b32 v6, v5 offset:0x81f
    s_waitcnt lgkmcnt(0)
    v_add_f32 v5, v5, v6
    ds_swizzle_b32 v6, v5 offset:0x101f
    s_waitcnt lgkmcnt(0)
    v_add_f32 v5, v5, v6
    ds_swizzle_b32 v6, v5 offset:0x201f
    s_waitcnt lgkmcnt(0)
    v_add_f32 v5, v5, v6
    ds_swizzle_b32 v6, v5 offset:0x401f
    s_waitcnt lgkmcnt(0)
    v_add_f32 v5, v5, v6
    v_mov_b32 v6, v5
    s_nop 1
    v_permlane32_swap_b32 v6, v5
    s_nop 1
    v_add_f32 v5, v5, v6
    v_mul_f32 v5, 0x3a800000, v5
    v_mov_b32 v7, 0
    v_sub_f32 v6, v24, v5
    v_fmac_f32 v7, v6, v6
    v_sub_f32 v6, v25, v5
    v_fmac_f32 v7, v6, v6
    v_sub_f32 v6, v26, v5
    v_fmac_f32 v7, v6, v6
    v_sub_f32 v6, v27, v5
    v_fmac_f32 v7, v6, v6
    v_sub_f32 v6, v28, v5
    v_fmac_f32 v7, v6, v6
    v_sub_f32 v6, v29, v5
    v_fmac_f32 v7, v6, v6
    v_sub_f32 v6, v30, v5
    v_fmac_f32 v7, v6, v6
    v_sub_f32 v6, v31, v5
    v_fmac_f32 v7, v6, v6
    v_sub_f32 v6, v32, v5
    v_fmac_f32 v7, v6, v6
    v_sub_f32 v6, v33, v5
    v_fmac_f32 v7, v6, v6
    v_sub_f32 v6, v34, v5
    v_fmac_f32 v7, v6, v6
    v_sub_f32 v6, v35, v5
    v_fmac_f32 v7, v6, v6
    v_sub_f32 v6, v36, v5
    v_fmac_f32 v7, v6, v6
    v_sub_f32 v6, v37, v5
    v_fmac_f32 v7, v6, v6
    v_sub_f32 v6, v38, v5
    v_fmac_f32 v7, v6, v6
    v_sub_f32 v6, v39, v5
    v_fmac_f32 v7, v6, v6
    ds_swizzle_b32 v6, v7 offset:0x41f
    s_waitcnt lgkmcnt(0)
    v_add_f32 v7, v7, v6
    ds_swizzle_b32 v6, v7 offset:0x81f
    s_waitcnt lgkmcnt(0)
    v_add_f32 v7, v7, v6
    ds_swizzle_b32 v6, v7 offset:0x101f
    s_waitcnt lgkmcnt(0)
    v_add_f32 v7, v7, v6
    ds_swizzle_b32 v6, v7 offset:0x201f
    s_waitcnt lgkmcnt(0)
    v_add_f32 v7, v7, v6
    ds_swizzle_b32 v6, v7 offset:0x401f
    s_waitcnt lgkmcnt(0)
    v_add_f32 v7, v7, v6
    v_mov_b32 v6, v7
    s_nop 1
    v_permlane32_swap_b32 v6, v7
    s_nop 1
    v_add_f32 v7, v7, v6
    v_mul_f32 v7, 0x3a800000, v7
    v_cvt_pk_bf16_f32 v5, v5, v5
    v_and_b32 v5, 0xffff0000, v5
    v_cvt_pk_bf16_f32 v7, v7, v7
    v_and_b32 v7, 0xffff0000, v7
    v_add_f32 v7, 0x3727c5ac, v7
    v_cvt_pk_bf16_f32 v7, v7, v7
    v_and_b32 v7, 0xffff0000, v7
    v_sqrt_f32 v7, v7
    s_nop 0
    v_cvt_pk_bf16_f32 v7, v7, v7
    v_and_b32 v7, 0xffff0000, v7
    v_rcp_f32 v7, v7
    s_nop 0
    v_mov_b32 v40, 0
    v_sub_f32 v24, v24, v5
    v_cvt_pk_bf16_f32 v24, v24, v24
    v_and_b32 v24, 0xffff0000, v24
    v_mul_f32 v24, v24, v7
    v_sub_f32 v25, v25, v5
    v_cvt_pk_bf16_f32 v25, v25, v25
    v_and_b32 v25, 0xffff0000, v25
    v_mul_f32 v25, v25, v7
    v_sub_f32 v26, v26, v5
    v_cvt_pk_bf16_f32 v26, v26, v26
    v_and_b32 v26, 0xffff0000, v26
    v_mul_f32 v26, v26, v7
    v_sub_f32 v27, v27, v5
    v_cvt_pk_bf16_f32 v27, v27, v27
    v_and_b32 v27, 0xffff0000, v27
    v_mul_f32 v27, v27, v7
    v_sub_f32 v28, v28, v5
    v_cvt_pk_bf16_f32 v28, v28, v28
    v_and_b32 v28, 0xffff0000, v28
    v_mul_f32 v28, v28, v7
    v_sub_f32 v29, v29, v5
    v_cvt_pk_bf16_f32 v29, v29, v29
    v_and_b32 v29, 0xffff0000, v29
    v_mul_f32 v29, v29, v7
    v_sub_f32 v30, v30, v5
    v_cvt_pk_bf16_f32 v30, v30, v30
    v_and_b32 v30, 0xffff0000, v30
    v_mul_f32 v30, v30, v7
    v_sub_f32 v31, v31, v5
    v_cvt_pk_bf16_f32 v31, v31, v31
    v_and_b32 v31, 0xffff0000, v31
    v_mul_f32 v31, v31, v7
    v_sub_f32 v32, v32, v5
    v_cvt_pk_bf16_f32 v32, v32, v32
    v_and_b32 v32, 0xffff0000, v32
    v_mul_f32 v32, v32, v7
    v_sub_f32 v33, v33, v5
    v_cvt_pk_bf16_f32 v33, v33, v33
    v_and_b32 v33, 0xffff0000, v33
    v_mul_f32 v33, v33, v7
    v_sub_f32 v34, v34, v5
    v_cvt_pk_bf16_f32 v34, v34, v34
    v_and_b32 v34, 0xffff0000, v34
    v_mul_f32 v34, v34, v7
    v_sub_f32 v35, v35, v5
    v_cvt_pk_bf16_f32 v35, v35, v35
    v_and_b32 v35, 0xffff0000, v35
    v_mul_f32 v35, v35, v7
    v_sub_f32 v36, v36, v5
    v_cvt_pk_bf16_f32 v36, v36, v36
    v_and_b32 v36, 0xffff0000, v36
    v_mul_f32 v36, v36, v7
    v_sub_f32 v37, v37, v5
    v_cvt_pk_bf16_f32 v37, v37, v37
    v_and_b32 v37, 0xffff0000, v37
    v_mul_f32 v37, v37, v7
    v_sub_f32 v38, v38, v5
    v_cvt_pk_bf16_f32 v38, v38, v38
    v_and_b32 v38, 0xffff0000, v38
    v_mul_f32 v38, v38, v7
    v_sub_f32 v39, v39, v5
    v_cvt_pk_bf16_f32 v39, v39, v39
    v_and_b32 v39, 0xffff0000, v39
    v_mul_f32 v39, v39, v7
    v_cvt_pk_bf16_f32 v8, v24, v25
    v_lshlrev_b32 v41, 16, v8
    v_lshlrev_b32 v42, 16, v16
    v_fmac_f32 v40, v41, v42
    v_and_b32 v41, 0xffff0000, v8
    v_and_b32 v42, 0xffff0000, v16
    v_fmac_f32 v40, v41, v42
    v_cvt_pk_bf16_f32 v9, v26, v27
    v_lshlrev_b32 v41, 16, v9
    v_lshlrev_b32 v42, 16, v17
    v_fmac_f32 v40, v41, v42
    v_and_b32 v41, 0xffff0000, v9
    v_and_b32 v42, 0xffff0000, v17
    v_fmac_f32 v40, v41, v42
    v_cvt_pk_bf16_f32 v10, v28, v29
    v_lshlrev_b32 v41, 16, v10
    v_lshlrev_b32 v42, 16, v18
    v_fmac_f32 v40, v41, v42
    v_and_b32 v41, 0xffff0000, v10
    v_and_b32 v42, 0xffff0000, v18
    v_fmac_f32 v40, v41, v42
    v_cvt_pk_bf16_f32 v11, v30, v31
    v_lshlrev_b32 v41, 16, v11
    v_lshlrev_b32 v42, 16, v19
    v_fmac_f32 v40, v41, v42
    v_and_b32 v41, 0xffff0000, v11
    v_and_b32 v42, 0xffff0000, v19
    v_fmac_f32 v40, v41, v42
    v_cvt_pk_bf16_f32 v12, v32, v33
    v_lshlrev_b32 v41, 16, v12
    v_lshlrev_b32 v42, 16, v20
    v_fmac_f32 v40, v41, v42
    v_and_b32 v41, 0xffff0000, v12
    v_and_b32 v42, 0xffff0000, v20
    v_fmac_f32 v40, v41, v42
    v_cvt_pk_bf16_f32 v13, v34, v35
    v_lshlrev_b32 v41, 16, v13
    v_lshlrev_b32 v42, 16, v21
    v_fmac_f32 v40, v41, v42
    v_and_b32 v41, 0xffff0000, v13
    v_and_b32 v42, 0xffff0000, v21
    v_fmac_f32 v40, v41, v42
    v_cvt_pk_bf16_f32 v14, v36, v37
    v_lshlrev_b32 v41, 16, v14
    v_lshlrev_b32 v42, 16, v22
    v_fmac_f32 v40, v41, v42
    v_and_b32 v41, 0xffff0000, v14
    v_and_b32 v42, 0xffff0000, v22
    v_fmac_f32 v40, v41, v42
    v_cvt_pk_bf16_f32 v15, v38, v39
    v_lshlrev_b32 v41, 16, v15
    v_lshlrev_b32 v42, 16, v23
    v_fmac_f32 v40, v41, v42
    v_and_b32 v41, 0xffff0000, v15
    v_and_b32 v42, 0xffff0000, v23
    v_fmac_f32 v40, v41, v42
    buffer_store_dwordx4 v[8:11], v4, s[12:15], 0 offen
    buffer_store_dwordx4 v[12:15], v4, s[12:15], 0 offen offset:1024
    ds_swizzle_b32 v6, v40 offset:0x41f
    s_waitcnt lgkmcnt(0)
    v_add_f32 v40, v40, v6
    ds_swizzle_b32 v6, v40 offset:0x81f
    s_waitcnt lgkmcnt(0)
    v_add_f32 v40, v40, v6
    ds_swizzle_b32 v6, v40 offset:0x101f
    s_waitcnt lgkmcnt(0)
    v_add_f32 v40, v40, v6
    ds_swizzle_b32 v6, v40 offset:0x201f
    s_waitcnt lgkmcnt(0)
    v_add_f32 v40, v40, v6
    ds_swizzle_b32 v6, v40 offset:0x401f
    s_waitcnt lgkmcnt(0)
    v_add_f32 v40, v40, v6
    v_mov_b32 v6, v40
    s_nop 1
    v_permlane32_swap_b32 v6, v40
    s_nop 1
    v_add_f32 v40, v40, v6
    v_lshlrev_b32 v1, 2, v1
    v_add_u32 v1, 16777216, v1
    buffer_store_dword v40, v1, s[12:15], 0 offen
ln_kernel_end1:
    s_endpgm
.globl gemm1_kernel
.p2align 8
.type gemm1_kernel,@function
gemm1_kernel:
    s_cmp_ge_u32 s2, 256
    s_cbranch_scc1 gemm1_kernel_end1
    s_load_dwordx2 s[4:5], s[0:1], 24
    s_load_dwordx2 s[8:9], s[0:1], 32
    s_load_dwordx2 s[12:13], s[0:1], 96
    s_waitcnt lgkmcnt(0)
    s_mov_b32 s6, 2097152
    s_mov_b32 s7, 0x00020000
    s_mov_b32 s10, 2097152
    s_mov_b32 s11, 0x00020000
    s_mov_b32 s14, 268435456
    s_mov_b32 s15, 0x00020000
    v_lshrrev_b32 v1, 6, v0
    s_nop 0
    v_readfirstlane_b32 s3, v1
    s_lshl_b32 s20, s2, 2
    s_add_u32 s20, s20, s3
    s_lshr_b32 s21, s20, 5
    s_and_b32 s22, s20, 31
    s_cmp_ge_u32 s22, 16
    s_cselect_b32 s4, s8, s4
    s_cselect_b32 s5, s9, s5
    v_and_b32 v2, 31, v0
    v_bfe_u32 v3, v0, 5, 1
    s_lshl_b32 s23, s21, 6
    v_add_u32 v4, s23, v2
    v_lshlrev_b32 v4, 11, v4
    v_lshl_add_u32 v4, v3, 4, v4
    s_and_b32 s24, s22, 15
    s_lshl_b32 s24, s24, 6
    v_add_u32 v5, s24, v2
    v_lshlrev_b32 v5, 11, v5
    v_lshl_add_u32 v5, v3, 4, v5
    v_mov_b32 v64, 0
    v_mov_b32 v65, 0
    v_mov_b32 v66, 0
    v_mov_b32 v67, 0
    v_mov_b32 v68, 0
    v_mov_b32 v69, 0
    v_mov_b32 v70, 0
    v_mov_b32 v71, 0
    v_mov_b32 v72, 0
    v_mov_b32 v73, 0
    v_mov_b32 v74, 0
    v_mov_b32 v75, 0
    v_mov_b32 v76, 0
    v_mov_b32 v77, 0
    v_mov_b32 v78, 0
    v_mov_b32 v79, 0
    v_mov_b32 v80, 0
    v_mov_b32 v81, 0
    v_mov_b32 v82, 0
    v_mov_b32 v83, 0
    v_mov_b32 v84, 0
    v_mov_b32 v85, 0
    v_mov_b32 v86, 0
    v_mov_b32 v87, 0
    v_mov_b32 v88, 0
    v_mov_b32 v89, 0
    v_mov_b32 v90, 0
    v_mov_b32 v91, 0
    v_mov_b32 v92, 0
    v_mov_b32 v93, 0
    v_mov_b32 v94, 0
    v_mov_b32 v95, 0
    v_mov_b32 v96, 0
    v_mov_b32 v97, 0
    v_mov_b32 v98, 0
    v_mov_b32 v99, 0
    v_mov_b32 v100, 0
    v_mov_b32 v101, 0
    v_mov_b32 v102, 0
    v_mov_b32 v103, 0
    v_mov_b32 v104, 0
    v_mov_b32 v105, 0
    v_mov_b32 v106, 0
    v_mov_b32 v107, 0
    v_mov_b32 v108, 0
    v_mov_b32 v109, 0
    v_mov_b32 v110, 0
    v_mov_b32 v111, 0
    v_mov_b32 v112, 0
    v_mov_b32 v113, 0
    v_mov_b32 v114, 0
    v_mov_b32 v115, 0
    v_mov_b32 v116, 0
    v_mov_b32 v117, 0
    v_mov_b32 v118, 0
    v_mov_b32 v119, 0
    v_mov_b32 v120, 0
    v_mov_b32 v121, 0
    v_mov_b32 v122, 0
    v_mov_b32 v123, 0
    v_mov_b32 v124, 0
    v_mov_b32 v125, 0
    v_mov_b32 v126, 0
    v_mov_b32 v127, 0
    s_mov_b32 s40, 0
    s_mov_b32 s41, 65536
    s_mov_b32 s42, 65536
gemm1_kernel_loop2:
    buffer_load_dwordx4 v[8:11], v4, s[12:15], s40 offen
    buffer_load_dwordx4 v[12:15], v4, s[12:15], s41 offen
    buffer_load_dwordx4 v[16:19], v5, s[4:7], s40 offen
    buffer_load_dwordx4 v[20:23], v5, s[4:7], s42 offen
    buffer_load_dwordx4 v[24:27], v4, s[12:15], s40 offen offset:32
    buffer_load_dwordx4 v[28:31], v4, s[12:15], s41 offen offset:32
    buffer_load_dwordx4 v[32:35], v5, s[4:7], s40 offen offset:32
    buffer_load_dwordx4 v[36:39], v5, s[4:7], s42 offen offset:32
    s_add_u32 s40, s40, 64
    s_add_u32 s41, s41, 64
    s_add_u32 s42, s42, 64
    s_waitcnt vmcnt(4)
    v_mfma_f32_32x32x16_bf16 v[64:79], v[8:11], v[16:19], v[64:79]
    v_mfma_f32_32x32x16_bf16 v[80:95], v[8:11], v[20:23], v[80:95]
    v_mfma_f32_32x32x16_bf16 v[96:111], v[12:15], v[16:19], v[96:111]
    v_mfma_f32_32x32x16_bf16 v[112:127], v[12:15], v[20:23], v[112:127]
    s_waitcnt vmcnt(0)
    v_mfma_f32_32x32x16_bf16 v[64:79], v[24:27], v[32:35], v[64:79]
    v_mfma_f32_32x32x16_bf16 v[80:95], v[24:27], v[36:39], v[80:95]
    v_mfma_f32_32x32x16_bf16 v[96:111], v[28:31], v[32:35], v[96:111]
    v_mfma_f32_32x32x16_bf16 v[112:127], v[28:31], v[36:39], v[112:127]
    s_cmp_lt_u32 s40, 2048
    s_cbranch_scc1 gemm1_kernel_loop2
    s_nop 15
    s_lshl_b32 s24, s22, 6
    v_add_u32 v6, s24, v2
    v_lshlrev_b32 v6, 12, v6
    v_lshl_add_u32 v6, v3, 3, v6
    s_lshl_b32 s23, s21, 7
    s_add_u32 s23, s23, 8388608
    v_add_u32 v6, s23, v6
    v_add_u32 v7, 131072, v6
    v_cvt_pk_bf16_f32 v64, v64, v65
    v_cvt_pk_bf16_f32 v65, v66, v67
    buffer_store_dwordx2 v[64:65], v6, s[12:15], 0 offen offset:0
    v_cvt_pk_bf16_f32 v68, v68, v69
    v_cvt_pk_bf16_f32 v69, v70, v71
    buffer_store_dwordx2 v[68:69], v6, s[12:15], 0 offen offset:16
    v_cvt_pk_bf16_f32 v72, v72, v73
    v_cvt_pk_bf16_f32 v73, v74, v75
    buffer_store_dwordx2 v[72:73], v6, s[12:15], 0 offen offset:32
    v_cvt_pk_bf16_f32 v76, v76, v77
    v_cvt_pk_bf16_f32 v77, v78, v79
    buffer_store_dwordx2 v[76:77], v6, s[12:15], 0 offen offset:48
    v_cvt_pk_bf16_f32 v80, v80, v81
    v_cvt_pk_bf16_f32 v81, v82, v83
    buffer_store_dwordx2 v[80:81], v7, s[12:15], 0 offen offset:0
    v_cvt_pk_bf16_f32 v84, v84, v85
    v_cvt_pk_bf16_f32 v85, v86, v87
    buffer_store_dwordx2 v[84:85], v7, s[12:15], 0 offen offset:16
    v_cvt_pk_bf16_f32 v88, v88, v89
    v_cvt_pk_bf16_f32 v89, v90, v91
    buffer_store_dwordx2 v[88:89], v7, s[12:15], 0 offen offset:32
    v_cvt_pk_bf16_f32 v92, v92, v93
    v_cvt_pk_bf16_f32 v93, v94, v95
    buffer_store_dwordx2 v[92:93], v7, s[12:15], 0 offen offset:48
    v_cvt_pk_bf16_f32 v96, v96, v97
    v_cvt_pk_bf16_f32 v97, v98, v99
    buffer_store_dwordx2 v[96:97], v6, s[12:15], 0 offen offset:64
    v_cvt_pk_bf16_f32 v100, v100, v101
    v_cvt_pk_bf16_f32 v101, v102, v103
    buffer_store_dwordx2 v[100:101], v6, s[12:15], 0 offen offset:80
    v_cvt_pk_bf16_f32 v104, v104, v105
    v_cvt_pk_bf16_f32 v105, v106, v107
    buffer_store_dwordx2 v[104:105], v6, s[12:15], 0 offen offset:96
    v_cvt_pk_bf16_f32 v108, v108, v109
    v_cvt_pk_bf16_f32 v109, v110, v111
    buffer_store_dwordx2 v[108:109], v6, s[12:15], 0 offen offset:112
    v_cvt_pk_bf16_f32 v112, v112, v113
    v_cvt_pk_bf16_f32 v113, v114, v115
    buffer_store_dwordx2 v[112:113], v7, s[12:15], 0 offen offset:64
    v_cvt_pk_bf16_f32 v116, v116, v117
    v_cvt_pk_bf16_f32 v117, v118, v119
    buffer_store_dwordx2 v[116:117], v7, s[12:15], 0 offen offset:80
    v_cvt_pk_bf16_f32 v120, v120, v121
    v_cvt_pk_bf16_f32 v121, v122, v123
    buffer_store_dwordx2 v[120:121], v7, s[12:15], 0 offen offset:96
    v_cvt_pk_bf16_f32 v124, v124, v125
    v_cvt_pk_bf16_f32 v125, v126, v127
    buffer_store_dwordx2 v[124:125], v7, s[12:15], 0 offen offset:112
gemm1_kernel_end1:
    s_endpgm
.globl gateup_kernel
.p2align 8
.type gateup_kernel,@function
gateup_kernel:
    s_cmp_ge_u32 s2, 56
    s_cbranch_scc1 gateup_kernel_end1
    s_load_dwordx2 s[4:5], s[0:1], 56
    s_load_dwordx2 s[8:9], s[0:1], 64
    s_load_dwordx2 s[12:13], s[0:1], 96
    s_waitcnt lgkmcnt(0)
    s_mov_b32 s6, 7340032
    s_mov_b32 s7, 0x00020000
    s_mov_b32 s10, 7340032
    s_mov_b32 s11, 0x00020000
    s_mov_b32 s14, 268435456
    s_mov_b32 s15, 0x00020000
    v_lshlrev_b32 v1, 5, v0
    v_add_u32 v1, 16777216, v1
    buffer_load_dwordx4 v[8:11], v1, s[12:15], 0 offen
    buffer_load_dwordx4 v[12:15], v1, s[12:15], 0 offen offset:16
    s_waitcnt vmcnt(0)
    s_mov_b32 s30, -1
    v_mov_b32 v16, 0xff800000
    v_mov_b32 v17, 0
    v_lshl_add_u32 v18, v0, 3, 0
    v_cmp_gt_f32 vcc, v8, v16
    v_cmp_ne_u32 s[34:35], s30, v18
    s_nop 1
    s_and_b64 vcc, vcc, s[34:35]
    s_nop 1
    v_cndmask_b32 v16, v16, v8, vcc
    v_cndmask_b32 v17, v17, v18, vcc
    v_lshl_add_u32 v18, v0, 3, 1
    v_cmp_gt_f32 vcc, v9, v16
    v_cmp_ne_u32 s[34:35], s30, v18
    s_nop 1
    s_and_b64 vcc, vcc, s[34:35]
    s_nop 1
    v_cndmask_b32 v16, v16, v9, vcc
    v_cndmask_b32 v17, v17, v18, vcc
    v_lshl_add_u32 v18, v0, 3, 2
    v_cmp_gt_f32 vcc, v10, v16
    v_cmp_ne_u32 s[34:35], s30, v18
    s_nop 1
    s_and_b64 vcc, vcc, s[34:35]
    s_nop 1
    v_cndmask_b32 v16, v16, v10, vcc
    v_cndmask_b32 v17, v17, v18, vcc
    v_lshl_add_u32 v18, v0, 3, 3
    v_cmp_gt_f32 vcc, v11, v16
    v_cmp_ne_u32 s[34:35], s30, v18
    s_nop 1
    s_and_b64 vcc, vcc, s[34:35]
    s_nop 1
    v_cndmask_b32 v16, v16, v11, vcc
    v_cndmask_b32 v17, v17, v18, vcc
    v_lshl_add_u32 v18, v0, 3, 4
    v_cmp_gt_f32 vcc, v12, v16
    v_cmp_ne_u32 s[34:35], s30, v18
    s_nop 1
    s_and_b64 vcc, vcc, s[34:35]
    s_nop 1
    v_cndmask_b32 v16, v16, v12, vcc
    v_cndmask_b32 v17, v17, v18, vcc
    v_lshl_add_u32 v18, v0, 3, 5
    v_cmp_gt_f32 vcc, v13, v16
    v_cmp_ne_u32 s[34:35], s30, v18
    s_nop 1
    s_and_b64 vcc, vcc, s[34:35]
    s_nop 1
    v_cndmask_b32 v16, v16, v13, vcc
    v_cndmask_b32 v17, v17, v18, vcc
    v_lshl_add_u32 v18, v0, 3, 6
    v_cmp_gt_f32 vcc, v14, v16
    v_cmp_ne_u32 s[34:35], s30, v18
    s_nop 1
    s_and_b64 vcc, vcc, s[34:35]
    s_nop 1
    v_cndmask_b32 v16, v16, v14, vcc
    v_cndmask_b32 v17, v17, v18, vcc
    v_lshl_add_u32 v18, v0, 3, 7
    v_cmp_gt_f32 vcc, v15, v16
    v_cmp_ne_u32 s[34:35], s30, v18
    s_nop 1
    s_and_b64 vcc, vcc, s[34:35]
    s_nop 1
    v_cndmask_b32 v16, v16, v15, vcc
    v_cndmask_b32 v17, v17, v18, vcc
    s_barrier
    v_lshlrev_b32 v19, 3, v0
    ds_write_b64 v19, v[16:17]
    s_waitcnt lgkmcnt(0)
    s_barrier
    v_mov_b32 v20, 0xff800000
    v_mov_b32 v21, 0
    v_mov_b32 v22, 0
    s_mov_b32 s36, 0
gateup_kernel_scan2:
    ds_read_b128 v[24:27], v22
    ds_read_b128 v[28:31], v22 offset:16
    s_waitcnt lgkmcnt(0)
    v_cmp_gt_f32 vcc, v24, v20
    s_nop 1
    v_cndmask_b32 v20, v20, v24, vcc
    v_cndmask_b32 v21, v21, v25, vcc
    v_cmp_gt_f32 vcc, v26, v20
    s_nop 1
    v_cndmask_b32 v20, v20, v26, vcc
    v_cndmask_b32 v21, v21, v27, vcc
    v_cmp_gt_f32 vcc, v28, v20
    s_nop 1
    v_cndmask_b32 v20, v20, v28, vcc
    v_cndmask_b32 v21, v21, v29, vcc
    v_cmp_gt_f32 vcc, v30, v20
    s_nop 1
    v_cndmask_b32 v20, v20, v30, vcc
    v_cndmask_b32 v21, v21, v31, vcc
    v_add_u32 v22, 32, v22
    s_add_u32 s36, s36, 1
    s_cmp_lt_u32 s36, 64
    s_cbranch_scc1 gateup_kernel_scan2
    s_nop 1
    v_readfirstlane_b32 s30, v21
    v_readfirstlane_b32 s32, v20
    s_nop 4
    v_mov_b32 v16, 0xff800000
    v_mov_b32 v17, 0
    v_lshl_add_u32 v18, v0, 3, 0
    v_cmp_gt_f32 vcc, v8, v16
    v_cmp_ne_u32 s[34:35], s30, v18
    s_nop 1
    s_and_b64 vcc, vcc, s[34:35]
    s_nop 1
    v_cndmask_b32 v16, v16, v8, vcc
    v_cndmask_b32 v17, v17, v18, vcc
    v_lshl_add_u32 v18, v0, 3, 1
    v_cmp_gt_f32 vcc, v9, v16
    v_cmp_ne_u32 s[34:35], s30, v18
    s_nop 1
    s_and_b64 vcc, vcc, s[34:35]
    s_nop 1
    v_cndmask_b32 v16, v16, v9, vcc
    v_cndmask_b32 v17, v17, v18, vcc
    v_lshl_add_u32 v18, v0, 3, 2
    v_cmp_gt_f32 vcc, v10, v16
    v_cmp_ne_u32 s[34:35], s30, v18
    s_nop 1
    s_and_b64 vcc, vcc, s[34:35]
    s_nop 1
    v_cndmask_b32 v16, v16, v10, vcc
    v_cndmask_b32 v17, v17, v18, vcc
    v_lshl_add_u32 v18, v0, 3, 3
    v_cmp_gt_f32 vcc, v11, v16
    v_cmp_ne_u32 s[34:35], s30, v18
    s_nop 1
    s_and_b64 vcc, vcc, s[34:35]
    s_nop 1
    v_cndmask_b32 v16, v16, v11, vcc
    v_cndmask_b32 v17, v17, v18, vcc
    v_lshl_add_u32 v18, v0, 3, 4
    v_cmp_gt_f32 vcc, v12, v16
    v_cmp_ne_u32 s[34:35], s30, v18
    s_nop 1
    s_and_b64 vcc, vcc, s[34:35]
    s_nop 1
    v_cndmask_b32 v16, v16, v12, vcc
    v_cndmask_b32 v17, v17, v18, vcc
    v_lshl_add_u32 v18, v0, 3, 5
    v_cmp_gt_f32 vcc, v13, v16
    v_cmp_ne_u32 s[34:35], s30, v18
    s_nop 1
    s_and_b64 vcc, vcc, s[34:35]
    s_nop 1
    v_cndmask_b32 v16, v16, v13, vcc
    v_cndmask_b32 v17, v17, v18, vcc
    v_lshl_add_u32 v18, v0, 3, 6
    v_cmp_gt_f32 vcc, v14, v16
    v_cmp_ne_u32 s[34:35], s30, v18
    s_nop 1
    s_and_b64 vcc, vcc, s[34:35]
    s_nop 1
    v_cndmask_b32 v16, v16, v14, vcc
    v_cndmask_b32 v17, v17, v18, vcc
    v_lshl_add_u32 v18, v0, 3, 7
    v_cmp_gt_f32 vcc, v15, v16
    v_cmp_ne_u32 s[34:35], s30, v18
    s_nop 1
    s_and_b64 vcc, vcc, s[34:35]
    s_nop 1
    v_cndmask_b32 v16, v16, v15, vcc
    v_cndmask_b32 v17, v17, v18, vcc
    s_barrier
    v_lshlrev_b32 v19, 3, v0
    ds_write_b64 v19, v[16:17]
    s_waitcnt lgkmcnt(0)
    s_barrier
    v_mov_b32 v20, 0xff800000
    v_mov_b32 v21, 0
    v_mov_b32 v22, 0
    s_mov_b32 s36, 0
gateup_kernel_scan3:
    ds_read_b128 v[24:27], v22
    ds_read_b128 v[28:31], v22 offset:16
    s_waitcnt lgkmcnt(0)
    v_cmp_gt_f32 vcc, v24, v20
    s_nop 1
    v_cndmask_b32 v20, v20, v24, vcc
    v_cndmask_b32 v21, v21, v25, vcc
    v_cmp_gt_f32 vcc, v26, v20
    s_nop 1
    v_cndmask_b32 v20, v20, v26, vcc
    v_cndmask_b32 v21, v21, v27, vcc
    v_cmp_gt_f32 vcc, v28, v20
    s_nop 1
    v_cndmask_b32 v20, v20, v28, vcc
    v_cndmask_b32 v21, v21, v29, vcc
    v_cmp_gt_f32 vcc, v30, v20
    s_nop 1
    v_cndmask_b32 v20, v20, v30, vcc
    v_cndmask_b32 v21, v21, v31, vcc
    v_add_u32 v22, 32, v22
    s_add_u32 s36, s36, 1
    s_cmp_lt_u32 s36, 64
    s_cbranch_scc1 gateup_kernel_scan3
    s_nop 1
    v_readfirstlane_b32 s31, v21
    v_readfirstlane_b32 s33, v20
    s_nop 4
    v_lshlrev_b32 v1, 3, v0
    s_lshl_b32 s36, s30, 11
    s_lshl_b32 s37, s31, 11
    buffer_load_dwordx2 v[8:9], v1, s[12:15], s36 offen
    buffer_load_dwordx2 v[10:11], v1, s[12:15], s37 offen
    s_waitcnt vmcnt(0)
    v_lshlrev_b32 v12, 16, v8
    v_lshlrev_b32 v13, 16, v10
    v_and_b32 v14, 0xffff0000, v8
    v_and_b32 v15, 0xffff0000, v10
    v_lshlrev_b32 v16, 16, v9
    v_lshlrev_b32 v17, 16, v11
    v_and_b32 v18, 0xffff0000, v9
    v_and_b32 v19, 0xffff0000, v11
    v_lshlrev_b32 v1, 5, v0
    ds_write_b128 v1, v[12:15] offset:8192
    ds_write_b128 v1, v[16:19] offset:8208
    s_waitcnt lgkmcnt(0)
    s_barrier
    v_and_b32 v2, 31, v0
    v_lshrrev_b32 v3, 5, v0
    s_mov_b32 s36, 917504
    v_mul_lo_u32 v4, v3, s36
    v_lshl_add_u32 v4, v2, 2, v4
    s_lshl_b32 s36, s2, 7
    v_add_u32 v4, s36, v4
    v_lshlrev_b32 v5, 10, v3
    v_add_u32 v5, 8192, v5
    v_mov_b32 v32, 0
    v_mov_b32 v33, 0
    v_mov_b32 v34, 0
    v_mov_b32 v35, 0
    v_mov_b32 v36, 0
    v_mov_b32 v37, 0
    v_mov_b32 v38, 0
    v_mov_b32 v39, 0
    s_mov_b32 s40, 0
    s_mov_b32 s41, 0
gateup_kernel_lp4:
    buffer_load_dword v40, v4, s[4:7], s40 offen
    buffer_load_dword v41, v4, s[8:11], s40 offen
    s_add_u32 s40, s40, 7168
    ds_read_b64 v[60:61], v5 offset:0
    buffer_load_dword v42, v4, s[4:7], s40 offen
    buffer_load_dword v43, v4, s[8:11], s40 offen
    s_add_u32 s40, s40, 7168
    ds_read_b64 v[62:63], v5 offset:8
    buffer_load_dword v44, v4, s[4:7], s40 offen
    buffer_load_dword v45, v4, s[8:11], s40 offen
    s_add_u32 s40, s40, 7168
    ds_read_b64 v[64:65], v5 offset:16
    buffer_load_dword v46, v4, s[4:7], s40 offen
    buffer_load_dword v47, v4, s[8:11], s40 offen
    s_add_u32 s40, s40, 7168
    ds_read_b64 v[66:67], v5 offset:24
    buffer_load_dword v48, v4, s[4:7], s40 offen
    buffer_load_dword v49, v4, s[8:11], s40 offen
    s_add_u32 s40, s40, 7168
    ds_read_b64 v[68:69], v5 offset:32
    buffer_load_dword v50, v4, s[4:7], s40 offen
    buffer_load_dword v51, v4, s[8:11], s40 offen
    s_add_u32 s40, s40, 7168
    ds_read_b64 v[70:71], v5 offset:40
    buffer_load_dword v52, v4, s[4:7], s40 offen
    buffer_load_dword v53, v4, s[8:11], s40 offen
    s_add_u32 s40, s40, 7168
    ds_read_b64 v[72:73], v5 offset:48
    buffer_load_dword v54, v4, s[4:7], s40 offen
    buffer_load_dword v55, v4, s[8:11], s40 offen
    s_add_u32 s40, s40, 7168
    ds_read_b64 v[74:75], v5 offset:56
    v_add_u32 v5, 64, v5
    s_waitcnt vmcnt(0) lgkmcnt(0)
    v_lshlrev_b32 v6, 16, v40
    v_and_b32 v7, 0xffff0000, v40
    v_fmac_f32 v32, v6, v60
    v_fmac_f32 v33, v7, v60
    v_fmac_f32 v34, v6, v61
    v_fmac_f32 v35, v7, v61
    v_lshlrev_b32 v6, 16, v41
    v_and_b32 v7, 0xffff0000, v41
    v_fmac_f32 v36, v6, v60
    v_fmac_f32 v37, v7, v60
    v_fmac_f32 v38, v6, v61
    v_fmac_f32 v39, v7, v61
    v_lshlrev_b32 v6, 16, v42
    v_and_b32 v7, 0xffff0000, v42
    v_fmac_f32 v32, v6, v62
    v_fmac_f32 v33, v7, v62
    v_fmac_f32 v34, v6, v63
    v_fmac_f32 v35, v7, v63
    v_lshlrev_b32 v6, 16, v43
    v_and_b32 v7, 0xffff0000, v43
    v_fmac_f32 v36, v6, v62
    v_fmac_f32 v37, v7, v62
    v_fmac_f32 v38, v6, v63
    v_fmac_f32 v39, v7, v63
    v_lshlrev_b32 v6, 16, v44
    v_and_b32 v7, 0xffff0000, v44
    v_fmac_f32 v32, v6, v64
    v_fmac_f32 v33, v7, v64
    v_fmac_f32 v34, v6, v65
    v_fmac_f32 v35, v7, v65
    v_lshlrev_b32 v6, 16, v45
    v_and_b32 v7, 0xffff0000, v45
    v_fmac_f32 v36, v6, v64
    v_fmac_f32 v37, v7, v64
    v_fmac_f32 v38, v6, v65
    v_fmac_f32 v39, v7, v65
    v_lshlrev_b32 v6, 16, v46
    v_and_b32 v7, 0xffff0000, v46
    v_fmac_f32 v32, v6, v66
    v_fmac_f32 v33, v7, v66
    v_fmac_f32 v34, v6, v67
    v_fmac_f32 v35, v7, v67
    v_lshlrev_b32 v6, 16, v47
    v_and_b32 v7, 0xffff0000, v47
    v_fmac_f32 v36, v6, v66
    v_fmac_f32 v37, v7, v66
    v_fmac_f32 v38, v6, v67
    v_fmac_f32 v39, v7, v67
    v_lshlrev_b32 v6, 16, v48
    v_and_b32 v7, 0xffff0000, v48
    v_fmac_f32 v32, v6, v68
    v_fmac_f32 v33, v7, v68
    v_fmac_f32 v34, v6, v69
    v_fmac_f32 v35, v7, v69
    v_lshlrev_b32 v6, 16, v49
    v_and_b32 v7, 0xffff0000, v49
    v_fmac_f32 v36, v6, v68
    v_fmac_f32 v37, v7, v68
    v_fmac_f32 v38, v6, v69
    v_fmac_f32 v39, v7, v69
    v_lshlrev_b32 v6, 16, v50
    v_and_b32 v7, 0xffff0000, v50
    v_fmac_f32 v32, v6, v70
    v_fmac_f32 v33, v7, v70
    v_fmac_f32 v34, v6, v71
    v_fmac_f32 v35, v7, v71
    v_lshlrev_b32 v6, 16, v51
    v_and_b32 v7, 0xffff0000, v51
    v_fmac_f32 v36, v6, v70
    v_fmac_f32 v37, v7, v70
    v_fmac_f32 v38, v6, v71
    v_fmac_f32 v39, v7, v71
    v_lshlrev_b32 v6, 16, v52
    v_and_b32 v7, 0xffff0000, v52
    v_fmac_f32 v32, v6, v72
    v_fmac_f32 v33, v7, v72
    v_fmac_f32 v34, v6, v73
    v_fmac_f32 v35, v7, v73
    v_lshlrev_b32 v6, 16, v53
    v_and_b32 v7, 0xffff0000, v53
    v_fmac_f32 v36, v6, v72
    v_fmac_f32 v37, v7, v72
    v_fmac_f32 v38, v6, v73
    v_fmac_f32 v39, v7, v73
    v_lshlrev_b32 v6, 16, v54
    v_and_b32 v7, 0xffff0000, v54
    v_fmac_f32 v32, v6, v74
    v_fmac_f32 v33, v7, v74
    v_fmac_f32 v34, v6, v75
    v_fmac_f32 v35, v7, v75
    v_lshlrev_b32 v6, 16, v55
    v_and_b32 v7, 0xffff0000, v55
    v_fmac_f32 v36, v6, v74
    v_fmac_f32 v37, v7, v74
    v_fmac_f32 v38, v6, v75
    v_fmac_f32 v39, v7, v75
    s_add_u32 s41, s41, 8
    s_cmp_lt_u32 s41, 128
    s_cbranch_scc1 gateup_kernel_lp4
    s_barrier
    v_lshlrev_b32 v6, 2, v0
    ds_write_b32 v6, v32 offset:16384
    ds_write_b32 v6, v33 offset:17408
    ds_write_b32 v6, v34 offset:18432
    ds_write_b32 v6, v35 offset:19456
    ds_write_b32 v6, v36 offset:20480
    ds_write_b32 v6, v37 offset:21504
    ds_write_b32 v6, v38 offset:22528
    ds_write_b32 v6, v39 offset:23552
    s_waitcnt lgkmcnt(0)
    s_barrier
    v_lshlrev_b32 v6, 2, v2
    ds_read_b32 v40, v6 offset:16384
    ds_read_b32 v41, v6 offset:16512
    ds_read_b32 v42, v6 offset:16640
    ds_read_b32 v43, v6 offset:16768
    ds_read_b32 v44, v6 offset:16896
    ds_read_b32 v45, v6 offset:17024
    ds_read_b32 v46, v6 offset:17152
    ds_read_b32 v47, v6 offset:17280
    s_waitcnt lgkmcnt(0)
    v_add_f32 v32, v40, v41
    v_add_f32 v32, v32, v42
    v_add_f32 v32, v32, v43
    v_add_f32 v32, v32, v44
    v_add_f32 v32, v32, v45
    v_add_f32 v32, v32, v46
    v_add_f32 v32, v32, v47
    ds_read_b32 v40, v6 offset:17408
    ds_read_b32 v41, v6 offset:17536
    ds_read_b32 v42, v6 offset:17664
    ds_read_b32 v43, v6 offset:17792
    ds_read_b32 v44, v6 offset:17920
    ds_read_b32 v45, v6 offset:18048
    ds_read_b32 v46, v6 offset:18176
    ds_read_b32 v47, v6 offset:18304
    s_waitcnt lgkmcnt(0)
    v_add_f32 v33, v40, v41
    v_add_f32 v33, v33, v42
    v_add_f32 v33, v33, v43
    v_add_f32 v33, v33, v44
    v_add_f32 v33, v33, v45
    v_add_f32 v33, v33, v46
    v_add_f32 v33, v33, v47
    ds_read_b32 v40, v6 offset:18432
    ds_read_b32 v41, v6 offset:18560
    ds_read_b32 v42, v6 offset:18688
    ds_read_b32 v43, v6 offset:18816
    ds_read_b32 v44, v6 offset:18944
    ds_read_b32 v45, v6 offset:19072
    ds_read_b32 v46, v6 offset:19200
    ds_read_b32 v47, v6 offset:19328
    s_waitcnt lgkmcnt(0)
    v_add_f32 v34, v40, v41
    v_add_f32 v34, v34, v42
    v_add_f32 v34, v34, v43
    v_add_f32 v34, v34, v44
    v_add_f32 v34, v34, v45
    v_add_f32 v34, v34, v46
    v_add_f32 v34, v34, v47
    ds_read_b32 v40, v6 offset:19456
    ds_read_b32 v41, v6 offset:19584
    ds_read_b32 v42, v6 offset:19712
    ds_read_b32 v43, v6 offset:19840
    ds_read_b32 v44, v6 offset:19968
    ds_read_b32 v45, v6 offset:20096
    ds_read_b32 v46, v6 offset:20224
    ds_read_b32 v47, v6 offset:20352
    s_waitcnt lgkmcnt(0)
    v_add_f32 v35, v40, v41
    v_add_f32 v35, v35, v42
    v_add_f32 v35, v35, v43
    v_add_f32 v35, v35, v44
    v_add_f32 v35, v35, v45
    v_add_f32 v35, v35, v46
    v_add_f32 v35, v35, v47
    ds_read_b32 v40, v6 offset:20480
    ds_read_b32 v41, v6 offset:20608
    ds_read_b32 v42, v6 offset:20736
    ds_read_b32 v43, v6 offset:20864
    ds_read_b32 v44, v6 offset:20992
    ds_read_b32 v45, v6 offset:21120
    ds_read_b32 v46, v6 offset:21248
    ds_read_b32 v47, v6 offset:21376
    s_waitcnt lgkmcnt(0)
    v_add_f32 v36, v40, v41
    v_add_f32 v36, v36, v42
    v_add_f32 v36, v36, v43
    v_add_f32 v36, v36, v44
    v_add_f32 v36, v36, v45
    v_add_f32 v36, v36, v46
    v_add_f32 v36, v36, v47
    ds_read_b32 v40, v6 offset:21504
    ds_read_b32 v41, v6 offset:21632
    ds_read_b32 v42, v6 offset:21760
    ds_read_b32 v43, v6 offset:21888
    ds_read_b32 v44, v6 offset:22016
    ds_read_b32 v45, v6 offset:22144
    ds_read_b32 v46, v6 offset:22272
    ds_read_b32 v47, v6 offset:22400
    s_waitcnt lgkmcnt(0)
    v_add_f32 v37, v40, v41
    v_add_f32 v37, v37, v42
    v_add_f32 v37, v37, v43
    v_add_f32 v37, v37, v44
    v_add_f32 v37, v37, v45
    v_add_f32 v37, v37, v46
    v_add_f32 v37, v37, v47
    ds_read_b32 v40, v6 offset:22528
    ds_read_b32 v41, v6 offset:22656
    ds_read_b32 v42, v6 offset:22784
    ds_read_b32 v43, v6 offset:22912
    ds_read_b32 v44, v6 offset:23040
    ds_read_b32 v45, v6 offset:23168
    ds_read_b32 v46, v6 offset:23296
    ds_read_b32 v47, v6 offset:23424
    s_waitcnt lgkmcnt(0)
    v_add_f32 v38, v40, v41
    v_add_f32 v38, v38, v42
    v_add_f32 v38, v38, v43
    v_add_f32 v38, v38, v44
    v_add_f32 v38, v38, v45
    v_add_f32 v38, v38, v46
    v_add_f32 v38, v38, v47
    ds_read_b32 v40, v6 offset:23552
    ds_read_b32 v41, v6 offset:23680
    ds_read_b32 v42, v6 offset:23808
    ds_read_b32 v43, v6 offset:23936
    ds_read_b32 v44, v6 offset:24064
    ds_read_b32 v45, v6 offset:24192
    ds_read_b32 v46, v6 offset:24320
    ds_read_b32 v47, v6 offset:24448
    s_waitcnt lgkmcnt(0)
    v_add_f32 v39, v40, v41
    v_add_f32 v39, v39, v42
    v_add_f32 v39, v39, v43
    v_add_f32 v39, v39, v44
    v_add_f32 v39, v39, v45
    v_add_f32 v39, v39, v46
    v_add_f32 v39, v39, v47
    v_cvt_pk_bf16_f32 v32, v32, v32
    v_and_b32 v32, 0xffff0000, v32
    v_cvt_pk_bf16_f32 v36, v36, v36
    v_and_b32 v36, 0xffff0000, v36
    v_mul_f32 v6, 0xbfb8aa3b, v32
    v_exp_f32 v6, v6
    s_nop 0
    v_add_f32 v6, 1.0, v6
    v_rcp_f32 v6, v6
    s_nop 0
    v_mul_f32 v32, v32, v6
    v_cvt_pk_bf16_f32 v32, v32, v32
    v_and_b32 v32, 0xffff0000, v32
    v_mul_f32 v32, v32, v36
    v_cvt_pk_bf16_f32 v32, v32, v32
    v_and_b32 v32, 0xffff0000, v32
    v_cvt_pk_bf16_f32 v33, v33, v33
    v_and_b32 v33, 0xffff0000, v33
    v_cvt_pk_bf16_f32 v37, v37, v37
    v_and_b32 v37, 0xffff0000, v37
    v_mul_f32 v6, 0xbfb8aa3b, v33
    v_exp_f32 v6, v6
    s_nop 0
    v_add_f32 v6, 1.0, v6
    v_rcp_f32 v6, v6
    s_nop 0
    v_mul_f32 v33, v33, v6
    v_cvt_pk_bf16_f32 v33, v33, v33
    v_and_b32 v33, 0xffff0000, v33
    v_mul_f32 v33, v33, v37
    v_cvt_pk_bf16_f32 v33, v33, v33
    v_and_b32 v33, 0xffff0000, v33
    v_cvt_pk_bf16_f32 v34, v34, v34
    v_and_b32 v34, 0xffff0000, v34
    v_cvt_pk_bf16_f32 v38, v38, v38
    v_and_b32 v38, 0xffff0000, v38
    v_mul_f32 v6, 0xbfb8aa3b, v34
    v_exp_f32 v6, v6
    s_nop 0
    v_add_f32 v6, 1.0, v6
    v_rcp_f32 v6, v6
    s_nop 0
    v_mul_f32 v34, v34, v6
    v_cvt_pk_bf16_f32 v34, v34, v34
    v_and_b32 v34, 0xffff0000, v34
    v_mul_f32 v34, v34, v38
    v_cvt_pk_bf16_f32 v34, v34, v34
    v_and_b32 v34, 0xffff0000, v34
    v_cvt_pk_bf16_f32 v35, v35, v35
    v_and_b32 v35, 0xffff0000, v35
    v_cvt_pk_bf16_f32 v39, v39, v39
    v_and_b32 v39, 0xffff0000, v39
    v_mul_f32 v6, 0xbfb8aa3b, v35
    v_exp_f32 v6, v6
    s_nop 0
    v_add_f32 v6, 1.0, v6
    v_rcp_f32 v6, v6
    s_nop 0
    v_mul_f32 v35, v35, v6
    v_cvt_pk_bf16_f32 v35, v35, v35
    v_and_b32 v35, 0xffff0000, v35
    v_mul_f32 v35, v35, v39
    v_cvt_pk_bf16_f32 v35, v35, v35
    v_and_b32 v35, 0xffff0000, v35
    v_mov_b32 v36, v32
    v_mov_b32 v37, v34
    v_mov_b32 v38, v33
    v_mov_b32 v39, v35
    s_lshl_b32 s36, s2, 9
    s_add_u32 s36, s36, 16842752
    v_lshlrev_b32 v6, 4, v2
    v_cmp_gt_u32 vcc, 32, v0
    s_and_saveexec_b64 s[34:35], vcc
    s_cbranch_execz gateup_kernel_end1
    buffer_store_dwordx4 v[36:39], v6, s[12:15], s36 offen
    v_mov_b32 v8, s30
    v_mov_b32 v9, s31
    v_mov_b32 v10, s32
    v_mov_b32 v11, s33
    v_mov_b32 v6, 16973824
    buffer_store_dwordx4 v[8:11], v6, s[12:15], 0 offen
gateup_kernel_end1:
    s_endpgm
.globl down_kernel
.p2align 8
.type down_kernel,@function
down_kernel:
    s_cmp_ge_u32 s2, 16
    s_cbranch_scc1 down_kernel_end1
    s_load_dwordx2 s[4:5], s[0:1], 72
    s_load_dwordx2 s[8:9], s[0:1], 96
    s_waitcnt lgkmcnt(0)
    s_mov_b32 s6, 7340032
    s_mov_b32 s7, 0x00020000
    s_mov_b32 s10, 268435456
    s_mov_b32 s11, 0x00020000
    v_lshlrev_b32 v1, 4, v0
    v_add_u32 v2, 16842752, v1
    buffer_load_dwordx4 v[8:11], v2, s[8:11], 0 offen
    v_add_u32 v2, 4096, v2
    buffer_load_dwordx4 v[12:15], v2, s[8:11], 0 offen
    v_add_u32 v2, 4096, v2
    buffer_load_dwordx4 v[16:19], v2, s[8:11], 0 offen
    v_add_u32 v2, 4096, v2
    buffer_load_dwordx4 v[20:23], v2, s[8:11], 0 offen
    v_add_u32 v2, 4096, v2
    buffer_load_dwordx4 v[24:27], v2, s[8:11], 0 offen
    v_add_u32 v2, 4096, v2
    buffer_load_dwordx4 v[28:31], v2, s[8:11], 0 offen
    v_add_u32 v2, 4096, v2
    buffer_load_dwordx4 v[32:35], v2, s[8:11], 0 offen
    v_add_u32 v2, 4096, v2
    v_mov_b32 v6, 16973824
    buffer_load_dwordx4 v[80:83], v6, s[8:11], 0 offen
    s_waitcnt vmcnt(0)
    ds_write_b128 v1, v[8:11] offset:0
    ds_write_b128 v1, v[12:15] offset:4096
    ds_write_b128 v1, v[16:19] offset:8192
    ds_write_b128 v1, v[20:23] offset:12288
    ds_write_b128 v1, v[24:27] offset:16384
    ds_write_b128 v1, v[28:31] offset:20480
    ds_write_b128 v1, v[32:35] offset:24576
    s_waitcnt lgkmcnt(0)
    s_barrier
    v_and_b32 v2, 31, v0
    v_lshrrev_b32 v3, 5, v0
    s_mov_b32 s36, 917504
    v_mul_lo_u32 v4, v3, s36
    v_lshl_add_u32 v4, v2, 2, v4
    s_lshl_b32 s36, s2, 7
    v_add_u32 v4, s36, v4
    s_mov_b32 s36, 3584
    v_mul_lo_u32 v5, v3, s36
    v_mov_b32 v32, 0
    v_mov_b32 v33, 0
    v_mov_b32 v34, 0
    v_mov_b32 v35, 0
    s_mov_b32 s40, 0
    s_mov_b32 s41, 0
down_kernel_lp2:
    buffer_load_dword v40, v4, s[4:7], s40 offen
    s_add_u32 s40, s40, 2048
    ds_read_b64 v[60:61], v5 offset:0
    buffer_load_dword v41, v4, s[4:7], s40 offen
    s_add_u32 s40, s40, 2048
    ds_read_b64 v[62:63], v5 offset:8
    buffer_load_dword v42, v4, s[4:7], s40 offen
    s_add_u32 s40, s40, 2048
    ds_read_b64 v[64:65], v5 offset:16
    buffer_load_dword v43, v4, s[4:7], s40 offen
    s_add_u32 s40, s40, 2048
    ds_read_b64 v[66:67], v5 offset:24
    buffer_load_dword v44, v4, s[4:7], s40 offen
    s_add_u32 s40, s40, 2048
    ds_read_b64 v[68:69], v5 offset:32
    buffer_load_dword v45, v4, s[4:7], s40 offen
    s_add_u32 s40, s40, 2048
    ds_read_b64 v[70:71], v5 offset:40
    buffer_load_dword v46, v4, s[4:7], s40 offen
    s_add_u32 s40, s40, 2048
    ds_read_b64 v[72:73], v5 offset:48
    buffer_load_dword v47, v4, s[4:7], s40 offen
    s_add_u32 s40, s40, 2048
    ds_read_b64 v[74:75], v5 offset:56
    v_add_u32 v5, 64, v5
    s_waitcnt vmcnt(0) lgkmcnt(0)
    v_lshlrev_b32 v6, 16, v40
    v_and_b32 v7, 0xffff0000, v40
    v_fmac_f32 v32, v6, v60
    v_fmac_f32 v33, v7, v60
    v_fmac_f32 v34, v6, v61
    v_fmac_f32 v35, v7, v61
    v_lshlrev_b32 v6, 16, v41
    v_and_b32 v7, 0xffff0000, v41
    v_fmac_f32 v32, v6, v62
    v_fmac_f32 v33, v7, v62
    v_fmac_f32 v34, v6, v63
    v_fmac_f32 v35, v7, v63
    v_lshlrev_b32 v6, 16, v42
    v_and_b32 v7, 0xffff0000, v42
    v_fmac_f32 v32, v6, v64
    v_fmac_f32 v33, v7, v64
    v_fmac_f32 v34, v6, v65
    v_fmac_f32 v35, v7, v65
    v_lshlrev_b32 v6, 16, v43
    v_and_b32 v7, 0xffff0000, v43
    v_fmac_f32 v32, v6, v66
    v_fmac_f32 v33, v7, v66
    v_fmac_f32 v34, v6, v67
    v_fmac_f32 v35, v7, v67
    v_lshlrev_b32 v6, 16, v44
    v_and_b32 v7, 0xffff0000, v44
    v_fmac_f32 v32, v6, v68
    v_fmac_f32 v33, v7, v68
    v_fmac_f32 v34, v6, v69
    v_fmac_f32 v35, v7, v69
    v_lshlrev_b32 v6, 16, v45
    v_and_b32 v7, 0xffff0000, v45
    v_fmac_f32 v32, v6, v70
    v_fmac_f32 v33, v7, v70
    v_fmac_f32 v34, v6, v71
    v_fmac_f32 v35, v7, v71
    v_lshlrev_b32 v6, 16, v46
    v_and_b32 v7, 0xffff0000, v46
    v_fmac_f32 v32, v6, v72
    v_fmac_f32 v33, v7, v72
    v_fmac_f32 v34, v6, v73
    v_fmac_f32 v35, v7, v73
    v_lshlrev_b32 v6, 16, v47
    v_and_b32 v7, 0xffff0000, v47
    v_fmac_f32 v32, v6, v74
    v_fmac_f32 v33, v7, v74
    v_fmac_f32 v34, v6, v75
    v_fmac_f32 v35, v7, v75
    s_add_u32 s41, s41, 8
    s_cmp_lt_u32 s41, 448
    s_cbranch_scc1 down_kernel_lp2
    s_barrier
    v_lshlrev_b32 v6, 2, v0
    ds_write_b32 v6, v32 offset:32768
    ds_write_b32 v6, v33 offset:33792
    ds_write_b32 v6, v34 offset:34816
    ds_write_b32 v6, v35 offset:35840
    s_waitcnt lgkmcnt(0)
    s_barrier
    v_lshlrev_b32 v6, 2, v2
    ds_read_b32 v40, v6 offset:32768
    ds_read_b32 v41, v6 offset:32896
    ds_read_b32 v42, v6 offset:33024
    ds_read_b32 v43, v6 offset:33152
    ds_read_b32 v44, v6 offset:33280
    ds_read_b32 v45, v6 offset:33408
    ds_read_b32 v46, v6 offset:33536
    ds_read_b32 v47, v6 offset:33664
    s_waitcnt lgkmcnt(0)
    v_add_f32 v32, v40, v41
    v_add_f32 v32, v32, v42
    v_add_f32 v32, v32, v43
    v_add_f32 v32, v32, v44
    v_add_f32 v32, v32, v45
    v_add_f32 v32, v32, v46
    v_add_f32 v32, v32, v47
    ds_read_b32 v40, v6 offset:33792
    ds_read_b32 v41, v6 offset:33920
    ds_read_b32 v42, v6 offset:34048
    ds_read_b32 v43, v6 offset:34176
    ds_read_b32 v44, v6 offset:34304
    ds_read_b32 v45, v6 offset:34432
    ds_read_b32 v46, v6 offset:34560
    ds_read_b32 v47, v6 offset:34688
    s_waitcnt lgkmcnt(0)
    v_add_f32 v33, v40, v41
    v_add_f32 v33, v33, v42
    v_add_f32 v33, v33, v43
    v_add_f32 v33, v33, v44
    v_add_f32 v33, v33, v45
    v_add_f32 v33, v33, v46
    v_add_f32 v33, v33, v47
    ds_read_b32 v40, v6 offset:34816
    ds_read_b32 v41, v6 offset:34944
    ds_read_b32 v42, v6 offset:35072
    ds_read_b32 v43, v6 offset:35200
    ds_read_b32 v44, v6 offset:35328
    ds_read_b32 v45, v6 offset:35456
    ds_read_b32 v46, v6 offset:35584
    ds_read_b32 v47, v6 offset:35712
    s_waitcnt lgkmcnt(0)
    v_add_f32 v34, v40, v41
    v_add_f32 v34, v34, v42
    v_add_f32 v34, v34, v43
    v_add_f32 v34, v34, v44
    v_add_f32 v34, v34, v45
    v_add_f32 v34, v34, v46
    v_add_f32 v34, v34, v47
    ds_read_b32 v40, v6 offset:35840
    ds_read_b32 v41, v6 offset:35968
    ds_read_b32 v42, v6 offset:36096
    ds_read_b32 v43, v6 offset:36224
    ds_read_b32 v44, v6 offset:36352
    ds_read_b32 v45, v6 offset:36480
    ds_read_b32 v46, v6 offset:36608
    ds_read_b32 v47, v6 offset:36736
    s_waitcnt lgkmcnt(0)
    v_add_f32 v35, v40, v41
    v_add_f32 v35, v35, v42
    v_add_f32 v35, v35, v43
    v_add_f32 v35, v35, v44
    v_add_f32 v35, v35, v45
    v_add_f32 v35, v35, v46
    v_add_f32 v35, v35, v47
    v_cvt_pk_bf16_f32 v82, v82, v82
    v_and_b32 v82, 0xffff0000, v82
    v_mul_f32 v6, 0xbfb8aa3b, v82
    v_exp_f32 v6, v6
    s_nop 0
    v_add_f32 v6, 1.0, v6
    v_rcp_f32 v6, v6
    s_nop 0
    v_cvt_pk_bf16_f32 v6, v6, v6
    v_and_b32 v6, 0xffff0000, v6
    v_cvt_pk_bf16_f32 v32, v32, v32
    v_and_b32 v32, 0xffff0000, v32
    v_mul_f32 v32, v32, v6
    v_cvt_pk_bf16_f32 v32, v32, v32
    v_and_b32 v32, 0xffff0000, v32
    v_cvt_pk_bf16_f32 v33, v33, v33
    v_and_b32 v33, 0xffff0000, v33
    v_mul_f32 v33, v33, v6
    v_cvt_pk_bf16_f32 v33, v33, v33
    v_and_b32 v33, 0xffff0000, v33
    v_cvt_pk_bf16_f32 v83, v83, v83
    v_and_b32 v83, 0xffff0000, v83
    v_mul_f32 v6, 0xbfb8aa3b, v83
    v_exp_f32 v6, v6
    s_nop 0
    v_add_f32 v6, 1.0, v6
    v_rcp_f32 v6, v6
    s_nop 0
    v_cvt_pk_bf16_f32 v6, v6, v6
    v_and_b32 v6, 0xffff0000, v6
    v_cvt_pk_bf16_f32 v34, v34, v34
    v_and_b32 v34, 0xffff0000, v34
    v_mul_f32 v34, v34, v6
    v_cvt_pk_bf16_f32 v34, v34, v34
    v_and_b32 v34, 0xffff0000, v34
    v_cvt_pk_bf16_f32 v35, v35, v35
    v_and_b32 v35, 0xffff0000, v35
    v_mul_f32 v35, v35, v6
    v_cvt_pk_bf16_f32 v35, v35, v35
    v_and_b32 v35, 0xffff0000, v35
    s_lshl_b32 s36, s2, 8
    s_add_u32 s36, s36, 16908288
    v_lshlrev_b32 v6, 3, v2
    v_add_u32 v7, 4096, v6
    v_cmp_gt_u32 vcc, 32, v0
    s_and_saveexec_b64 s[34:35], vcc
    s_cbranch_execz down_kernel_end1
    buffer_store_dwordx2 v[32:33], v6, s[8:11], s36 offen
    buffer_store_dwordx2 v[34:35], v7, s[8:11], s36 offen
down_kernel_end1:
    s_endpgm
.globl gemm2_kernel
.p2align 8
.type gemm2_kernel,@function
gemm2_kernel:
    s_cmp_ge_u32 s2, 128
    s_cbranch_scc1 gemm2_kernel_end1
    s_load_dwordx2 s[4:5], s[0:1], 8
    s_load_dwordx2 s[8:9], s[0:1], 16
    s_load_dwordx2 s[12:13], s[0:1], 96
    s_load_dwordx2 s[16:17], s[0:1], 0
    s_load_dwordx2 s[20:21], s[0:1], 80
    s_waitcnt lgkmcnt(0)
    s_mov_b32 s6, 8388608
    s_mov_b32 s7, 0x00020000
    s_mov_b32 s10, 8388608
    s_mov_b32 s11, 0x00020000
    s_mov_b32 s14, 268435456
    s_mov_b32 s15, 0x00020000
    s_mov_b32 s18, 4194304
    s_mov_b32 s19, 0x00020000
    s_mov_b32 s22, 4194304
    s_mov_b32 s23, 0x00020000
    v_lshrrev_b32 v1, 6, v0
    s_nop 0
    v_readfirstlane_b32 s3, v1
    s_lshl_b32 s30, s2, 2
    s_add_u32 s30, s30, s3
    s_lshr_b32 s31, s30, 4
    s_and_b32 s32, s30, 15
    v_and_b32 v2, 31, v0
    v_bfe_u32 v3, v0, 5, 1
    s_lshl_b32 s33, s32, 6
    v_add_u32 v4, s33, v2
    v_lshlrev_b32 v4, 12, v4
    v_lshl_add_u32 v4, v3, 4, v4
    v_add_u32 v4, 8388608, v4
    s_lshl_b32 s34, s31, 6
    v_add_u32 v5, s34, v2
    v_lshlrev_b32 v5, 12, v5
    v_lshl_add_u32 v5, v3, 4, v5
    v_mov_b32 v64, 0
    v_mov_b32 v65, 0
    v_mov_b32 v66, 0
    v_mov_b32 v67, 0
    v_mov_b32 v68, 0
    v_mov_b32 v69, 0
    v_mov_b32 v70, 0
    v_mov_b32 v71, 0
    v_mov_b32 v72, 0
    v_mov_b32 v73, 0
    v_mov_b32 v74, 0
    v_mov_b32 v75, 0
    v_mov_b32 v76, 0
    v_mov_b32 v77, 0
    v_mov_b32 v78, 0
    v_mov_b32 v79, 0
    v_mov_b32 v80, 0
    v_mov_b32 v81, 0
    v_mov_b32 v82, 0
    v_mov_b32 v83, 0
    v_mov_b32 v84, 0
    v_mov_b32 v85, 0
    v_mov_b32 v86, 0
    v_mov_b32 v87, 0
    v_mov_b32 v88, 0
    v_mov_b32 v89, 0
    v_mov_b32 v90, 0
    v_mov_b32 v91, 0
    v_mov_b32 v92, 0
    v_mov_b32 v93, 0
    v_mov_b32 v94, 0
    v_mov_b32 v95, 0
    v_mov_b32 v96, 0
    v_mov_b32 v97, 0
    v_mov_b32 v98, 0
    v_mov_b32 v99, 0
    v_mov_b32 v100, 0
    v_mov_b32 v101, 0
    v_mov_b32 v102, 0
    v_mov_b32 v103, 0
    v_mov_b32 v104, 0
    v_mov_b32 v105, 0
    v_mov_b32 v106, 0
    v_mov_b32 v107, 0
    v_mov_b32 v108, 0
    v_mov_b32 v109, 0
    v_mov_b32 v110, 0
    v_mov_b32 v111, 0
    v_mov_b32 v112, 0
    v_mov_b32 v113, 0
    v_mov_b32 v114, 0
    v_mov_b32 v115, 0
    v_mov_b32 v116, 0
    v_mov_b32 v117, 0
    v_mov_b32 v118, 0
    v_mov_b32 v119, 0
    v_mov_b32 v120, 0
    v_mov_b32 v121, 0
    v_mov_b32 v122, 0
    v_mov_b32 v123, 0
    v_mov_b32 v124, 0
    v_mov_b32 v125, 0
    v_mov_b32 v126, 0
    v_mov_b32 v127, 0
    v_mov_b32 v128, 0
    v_mov_b32 v129, 0
    v_mov_b32 v130, 0
    v_mov_b32 v131, 0
    v_mov_b32 v132, 0
    v_mov_b32 v133, 0
    v_mov_b32 v134, 0
    v_mov_b32 v135, 0
    v_mov_b32 v136, 0
    v_mov_b32 v137, 0
    v_mov_b32 v138, 0
    v_mov_b32 v139, 0
    v_mov_b32 v140, 0
    v_mov_b32 v141, 0
    v_mov_b32 v142, 0
    v_mov_b32 v143, 0
    v_mov_b32 v144, 0
    v_mov_b32 v145, 0
    v_mov_b32 v146, 0
    v_mov_b32 v147, 0
    v_mov_b32 v148, 0
    v_mov_b32 v149, 0
    v_mov_b32 v150, 0
    v_mov_b32 v151, 0
    v_mov_b32 v152, 0
    v_mov_b32 v153, 0
    v_mov_b32 v154, 0
    v_mov_b32 v155, 0
    v_mov_b32 v156, 0
    v_mov_b32 v157, 0
    v_mov_b32 v158, 0
    v_mov_b32 v159, 0
    v_mov_b32 v160, 0
    v_mov_b32 v161, 0
    v_mov_b32 v162, 0
    v_mov_b32 v163, 0
    v_mov_b32 v164, 0
    v_mov_b32 v165, 0
    v_mov_b32 v166, 0
    v_mov_b32 v167, 0
    v_mov_b32 v168, 0
    v_mov_b32 v169, 0
    v_mov_b32 v170, 0
    v_mov_b32 v171, 0
    v_mov_b32 v172, 0
    v_mov_b32 v173, 0
    v_mov_b32 v174, 0
    v_mov_b32 v175, 0
    v_mov_b32 v176, 0
    v_mov_b32 v177, 0
    v_mov_b32 v178, 0
    v_mov_b32 v179, 0
    v_mov_b32 v180, 0
    v_mov_b32 v181, 0
    v_mov_b32 v182, 0
    v_mov_b32 v183, 0
    v_mov_b32 v184, 0
    v_mov_b32 v185, 0
    v_mov_b32 v186, 0
    v_mov_b32 v187, 0
    v_mov_b32 v188, 0
    v_mov_b32 v189, 0
    v_mov_b32 v190, 0
    v_mov_b32 v191, 0
    s_mov_b32 s40, 0
    s_mov_b32 s41, 131072
    s_mov_b32 s42, 131072
gemm2_kernel_loop2:
    buffer_load_dwordx4 v[8:11], v4, s[12:15], s40 offen
    buffer_load_dwordx4 v[12:15], v4, s[12:15], s41 offen
    buffer_load_dwordx4 v[16:19], v5, s[4:7], s40 offen
    buffer_load_dwordx4 v[20:23], v5, s[4:7], s42 offen
    buffer_load_dwordx4 v[24:27], v4, s[12:15], s40 offen offset:32
    buffer_load_dwordx4 v[28:31], v4, s[12:15], s41 offen offset:32
    buffer_load_dwordx4 v[32:35], v5, s[4:7], s40 offen offset:32
    buffer_load_dwordx4 v[36:39], v5, s[4:7], s42 offen offset:32
    s_add_u32 s40, s40, 64
    s_add_u32 s41, s41, 64
    s_add_u32 s42, s42, 64
    s_waitcnt vmcnt(4)
    v_mfma_f32_32x32x16_bf16 v[64:79], v[8:11], v[16:19], v[64:79]
    v_mfma_f32_32x32x16_bf16 v[80:95], v[8:11], v[20:23], v[80:95]
    v_mfma_f32_32x32x16_bf16 v[96:111], v[12:15], v[16:19], v[96:111]
    v_mfma_f32_32x32x16_bf16 v[112:127], v[12:15], v[20:23], v[112:127]
    s_waitcnt vmcnt(0)
    v_mfma_f32_32x32x16_bf16 v[64:79], v[24:27], v[32:35], v[64:79]
    v_mfma_f32_32x32x16_bf16 v[80:95], v[24:27], v[36:39], v[80:95]
    v_mfma_f32_32x32x16_bf16 v[96:111], v[28:31], v[32:35], v[96:111]
    v_mfma_f32_32x32x16_bf16 v[112:127], v[28:31], v[36:39], v[112:127]
    s_cmp_lt_u32 s40, 4096
    s_cbranch_scc1 gemm2_kernel_loop2
    v_add_u32 v4, 4194304, v4
    s_mov_b32 s40, 0
    s_mov_b32 s41, 131072
    s_mov_b32 s42, 131072
gemm2_kernel_loop3:
    buffer_load_dwordx4 v[8:11], v4, s[12:15], s40 offen
    buffer_load_dwordx4 v[12:15], v4, s[12:15], s41 offen
    buffer_load_dwordx4 v[16:19], v5, s[8:11], s40 offen
    buffer_load_dwordx4 v[20:23], v5, s[8:11], s42 offen
    buffer_load_dwordx4 v[24:27], v4, s[12:15], s40 offen offset:32
    buffer_load_dwordx4 v[28:31], v4, s[12:15], s41 offen offset:32
    buffer_load_dwordx4 v[32:35], v5, s[8:11], s40 offen offset:32
    buffer_load_dwordx4 v[36:39], v5, s[8:11], s42 offen offset:32
    s_add_u32 s40, s40, 64
    s_add_u32 s41, s41, 64
    s_add_u32 s42, s42, 64
    s_waitcnt vmcnt(4)
    v_mfma_f32_32x32x16_bf16 v[128:143], v[8:11], v[16:19], v[128:143]
    v_mfma_f32_32x32x16_bf16 v[144:159], v[8:11], v[20:23], v[144:159]
    v_mfma_f32_32x32x16_bf16 v[160:175], v[12:15], v[16:19], v[160:175]
    v_mfma_f32_32x32x16_bf16 v[176:191], v[12:15], v[20:23], v[176:191]
    s_waitcnt vmcnt(0)
    v_mfma_f32_32x32x16_bf16 v[128:143], v[24:27], v[32:35], v[128:143]
    v_mfma_f32_32x32x16_bf16 v[144:159], v[24:27], v[36:39], v[144:159]
    v_mfma_f32_32x32x16_bf16 v[160:175], v[28:31], v[32:35], v[160:175]
    v_mfma_f32_32x32x16_bf16 v[176:191], v[28:31], v[36:39], v[176:191]
    s_cmp_lt_u32 s40, 4096
    s_cbranch_scc1 gemm2_kernel_loop3
    v_mov_b32 v6, 16973824
    buffer_load_dwordx2 v[40:41], v6, s[12:15], 0 offen
    s_nop 15
    v_add_u32 v6, s34, v2
    v_add_u32 v6, 0, v6
    v_lshlrev_b32 v7, 11, v6
    v_lshl_add_u32 v7, v3, 3, v7
    s_lshl_b32 s35, s32, 7
    v_add_u32 v7, s35, v7
    s_lshl_b32 s35, s32, 8
    s_add_u32 s35, s35, 16908288
    v_lshlrev_b32 v42, 4, v3
    v_add_u32 v42, s35, v42
    v_add_u32 v43, 4096, v42
    s_waitcnt vmcnt(0)
    v_cmp_eq_u32 s[36:37], v6, v40
    v_cmp_eq_u32 s[38:39], v6, v41
    buffer_load_dwordx2 v[8:9], v7, s[16:19], 0 offen offset:0
    buffer_load_dwordx2 v[10:11], v7, s[12:15], 0 offen offset:0
    buffer_load_dwordx4 v[12:15], v42, s[12:15], 0 offen offset:0
    buffer_load_dwordx4 v[16:19], v43, s[12:15], 0 offen offset:0
    s_waitcnt vmcnt(0)
    v_cvt_pk_bf16_f32 v64, v64, v64
    v_and_b32 v64, 0xffff0000, v64
    v_cvt_pk_bf16_f32 v128, v128, v128
    v_and_b32 v128, 0xffff0000, v128
    v_sub_f32 v64, v64, v128
    v_cvt_pk_bf16_f32 v64, v64, v64
    v_and_b32 v64, 0xffff0000, v64
    v_lshlrev_b32 v20, 16, v8
    v_lshlrev_b32 v21, 16, v10
    v_add_f32 v64, v64, v20
    v_cvt_pk_bf16_f32 v64, v64, v64
    v_and_b32 v64, 0xffff0000, v64
    v_cndmask_b32 v22, 0, v12, s[36:37]
    v_cndmask_b32 v22, v22, v16, s[38:39]
    v_add_f32 v21, v21, v22
    v_cvt_pk_bf16_f32 v21, v21, v21
    v_and_b32 v21, 0xffff0000, v21
    v_add_f32 v64, v64, v21
    v_cvt_pk_bf16_f32 v65, v65, v65
    v_and_b32 v65, 0xffff0000, v65
    v_cvt_pk_bf16_f32 v129, v129, v129
    v_and_b32 v129, 0xffff0000, v129
    v_sub_f32 v65, v65, v129
    v_cvt_pk_bf16_f32 v65, v65, v65
    v_and_b32 v65, 0xffff0000, v65
    v_and_b32 v20, 0xffff0000, v8
    v_and_b32 v21, 0xffff0000, v10
    v_add_f32 v65, v65, v20
    v_cvt_pk_bf16_f32 v65, v65, v65
    v_and_b32 v65, 0xffff0000, v65
    v_cndmask_b32 v22, 0, v13, s[36:37]
    v_cndmask_b32 v22, v22, v17, s[38:39]
    v_add_f32 v21, v21, v22
    v_cvt_pk_bf16_f32 v21, v21, v21
    v_and_b32 v21, 0xffff0000, v21
    v_add_f32 v65, v65, v21
    v_cvt_pk_bf16_f32 v66, v66, v66
    v_and_b32 v66, 0xffff0000, v66
    v_cvt_pk_bf16_f32 v130, v130, v130
    v_and_b32 v130, 0xffff0000, v130
    v_sub_f32 v66, v66, v130
    v_cvt_pk_bf16_f32 v66, v66, v66
    v_and_b32 v66, 0xffff0000, v66
    v_lshlrev_b32 v20, 16, v9
    v_lshlrev_b32 v21, 16, v11
    v_add_f32 v66, v66, v20
    v_cvt_pk_bf16_f32 v66, v66, v66
    v_and_b32 v66, 0xffff0000, v66
    v_cndmask_b32 v22, 0, v14, s[36:37]
    v_cndmask_b32 v22, v22, v18, s[38:39]
    v_add_f32 v21, v21, v22
    v_cvt_pk_bf16_f32 v21, v21, v21
    v_and_b32 v21, 0xffff0000, v21
    v_add_f32 v66, v66, v21
    v_cvt_pk_bf16_f32 v67, v67, v67
    v_and_b32 v67, 0xffff0000, v67
    v_cvt_pk_bf16_f32 v131, v131, v131
    v_and_b32 v131, 0xffff0000, v131
    v_sub_f32 v67, v67, v131
    v_cvt_pk_bf16_f32 v67, v67, v67
    v_and_b32 v67, 0xffff0000, v67
    v_and_b32 v20, 0xffff0000, v9
    v_and_b32 v21, 0xffff0000, v11
    v_add_f32 v67, v67, v20
    v_cvt_pk_bf16_f32 v67, v67, v67
    v_and_b32 v67, 0xffff0000, v67
    v_cndmask_b32 v22, 0, v15, s[36:37]
    v_cndmask_b32 v22, v22, v19, s[38:39]
    v_add_f32 v21, v21, v22
    v_cvt_pk_bf16_f32 v21, v21, v21
    v_and_b32 v21, 0xffff0000, v21
    v_add_f32 v67, v67, v21
    v_cvt_pk_bf16_f32 v64, v64, v65
    v_cvt_pk_bf16_f32 v65, v66, v67
    buffer_store_dwordx2 v[64:65], v7, s[20:23], 0 offen offset:0
    buffer_load_dwordx2 v[8:9], v7, s[16:19], 0 offen offset:16
    buffer_load_dwordx2 v[10:11], v7, s[12:15], 0 offen offset:16
    buffer_load_dwordx4 v[12:15], v42, s[12:15], 0 offen offset:32
    buffer_load_dwordx4 v[16:19], v43, s[12:15], 0 offen offset:32
    s_waitcnt vmcnt(0)
    v_cvt_pk_bf16_f32 v68, v68, v68
    v_and_b32 v68, 0xffff0000, v68
    v_cvt_pk_bf16_f32 v132, v132, v132
    v_and_b32 v132, 0xffff0000, v132
    v_sub_f32 v68, v68, v132
    v_cvt_pk_bf16_f32 v68, v68, v68
    v_and_b32 v68, 0xffff0000, v68
    v_lshlrev_b32 v20, 16, v8
    v_lshlrev_b32 v21, 16, v10
    v_add_f32 v68, v68, v20
    v_cvt_pk_bf16_f32 v68, v68, v68
    v_and_b32 v68, 0xffff0000, v68
    v_cndmask_b32 v22, 0, v12, s[36:37]
    v_cndmask_b32 v22, v22, v16, s[38:39]
    v_add_f32 v21, v21, v22
    v_cvt_pk_bf16_f32 v21, v21, v21
    v_and_b32 v21, 0xffff0000, v21
    v_add_f32 v68, v68, v21
    v_cvt_pk_bf16_f32 v69, v69, v69
    v_and_b32 v69, 0xffff0000, v69
    v_cvt_pk_bf16_f32 v133, v133, v133
    v_and_b32 v133, 0xffff0000, v133
    v_sub_f32 v69, v69, v133
    v_cvt_pk_bf16_f32 v69, v69, v69
    v_and_b32 v69, 0xffff0000, v69
    v_and_b32 v20, 0xffff0000, v8
    v_and_b32 v21, 0xffff0000, v10
    v_add_f32 v69, v69, v20
    v_cvt_pk_bf16_f32 v69, v69, v69
    v_and_b32 v69, 0xffff0000, v69
    v_cndmask_b32 v22, 0, v13, s[36:37]
    v_cndmask_b32 v22, v22, v17, s[38:39]
    v_add_f32 v21, v21, v22
    v_cvt_pk_bf16_f32 v21, v21, v21
    v_and_b32 v21, 0xffff0000, v21
    v_add_f32 v69, v69, v21
    v_cvt_pk_bf16_f32 v70, v70, v70
    v_and_b32 v70, 0xffff0000, v70
    v_cvt_pk_bf16_f32 v134, v134, v134
    v_and_b32 v134, 0xffff0000, v134
    v_sub_f32 v70, v70, v134
    v_cvt_pk_bf16_f32 v70, v70, v70
    v_and_b32 v70, 0xffff0000, v70
    v_lshlrev_b32 v20, 16, v9
    v_lshlrev_b32 v21, 16, v11
    v_add_f32 v70, v70, v20
    v_cvt_pk_bf16_f32 v70, v70, v70
    v_and_b32 v70, 0xffff0000, v70
    v_cndmask_b32 v22, 0, v14, s[36:37]
    v_cndmask_b32 v22, v22, v18, s[38:39]
    v_add_f32 v21, v21, v22
    v_cvt_pk_bf16_f32 v21, v21, v21
    v_and_b32 v21, 0xffff0000, v21
    v_add_f32 v70, v70, v21
    v_cvt_pk_bf16_f32 v71, v71, v71
    v_and_b32 v71, 0xffff0000, v71
    v_cvt_pk_bf16_f32 v135, v135, v135
    v_and_b32 v135, 0xffff0000, v135
    v_sub_f32 v71, v71, v135
    v_cvt_pk_bf16_f32 v71, v71, v71
    v_and_b32 v71, 0xffff0000, v71
    v_and_b32 v20, 0xffff0000, v9
    v_and_b32 v21, 0xffff0000, v11
    v_add_f32 v71, v71, v20
    v_cvt_pk_bf16_f32 v71, v71, v71
    v_and_b32 v71, 0xffff0000, v71
    v_cndmask_b32 v22, 0, v15, s[36:37]
    v_cndmask_b32 v22, v22, v19, s[38:39]
    v_add_f32 v21, v21, v22
    v_cvt_pk_bf16_f32 v21, v21, v21
    v_and_b32 v21, 0xffff0000, v21
    v_add_f32 v71, v71, v21
    v_cvt_pk_bf16_f32 v68, v68, v69
    v_cvt_pk_bf16_f32 v69, v70, v71
    buffer_store_dwordx2 v[68:69], v7, s[20:23], 0 offen offset:16
    buffer_load_dwordx2 v[8:9], v7, s[16:19], 0 offen offset:32
    buffer_load_dwordx2 v[10:11], v7, s[12:15], 0 offen offset:32
    buffer_load_dwordx4 v[12:15], v42, s[12:15], 0 offen offset:64
    buffer_load_dwordx4 v[16:19], v43, s[12:15], 0 offen offset:64
    s_waitcnt vmcnt(0)
    v_cvt_pk_bf16_f32 v72, v72, v72
    v_and_b32 v72, 0xffff0000, v72
    v_cvt_pk_bf16_f32 v136, v136, v136
    v_and_b32 v136, 0xffff0000, v136
    v_sub_f32 v72, v72, v136
    v_cvt_pk_bf16_f32 v72, v72, v72
    v_and_b32 v72, 0xffff0000, v72
    v_lshlrev_b32 v20, 16, v8
    v_lshlrev_b32 v21, 16, v10
    v_add_f32 v72, v72, v20
    v_cvt_pk_bf16_f32 v72, v72, v72
    v_and_b32 v72, 0xffff0000, v72
    v_cndmask_b32 v22, 0, v12, s[36:37]
    v_cndmask_b32 v22, v22, v16, s[38:39]
    v_add_f32 v21, v21, v22
    v_cvt_pk_bf16_f32 v21, v21, v21
    v_and_b32 v21, 0xffff0000, v21
    v_add_f32 v72, v72, v21
    v_cvt_pk_bf16_f32 v73, v73, v73
    v_and_b32 v73, 0xffff0000, v73
    v_cvt_pk_bf16_f32 v137, v137, v137
    v_and_b32 v137, 0xffff0000, v137
    v_sub_f32 v73, v73, v137
    v_cvt_pk_bf16_f32 v73, v73, v73
    v_and_b32 v73, 0xffff0000, v73
    v_and_b32 v20, 0xffff0000, v8
    v_and_b32 v21, 0xffff0000, v10
    v_add_f32 v73, v73, v20
    v_cvt_pk_bf16_f32 v73, v73, v73
    v_and_b32 v73, 0xffff0000, v73
    v_cndmask_b32 v22, 0, v13, s[36:37]
    v_cndmask_b32 v22, v22, v17, s[38:39]
    v_add_f32 v21, v21, v22
    v_cvt_pk_bf16_f32 v21, v21, v21
    v_and_b32 v21, 0xffff0000, v21
    v_add_f32 v73, v73, v21
    v_cvt_pk_bf16_f32 v74, v74, v74
    v_and_b32 v74, 0xffff0000, v74
    v_cvt_pk_bf16_f32 v138, v138, v138
    v_and_b32 v138, 0xffff0000, v138
    v_sub_f32 v74, v74, v138
    v_cvt_pk_bf16_f32 v74, v74, v74
    v_and_b32 v74, 0xffff0000, v74
    v_lshlrev_b32 v20, 16, v9
    v_lshlrev_b32 v21, 16, v11
    v_add_f32 v74, v74, v20
    v_cvt_pk_bf16_f32 v74, v74, v74
    v_and_b32 v74, 0xffff0000, v74
    v_cndmask_b32 v22, 0, v14, s[36:37]
    v_cndmask_b32 v22, v22, v18, s[38:39]
    v_add_f32 v21, v21, v22
    v_cvt_pk_bf16_f32 v21, v21, v21
    v_and_b32 v21, 0xffff0000, v21
    v_add_f32 v74, v74, v21
    v_cvt_pk_bf16_f32 v75, v75, v75
    v_and_b32 v75, 0xffff0000, v75
    v_cvt_pk_bf16_f32 v139, v139, v139
    v_and_b32 v139, 0xffff0000, v139
    v_sub_f32 v75, v75, v139
    v_cvt_pk_bf16_f32 v75, v75, v75
    v_and_b32 v75, 0xffff0000, v75
    v_and_b32 v20, 0xffff0000, v9
    v_and_b32 v21, 0xffff0000, v11
    v_add_f32 v75, v75, v20
    v_cvt_pk_bf16_f32 v75, v75, v75
    v_and_b32 v75, 0xffff0000, v75
    v_cndmask_b32 v22, 0, v15, s[36:37]
    v_cndmask_b32 v22, v22, v19, s[38:39]
    v_add_f32 v21, v21, v22
    v_cvt_pk_bf16_f32 v21, v21, v21
    v_and_b32 v21, 0xffff0000, v21
    v_add_f32 v75, v75, v21
    v_cvt_pk_bf16_f32 v72, v72, v73
    v_cvt_pk_bf16_f32 v73, v74, v75
    buffer_store_dwordx2 v[72:73], v7, s[20:23], 0 offen offset:32
    buffer_load_dwordx2 v[8:9], v7, s[16:19], 0 offen offset:48
    buffer_load_dwordx2 v[10:11], v7, s[12:15], 0 offen offset:48
    buffer_load_dwordx4 v[12:15], v42, s[12:15], 0 offen offset:96
    buffer_load_dwordx4 v[16:19], v43, s[12:15], 0 offen offset:96
    s_waitcnt vmcnt(0)
    v_cvt_pk_bf16_f32 v76, v76, v76
    v_and_b32 v76, 0xffff0000, v76
    v_cvt_pk_bf16_f32 v140, v140, v140
    v_and_b32 v140, 0xffff0000, v140
    v_sub_f32 v76, v76, v140
    v_cvt_pk_bf16_f32 v76, v76, v76
    v_and_b32 v76, 0xffff0000, v76
    v_lshlrev_b32 v20, 16, v8
    v_lshlrev_b32 v21, 16, v10
    v_add_f32 v76, v76, v20
    v_cvt_pk_bf16_f32 v76, v76, v76
    v_and_b32 v76, 0xffff0000, v76
    v_cndmask_b32 v22, 0, v12, s[36:37]
    v_cndmask_b32 v22, v22, v16, s[38:39]
    v_add_f32 v21, v21, v22
    v_cvt_pk_bf16_f32 v21, v21, v21
    v_and_b32 v21, 0xffff0000, v21
    v_add_f32 v76, v76, v21
    v_cvt_pk_bf16_f32 v77, v77, v77
    v_and_b32 v77, 0xffff0000, v77
    v_cvt_pk_bf16_f32 v141, v141, v141
    v_and_b32 v141, 0xffff0000, v141
    v_sub_f32 v77, v77, v141
    v_cvt_pk_bf16_f32 v77, v77, v77
    v_and_b32 v77, 0xffff0000, v77
    v_and_b32 v20, 0xffff0000, v8
    v_and_b32 v21, 0xffff0000, v10
    v_add_f32 v77, v77, v20
    v_cvt_pk_bf16_f32 v77, v77, v77
    v_and_b32 v77, 0xffff0000, v77
    v_cndmask_b32 v22, 0, v13, s[36:37]
    v_cndmask_b32 v22, v22, v17, s[38:39]
    v_add_f32 v21, v21, v22
    v_cvt_pk_bf16_f32 v21, v21, v21
    v_and_b32 v21, 0xffff0000, v21
    v_add_f32 v77, v77, v21
    v_cvt_pk_bf16_f32 v78, v78, v78
    v_and_b32 v78, 0xffff0000, v78
    v_cvt_pk_bf16_f32 v142, v142, v142
    v_and_b32 v142, 0xffff0000, v142
    v_sub_f32 v78, v78, v142
    v_cvt_pk_bf16_f32 v78, v78, v78
    v_and_b32 v78, 0xffff0000, v78
    v_lshlrev_b32 v20, 16, v9
    v_lshlrev_b32 v21, 16, v11
    v_add_f32 v78, v78, v20
    v_cvt_pk_bf16_f32 v78, v78, v78
    v_and_b32 v78, 0xffff0000, v78
    v_cndmask_b32 v22, 0, v14, s[36:37]
    v_cndmask_b32 v22, v22, v18, s[38:39]
    v_add_f32 v21, v21, v22
    v_cvt_pk_bf16_f32 v21, v21, v21
    v_and_b32 v21, 0xffff0000, v21
    v_add_f32 v78, v78, v21
    v_cvt_pk_bf16_f32 v79, v79, v79
    v_and_b32 v79, 0xffff0000, v79
    v_cvt_pk_bf16_f32 v143, v143, v143
    v_and_b32 v143, 0xffff0000, v143
    v_sub_f32 v79, v79, v143
    v_cvt_pk_bf16_f32 v79, v79, v79
    v_and_b32 v79, 0xffff0000, v79
    v_and_b32 v20, 0xffff0000, v9
    v_and_b32 v21, 0xffff0000, v11
    v_add_f32 v79, v79, v20
    v_cvt_pk_bf16_f32 v79, v79, v79
    v_and_b32 v79, 0xffff0000, v79
    v_cndmask_b32 v22, 0, v15, s[36:37]
    v_cndmask_b32 v22, v22, v19, s[38:39]
    v_add_f32 v21, v21, v22
    v_cvt_pk_bf16_f32 v21, v21, v21
    v_and_b32 v21, 0xffff0000, v21
    v_add_f32 v79, v79, v21
    v_cvt_pk_bf16_f32 v76, v76, v77
    v_cvt_pk_bf16_f32 v77, v78, v79
    buffer_store_dwordx2 v[76:77], v7, s[20:23], 0 offen offset:48
    buffer_load_dwordx2 v[8:9], v7, s[16:19], 0 offen offset:64
    buffer_load_dwordx2 v[10:11], v7, s[12:15], 0 offen offset:64
    buffer_load_dwordx4 v[12:15], v42, s[12:15], 0 offen offset:128
    buffer_load_dwordx4 v[16:19], v43, s[12:15], 0 offen offset:128
    s_waitcnt vmcnt(0)
    v_cvt_pk_bf16_f32 v96, v96, v96
    v_and_b32 v96, 0xffff0000, v96
    v_cvt_pk_bf16_f32 v160, v160, v160
    v_and_b32 v160, 0xffff0000, v160
    v_sub_f32 v96, v96, v160
    v_cvt_pk_bf16_f32 v96, v96, v96
    v_and_b32 v96, 0xffff0000, v96
    v_lshlrev_b32 v20, 16, v8
    v_lshlrev_b32 v21, 16, v10
    v_add_f32 v96, v96, v20
    v_cvt_pk_bf16_f32 v96, v96, v96
    v_and_b32 v96, 0xffff0000, v96
    v_cndmask_b32 v22, 0, v12, s[36:37]
    v_cndmask_b32 v22, v22, v16, s[38:39]
    v_add_f32 v21, v21, v22
    v_cvt_pk_bf16_f32 v21, v21, v21
    v_and_b32 v21, 0xffff0000, v21
    v_add_f32 v96, v96, v21
    v_cvt_pk_bf16_f32 v97, v97, v97
    v_and_b32 v97, 0xffff0000, v97
    v_cvt_pk_bf16_f32 v161, v161, v161
    v_and_b32 v161, 0xffff0000, v161
    v_sub_f32 v97, v97, v161
    v_cvt_pk_bf16_f32 v97, v97, v97
    v_and_b32 v97, 0xffff0000, v97
    v_and_b32 v20, 0xffff0000, v8
    v_and_b32 v21, 0xffff0000, v10
    v_add_f32 v97, v97, v20
    v_cvt_pk_bf16_f32 v97, v97, v97
    v_and_b32 v97, 0xffff0000, v97
    v_cndmask_b32 v22, 0, v13, s[36:37]
    v_cndmask_b32 v22, v22, v17, s[38:39]
    v_add_f32 v21, v21, v22
    v_cvt_pk_bf16_f32 v21, v21, v21
    v_and_b32 v21, 0xffff0000, v21
    v_add_f32 v97, v97, v21
    v_cvt_pk_bf16_f32 v98, v98, v98
    v_and_b32 v98, 0xffff0000, v98
    v_cvt_pk_bf16_f32 v162, v162, v162
    v_and_b32 v162, 0xffff0000, v162
    v_sub_f32 v98, v98, v162
    v_cvt_pk_bf16_f32 v98, v98, v98
    v_and_b32 v98, 0xffff0000, v98
    v_lshlrev_b32 v20, 16, v9
    v_lshlrev_b32 v21, 16, v11
    v_add_f32 v98, v98, v20
    v_cvt_pk_bf16_f32 v98, v98, v98
    v_and_b32 v98, 0xffff0000, v98
    v_cndmask_b32 v22, 0, v14, s[36:37]
    v_cndmask_b32 v22, v22, v18, s[38:39]
    v_add_f32 v21, v21, v22
    v_cvt_pk_bf16_f32 v21, v21, v21
    v_and_b32 v21, 0xffff0000, v21
    v_add_f32 v98, v98, v21
    v_cvt_pk_bf16_f32 v99, v99, v99
    v_and_b32 v99, 0xffff0000, v99
    v_cvt_pk_bf16_f32 v163, v163, v163
    v_and_b32 v163, 0xffff0000, v163
    v_sub_f32 v99, v99, v163
    v_cvt_pk_bf16_f32 v99, v99, v99
    v_and_b32 v99, 0xffff0000, v99
    v_and_b32 v20, 0xffff0000, v9
    v_and_b32 v21, 0xffff0000, v11
    v_add_f32 v99, v99, v20
    v_cvt_pk_bf16_f32 v99, v99, v99
    v_and_b32 v99, 0xffff0000, v99
    v_cndmask_b32 v22, 0, v15, s[36:37]
    v_cndmask_b32 v22, v22, v19, s[38:39]
    v_add_f32 v21, v21, v22
    v_cvt_pk_bf16_f32 v21, v21, v21
    v_and_b32 v21, 0xffff0000, v21
    v_add_f32 v99, v99, v21
    v_cvt_pk_bf16_f32 v96, v96, v97
    v_cvt_pk_bf16_f32 v97, v98, v99
    buffer_store_dwordx2 v[96:97], v7, s[20:23], 0 offen offset:64
    buffer_load_dwordx2 v[8:9], v7, s[16:19], 0 offen offset:80
    buffer_load_dwordx2 v[10:11], v7, s[12:15], 0 offen offset:80
    buffer_load_dwordx4 v[12:15], v42, s[12:15], 0 offen offset:160
    buffer_load_dwordx4 v[16:19], v43, s[12:15], 0 offen offset:160
    s_waitcnt vmcnt(0)
    v_cvt_pk_bf16_f32 v100, v100, v100
    v_and_b32 v100, 0xffff0000, v100
    v_cvt_pk_bf16_f32 v164, v164, v164
    v_and_b32 v164, 0xffff0000, v164
    v_sub_f32 v100, v100, v164
    v_cvt_pk_bf16_f32 v100, v100, v100
    v_and_b32 v100, 0xffff0000, v100
    v_lshlrev_b32 v20, 16, v8
    v_lshlrev_b32 v21, 16, v10
    v_add_f32 v100, v100, v20
    v_cvt_pk_bf16_f32 v100, v100, v100
    v_and_b32 v100, 0xffff0000, v100
    v_cndmask_b32 v22, 0, v12, s[36:37]
    v_cndmask_b32 v22, v22, v16, s[38:39]
    v_add_f32 v21, v21, v22
    v_cvt_pk_bf16_f32 v21, v21, v21
    v_and_b32 v21, 0xffff0000, v21
    v_add_f32 v100, v100, v21
    v_cvt_pk_bf16_f32 v101, v101, v101
    v_and_b32 v101, 0xffff0000, v101
    v_cvt_pk_bf16_f32 v165, v165, v165
    v_and_b32 v165, 0xffff0000, v165
    v_sub_f32 v101, v101, v165
    v_cvt_pk_bf16_f32 v101, v101, v101
    v_and_b32 v101, 0xffff0000, v101
    v_and_b32 v20, 0xffff0000, v8
    v_and_b32 v21, 0xffff0000, v10
    v_add_f32 v101, v101, v20
    v_cvt_pk_bf16_f32 v101, v101, v101
    v_and_b32 v101, 0xffff0000, v101
    v_cndmask_b32 v22, 0, v13, s[36:37]
    v_cndmask_b32 v22, v22, v17, s[38:39]
    v_add_f32 v21, v21, v22
    v_cvt_pk_bf16_f32 v21, v21, v21
    v_and_b32 v21, 0xffff0000, v21
    v_add_f32 v101, v101, v21
    v_cvt_pk_bf16_f32 v102, v102, v102
    v_and_b32 v102, 0xffff0000, v102
    v_cvt_pk_bf16_f32 v166, v166, v166
    v_and_b32 v166, 0xffff0000, v166
    v_sub_f32 v102, v102, v166
    v_cvt_pk_bf16_f32 v102, v102, v102
    v_and_b32 v102, 0xffff0000, v102
    v_lshlrev_b32 v20, 16, v9
    v_lshlrev_b32 v21, 16, v11
    v_add_f32 v102, v102, v20
    v_cvt_pk_bf16_f32 v102, v102, v102
    v_and_b32 v102, 0xffff0000, v102
    v_cndmask_b32 v22, 0, v14, s[36:37]
    v_cndmask_b32 v22, v22, v18, s[38:39]
    v_add_f32 v21, v21, v22
    v_cvt_pk_bf16_f32 v21, v21, v21
    v_and_b32 v21, 0xffff0000, v21
    v_add_f32 v102, v102, v21
    v_cvt_pk_bf16_f32 v103, v103, v103
    v_and_b32 v103, 0xffff0000, v103
    v_cvt_pk_bf16_f32 v167, v167, v167
    v_and_b32 v167, 0xffff0000, v167
    v_sub_f32 v103, v103, v167
    v_cvt_pk_bf16_f32 v103, v103, v103
    v_and_b32 v103, 0xffff0000, v103
    v_and_b32 v20, 0xffff0000, v9
    v_and_b32 v21, 0xffff0000, v11
    v_add_f32 v103, v103, v20
    v_cvt_pk_bf16_f32 v103, v103, v103
    v_and_b32 v103, 0xffff0000, v103
    v_cndmask_b32 v22, 0, v15, s[36:37]
    v_cndmask_b32 v22, v22, v19, s[38:39]
    v_add_f32 v21, v21, v22
    v_cvt_pk_bf16_f32 v21, v21, v21
    v_and_b32 v21, 0xffff0000, v21
    v_add_f32 v103, v103, v21
    v_cvt_pk_bf16_f32 v100, v100, v101
    v_cvt_pk_bf16_f32 v101, v102, v103
    buffer_store_dwordx2 v[100:101], v7, s[20:23], 0 offen offset:80
    buffer_load_dwordx2 v[8:9], v7, s[16:19], 0 offen offset:96
    buffer_load_dwordx2 v[10:11], v7, s[12:15], 0 offen offset:96
    buffer_load_dwordx4 v[12:15], v42, s[12:15], 0 offen offset:192
    buffer_load_dwordx4 v[16:19], v43, s[12:15], 0 offen offset:192
    s_waitcnt vmcnt(0)
    v_cvt_pk_bf16_f32 v104, v104, v104
    v_and_b32 v104, 0xffff0000, v104
    v_cvt_pk_bf16_f32 v168, v168, v168
    v_and_b32 v168, 0xffff0000, v168
    v_sub_f32 v104, v104, v168
    v_cvt_pk_bf16_f32 v104, v104, v104
    v_and_b32 v104, 0xffff0000, v104
    v_lshlrev_b32 v20, 16, v8
    v_lshlrev_b32 v21, 16, v10
    v_add_f32 v104, v104, v20
    v_cvt_pk_bf16_f32 v104, v104, v104
    v_and_b32 v104, 0xffff0000, v104
    v_cndmask_b32 v22, 0, v12, s[36:37]
    v_cndmask_b32 v22, v22, v16, s[38:39]
    v_add_f32 v21, v21, v22
    v_cvt_pk_bf16_f32 v21, v21, v21
    v_and_b32 v21, 0xffff0000, v21
    v_add_f32 v104, v104, v21
    v_cvt_pk_bf16_f32 v105, v105, v105
    v_and_b32 v105, 0xffff0000, v105
    v_cvt_pk_bf16_f32 v169, v169, v169
    v_and_b32 v169, 0xffff0000, v169
    v_sub_f32 v105, v105, v169
    v_cvt_pk_bf16_f32 v105, v105, v105
    v_and_b32 v105, 0xffff0000, v105
    v_and_b32 v20, 0xffff0000, v8
    v_and_b32 v21, 0xffff0000, v10
    v_add_f32 v105, v105, v20
    v_cvt_pk_bf16_f32 v105, v105, v105
    v_and_b32 v105, 0xffff0000, v105
    v_cndmask_b32 v22, 0, v13, s[36:37]
    v_cndmask_b32 v22, v22, v17, s[38:39]
    v_add_f32 v21, v21, v22
    v_cvt_pk_bf16_f32 v21, v21, v21
    v_and_b32 v21, 0xffff0000, v21
    v_add_f32 v105, v105, v21
    v_cvt_pk_bf16_f32 v106, v106, v106
    v_and_b32 v106, 0xffff0000, v106
    v_cvt_pk_bf16_f32 v170, v170, v170
    v_and_b32 v170, 0xffff0000, v170
    v_sub_f32 v106, v106, v170
    v_cvt_pk_bf16_f32 v106, v106, v106
    v_and_b32 v106, 0xffff0000, v106
    v_lshlrev_b32 v20, 16, v9
    v_lshlrev_b32 v21, 16, v11
    v_add_f32 v106, v106, v20
    v_cvt_pk_bf16_f32 v106, v106, v106
    v_and_b32 v106, 0xffff0000, v106
    v_cndmask_b32 v22, 0, v14, s[36:37]
    v_cndmask_b32 v22, v22, v18, s[38:39]
    v_add_f32 v21, v21, v22
    v_cvt_pk_bf16_f32 v21, v21, v21
    v_and_b32 v21, 0xffff0000, v21
    v_add_f32 v106, v106, v21
    v_cvt_pk_bf16_f32 v107, v107, v107
    v_and_b32 v107, 0xffff0000, v107
    v_cvt_pk_bf16_f32 v171, v171, v171
    v_and_b32 v171, 0xffff0000, v171
    v_sub_f32 v107, v107, v171
    v_cvt_pk_bf16_f32 v107, v107, v107
    v_and_b32 v107, 0xffff0000, v107
    v_and_b32 v20, 0xffff0000, v9
    v_and_b32 v21, 0xffff0000, v11
    v_add_f32 v107, v107, v20
    v_cvt_pk_bf16_f32 v107, v107, v107
    v_and_b32 v107, 0xffff0000, v107
    v_cndmask_b32 v22, 0, v15, s[36:37]
    v_cndmask_b32 v22, v22, v19, s[38:39]
    v_add_f32 v21, v21, v22
    v_cvt_pk_bf16_f32 v21, v21, v21
    v_and_b32 v21, 0xffff0000, v21
    v_add_f32 v107, v107, v21
    v_cvt_pk_bf16_f32 v104, v104, v105
    v_cvt_pk_bf16_f32 v105, v106, v107
    buffer_store_dwordx2 v[104:105], v7, s[20:23], 0 offen offset:96
    buffer_load_dwordx2 v[8:9], v7, s[16:19], 0 offen offset:112
    buffer_load_dwordx2 v[10:11], v7, s[12:15], 0 offen offset:112
    buffer_load_dwordx4 v[12:15], v42, s[12:15], 0 offen offset:224
    buffer_load_dwordx4 v[16:19], v43, s[12:15], 0 offen offset:224
    s_waitcnt vmcnt(0)
    v_cvt_pk_bf16_f32 v108, v108, v108
    v_and_b32 v108, 0xffff0000, v108
    v_cvt_pk_bf16_f32 v172, v172, v172
    v_and_b32 v172, 0xffff0000, v172
    v_sub_f32 v108, v108, v172
    v_cvt_pk_bf16_f32 v108, v108, v108
    v_and_b32 v108, 0xffff0000, v108
    v_lshlrev_b32 v20, 16, v8
    v_lshlrev_b32 v21, 16, v10
    v_add_f32 v108, v108, v20
    v_cvt_pk_bf16_f32 v108, v108, v108
    v_and_b32 v108, 0xffff0000, v108
    v_cndmask_b32 v22, 0, v12, s[36:37]
    v_cndmask_b32 v22, v22, v16, s[38:39]
    v_add_f32 v21, v21, v22
    v_cvt_pk_bf16_f32 v21, v21, v21
    v_and_b32 v21, 0xffff0000, v21
    v_add_f32 v108, v108, v21
    v_cvt_pk_bf16_f32 v109, v109, v109
    v_and_b32 v109, 0xffff0000, v109
    v_cvt_pk_bf16_f32 v173, v173, v173
    v_and_b32 v173, 0xffff0000, v173
    v_sub_f32 v109, v109, v173
    v_cvt_pk_bf16_f32 v109, v109, v109
    v_and_b32 v109, 0xffff0000, v109
    v_and_b32 v20, 0xffff0000, v8
    v_and_b32 v21, 0xffff0000, v10
    v_add_f32 v109, v109, v20
    v_cvt_pk_bf16_f32 v109, v109, v109
    v_and_b32 v109, 0xffff0000, v109
    v_cndmask_b32 v22, 0, v13, s[36:37]
    v_cndmask_b32 v22, v22, v17, s[38:39]
    v_add_f32 v21, v21, v22
    v_cvt_pk_bf16_f32 v21, v21, v21
    v_and_b32 v21, 0xffff0000, v21
    v_add_f32 v109, v109, v21
    v_cvt_pk_bf16_f32 v110, v110, v110
    v_and_b32 v110, 0xffff0000, v110
    v_cvt_pk_bf16_f32 v174, v174, v174
    v_and_b32 v174, 0xffff0000, v174
    v_sub_f32 v110, v110, v174
    v_cvt_pk_bf16_f32 v110, v110, v110
    v_and_b32 v110, 0xffff0000, v110
    v_lshlrev_b32 v20, 16, v9
    v_lshlrev_b32 v21, 16, v11
    v_add_f32 v110, v110, v20
    v_cvt_pk_bf16_f32 v110, v110, v110
    v_and_b32 v110, 0xffff0000, v110
    v_cndmask_b32 v22, 0, v14, s[36:37]
    v_cndmask_b32 v22, v22, v18, s[38:39]
    v_add_f32 v21, v21, v22
    v_cvt_pk_bf16_f32 v21, v21, v21
    v_and_b32 v21, 0xffff0000, v21
    v_add_f32 v110, v110, v21
    v_cvt_pk_bf16_f32 v111, v111, v111
    v_and_b32 v111, 0xffff0000, v111
    v_cvt_pk_bf16_f32 v175, v175, v175
    v_and_b32 v175, 0xffff0000, v175
    v_sub_f32 v111, v111, v175
    v_cvt_pk_bf16_f32 v111, v111, v111
    v_and_b32 v111, 0xffff0000, v111
    v_and_b32 v20, 0xffff0000, v9
    v_and_b32 v21, 0xffff0000, v11
    v_add_f32 v111, v111, v20
    v_cvt_pk_bf16_f32 v111, v111, v111
    v_and_b32 v111, 0xffff0000, v111
    v_cndmask_b32 v22, 0, v15, s[36:37]
    v_cndmask_b32 v22, v22, v19, s[38:39]
    v_add_f32 v21, v21, v22
    v_cvt_pk_bf16_f32 v21, v21, v21
    v_and_b32 v21, 0xffff0000, v21
    v_add_f32 v111, v111, v21
    v_cvt_pk_bf16_f32 v108, v108, v109
    v_cvt_pk_bf16_f32 v109, v110, v111
    buffer_store_dwordx2 v[108:109], v7, s[20:23], 0 offen offset:112
    v_add_u32 v6, s34, v2
    v_add_u32 v6, 32, v6
    v_lshlrev_b32 v7, 11, v6
    v_lshl_add_u32 v7, v3, 3, v7
    s_lshl_b32 s35, s32, 7
    v_add_u32 v7, s35, v7
    s_lshl_b32 s35, s32, 8
    s_add_u32 s35, s35, 16908288
    v_lshlrev_b32 v42, 4, v3
    v_add_u32 v42, s35, v42
    v_add_u32 v43, 4096, v42
    s_waitcnt vmcnt(0)
    v_cmp_eq_u32 s[36:37], v6, v40
    v_cmp_eq_u32 s[38:39], v6, v41
    buffer_load_dwordx2 v[8:9], v7, s[16:19], 0 offen offset:0
    buffer_load_dwordx2 v[10:11], v7, s[12:15], 0 offen offset:0
    buffer_load_dwordx4 v[12:15], v42, s[12:15], 0 offen offset:0
    buffer_load_dwordx4 v[16:19], v43, s[12:15], 0 offen offset:0
    s_waitcnt vmcnt(0)
    v_cvt_pk_bf16_f32 v80, v80, v80
    v_and_b32 v80, 0xffff0000, v80
    v_cvt_pk_bf16_f32 v144, v144, v144
    v_and_b32 v144, 0xffff0000, v144
    v_sub_f32 v80, v80, v144
    v_cvt_pk_bf16_f32 v80, v80, v80
    v_and_b32 v80, 0xffff0000, v80
    v_lshlrev_b32 v20, 16, v8
    v_lshlrev_b32 v21, 16, v10
    v_add_f32 v80, v80, v20
    v_cvt_pk_bf16_f32 v80, v80, v80
    v_and_b32 v80, 0xffff0000, v80
    v_cndmask_b32 v22, 0, v12, s[36:37]
    v_cndmask_b32 v22, v22, v16, s[38:39]
    v_add_f32 v21, v21, v22
    v_cvt_pk_bf16_f32 v21, v21, v21
    v_and_b32 v21, 0xffff0000, v21
    v_add_f32 v80, v80, v21
    v_cvt_pk_bf16_f32 v81, v81, v81
    v_and_b32 v81, 0xffff0000, v81
    v_cvt_pk_bf16_f32 v145, v145, v145
    v_and_b32 v145, 0xffff0000, v145
    v_sub_f32 v81, v81, v145
    v_cvt_pk_bf16_f32 v81, v81, v81
    v_and_b32 v81, 0xffff0000, v81
    v_and_b32 v20, 0xffff0000, v8
    v_and_b32 v21, 0xffff0000, v10
    v_add_f32 v81, v81, v20
    v_cvt_pk_bf16_f32 v81, v81, v81
    v_and_b32 v81, 0xffff0000, v81
    v_cndmask_b32 v22, 0, v13, s[36:37]
    v_cndmask_b32 v22, v22, v17, s[38:39]
    v_add_f32 v21, v21, v22
    v_cvt_pk_bf16_f32 v21, v21, v21
    v_and_b32 v21, 0xffff0000, v21
    v_add_f32 v81, v81, v21
    v_cvt_pk_bf16_f32 v82, v82, v82
    v_and_b32 v82, 0xffff0000, v82
    v_cvt_pk_bf16_f32 v146, v146, v146
    v_and_b32 v146, 0xffff0000, v146
    v_sub_f32 v82, v82, v146
    v_cvt_pk_bf16_f32 v82, v82, v82
    v_and_b32 v82, 0xffff0000, v82
    v_lshlrev_b32 v20, 16, v9
    v_lshlrev_b32 v21, 16, v11
    v_add_f32 v82, v82, v20
    v_cvt_pk_bf16_f32 v82, v82, v82
    v_and_b32 v82, 0xffff0000, v82
    v_cndmask_b32 v22, 0, v14, s[36:37]
    v_cndmask_b32 v22, v22, v18, s[38:39]
    v_add_f32 v21, v21, v22
    v_cvt_pk_bf16_f32 v21, v21, v21
    v_and_b32 v21, 0xffff0000, v21
    v_add_f32 v82, v82, v21
    v_cvt_pk_bf16_f32 v83, v83, v83
    v_and_b32 v83, 0xffff0000, v83
    v_cvt_pk_bf16_f32 v147, v147, v147
    v_and_b32 v147, 0xffff0000, v147
    v_sub_f32 v83, v83, v147
    v_cvt_pk_bf16_f32 v83, v83, v83
    v_and_b32 v83, 0xffff0000, v83
    v_and_b32 v20, 0xffff0000, v9
    v_and_b32 v21, 0xffff0000, v11
    v_add_f32 v83, v83, v20
    v_cvt_pk_bf16_f32 v83, v83, v83
    v_and_b32 v83, 0xffff0000, v83
    v_cndmask_b32 v22, 0, v15, s[36:37]
    v_cndmask_b32 v22, v22, v19, s[38:39]
    v_add_f32 v21, v21, v22
    v_cvt_pk_bf16_f32 v21, v21, v21
    v_and_b32 v21, 0xffff0000, v21
    v_add_f32 v83, v83, v21
    v_cvt_pk_bf16_f32 v80, v80, v81
    v_cvt_pk_bf16_f32 v81, v82, v83
    buffer_store_dwordx2 v[80:81], v7, s[20:23], 0 offen offset:0
    buffer_load_dwordx2 v[8:9], v7, s[16:19], 0 offen offset:16
    buffer_load_dwordx2 v[10:11], v7, s[12:15], 0 offen offset:16
    buffer_load_dwordx4 v[12:15], v42, s[12:15], 0 offen offset:32
    buffer_load_dwordx4 v[16:19], v43, s[12:15], 0 offen offset:32
    s_waitcnt vmcnt(0)
    v_cvt_pk_bf16_f32 v84, v84, v84
    v_and_b32 v84, 0xffff0000, v84
    v_cvt_pk_bf16_f32 v148, v148, v148
    v_and_b32 v148, 0xffff0000, v148
    v_sub_f32 v84, v84, v148
    v_cvt_pk_bf16_f32 v84, v84, v84
    v_and_b32 v84, 0xffff0000, v84
    v_lshlrev_b32 v20, 16, v8
    v_lshlrev_b32 v21, 16, v10
    v_add_f32 v84, v84, v20
    v_cvt_pk_bf16_f32 v84, v84, v84
    v_and_b32 v84, 0xffff0000, v84
    v_cndmask_b32 v22, 0, v12, s[36:37]
    v_cndmask_b32 v22, v22, v16, s[38:39]
    v_add_f32 v21, v21, v22
    v_cvt_pk_bf16_f32 v21, v21, v21
    v_and_b32 v21, 0xffff0000, v21
    v_add_f32 v84, v84, v21
    v_cvt_pk_bf16_f32 v85, v85, v85
    v_and_b32 v85, 0xffff0000, v85
    v_cvt_pk_bf16_f32 v149, v149, v149
    v_and_b32 v149, 0xffff0000, v149
    v_sub_f32 v85, v85, v149
    v_cvt_pk_bf16_f32 v85, v85, v85
    v_and_b32 v85, 0xffff0000, v85
    v_and_b32 v20, 0xffff0000, v8
    v_and_b32 v21, 0xffff0000, v10
    v_add_f32 v85, v85, v20
    v_cvt_pk_bf16_f32 v85, v85, v85
    v_and_b32 v85, 0xffff0000, v85
    v_cndmask_b32 v22, 0, v13, s[36:37]
    v_cndmask_b32 v22, v22, v17, s[38:39]
    v_add_f32 v21, v21, v22
    v_cvt_pk_bf16_f32 v21, v21, v21
    v_and_b32 v21, 0xffff0000, v21
    v_add_f32 v85, v85, v21
    v_cvt_pk_bf16_f32 v86, v86, v86
    v_and_b32 v86, 0xffff0000, v86
    v_cvt_pk_bf16_f32 v150, v150, v150
    v_and_b32 v150, 0xffff0000, v150
    v_sub_f32 v86, v86, v150
    v_cvt_pk_bf16_f32 v86, v86, v86
    v_and_b32 v86, 0xffff0000, v86
    v_lshlrev_b32 v20, 16, v9
    v_lshlrev_b32 v21, 16, v11
    v_add_f32 v86, v86, v20
    v_cvt_pk_bf16_f32 v86, v86, v86
    v_and_b32 v86, 0xffff0000, v86
    v_cndmask_b32 v22, 0, v14, s[36:37]
    v_cndmask_b32 v22, v22, v18, s[38:39]
    v_add_f32 v21, v21, v22
    v_cvt_pk_bf16_f32 v21, v21, v21
    v_and_b32 v21, 0xffff0000, v21
    v_add_f32 v86, v86, v21
    v_cvt_pk_bf16_f32 v87, v87, v87
    v_and_b32 v87, 0xffff0000, v87
    v_cvt_pk_bf16_f32 v151, v151, v151
    v_and_b32 v151, 0xffff0000, v151
    v_sub_f32 v87, v87, v151
    v_cvt_pk_bf16_f32 v87, v87, v87
    v_and_b32 v87, 0xffff0000, v87
    v_and_b32 v20, 0xffff0000, v9
    v_and_b32 v21, 0xffff0000, v11
    v_add_f32 v87, v87, v20
    v_cvt_pk_bf16_f32 v87, v87, v87
    v_and_b32 v87, 0xffff0000, v87
    v_cndmask_b32 v22, 0, v15, s[36:37]
    v_cndmask_b32 v22, v22, v19, s[38:39]
    v_add_f32 v21, v21, v22
    v_cvt_pk_bf16_f32 v21, v21, v21
    v_and_b32 v21, 0xffff0000, v21
    v_add_f32 v87, v87, v21
    v_cvt_pk_bf16_f32 v84, v84, v85
    v_cvt_pk_bf16_f32 v85, v86, v87
    buffer_store_dwordx2 v[84:85], v7, s[20:23], 0 offen offset:16
    buffer_load_dwordx2 v[8:9], v7, s[16:19], 0 offen offset:32
    buffer_load_dwordx2 v[10:11], v7, s[12:15], 0 offen offset:32
    buffer_load_dwordx4 v[12:15], v42, s[12:15], 0 offen offset:64
    buffer_load_dwordx4 v[16:19], v43, s[12:15], 0 offen offset:64
    s_waitcnt vmcnt(0)
    v_cvt_pk_bf16_f32 v88, v88, v88
    v_and_b32 v88, 0xffff0000, v88
    v_cvt_pk_bf16_f32 v152, v152, v152
    v_and_b32 v152, 0xffff0000, v152
    v_sub_f32 v88, v88, v152
    v_cvt_pk_bf16_f32 v88, v88, v88
    v_and_b32 v88, 0xffff0000, v88
    v_lshlrev_b32 v20, 16, v8
    v_lshlrev_b32 v21, 16, v10
    v_add_f32 v88, v88, v20
    v_cvt_pk_bf16_f32 v88, v88, v88
    v_and_b32 v88, 0xffff0000, v88
    v_cndmask_b32 v22, 0, v12, s[36:37]
    v_cndmask_b32 v22, v22, v16, s[38:39]
    v_add_f32 v21, v21, v22
    v_cvt_pk_bf16_f32 v21, v21, v21
    v_and_b32 v21, 0xffff0000, v21
    v_add_f32 v88, v88, v21
    v_cvt_pk_bf16_f32 v89, v89, v89
    v_and_b32 v89, 0xffff0000, v89
    v_cvt_pk_bf16_f32 v153, v153, v153
    v_and_b32 v153, 0xffff0000, v153
    v_sub_f32 v89, v89, v153
    v_cvt_pk_bf16_f32 v89, v89, v89
    v_and_b32 v89, 0xffff0000, v89
    v_and_b32 v20, 0xffff0000, v8
    v_and_b32 v21, 0xffff0000, v10
    v_add_f32 v89, v89, v20
    v_cvt_pk_bf16_f32 v89, v89, v89
    v_and_b32 v89, 0xffff0000, v89
    v_cndmask_b32 v22, 0, v13, s[36:37]
    v_cndmask_b32 v22, v22, v17, s[38:39]
    v_add_f32 v21, v21, v22
    v_cvt_pk_bf16_f32 v21, v21, v21
    v_and_b32 v21, 0xffff0000, v21
    v_add_f32 v89, v89, v21
    v_cvt_pk_bf16_f32 v90, v90, v90
    v_and_b32 v90, 0xffff0000, v90
    v_cvt_pk_bf16_f32 v154, v154, v154
    v_and_b32 v154, 0xffff0000, v154
    v_sub_f32 v90, v90, v154
    v_cvt_pk_bf16_f32 v90, v90, v90
    v_and_b32 v90, 0xffff0000, v90
    v_lshlrev_b32 v20, 16, v9
    v_lshlrev_b32 v21, 16, v11
    v_add_f32 v90, v90, v20
    v_cvt_pk_bf16_f32 v90, v90, v90
    v_and_b32 v90, 0xffff0000, v90
    v_cndmask_b32 v22, 0, v14, s[36:37]
    v_cndmask_b32 v22, v22, v18, s[38:39]
    v_add_f32 v21, v21, v22
    v_cvt_pk_bf16_f32 v21, v21, v21
    v_and_b32 v21, 0xffff0000, v21
    v_add_f32 v90, v90, v21
    v_cvt_pk_bf16_f32 v91, v91, v91
    v_and_b32 v91, 0xffff0000, v91
    v_cvt_pk_bf16_f32 v155, v155, v155
    v_and_b32 v155, 0xffff0000, v155
    v_sub_f32 v91, v91, v155
    v_cvt_pk_bf16_f32 v91, v91, v91
    v_and_b32 v91, 0xffff0000, v91
    v_and_b32 v20, 0xffff0000, v9
    v_and_b32 v21, 0xffff0000, v11
    v_add_f32 v91, v91, v20
    v_cvt_pk_bf16_f32 v91, v91, v91
    v_and_b32 v91, 0xffff0000, v91
    v_cndmask_b32 v22, 0, v15, s[36:37]
    v_cndmask_b32 v22, v22, v19, s[38:39]
    v_add_f32 v21, v21, v22
    v_cvt_pk_bf16_f32 v21, v21, v21
    v_and_b32 v21, 0xffff0000, v21
    v_add_f32 v91, v91, v21
    v_cvt_pk_bf16_f32 v88, v88, v89
    v_cvt_pk_bf16_f32 v89, v90, v91
    buffer_store_dwordx2 v[88:89], v7, s[20:23], 0 offen offset:32
    buffer_load_dwordx2 v[8:9], v7, s[16:19], 0 offen offset:48
    buffer_load_dwordx2 v[10:11], v7, s[12:15], 0 offen offset:48
    buffer_load_dwordx4 v[12:15], v42, s[12:15], 0 offen offset:96
    buffer_load_dwordx4 v[16:19], v43, s[12:15], 0 offen offset:96
    s_waitcnt vmcnt(0)
    v_cvt_pk_bf16_f32 v92, v92, v92
    v_and_b32 v92, 0xffff0000, v92
    v_cvt_pk_bf16_f32 v156, v156, v156
    v_and_b32 v156, 0xffff0000, v156
    v_sub_f32 v92, v92, v156
    v_cvt_pk_bf16_f32 v92, v92, v92
    v_and_b32 v92, 0xffff0000, v92
    v_lshlrev_b32 v20, 16, v8
    v_lshlrev_b32 v21, 16, v10
    v_add_f32 v92, v92, v20
    v_cvt_pk_bf16_f32 v92, v92, v92
    v_and_b32 v92, 0xffff0000, v92
    v_cndmask_b32 v22, 0, v12, s[36:37]
    v_cndmask_b32 v22, v22, v16, s[38:39]
    v_add_f32 v21, v21, v22
    v_cvt_pk_bf16_f32 v21, v21, v21
    v_and_b32 v21, 0xffff0000, v21
    v_add_f32 v92, v92, v21
    v_cvt_pk_bf16_f32 v93, v93, v93
    v_and_b32 v93, 0xffff0000, v93
    v_cvt_pk_bf16_f32 v157, v157, v157
    v_and_b32 v157, 0xffff0000, v157
    v_sub_f32 v93, v93, v157
    v_cvt_pk_bf16_f32 v93, v93, v93
    v_and_b32 v93, 0xffff0000, v93
    v_and_b32 v20, 0xffff0000, v8
    v_and_b32 v21, 0xffff0000, v10
    v_add_f32 v93, v93, v20
    v_cvt_pk_bf16_f32 v93, v93, v93
    v_and_b32 v93, 0xffff0000, v93
    v_cndmask_b32 v22, 0, v13, s[36:37]
    v_cndmask_b32 v22, v22, v17, s[38:39]
    v_add_f32 v21, v21, v22
    v_cvt_pk_bf16_f32 v21, v21, v21
    v_and_b32 v21, 0xffff0000, v21
    v_add_f32 v93, v93, v21
    v_cvt_pk_bf16_f32 v94, v94, v94
    v_and_b32 v94, 0xffff0000, v94
    v_cvt_pk_bf16_f32 v158, v158, v158
    v_and_b32 v158, 0xffff0000, v158
    v_sub_f32 v94, v94, v158
    v_cvt_pk_bf16_f32 v94, v94, v94
    v_and_b32 v94, 0xffff0000, v94
    v_lshlrev_b32 v20, 16, v9
    v_lshlrev_b32 v21, 16, v11
    v_add_f32 v94, v94, v20
    v_cvt_pk_bf16_f32 v94, v94, v94
    v_and_b32 v94, 0xffff0000, v94
    v_cndmask_b32 v22, 0, v14, s[36:37]
    v_cndmask_b32 v22, v22, v18, s[38:39]
    v_add_f32 v21, v21, v22
    v_cvt_pk_bf16_f32 v21, v21, v21
    v_and_b32 v21, 0xffff0000, v21
    v_add_f32 v94, v94, v21
    v_cvt_pk_bf16_f32 v95, v95, v95
    v_and_b32 v95, 0xffff0000, v95
    v_cvt_pk_bf16_f32 v159, v159, v159
    v_and_b32 v159, 0xffff0000, v159
    v_sub_f32 v95, v95, v159
    v_cvt_pk_bf16_f32 v95, v95, v95
    v_and_b32 v95, 0xffff0000, v95
    v_and_b32 v20, 0xffff0000, v9
    v_and_b32 v21, 0xffff0000, v11
    v_add_f32 v95, v95, v20
    v_cvt_pk_bf16_f32 v95, v95, v95
    v_and_b32 v95, 0xffff0000, v95
    v_cndmask_b32 v22, 0, v15, s[36:37]
    v_cndmask_b32 v22, v22, v19, s[38:39]
    v_add_f32 v21, v21, v22
    v_cvt_pk_bf16_f32 v21, v21, v21
    v_and_b32 v21, 0xffff0000, v21
    v_add_f32 v95, v95, v21
    v_cvt_pk_bf16_f32 v92, v92, v93
    v_cvt_pk_bf16_f32 v93, v94, v95
    buffer_store_dwordx2 v[92:93], v7, s[20:23], 0 offen offset:48
    buffer_load_dwordx2 v[8:9], v7, s[16:19], 0 offen offset:64
    buffer_load_dwordx2 v[10:11], v7, s[12:15], 0 offen offset:64
    buffer_load_dwordx4 v[12:15], v42, s[12:15], 0 offen offset:128
    buffer_load_dwordx4 v[16:19], v43, s[12:15], 0 offen offset:128
    s_waitcnt vmcnt(0)
    v_cvt_pk_bf16_f32 v112, v112, v112
    v_and_b32 v112, 0xffff0000, v112
    v_cvt_pk_bf16_f32 v176, v176, v176
    v_and_b32 v176, 0xffff0000, v176
    v_sub_f32 v112, v112, v176
    v_cvt_pk_bf16_f32 v112, v112, v112
    v_and_b32 v112, 0xffff0000, v112
    v_lshlrev_b32 v20, 16, v8
    v_lshlrev_b32 v21, 16, v10
    v_add_f32 v112, v112, v20
    v_cvt_pk_bf16_f32 v112, v112, v112
    v_and_b32 v112, 0xffff0000, v112
    v_cndmask_b32 v22, 0, v12, s[36:37]
    v_cndmask_b32 v22, v22, v16, s[38:39]
    v_add_f32 v21, v21, v22
    v_cvt_pk_bf16_f32 v21, v21, v21
    v_and_b32 v21, 0xffff0000, v21
    v_add_f32 v112, v112, v21
    v_cvt_pk_bf16_f32 v113, v113, v113
    v_and_b32 v113, 0xffff0000, v113
    v_cvt_pk_bf16_f32 v177, v177, v177
    v_and_b32 v177, 0xffff0000, v177
    v_sub_f32 v113, v113, v177
    v_cvt_pk_bf16_f32 v113, v113, v113
    v_and_b32 v113, 0xffff0000, v113
    v_and_b32 v20, 0xffff0000, v8
    v_and_b32 v21, 0xffff0000, v10
    v_add_f32 v113, v113, v20
    v_cvt_pk_bf16_f32 v113, v113, v113
    v_and_b32 v113, 0xffff0000, v113
    v_cndmask_b32 v22, 0, v13, s[36:37]
    v_cndmask_b32 v22, v22, v17, s[38:39]
    v_add_f32 v21, v21, v22
    v_cvt_pk_bf16_f32 v21, v21, v21
    v_and_b32 v21, 0xffff0000, v21
    v_add_f32 v113, v113, v21
    v_cvt_pk_bf16_f32 v114, v114, v114
    v_and_b32 v114, 0xffff0000, v114
    v_cvt_pk_bf16_f32 v178, v178, v178
    v_and_b32 v178, 0xffff0000, v178
    v_sub_f32 v114, v114, v178
    v_cvt_pk_bf16_f32 v114, v114, v114
    v_and_b32 v114, 0xffff0000, v114
    v_lshlrev_b32 v20, 16, v9
    v_lshlrev_b32 v21, 16, v11
    v_add_f32 v114, v114, v20
    v_cvt_pk_bf16_f32 v114, v114, v114
    v_and_b32 v114, 0xffff0000, v114
    v_cndmask_b32 v22, 0, v14, s[36:37]
    v_cndmask_b32 v22, v22, v18, s[38:39]
    v_add_f32 v21, v21, v22
    v_cvt_pk_bf16_f32 v21, v21, v21
    v_and_b32 v21, 0xffff0000, v21
    v_add_f32 v114, v114, v21
    v_cvt_pk_bf16_f32 v115, v115, v115
    v_and_b32 v115, 0xffff0000, v115
    v_cvt_pk_bf16_f32 v179, v179, v179
    v_and_b32 v179, 0xffff0000, v179
    v_sub_f32 v115, v115, v179
    v_cvt_pk_bf16_f32 v115, v115, v115
    v_and_b32 v115, 0xffff0000, v115
    v_and_b32 v20, 0xffff0000, v9
    v_and_b32 v21, 0xffff0000, v11
    v_add_f32 v115, v115, v20
    v_cvt_pk_bf16_f32 v115, v115, v115
    v_and_b32 v115, 0xffff0000, v115
    v_cndmask_b32 v22, 0, v15, s[36:37]
    v_cndmask_b32 v22, v22, v19, s[38:39]
    v_add_f32 v21, v21, v22
    v_cvt_pk_bf16_f32 v21, v21, v21
    v_and_b32 v21, 0xffff0000, v21
    v_add_f32 v115, v115, v21
    v_cvt_pk_bf16_f32 v112, v112, v113
    v_cvt_pk_bf16_f32 v113, v114, v115
    buffer_store_dwordx2 v[112:113], v7, s[20:23], 0 offen offset:64
    buffer_load_dwordx2 v[8:9], v7, s[16:19], 0 offen offset:80
    buffer_load_dwordx2 v[10:11], v7, s[12:15], 0 offen offset:80
    buffer_load_dwordx4 v[12:15], v42, s[12:15], 0 offen offset:160
    buffer_load_dwordx4 v[16:19], v43, s[12:15], 0 offen offset:160
    s_waitcnt vmcnt(0)
    v_cvt_pk_bf16_f32 v116, v116, v116
    v_and_b32 v116, 0xffff0000, v116
    v_cvt_pk_bf16_f32 v180, v180, v180
    v_and_b32 v180, 0xffff0000, v180
    v_sub_f32 v116, v116, v180
    v_cvt_pk_bf16_f32 v116, v116, v116
    v_and_b32 v116, 0xffff0000, v116
    v_lshlrev_b32 v20, 16, v8
    v_lshlrev_b32 v21, 16, v10
    v_add_f32 v116, v116, v20
    v_cvt_pk_bf16_f32 v116, v116, v116
    v_and_b32 v116, 0xffff0000, v116
    v_cndmask_b32 v22, 0, v12, s[36:37]
    v_cndmask_b32 v22, v22, v16, s[38:39]
    v_add_f32 v21, v21, v22
    v_cvt_pk_bf16_f32 v21, v21, v21
    v_and_b32 v21, 0xffff0000, v21
    v_add_f32 v116, v116, v21
    v_cvt_pk_bf16_f32 v117, v117, v117
    v_and_b32 v117, 0xffff0000, v117
    v_cvt_pk_bf16_f32 v181, v181, v181
    v_and_b32 v181, 0xffff0000, v181
    v_sub_f32 v117, v117, v181
    v_cvt_pk_bf16_f32 v117, v117, v117
    v_and_b32 v117, 0xffff0000, v117
    v_and_b32 v20, 0xffff0000, v8
    v_and_b32 v21, 0xffff0000, v10
    v_add_f32 v117, v117, v20
    v_cvt_pk_bf16_f32 v117, v117, v117
    v_and_b32 v117, 0xffff0000, v117
    v_cndmask_b32 v22, 0, v13, s[36:37]
    v_cndmask_b32 v22, v22, v17, s[38:39]
    v_add_f32 v21, v21, v22
    v_cvt_pk_bf16_f32 v21, v21, v21
    v_and_b32 v21, 0xffff0000, v21
    v_add_f32 v117, v117, v21
    v_cvt_pk_bf16_f32 v118, v118, v118
    v_and_b32 v118, 0xffff0000, v118
    v_cvt_pk_bf16_f32 v182, v182, v182
    v_and_b32 v182, 0xffff0000, v182
    v_sub_f32 v118, v118, v182
    v_cvt_pk_bf16_f32 v118, v118, v118
    v_and_b32 v118, 0xffff0000, v118
    v_lshlrev_b32 v20, 16, v9
    v_lshlrev_b32 v21, 16, v11
    v_add_f32 v118, v118, v20
    v_cvt_pk_bf16_f32 v118, v118, v118
    v_and_b32 v118, 0xffff0000, v118
    v_cndmask_b32 v22, 0, v14, s[36:37]
    v_cndmask_b32 v22, v22, v18, s[38:39]
    v_add_f32 v21, v21, v22
    v_cvt_pk_bf16_f32 v21, v21, v21
    v_and_b32 v21, 0xffff0000, v21
    v_add_f32 v118, v118, v21
    v_cvt_pk_bf16_f32 v119, v119, v119
    v_and_b32 v119, 0xffff0000, v119
    v_cvt_pk_bf16_f32 v183, v183, v183
    v_and_b32 v183, 0xffff0000, v183
    v_sub_f32 v119, v119, v183
    v_cvt_pk_bf16_f32 v119, v119, v119
    v_and_b32 v119, 0xffff0000, v119
    v_and_b32 v20, 0xffff0000, v9
    v_and_b32 v21, 0xffff0000, v11
    v_add_f32 v119, v119, v20
    v_cvt_pk_bf16_f32 v119, v119, v119
    v_and_b32 v119, 0xffff0000, v119
    v_cndmask_b32 v22, 0, v15, s[36:37]
    v_cndmask_b32 v22, v22, v19, s[38:39]
    v_add_f32 v21, v21, v22
    v_cvt_pk_bf16_f32 v21, v21, v21
    v_and_b32 v21, 0xffff0000, v21
    v_add_f32 v119, v119, v21
    v_cvt_pk_bf16_f32 v116, v116, v117
    v_cvt_pk_bf16_f32 v117, v118, v119
    buffer_store_dwordx2 v[116:117], v7, s[20:23], 0 offen offset:80
    buffer_load_dwordx2 v[8:9], v7, s[16:19], 0 offen offset:96
    buffer_load_dwordx2 v[10:11], v7, s[12:15], 0 offen offset:96
    buffer_load_dwordx4 v[12:15], v42, s[12:15], 0 offen offset:192
    buffer_load_dwordx4 v[16:19], v43, s[12:15], 0 offen offset:192
    s_waitcnt vmcnt(0)
    v_cvt_pk_bf16_f32 v120, v120, v120
    v_and_b32 v120, 0xffff0000, v120
    v_cvt_pk_bf16_f32 v184, v184, v184
    v_and_b32 v184, 0xffff0000, v184
    v_sub_f32 v120, v120, v184
    v_cvt_pk_bf16_f32 v120, v120, v120
    v_and_b32 v120, 0xffff0000, v120
    v_lshlrev_b32 v20, 16, v8
    v_lshlrev_b32 v21, 16, v10
    v_add_f32 v120, v120, v20
    v_cvt_pk_bf16_f32 v120, v120, v120
    v_and_b32 v120, 0xffff0000, v120
    v_cndmask_b32 v22, 0, v12, s[36:37]
    v_cndmask_b32 v22, v22, v16, s[38:39]
    v_add_f32 v21, v21, v22
    v_cvt_pk_bf16_f32 v21, v21, v21
    v_and_b32 v21, 0xffff0000, v21
    v_add_f32 v120, v120, v21
    v_cvt_pk_bf16_f32 v121, v121, v121
    v_and_b32 v121, 0xffff0000, v121
    v_cvt_pk_bf16_f32 v185, v185, v185
    v_and_b32 v185, 0xffff0000, v185
    v_sub_f32 v121, v121, v185
    v_cvt_pk_bf16_f32 v121, v121, v121
    v_and_b32 v121, 0xffff0000, v121
    v_and_b32 v20, 0xffff0000, v8
    v_and_b32 v21, 0xffff0000, v10
    v_add_f32 v121, v121, v20
    v_cvt_pk_bf16_f32 v121, v121, v121
    v_and_b32 v121, 0xffff0000, v121
    v_cndmask_b32 v22, 0, v13, s[36:37]
    v_cndmask_b32 v22, v22, v17, s[38:39]
    v_add_f32 v21, v21, v22
    v_cvt_pk_bf16_f32 v21, v21, v21
    v_and_b32 v21, 0xffff0000, v21
    v_add_f32 v121, v121, v21
    v_cvt_pk_bf16_f32 v122, v122, v122
    v_and_b32 v122, 0xffff0000, v122
    v_cvt_pk_bf16_f32 v186, v186, v186
    v_and_b32 v186, 0xffff0000, v186
    v_sub_f32 v122, v122, v186
    v_cvt_pk_bf16_f32 v122, v122, v122
    v_and_b32 v122, 0xffff0000, v122
    v_lshlrev_b32 v20, 16, v9
    v_lshlrev_b32 v21, 16, v11
    v_add_f32 v122, v122, v20
    v_cvt_pk_bf16_f32 v122, v122, v122
    v_and_b32 v122, 0xffff0000, v122
    v_cndmask_b32 v22, 0, v14, s[36:37]
    v_cndmask_b32 v22, v22, v18, s[38:39]
    v_add_f32 v21, v21, v22
    v_cvt_pk_bf16_f32 v21, v21, v21
    v_and_b32 v21, 0xffff0000, v21
    v_add_f32 v122, v122, v21
    v_cvt_pk_bf16_f32 v123, v123, v123
    v_and_b32 v123, 0xffff0000, v123
    v_cvt_pk_bf16_f32 v187, v187, v187
    v_and_b32 v187, 0xffff0000, v187
    v_sub_f32 v123, v123, v187
    v_cvt_pk_bf16_f32 v123, v123, v123
    v_and_b32 v123, 0xffff0000, v123
    v_and_b32 v20, 0xffff0000, v9
    v_and_b32 v21, 0xffff0000, v11
    v_add_f32 v123, v123, v20
    v_cvt_pk_bf16_f32 v123, v123, v123
    v_and_b32 v123, 0xffff0000, v123
    v_cndmask_b32 v22, 0, v15, s[36:37]
    v_cndmask_b32 v22, v22, v19, s[38:39]
    v_add_f32 v21, v21, v22
    v_cvt_pk_bf16_f32 v21, v21, v21
    v_and_b32 v21, 0xffff0000, v21
    v_add_f32 v123, v123, v21
    v_cvt_pk_bf16_f32 v120, v120, v121
    v_cvt_pk_bf16_f32 v121, v122, v123
    buffer_store_dwordx2 v[120:121], v7, s[20:23], 0 offen offset:96
    buffer_load_dwordx2 v[8:9], v7, s[16:19], 0 offen offset:112
    buffer_load_dwordx2 v[10:11], v7, s[12:15], 0 offen offset:112
    buffer_load_dwordx4 v[12:15], v42, s[12:15], 0 offen offset:224
    buffer_load_dwordx4 v[16:19], v43, s[12:15], 0 offen offset:224
    s_waitcnt vmcnt(0)
    v_cvt_pk_bf16_f32 v124, v124, v124
    v_and_b32 v124, 0xffff0000, v124
    v_cvt_pk_bf16_f32 v188, v188, v188
    v_and_b32 v188, 0xffff0000, v188
    v_sub_f32 v124, v124, v188
    v_cvt_pk_bf16_f32 v124, v124, v124
    v_and_b32 v124, 0xffff0000, v124
    v_lshlrev_b32 v20, 16, v8
    v_lshlrev_b32 v21, 16, v10
    v_add_f32 v124, v124, v20
    v_cvt_pk_bf16_f32 v124, v124, v124
    v_and_b32 v124, 0xffff0000, v124
    v_cndmask_b32 v22, 0, v12, s[36:37]
    v_cndmask_b32 v22, v22, v16, s[38:39]
    v_add_f32 v21, v21, v22
    v_cvt_pk_bf16_f32 v21, v21, v21
    v_and_b32 v21, 0xffff0000, v21
    v_add_f32 v124, v124, v21
    v_cvt_pk_bf16_f32 v125, v125, v125
    v_and_b32 v125, 0xffff0000, v125
    v_cvt_pk_bf16_f32 v189, v189, v189
    v_and_b32 v189, 0xffff0000, v189
    v_sub_f32 v125, v125, v189
    v_cvt_pk_bf16_f32 v125, v125, v125
    v_and_b32 v125, 0xffff0000, v125
    v_and_b32 v20, 0xffff0000, v8
    v_and_b32 v21, 0xffff0000, v10
    v_add_f32 v125, v125, v20
    v_cvt_pk_bf16_f32 v125, v125, v125
    v_and_b32 v125, 0xffff0000, v125
    v_cndmask_b32 v22, 0, v13, s[36:37]
    v_cndmask_b32 v22, v22, v17, s[38:39]
    v_add_f32 v21, v21, v22
    v_cvt_pk_bf16_f32 v21, v21, v21
    v_and_b32 v21, 0xffff0000, v21
    v_add_f32 v125, v125, v21
    v_cvt_pk_bf16_f32 v126, v126, v126
    v_and_b32 v126, 0xffff0000, v126
    v_cvt_pk_bf16_f32 v190, v190, v190
    v_and_b32 v190, 0xffff0000, v190
    v_sub_f32 v126, v126, v190
    v_cvt_pk_bf16_f32 v126, v126, v126
    v_and_b32 v126, 0xffff0000, v126
    v_lshlrev_b32 v20, 16, v9
    v_lshlrev_b32 v21, 16, v11
    v_add_f32 v126, v126, v20
    v_cvt_pk_bf16_f32 v126, v126, v126
    v_and_b32 v126, 0xffff0000, v126
    v_cndmask_b32 v22, 0, v14, s[36:37]
    v_cndmask_b32 v22, v22, v18, s[38:39]
    v_add_f32 v21, v21, v22
    v_cvt_pk_bf16_f32 v21, v21, v21
    v_and_b32 v21, 0xffff0000, v21
    v_add_f32 v126, v126, v21
    v_cvt_pk_bf16_f32 v127, v127, v127
    v_and_b32 v127, 0xffff0000, v127
    v_cvt_pk_bf16_f32 v191, v191, v191
    v_and_b32 v191, 0xffff0000, v191
    v_sub_f32 v127, v127, v191
    v_cvt_pk_bf16_f32 v127, v127, v127
    v_and_b32 v127, 0xffff0000, v127
    v_and_b32 v20, 0xffff0000, v9
    v_and_b32 v21, 0xffff0000, v11
    v_add_f32 v127, v127, v20
    v_cvt_pk_bf16_f32 v127, v127, v127
    v_and_b32 v127, 0xffff0000, v127
    v_cndmask_b32 v22, 0, v15, s[36:37]
    v_cndmask_b32 v22, v22, v19, s[38:39]
    v_add_f32 v21, v21, v22
    v_cvt_pk_bf16_f32 v21, v21, v21
    v_and_b32 v21, 0xffff0000, v21
    v_add_f32 v127, v127, v21
    v_cvt_pk_bf16_f32 v124, v124, v125
    v_cvt_pk_bf16_f32 v125, v126, v127
    buffer_store_dwordx2 v[124:125], v7, s[20:23], 0 offen offset:112
gemm2_kernel_end1:
    s_endpgm
.section .rodata,"a"
.p2align 6
.amdhsa_kernel ln_kernel
  .amdhsa_next_free_vgpr 64
  .amdhsa_next_free_sgpr 102
  .amdhsa_accum_offset 64
  .amdhsa_group_segment_fixed_size 0
  .amdhsa_kernarg_size 104
  .amdhsa_user_sgpr_count 2
  .amdhsa_user_sgpr_kernarg_segment_ptr 1
  .amdhsa_system_sgpr_workgroup_id_x 1
.end_amdhsa_kernel
.p2align 6
.amdhsa_kernel gemm1_kernel
  .amdhsa_next_free_vgpr 128
  .amdhsa_next_free_sgpr 102
  .amdhsa_accum_offset 128
  .amdhsa_group_segment_fixed_size 0
  .amdhsa_kernarg_size 104
  .amdhsa_user_sgpr_count 2
  .amdhsa_user_sgpr_kernarg_segment_ptr 1
  .amdhsa_system_sgpr_workgroup_id_x 1
.end_amdhsa_kernel
.p2align 6
.amdhsa_kernel gateup_kernel
  .amdhsa_next_free_vgpr 96
  .amdhsa_next_free_sgpr 102
  .amdhsa_accum_offset 96
  .amdhsa_group_segment_fixed_size 0
  .amdhsa_kernarg_size 104
  .amdhsa_user_sgpr_count 2
  .amdhsa_user_sgpr_kernarg_segment_ptr 1
  .amdhsa_system_sgpr_workgroup_id_x 1
.end_amdhsa_kernel
.p2align 6
.amdhsa_kernel down_kernel
  .amdhsa_next_free_vgpr 96
  .amdhsa_next_free_sgpr 102
  .amdhsa_accum_offset 96
  .amdhsa_group_segment_fixed_size 0
  .amdhsa_kernarg_size 104
  .amdhsa_user_sgpr_count 2
  .amdhsa_user_sgpr_kernarg_segment_ptr 1
  .amdhsa_system_sgpr_workgroup_id_x 1
.end_amdhsa_kernel
.p2align 6
.amdhsa_kernel gemm2_kernel
  .amdhsa_next_free_vgpr 224
  .amdhsa_next_free_sgpr 102
  .amdhsa_accum_offset 224
  .amdhsa_group_segment_fixed_size 0
  .amdhsa_kernarg_size 104
  .amdhsa_user_sgpr_count 2
  .amdhsa_user_sgpr_kernarg_segment_ptr 1
  .amdhsa_system_sgpr_workgroup_id_x 1
.end_amdhsa_kernel
```

```asm
; @launch grid=(256,1,1) block=(576,1,1) lds=159744
.amdgcn_target "amdgcn-amd-amdhsa--gfx950"
.text
.globl parallel_sum__spectral_fnet__moe_arch_mod__prompt_kernel
.p2align 12
.type parallel_sum__spectral_fnet__moe_arch_mod__prompt_kernel,@function
parallel_sum__spectral_fnet__moe_arch_mod__prompt_kernel:
    s_cmp_ge_u32 s2, 256
    s_cbranch_scc1 END
    s_load_dwordx2 s[4:5], s[0:1], 0
    s_load_dwordx2 s[28:29], s[0:1], 48
    s_load_dwordx2 s[8:9], s[0:1], 96
    s_load_dwordx2 s[12:13], s[0:1], 56
    s_load_dwordx2 s[16:17], s[0:1], 64
    s_load_dwordx2 s[20:21], s[0:1], 72
    s_load_dwordx2 s[24:25], s[0:1], 80
    v_lshrrev_b32 v2, 6, v0
    v_and_b32 v1, 63, v0
    s_and_b32 s33, s2, 7
    v_readfirstlane_b32 s32, v2
    s_lshr_b32 s38, s2, 4
    s_lshl3_add_u32 s36, s38, s33
    s_lshr_b32 s34, s2, 3
    s_and_b32 s35, s34, 1
    s_cmp_eq_u32 s36, 0
    s_cselect_b32 s38, 128, s36
    s_sub_u32 s37, 2048, s38
    s_mov_b32 s6, 4194304
    s_mov_b32 s7, 0x00020000
    s_mov_b32 s10, 3145728
    s_mov_b32 s11, 0x00020000
    s_mov_b32 s26, 4194304
    s_mov_b32 s27, 0x00020000
    s_cmp_eq_u32 s32, 8
    s_cbranch_scc1 COMM
    s_lshl_b32 s38, s32, 8
    s_add_u32 s40, s36, s38
    s_sub_u32 s38, s37, s38
    s_cmp_eq_u32 s35, 0
    s_cselect_b32 s41, s38, s40
    s_cselect_b32 s40, s40, s38
    s_lshl_b32 s42, s32, 11
    s_lshl_b32 s38, s35, 14
    s_add_u32 s42, s42, s38
    v_and_b32 v3, 32, v1
    v_lshlrev_b32 v2, 4, v1
    v_xor_b32 v2, v2, v3
    s_mov_b32 m0, s42
    s_lshl_b32 s38, s40, 11
    s_lshl_b32 s39, s41, 11
    s_mov_b32 s30, 2048
    s_mov_b32 s31, 0x00020000
    s_waitcnt lgkmcnt(0)
    buffer_load_dwordx4 v2, s[4:7], s38 offen lds
    buffer_load_dwordx4 v2, s[4:7], s38 offen offset:1024 lds
    buffer_load_dwordx4 v[4:7], v2, s[28:31], 0 offen
    buffer_load_dwordx4 v[8:11], v2, s[28:31], 0 offen offset:1024
    s_xor_b32 m0, s42, 16384
    s_nop 0
    buffer_load_dwordx4 v2, s[4:7], s39 offen lds
    buffer_load_dwordx4 v2, s[4:7], s39 offen offset:1024 lds
    s_cmp_lt_u32 s2, 224
    s_cselect_b32 s14, 7340032, 0
    s_mov_b32 s15, 0x00020000
    s_mov_b32 s18, s14
    s_mov_b32 s19, 0x00020000
    s_mov_b32 s22, s14
    s_mov_b32 s23, 0x00020000
    s_mul_i32 s46, s33, 28
    s_add_u32 s46, s46, s34
    s_mul_i32 s43, s32, 917504
    s_lshl_b32 s38, s46, 5
    s_add_u32 s43, s43, s38
    s_lshl_b32 s44, s46, 15
    s_lshl_b32 s38, s32, 8
    s_add_u32 s44, s44, s38
    s_lshl_b32 s45, s32, 12
    s_add_u32 s45, s45, 61440
    v_lshrrev_b32 v17, 1, v1
    v_and_b32 v17, 0x13, v17
    v_and_or_b32 v17, v1, 8, v17
    v_lshrrev_b32 v12, 2, v1
    v_and_or_b32 v17, v12, 4, v17
    v_mul_u32_u24 v17, 7168, v17
    v_and_b32 v18, 1, v1
    v_lshl_add_u32 v15, v18, 4, v17
    v_and_b32 v2, 15, v1
    v_lshrrev_b32 v3, 4, v1
    v_and_b32 v12, 3, v12
    v_and_b32 v13, 3, v1
    v_and_b32 v14, 1, v3
    v_lshlrev_b32 v17, 2, v3
    v_xor_b32 v17, v17, v2
    v_lshlrev_b32 v17, 4, v17
    v_lshl_add_u32 v16, v3, 11, v17
    s_add_u32 m0, s45, 0
    s_add_u32 s47, s43, 0
    buffer_load_dwordx4 v15, s[12:15], s47 offen lds
    s_add_u32 m0, s45, 32768
    s_add_u32 s47, s43, 0
    buffer_load_dwordx4 v15, s[16:19], s47 offen lds
    s_add_u32 m0, s45, 1024
    s_add_u32 s47, s43, 229376
    buffer_load_dwordx4 v15, s[12:15], s47 offen lds
    s_add_u32 m0, s45, 33792
    s_add_u32 s47, s43, 229376
    buffer_load_dwordx4 v15, s[16:19], s47 offen lds
    s_lshl_b32 s48, s35, 3
    s_cmp_eq_u32 s35, 0
    s_cselect_b32 s38, 1, 99
    v_lshrrev_b32 v17, 1, v2
    v_add_u32 v17, s48, v17
    v_and_b32 v30, 1, v2
    v_cmp_ne_u32 vcc, s38, v2
    s_nop 1
    v_cndmask_b32 v17, 16, v17, vcc
    v_cndmask_b32 v30, 0, v30, vcc
    v_cvt_f32_u32 v17, v17
    v_cvt_f32_u32 v30, v30
    v_cvt_f32_u32 v31, v3
    v_mul_f32 v17, 0x3d000000, v17
    v_mul_f32 v30, 0x3e800000, v30
    v_mul_f32 v32, 4.0, v31
    v_add_f32 v31, v32, v32
    v_fma_f32 v22, v17, v31, v30
    v_add_f32 v23, v22, v17
    v_add_f32 v24, v23, v17
    v_add_f32 v25, v24, v17
    v_add_f32 v26, v25, v17
    v_add_f32 v27, v26, v17
    v_add_f32 v28, v27, v17
    v_add_f32 v29, v28, v17
    v_cos_f32 v22, v22
    v_cos_f32 v23, v23
    s_nop 0
    v_cvt_pk_bf16_f32 v18, v22, v23
    v_cos_f32 v24, v24
    v_cos_f32 v25, v25
    s_nop 0
    v_cvt_pk_bf16_f32 v19, v24, v25
    v_cos_f32 v26, v26
    v_cos_f32 v27, v27
    s_nop 0
    v_cvt_pk_bf16_f32 v20, v26, v27
    v_cos_f32 v28, v28
    v_cos_f32 v29, v29
    s_nop 0
    v_cvt_pk_bf16_f32 v21, v28, v29
    s_add_u32 s38, s38, -1
    v_cmp_ne_u32 vcc, s38, v2
    v_mov_b32 v33, 0xc2000000
    v_mov_b32 v34, 0x3a800000
    v_cndmask_b32 v33, v33, 0, vcc
    s_add_u32 s48, s48, s32
    s_cmp_eq_u32 s48, 0
    s_cselect_b32 s38, 16, s48
    s_add_u32 s38, s38, 992
    v_lshl_add_u32 v17, v2, 5, s48
    v_mov_b32 v31, 512
    v_cmp_eq_u32 vcc, 0, v17
    s_nop 1
    v_cndmask_b32 v17, v17, v31, vcc
    v_cvt_f32_u32 v17, v17
    v_mul_f32 v17, v34, v17
    v_mul_f32 v22, v17, v32
    v_fmamk_f32 v26, v17, 0x41800000, v22
    v_add_f32 v23, v22, v17
    v_add_f32 v27, v26, v17
    v_add_f32 v24, v23, v17
    v_add_f32 v28, v27, v17
    v_add_f32 v25, v24, v17
    v_add_f32 v29, v28, v17
    v_sin_f32 v60, v22
    v_sin_f32 v61, v23
    v_cos_f32 v22, v22
    v_cos_f32 v23, v23
    v_cvt_pk_bf16_f32 v40, v60, v61
    v_cvt_pk_bf16_f32 v36, v22, v23
    v_sin_f32 v60, v24
    v_sin_f32 v61, v25
    v_cos_f32 v24, v24
    v_cos_f32 v25, v25
    v_cvt_pk_bf16_f32 v41, v60, v61
    v_cvt_pk_bf16_f32 v37, v24, v25
    v_sin_f32 v60, v26
    v_sin_f32 v61, v27
    v_cos_f32 v26, v26
    v_cos_f32 v27, v27
    v_cvt_pk_bf16_f32 v42, v60, v61
    v_cvt_pk_bf16_f32 v38, v26, v27
    v_sin_f32 v60, v28
    v_sin_f32 v61, v29
    v_cos_f32 v28, v28
    v_cos_f32 v29, v29
    v_cvt_pk_bf16_f32 v43, v60, v61
    v_cvt_pk_bf16_f32 v39, v28, v29
    v_xor_b32 v44, 0x80008000, v40
    v_xor_b32 v45, 0x80008000, v41
    v_xor_b32 v46, 0x80008000, v42
    v_xor_b32 v47, 0x80008000, v43
    v_lshlrev_b32 v17, 5, v2
    v_sub_u32 v17, s38, v17
    v_cvt_f32_u32 v17, v17
    v_mul_f32 v17, v34, v17
    v_mul_f32 v22, v17, v32
    v_fmamk_f32 v26, v17, 0x41800000, v22
    v_add_f32 v23, v22, v17
    v_add_f32 v27, v26, v17
    v_add_f32 v24, v23, v17
    v_add_f32 v28, v27, v17
    v_add_f32 v25, v24, v17
    v_add_f32 v29, v28, v17
    v_sin_f32 v60, v22
    v_sin_f32 v61, v23
    v_cos_f32 v22, v22
    v_cos_f32 v23, v23
    v_cvt_pk_bf16_f32 v52, v60, v61
    v_cvt_pk_bf16_f32 v48, v22, v23
    v_sin_f32 v60, v24
    v_sin_f32 v61, v25
    v_cos_f32 v24, v24
    v_cos_f32 v25, v25
    v_cvt_pk_bf16_f32 v53, v60, v61
    v_cvt_pk_bf16_f32 v49, v24, v25
    v_sin_f32 v60, v26
    v_sin_f32 v61, v27
    v_cos_f32 v26, v26
    v_cos_f32 v27, v27
    v_cvt_pk_bf16_f32 v54, v60, v61
    v_cvt_pk_bf16_f32 v50, v26, v27
    v_sin_f32 v60, v28
    v_sin_f32 v61, v29
    v_cos_f32 v28, v28
    v_cos_f32 v29, v29
    v_cvt_pk_bf16_f32 v55, v60, v61
    v_cvt_pk_bf16_f32 v51, v28, v29
    v_xor_b32 v56, 0x80008000, v48
    v_xor_b32 v57, 0x80008000, v49
    v_xor_b32 v58, 0x80008000, v50
    v_xor_b32 v59, 0x80008000, v51
    v_lshrrev_b32 v17, 1, v2
    v_and_b32 v30, 1, v2
    v_cvt_f32_u32 v17, v17
    v_cvt_f32_u32 v31, v30
    v_cmp_gt_u32 vcc, 32, v1
    v_mov_b32 v35, 0xbe800000
    v_mul_f32 v17, 0x3e000000, v17
    s_cmp_eq_u32 s36, 0
    s_cbranch_scc1 BFQ0
    v_mul_f32 v30, 0x3e800000, v31
    v_cndmask_b32 v35, -v35, v35, vcc
    s_branch BFGO
BFQ0:
    v_lshrrev_b32 v31, 5, v1
    v_cmp_eq_u32 s[50:51], v31, v30
    v_mul_f32 v30, 0x40f00000, v17
    v_cndmask_b32 v30, v30, 0, vcc
    v_cndmask_b32 v17, -v17, v17, vcc
    v_cndmask_b32 v30, -v35, v30, s[50:51]
    v_cndmask_b32 v17, 0, v17, s[50:51]
    v_cndmask_b32 v35, 0, v35, s[50:51]
BFGO:
    v_cvt_f32_u32 v31, v14
    v_mul_f32 v31, 4.0, v31
    v_fma_f32 v22, v17, v31, v30
    v_add_f32 v23, v22, v17
    v_add_f32 v24, v23, v17
    v_add_f32 v25, v24, v17
    v_add_f32 v26, v22, v35
    v_add_f32 v27, v23, v35
    v_add_f32 v28, v24, v35
    v_add_f32 v29, v25, v35
    v_cos_f32 v22, v22
    v_cos_f32 v23, v23
    v_cos_f32 v24, v24
    v_cos_f32 v25, v25
    v_cos_f32 v26, v26
    v_cos_f32 v27, v27
    v_cos_f32 v28, v28
    v_cos_f32 v29, v29
    v_lshl_add_u32 v32, v1, 4, s42
    v_xor_b32 v35, 16384, v32
    s_lshl_b32 s38, s32, 11
    v_lshl_add_u32 v31, v3, 9, s38
    v_lshl_add_u32 v31, v12, 6, v31
    v_lshl_add_u32 v31, v14, 5, v31
    v_lshl_add_u32 v60, v13, 3, v31
    v_xor_b32 v61, 32, v60
    s_cmp_lt_u32 s32, 4
    s_cselect_b32 s38, 0, 3
    s_lshl_b32 s39, s32, 6
    s_add_u32 s39, s39, 32768
    v_mul_u32_u24 v17, 1040, v2
    v_xor_b32 v31, s38, v3
    v_add_u32 v17, s39, v17
    v_lshl_add_u32 v62, v31, 4, v17
    v_xor_b32 v31, 2, v31
    v_lshl_add_u32 v63, v31, 4, v17
    s_mul_i32 s38, s32, 2080
    s_add_u32 s38, s38, 32768
    v_sub_u32 v31, 4, v12
    v_and_b32 v31, 3, v31
    v_xor_b32 v31, v31, v3
    v_lshl_add_u32 v17, v2, 6, s38
    v_lshl_add_u32 v66, v31, 4, v17
    s_lshl_b32 s38, s32, 2
    s_add_u32 s38, s38, 58112
    v_mov_b32 v64, s38
    s_lshl_b32 s39, s35, 5
    v_add_u32 v65, s39, v64
    v_lshlrev_b32 v71, 4, v3
    v_lshlrev_b32 v31, 8, v3
    v_lshl_add_u32 v31, v2, 3, v31
    s_mul_i32 s38, s32, 1088
    s_add_u32 s38, s38, 49408
    v_add_u32 v67, s38, v31
    s_sub_u32 s38, 8, s32
    s_and_b32 s38, s38, 7
    s_mul_i32 s38, s38, 1088
    s_add_u32 s38, s38, 49412
    v_add_u32 v68, s38, v31
    s_lshl_b32 s38, s32, 7
    s_add_u32 s38, s38, 49408
    v_mul_u32_u24 v31, 1088, v12
    v_lshl_add_u32 v17, v3, 2, v13
    v_add_u32 v31, s38, v31
    v_lshl_add_u32 v69, v17, 3, v31
    v_lshrrev_b32 v31, 2, v1
    v_lshlrev_b32 v31, 14, v31
    v_lshl_add_u32 v70, v13, 4, v31
    s_lshl_b32 s49, s32, 18
    s_lshl_b32 s38, s36, 7
    s_add_u32 s49, s49, s38
    s_lshl_b32 s38, s35, 6
    s_add_u32 s49, s49, s38
    v_mov_b32 v17, 0
    v_mov_b32 v30, 0
    v_mov_b32 v31, 0
    v_mov_b32 v72, 0
    v_mov_b32 v73, 0
    v_mov_b32 v74, 0
    s_waitcnt vmcnt(6)
    ds_read_b128 v[76:79], v32
    ds_read_b128 v[80:83], v32 offset:1024
    s_waitcnt vmcnt(4)
    ds_read_b128 v[84:87], v35
    ds_read_b128 v[88:91], v35 offset:1024
    ds_read_b64_tr_b16 v[92:93], v60 offset:0
    ds_read_b64_tr_b16 v[94:95], v60 offset:256
    ds_read_b64_tr_b16 v[96:97], v61 offset:0
    ds_read_b64_tr_b16 v[98:99], v61 offset:256
    ds_read_b64_tr_b16 v[100:101], v60 offset:16384
    ds_read_b64_tr_b16 v[102:103], v60 offset:16640
    ds_read_b64_tr_b16 v[104:105], v61 offset:16384
    ds_read_b64_tr_b16 v[106:107], v61 offset:16640
    v_dot2c_f32_bf16 v72, 0x3f803f80, v4
    v_dot2c_f32_bf16 v72, 0x3f803f80, v5
    v_dot2c_f32_bf16 v72, 0x3f803f80, v6
    v_dot2c_f32_bf16 v72, 0x3f803f80, v7
    v_dot2c_f32_bf16 v72, 0x3f803f80, v8
    v_dot2c_f32_bf16 v72, 0x3f803f80, v9
    v_dot2c_f32_bf16 v72, 0x3f803f80, v10
    v_dot2c_f32_bf16 v72, 0x3f803f80, v11
    s_waitcnt lgkmcnt(10)
    v_dot2c_f32_bf16 v17, 0x3f803f80, v76
    v_dot2c_f32_bf16 v30, v76, v76
    v_dot2c_f32_bf16 v31, v76, v4
    v_dot2c_f32_bf16 v17, 0x3f803f80, v77
    v_dot2c_f32_bf16 v30, v77, v77
    v_dot2c_f32_bf16 v31, v77, v5
    v_dot2c_f32_bf16 v17, 0x3f803f80, v78
    v_dot2c_f32_bf16 v30, v78, v78
    v_dot2c_f32_bf16 v31, v78, v6
    v_dot2c_f32_bf16 v17, 0x3f803f80, v79
    v_dot2c_f32_bf16 v30, v79, v79
    v_dot2c_f32_bf16 v31, v79, v7
    v_dot2c_f32_bf16 v17, 0x3f803f80, v80
    v_dot2c_f32_bf16 v30, v80, v80
    v_dot2c_f32_bf16 v31, v80, v8
    v_dot2c_f32_bf16 v17, 0x3f803f80, v81
    v_dot2c_f32_bf16 v30, v81, v81
    v_dot2c_f32_bf16 v31, v81, v9
    v_dot2c_f32_bf16 v17, 0x3f803f80, v82
    v_dot2c_f32_bf16 v30, v82, v82
    v_dot2c_f32_bf16 v31, v82, v10
    v_dot2c_f32_bf16 v17, 0x3f803f80, v83
    v_dot2c_f32_bf16 v30, v83, v83
    v_dot2c_f32_bf16 v31, v83, v11
    s_nop 1
    v_permlane32_swap_b32 v17, v30
    v_permlane32_swap_b32 v31, v72
    v_add_f32 v17, v17, v30
    v_add_f32 v31, v31, v72
    s_nop 1
    v_permlane16_swap_b32 v17, v31
    v_add_f32 v17, v17, v31
    s_nop 1
    v_add_f32_dpp v17, v17, v17 row_ror:8 row_mask:0xf bank_mask:0xf
    s_nop 1
    v_add_f32_dpp v17, v17, v17 row_ror:4 row_mask:0xf bank_mask:0xf
    s_nop 1
    v_add_f32_dpp v17, v17, v17 row_ror:2 row_mask:0xf bank_mask:0xf
    s_nop 1
    v_add_f32_dpp v17, v17, v17 row_ror:1 row_mask:0xf bank_mask:0xf
    s_nop 0
    v_readlane_b32 s52, v17, 0
    v_readlane_b32 s53, v17, 32
    v_readlane_b32 s54, v17, 16
    v_readlane_b32 s55, v17, 48
    v_mul_f32 v75, s52, v34
    v_mul_f32 v30, s53, v34
    v_mov_b32 v31, s54
    v_fma_f32 v30, -v75, v75, v30
    v_fma_f32 v31, -v75, s55, v31
    v_max_f32 v30, 0, v30
    v_add_f32 v30, 0x3727c5ac, v30
    v_rsq_f32 v108, v30
    s_nop 0
    v_mul_f32 v31, v31, v108
    v_ashrrev_i32 v30, 31, v31
    v_or_b32 v30, 0x80000000, v30
    v_xor_b32 v30, v31, v30
    v_and_b32 v30, 0xfffff800, v30
    v_or_b32 v30, s40, v30
    s_mov_b64 exec, 1
    ds_write2_b32 v64, v30, v75 offset0:16 offset1:40
    ds_write_b32 v65, v108
    s_mov_b64 exec, -1
    s_waitcnt lgkmcnt(0)
    s_barrier
    v_dot2c_f32_bf16 v73, 0x3f803f80, v84
    v_dot2c_f32_bf16 v74, v84, v84
    v_dot2c_f32_bf16 v73, 0x3f803f80, v85
    v_dot2c_f32_bf16 v74, v85, v85
    v_dot2c_f32_bf16 v73, 0x3f803f80, v86
    v_dot2c_f32_bf16 v74, v86, v86
    v_dot2c_f32_bf16 v73, 0x3f803f80, v87
    v_dot2c_f32_bf16 v74, v87, v87
    v_dot2c_f32_bf16 v73, 0x3f803f80, v88
    v_dot2c_f32_bf16 v74, v88, v88
    v_dot2c_f32_bf16 v73, 0x3f803f80, v89
    v_dot2c_f32_bf16 v74, v89, v89
    v_dot2c_f32_bf16 v73, 0x3f803f80, v90
    v_dot2c_f32_bf16 v74, v90, v90
    v_dot2c_f32_bf16 v73, 0x3f803f80, v91
    v_dot2c_f32_bf16 v74, v91, v91
    s_nop 2
    v_permlane32_swap_b32 v73, v74
    v_mul_f32 v110, v33, v75
    v_mul_f32 v111, v33, v75
    v_mul_f32 v112, v33, v75
    v_mul_f32 v113, v33, v75
    v_add_f32 v73, v73, v74
    v_mov_b32 v74, v73
    v_mfma_f32_16x16x32_bf16 v[118:121], v[92:95], v[18:21], v[110:113]
    s_nop 0
    v_permlane16_swap_b32 v73, v74
    v_mfma_f32_16x16x32_bf16 v[122:125], v[96:99], v[18:21], v[110:113]
    v_add_f32 v73, v73, v74
    s_nop 1
    v_add_f32_dpp v73, v73, v73 row_ror:8 row_mask:0xf bank_mask:0xf
    s_nop 1
    v_add_f32_dpp v73, v73, v73 row_ror:4 row_mask:0xf bank_mask:0xf
    s_nop 1
    v_add_f32_dpp v73, v73, v73 row_ror:2 row_mask:0xf bank_mask:0xf
    s_nop 1
    v_add_f32_dpp v73, v73, v73 row_ror:1 row_mask:0xf bank_mask:0xf
    s_nop 0
    v_readlane_b32 s52, v73, 0
    v_readlane_b32 s53, v73, 32
    v_cvt_pk_bf16_f32 v134, v118, v119
    v_cvt_pk_bf16_f32 v135, v120, v121
    v_cvt_pk_bf16_f32 v136, v122, v123
    v_cvt_pk_bf16_f32 v137, v124, v125
    v_mul_f32 v73, s52, v34
    v_mul_f32 v74, s53, v34
    ds_write_b128 v62, v[134:137]
    v_mul_f32 v114, v33, v73
    v_mul_f32 v115, v33, v73
    v_mul_f32 v116, v33, v73
    v_mul_f32 v117, v33, v73
    v_fma_f32 v74, -v73, v73, v74
    s_nop 0
    v_mfma_f32_16x16x32_bf16 v[126:129], v[100:103], v[18:21], v[114:117]
    v_mfma_f32_16x16x32_bf16 v[130:133], v[104:107], v[18:21], v[114:117]
    v_max_f32 v74, 0, v74
    v_add_f32 v74, 0x3727c5ac, v74
    v_rsq_f32 v74, v74
    v_xor_b32 v65, 32, v65
    s_mov_b64 exec, 1
    ds_write_b32 v65, v74
    s_mov_b64 exec, -1
    v_cvt_pk_bf16_f32 v138, v126, v127
    v_cvt_pk_bf16_f32 v139, v128, v129
    v_cvt_pk_bf16_f32 v140, v130, v131
    v_cvt_pk_bf16_f32 v141, v132, v133
    ds_write_b128 v63, v[138:141] offset:512
    s_waitcnt lgkmcnt(0)
    s_barrier
    ds_read_b128 v[4:7], v66
    ds_read_b128 v[8:11], v66 offset:1040
    ds_read_b128 v[18:21], v71 offset:58112
    s_waitcnt lgkmcnt(1)
    s_cmp_eq_u32 s48, 0
    s_cbranch_scc1 SPECC
    v_mfma_f32_16x16x32_bf16 v[30:33], v[4:7], v[36:39], 0
    v_mfma_f32_16x16x32_bf16 v[60:63], v[4:7], v[44:47], 0
    v_mfma_f32_16x16x32_bf16 v[72:75], v[4:7], v[48:51], 0
    v_mfma_f32_16x16x32_bf16 v[76:79], v[4:7], v[52:55], 0
    v_mfma_f32_16x16x32_bf16 v[30:33], v[8:11], v[40:43], v[30:33]
    v_mfma_f32_16x16x32_bf16 v[60:63], v[8:11], v[36:39], v[60:63]
    v_mfma_f32_16x16x32_bf16 v[72:75], v[8:11], v[52:55], v[72:75]
    v_mfma_f32_16x16x32_bf16 v[76:79], v[8:11], v[56:59], v[76:79]
SPECD:
    s_waitcnt lgkmcnt(0)
    v_mul_f32 v22, v22, v18
    v_mul_f32 v23, v23, v19
    v_mul_f32 v24, v24, v20
    v_mul_f32 v25, v25, v21
    v_mul_f32 v26, v26, v18
    v_mul_f32 v27, v27, v19
    v_mul_f32 v28, v28, v20
    v_mul_f32 v29, v29, v21
    v_cvt_pk_bf16_f32 v80, v22, v23
    v_cvt_pk_bf16_f32 v81, v24, v25
    v_cvt_pk_bf16_f32 v82, v26, v27
    v_cvt_pk_bf16_f32 v83, v28, v29
    v_cvt_pk_bf16_f32 v84, v30, v31
    v_cvt_pk_bf16_f32 v85, v32, v33
    v_cvt_pk_bf16_f32 v86, v60, v61
    v_cvt_pk_bf16_f32 v87, v62, v63
    s_nop 1
    v_mfma_f32_16x16x32_bf16 v[4:7], v[80:83], v[84:87], 0
    v_cvt_pk_bf16_f32 v88, v72, v73
    v_cvt_pk_bf16_f32 v89, v74, v75
    v_cvt_pk_bf16_f32 v90, v76, v77
    v_cvt_pk_bf16_f32 v91, v78, v79
    s_nop 1
    v_mfma_f32_16x16x32_bf16 v[8:11], v[80:83], v[88:91], 0
    s_nop 0
    v_cvt_pk_bf16_f32 v84, v4, v5
    v_cvt_pk_bf16_f32 v85, v6, v7
    ds_write2_b32 v67, v84, v85 offset1:32
    s_nop 3
    v_cvt_pk_bf16_f32 v88, v8, v9
    v_cvt_pk_bf16_f32 v89, v10, v11
    ds_write2_b32 v68, v88, v89 offset1:32
    s_waitcnt lgkmcnt(0)
    s_barrier
    ds_read_b64_tr_b16 v[80:81], v69
    ds_read_b64_tr_b16 v[82:83], v69 offset:4352
    s_and_b32 s56, s34, 15
    s_lshr_b32 s57, s34, 4
    s_lshl3_add_u32 s38, s57, s32
    s_lshl_b32 s38, s38, 7
    s_add_u32 s38, s38, s33
    v_lshl_add_u32 v17, v2, 3, s38
    v_sub_u32 v35, 2048, v17
    v_and_b32 v35, 2047, v35
    s_waitcnt lgkmcnt(0)
    buffer_store_dwordx4 v[80:83], v70, s[8:11], s49 offen sc1
    s_lshl_b32 s38, s56, 6
    v_lshl_add_u32 v94, v3, 4, s38
    v_lshl_add_u32 v64, v17, 11, v94
    v_sub_u32 v94, 2032, v94
    v_lshl_add_u32 v65, v35, 11, v94
    buffer_load_dwordx4 v[96:99], v64, s[4:7], 0 offen
    buffer_load_dwordx4 v[100:103], v65, s[4:7], 0 offen
    s_add_u32 m0, s45, 2048
    s_add_u32 s47, s43, 458752
    buffer_load_dwordx4 v15, s[12:15], s47 offen lds
    s_add_u32 m0, s45, 34816
    s_add_u32 s47, s43, 458752
    buffer_load_dwordx4 v15, s[16:19], s47 offen lds
    v_and_b32 v94, 7, v17
    v_and_b32 v95, 0x7f8, v17
    v_lshl_add_u32 v92, v94, 11, v95
    v_and_b32 v94, 7, v35
    v_and_b32 v95, 0x7f8, v35
    v_lshl_add_u32 v93, v94, 11, v95
    v_cvt_f32_u32 v71, v17
    v_lshrrev_b32 v94, 5, v1
    v_lshlrev_b32 v95, 1, v14
    v_lshl_add_u32 v94, v94, 3, v95
    v_mul_f32 v71, 0x3a000000, v71
    v_cvt_f32_u32 v94, v94
    v_mul_f32 v5, 0x41800000, v71
    v_mul_f32 v6, v71, v94
    v_add_f32 v7, v6, v71
    v_fma_f32 v8, v71, 4.0, v6
    v_fma_f32 v9, v71, 4.0, v7
    v_cos_f32 v18, v6
    v_sin_f32 v104, v6
    v_cos_f32 v19, v7
    v_sin_f32 v105, v7
    v_cos_f32 v20, v8
    v_sin_f32 v106, v8
    v_cos_f32 v21, v9
    v_sin_f32 v107, v9
    v_add_f32 v6, v6, v5
    v_cvt_pk_bf16_f32 v104, v18, v104
    v_add_f32 v7, v7, v5
    v_cvt_pk_bf16_f32 v105, v19, v105
    v_add_f32 v8, v8, v5
    v_cvt_pk_bf16_f32 v106, v20, v106
    v_add_f32 v9, v9, v5
    v_cvt_pk_bf16_f32 v107, v21, v107
    v_cos_f32 v18, v6
    v_sin_f32 v108, v6
    v_cos_f32 v19, v7
    v_sin_f32 v109, v7
    v_cos_f32 v20, v8
    v_sin_f32 v110, v8
    v_cos_f32 v21, v9
    v_sin_f32 v111, v9
    v_add_f32 v6, v6, v5
    v_cvt_pk_bf16_f32 v108, v18, v108
    v_add_f32 v7, v7, v5
    v_cvt_pk_bf16_f32 v109, v19, v109
    v_add_f32 v8, v8, v5
    v_cvt_pk_bf16_f32 v110, v20, v110
    v_add_f32 v9, v9, v5
    v_cvt_pk_bf16_f32 v111, v21, v111
    v_cos_f32 v18, v6
    v_sin_f32 v112, v6
    v_cos_f32 v19, v7
    v_sin_f32 v113, v7
    v_cos_f32 v20, v8
    v_sin_f32 v114, v8
    v_cos_f32 v21, v9
    v_sin_f32 v115, v9
    v_add_f32 v6, v6, v5
    v_cvt_pk_bf16_f32 v112, v18, v112
    v_add_f32 v7, v7, v5
    v_cvt_pk_bf16_f32 v113, v19, v113
    v_add_f32 v8, v8, v5
    v_cvt_pk_bf16_f32 v114, v20, v114
    v_add_f32 v9, v9, v5
    v_cvt_pk_bf16_f32 v115, v21, v115
    s_add_u32 m0, s45, 3072
    s_add_u32 s47, s43, 688128
    buffer_load_dwordx4 v15, s[12:15], s47 offen lds
    v_cos_f32 v18, v6
    v_sin_f32 v116, v6
    v_cos_f32 v19, v7
    v_sin_f32 v117, v7
    v_cos_f32 v20, v8
    v_sin_f32 v118, v8
    v_cos_f32 v21, v9
    v_sin_f32 v119, v9
    v_add_f32 v6, v6, v5
    v_cvt_pk_bf16_f32 v116, v18, v116
    v_add_f32 v7, v7, v5
    v_cvt_pk_bf16_f32 v117, v19, v117
    v_add_f32 v8, v8, v5
    v_cvt_pk_bf16_f32 v118, v20, v118
    v_add_f32 v9, v9, v5
    v_cvt_pk_bf16_f32 v119, v21, v119
    v_cos_f32 v18, v6
    v_sin_f32 v120, v6
    v_cos_f32 v19, v7
    v_sin_f32 v121, v7
    v_cos_f32 v20, v8
    v_sin_f32 v122, v8
    v_cos_f32 v21, v9
    v_sin_f32 v123, v9
    v_add_f32 v6, v6, v5
    v_cvt_pk_bf16_f32 v120, v18, v120
    v_add_f32 v7, v7, v5
    v_cvt_pk_bf16_f32 v121, v19, v121
    v_add_f32 v8, v8, v5
    v_cvt_pk_bf16_f32 v122, v20, v122
    v_add_f32 v9, v9, v5
    v_cvt_pk_bf16_f32 v123, v21, v123
    s_add_u32 m0, s45, 35840
    s_add_u32 s47, s43, 688128
    buffer_load_dwordx4 v15, s[16:19], s47 offen lds
    v_cos_f32 v18, v6
    v_sin_f32 v124, v6
    v_cos_f32 v19, v7
    v_sin_f32 v125, v7
    v_cos_f32 v20, v8
    v_sin_f32 v126, v8
    v_cos_f32 v21, v9
    v_sin_f32 v127, v9
    v_add_f32 v6, v6, v5
    v_cvt_pk_bf16_f32 v124, v18, v124
    v_add_f32 v7, v7, v5
    v_cvt_pk_bf16_f32 v125, v19, v125
    v_add_f32 v8, v8, v5
    v_cvt_pk_bf16_f32 v126, v20, v126
    v_add_f32 v9, v9, v5
    v_cvt_pk_bf16_f32 v127, v21, v127
    v_cos_f32 v18, v6
    v_sin_f32 v128, v6
    v_cos_f32 v19, v7
    v_sin_f32 v129, v7
    v_cos_f32 v20, v8
    v_sin_f32 v130, v8
    v_cos_f32 v21, v9
    v_sin_f32 v131, v9
    v_add_f32 v6, v6, v5
    v_cvt_pk_bf16_f32 v128, v18, v128
    v_add_f32 v7, v7, v5
    v_cvt_pk_bf16_f32 v129, v19, v129
    v_add_f32 v8, v8, v5
    v_cvt_pk_bf16_f32 v130, v20, v130
    v_add_f32 v9, v9, v5
    v_cvt_pk_bf16_f32 v131, v21, v131
    v_cos_f32 v18, v6
    v_sin_f32 v132, v6
    v_cos_f32 v19, v7
    v_sin_f32 v133, v7
    v_cos_f32 v20, v8
    v_sin_f32 v134, v8
    v_cos_f32 v21, v9
    v_sin_f32 v135, v9
    v_cvt_pk_bf16_f32 v132, v18, v132
    v_cvt_pk_bf16_f32 v133, v19, v133
    v_cvt_pk_bf16_f32 v134, v20, v134
    v_cvt_pk_bf16_f32 v135, v21, v135
    v_and_b32 v94, 1, v2
    v_lshlrev_b32 v94, 31, v94
    v_or_b32 v94, 0x3f803f80, v94
    v_cmp_gt_u32 vcc, 16, v1
    s_nop 1
    v_cndmask_b32 v104, v104, v94, vcc
    s_lshl_b32 s38, s33, 18
    s_lshl_b32 s39, s32, 11
    s_add_u32 s38, s38, s39
    s_lshl_b32 s58, s56, 14
    s_add_u32 s58, s58, s38
    s_add_u32 s59, s56, 1
    s_and_b32 s59, s59, 15
    s_lshl_b32 s59, s59, 14
    s_add_u32 s59, s59, s38
    v_lshrrev_b32 v18, 2, v1
    v_and_b32 v19, 1, v1
    v_bfe_u32 v20, v1, 1, 1
    v_lshlrev_b32 v94, 7, v18
    v_lshl_add_u32 v4, v13, 4, v94
    v_lshl_add_u32 v5, v19, 4, v94
    s_mul_i32 s38, s32, 3072
    v_lshl_add_u32 v94, v18, 1, v19
    v_mul_u32_u24 v94, 96, v94
    v_add_u32 v8, s38, v94
    v_mad_u32_u24 v6, v20, 24, v8
    v_lshl_add_u32 v7, v20, 3, v8
    v_lshrrev_b32 v94, 5, v1
    v_lshl_add_u32 v95, v14, 2, v12
    v_lshl_add_u32 v94, v94, 4, v95
    v_mul_u32_u24 v94, 96, v94
    v_lshl_add_u32 v9, v13, 3, v94
    s_cmp_eq_u32 s56, 0
    s_cselect_b32 s38, 0x0908, 0
    s_xor_b32 s38, s38, 0x07060504
    v_cmp_eq_u32 vcc, 1, v20
    v_mov_b32 v94, 0x07060100
    v_mov_b32 v11, 0x07060504
    v_mov_b32 v10, s38
    v_cndmask_b32 v11, v11, v94, vcc
    v_cndmask_b32 v10, v10, v94, vcc
    v_lshrrev_b32 v94, 5, v1
    v_lshl_add_u32 v94, v94, 9, s45
    v_lshl_add_u32 v94, v14, 7, v94
    v_lshl_add_u32 v94, v12, 5, v94
    v_lshl_add_u32 v18, v13, 3, v94
    s_add_u32 s38, s45, 65536
    v_lshl_add_u32 v94, v3, 10, s38
    v_mad_u32_u24 v94, v12, 64, v94
    v_lshl_add_u32 v94, v12, 8, v94
    v_lshl_add_u32 v94, v13, 4, v94
    v_lshl_add_u32 v24, v14, 3, v94
    v_xor_b32 v25, 8, v24
    v_xor_b32 v26, 64, v24
    v_xor_b32 v27, 72, v24
    v_xor_b32 v28, 128, v24
    v_xor_b32 v29, 136, v24
    v_xor_b32 v30, 192, v24
    v_xor_b32 v31, 200, v24
    v_lshlrev_b32 v94, 9, v3
    v_lshl_add_u32 v20, v2, 4, v94
    s_lshl_b32 s38, s32, 5
    v_add_u32 v19, s38, v20
    v_lshlrev_b32 v23, 4, v3
    v_and_b32 v95, 1, v2
    v_lshl_add_u32 v94, v95, 5, v12
    v_mul_u32_u24 v94, 14336, v94
    v_add_u32 v21, v94, v23
    v_lshlrev_b32 v22, 2, v95
    v_mov_b32 v36, 0x3f803f80
    v_mov_b32 v37, 0x3f803f80
    v_mov_b32 v38, 0x3f803f80
    v_mov_b32 v39, 0x3f803f80
    v_mov_b32 v40, 0x3f803f80
    v_mov_b32 v41, 0x3f803f80
    v_mov_b32 v42, 0x3f803f80
    v_mov_b32 v43, 0x3f803f80
    v_mov_b32 v44, 0x3f803f80
    v_mov_b32 v45, 0x3f803f80
    v_mov_b32 v46, 0x3f803f80
    v_mov_b32 v47, 0x3f803f80
    v_mov_b32 v48, 0x3f803f80
    v_mov_b32 v49, 0x3f803f80
    v_mov_b32 v50, 0x3f803f80
    v_mov_b32 v51, 0x3f803f80
    s_mov_b32 s40, 0xc0003
    s_mov_b32 s41, 0xc0003
    s_mov_b32 s48, 0x3000c
    s_mov_b32 s49, 0x3000c
    s_mov_b32 s50, 0xc00030
    s_mov_b32 s51, 0xc00030
    s_mov_b32 s52, 0x3000c0
    s_mov_b32 s53, 0x3000c0
    s_mov_b32 s54, 0xc000300
    s_mov_b32 s55, 0xc000300
    s_mov_b32 s60, 0x3000c00
    s_mov_b32 s61, 0x3000c00
    s_mov_b32 s62, 0xc0003000
    s_mov_b32 s63, 0xc0003000
    s_mov_b32 s64, 0x3000c000
    s_mov_b32 s65, 0x3000c000
    s_mov_b32 s56, 0x00030003
    s_mov_b32 s57, 0x00030003
    s_mul_i32 s42, s32, 57344
    s_lshl_b32 s38, s46, 6
    s_add_u32 s42, s42, s38
    s_add_u32 s42, s42, 2228224
    s_lshl_b32 s66, s32, 8
    s_mov_b32 s67, 2097152
    s_mov_b32 s68, 0
    s_waitcnt vmcnt(4)
    v_lshlrev_b32 v52, 16, v96
    v_and_b32 v53, 0xffff0000, v96
    v_lshlrev_b32 v54, 16, v97
    v_and_b32 v55, 0xffff0000, v97
    v_lshlrev_b32 v56, 16, v98
    v_and_b32 v57, 0xffff0000, v98
    v_lshlrev_b32 v58, 16, v99
    v_and_b32 v59, 0xffff0000, v99
    v_lshlrev_b32 v66, 16, v100
    v_and_b32 v67, 0xffff0000, v100
    v_lshlrev_b32 v68, 16, v101
    v_and_b32 v69, 0xffff0000, v101
    v_lshlrev_b32 v70, 16, v102
    v_and_b32 v71, 0xffff0000, v102
    v_lshlrev_b32 v72, 16, v103
    v_and_b32 v73, 0xffff0000, v103
    s_barrier
    ds_read_b32 v33, v22 offset:58240
    v_mov_b32 v94, 0
    ds_read_b64 v[84:85], v94 offset:58240
    buffer_load_dwordx4 v[60:63], v4, s[8:11], s58 offen sc1
    buffer_load_dwordx4 v[74:77], v4, s[8:11], s58 offen offset:64 sc1
    buffer_load_dword v32, v5, s[8:11], s59 offen sc1
    buffer_load_dwordx2 v[78:79], v92, s[8:11], s67 offen sc1
    buffer_load_dwordx2 v[80:81], v93, s[8:11], s67 offen sc1
    s_waitcnt lgkmcnt(1)
    v_and_b32 v94, 7, v33
    v_and_b32 v95, 0x7f8, v33
    v_lshl_add_u32 v22, v94, 11, v95
    v_lshl_add_u32 v33, v33, 11, v23
    buffer_load_dwordx2 v[82:83], v22, s[8:11], s67 offen sc1
    s_mov_b64 exec, s[56:57]
    buffer_load_dwordx4 v[36:39], v33, s[4:7], s66 offen offset:0
    buffer_load_dwordx4 v[40:43], v33, s[4:7], s66 offen offset:64
    buffer_load_dwordx4 v[44:47], v33, s[4:7], s66 offen offset:128
    buffer_load_dwordx4 v[48:51], v33, s[4:7], s66 offen offset:192
    s_mov_b64 exec, -1
    s_add_u32 m0, s45, 65536
    s_add_u32 s47, s44, 0
    buffer_load_dwordx4 v16, s[20:23], s47 offen lds
    s_add_u32 m0, s45, 66560
    s_add_u32 s47, s44, 8192
    buffer_load_dwordx4 v16, s[20:23], s47 offen lds
    s_add_u32 m0, s45, 67584
    s_add_u32 s47, s44, 16384
    buffer_load_dwordx4 v16, s[20:23], s47 offen lds
    s_add_u32 m0, s45, 68608
    s_add_u32 s47, s44, 24576
    buffer_load_dwordx4 v16, s[20:23], s47 offen lds
    s_waitcnt lgkmcnt(0)
    v_cmp_eq_u32 s[34:35], v17, v84
    v_cmp_eq_u32 vcc, v17, v85
    v_cmp_eq_u32 s[36:37], v35, v84
    v_cmp_eq_u32 s[70:71], v35, v85
    v_bfrev_b32 v94, 1
    v_lshlrev_b32 v95, 5, v3
    v_cndmask_b32 v17, 0, 64, vcc
    v_cndmask_b32 v35, 0, 64, s[70:71]
    s_or_b64 s[34:35], s[34:35], vcc
    s_or_b64 s[36:37], s[36:37], s[70:71]
    v_lshl_add_u32 v17, v17, 1, v95
    v_sub_u32 v95, 96, v95
    v_lshl_add_u32 v35, v35, 1, v95
    v_cndmask_b32 v64, v64, v94, s[34:35]
    v_cndmask_b32 v65, v65, v94, s[36:37]
    s_waitcnt vmcnt(8)
UCHK:
    v_max3_u32 v94, v60, v61, v62
    v_max3_u32 v95, v74, v75, v76
    v_max3_u32 v94, v94, v63, v77
    v_max3_u32 v95, v95, v32, v78
    v_max3_u32 v94, v94, v79, v80
    v_max3_u32 v95, v95, v81, v82
    v_max3_u32 v94, v94, v95, v83
    v_cmp_eq_u32 vcc, -1, v94
    s_cbranch_vccnz URETRY
UOK:
    v_perm_b32 v94, v60, v74, v10
    v_perm_b32 v74, v74, v60, v11
    ds_write_b32 v8, v32 offset:32
    v_mov_b32 v60, v94
    ds_write_b64 v6, v[62:63] offset:40
    ds_write_b64 v7, v[76:77] offset:48
    ds_write_b64 v7, v[74:75] offset:8
    ds_write_b64 v6, v[60:61]
    v_mul_f32 v79, -v78, v79
    v_add_f32 v78, 1.0, v78
    v_mul_f32 v81, -v80, v81
    v_add_f32 v80, 1.0, v80
    v_fma_f32 v52, v52, v78, v79
    v_fma_f32 v53, v53, v78, v79
    v_fma_f32 v54, v54, v78, v79
    v_fma_f32 v55, v55, v78, v79
    v_fma_f32 v56, v56, v78, v79
    v_fma_f32 v57, v57, v78, v79
    v_fma_f32 v58, v58, v78, v79
    v_fma_f32 v59, v59, v78, v79
    v_fma_f32 v66, v66, v80, v81
    v_fma_f32 v67, v67, v80, v81
    v_fma_f32 v68, v68, v80, v81
    v_fma_f32 v69, v69, v80, v81
    v_fma_f32 v70, v70, v80, v81
    v_fma_f32 v71, v71, v80, v81
    v_fma_f32 v72, v72, v80, v81
    v_fma_f32 v73, v73, v80, v81
    s_waitcnt lgkmcnt(0)
    s_barrier
    ds_read_b64_tr_b16 v[84:85], v9 offset:0
    ds_read_b64_tr_b16 v[86:87], v9 offset:768
    ds_read_b64_tr_b16 v[88:89], v9 offset:40
    ds_read_b64_tr_b16 v[90:91], v9 offset:808
    ds_read_b64_tr_b16 v[96:97], v9 offset:8
    ds_read_b64_tr_b16 v[98:99], v9 offset:776
    ds_read_b64_tr_b16 v[100:101], v9 offset:3072
    ds_read_b64_tr_b16 v[102:103], v9 offset:3840
    ds_read_b64_tr_b16 v[136:137], v9 offset:3112
    ds_read_b64_tr_b16 v[138:139], v9 offset:3880
    ds_read_b64_tr_b16 v[140:141], v9 offset:3080
    ds_read_b64_tr_b16 v[142:143], v9 offset:3848
    s_waitcnt lgkmcnt(10)
    v_mfma_f32_16x16x32_bf16 v[60:63], v[84:87], v[104:107], 0
    s_waitcnt lgkmcnt(8)
    v_mfma_f32_16x16x32_bf16 v[74:77], v[88:91], v[104:107], 0
    s_waitcnt lgkmcnt(6)
    v_mfma_f32_16x16x32_bf16 v[78:81], v[96:99], v[104:107], 0
    ds_read_b64_tr_b16 v[84:85], v9 offset:6144
    ds_read_b64_tr_b16 v[86:87], v9 offset:6912
    ds_read_b64_tr_b16 v[88:89], v9 offset:6184
    ds_read_b64_tr_b16 v[90:91], v9 offset:6952
    ds_read_b64_tr_b16 v[96:97], v9 offset:6152
    ds_read_b64_tr_b16 v[98:99], v9 offset:6920
    s_waitcnt lgkmcnt(10)
    v_mfma_f32_16x16x32_bf16 v[60:63], v[100:103], v[108:111], v[60:63]
    s_waitcnt lgkmcnt(8)
    v_mfma_f32_16x16x32_bf16 v[74:77], v[136:139], v[108:111], v[74:77]
    s_waitcnt lgkmcnt(6)
    v_mfma_f32_16x16x32_bf16 v[78:81], v[140:143], v[108:111], v[78:81]
    ds_read_b64_tr_b16 v[100:101], v9 offset:9216
    ds_read_b64_tr_b16 v[102:103], v9 offset:9984
    ds_read_b64_tr_b16 v[136:137], v9 offset:9256
    ds_read_b64_tr_b16 v[138:139], v9 offset:10024
    ds_read_b64_tr_b16 v[140:141], v9 offset:9224
    ds_read_b64_tr_b16 v[142:143], v9 offset:9992
    s_waitcnt lgkmcnt(10)
    v_mfma_f32_16x16x32_bf16 v[60:63], v[84:87], v[112:115], v[60:63]
    s_waitcnt lgkmcnt(8)
    v_mfma_f32_16x16x32_bf16 v[74:77], v[88:91], v[112:115], v[74:77]
    s_waitcnt lgkmcnt(6)
    v_mfma_f32_16x16x32_bf16 v[78:81], v[96:99], v[112:115], v[78:81]
    ds_read_b64_tr_b16 v[84:85], v9 offset:12288
    ds_read_b64_tr_b16 v[86:87], v9 offset:13056
    ds_read_b64_tr_b16 v[88:89], v9 offset:12328
    ds_read_b64_tr_b16 v[90:91], v9 offset:13096
    ds_read_b64_tr_b16 v[96:97], v9 offset:12296
    ds_read_b64_tr_b16 v[98:99], v9 offset:13064
    s_waitcnt lgkmcnt(10)
    v_mfma_f32_16x16x32_bf16 v[60:63], v[100:103], v[116:119], v[60:63]
    s_waitcnt lgkmcnt(8)
    v_mfma_f32_16x16x32_bf16 v[74:77], v[136:139], v[116:119], v[74:77]
    s_waitcnt lgkmcnt(6)
    v_mfma_f32_16x16x32_bf16 v[78:81], v[140:143], v[116:119], v[78:81]
    ds_read_b64_tr_b16 v[100:101], v9 offset:15360
    ds_read_b64_tr_b16 v[102:103], v9 offset:16128
    ds_read_b64_tr_b16 v[136:137], v9 offset:15400
    ds_read_b64_tr_b16 v[138:139], v9 offset:16168
    ds_read_b64_tr_b16 v[140:141], v9 offset:15368
    ds_read_b64_tr_b16 v[142:143], v9 offset:16136
    s_waitcnt lgkmcnt(10)
    v_mfma_f32_16x16x32_bf16 v[60:63], v[84:87], v[120:123], v[60:63]
    s_waitcnt lgkmcnt(8)
    v_mfma_f32_16x16x32_bf16 v[74:77], v[88:91], v[120:123], v[74:77]
    s_waitcnt lgkmcnt(6)
    v_mfma_f32_16x16x32_bf16 v[78:81], v[96:99], v[120:123], v[78:81]
    ds_read_b64_tr_b16 v[84:85], v9 offset:18432
    ds_read_b64_tr_b16 v[86:87], v9 offset:19200
    ds_read_b64_tr_b16 v[88:89], v9 offset:18472
    ds_read_b64_tr_b16 v[90:91], v9 offset:19240
    ds_read_b64_tr_b16 v[96:97], v9 offset:18440
    ds_read_b64_tr_b16 v[98:99], v9 offset:19208
    s_waitcnt lgkmcnt(10)
    v_mfma_f32_16x16x32_bf16 v[60:63], v[100:103], v[124:127], v[60:63]
    s_waitcnt lgkmcnt(8)
    v_mfma_f32_16x16x32_bf16 v[74:77], v[136:139], v[124:127], v[74:77]
    s_waitcnt lgkmcnt(6)
    v_mfma_f32_16x16x32_bf16 v[78:81], v[140:143], v[124:127], v[78:81]
    ds_read_b64_tr_b16 v[100:101], v9 offset:21504
    ds_read_b64_tr_b16 v[102:103], v9 offset:22272
    ds_read_b64_tr_b16 v[136:137], v9 offset:21544
    ds_read_b64_tr_b16 v[138:139], v9 offset:22312
    ds_read_b64_tr_b16 v[140:141], v9 offset:21512
    ds_read_b64_tr_b16 v[142:143], v9 offset:22280
    s_waitcnt lgkmcnt(10)
    v_mfma_f32_16x16x32_bf16 v[60:63], v[84:87], v[128:131], v[60:63]
    s_waitcnt lgkmcnt(8)
    v_mfma_f32_16x16x32_bf16 v[74:77], v[88:91], v[128:131], v[74:77]
    s_waitcnt lgkmcnt(6)
    v_mfma_f32_16x16x32_bf16 v[78:81], v[96:99], v[128:131], v[78:81]
    s_waitcnt lgkmcnt(4)
    v_mfma_f32_16x16x32_bf16 v[60:63], v[100:103], v[132:135], v[60:63]
    s_waitcnt lgkmcnt(2)
    v_mfma_f32_16x16x32_bf16 v[74:77], v[136:139], v[132:135], v[74:77]
    s_waitcnt lgkmcnt(0)
    v_mfma_f32_16x16x32_bf16 v[78:81], v[140:143], v[132:135], v[78:81]
    s_nop 3
    v_add_f32 v52, v52, v60
    v_add_f32 v53, v53, v61
    v_add_f32 v54, v54, v62
    v_add_f32 v55, v55, v63
    v_add_f32 v71, v71, v63
    v_add_f32 v72, v72, v62
    v_add_f32 v73, v73, v61
    v_add_f32 v56, v56, v74
    v_add_f32 v67, v67, v77
    v_add_f32 v57, v57, v75
    v_add_f32 v68, v68, v76
    v_add_f32 v58, v58, v76
    v_add_f32 v69, v69, v75
    v_add_f32 v59, v59, v77
    v_add_f32 v70, v70, v74
    v_add_f32 v66, v66, v78
    v_cvt_pk_bf16_f32 v84, v52, v53
    v_cvt_pk_bf16_f32 v85, v54, v55
    v_cvt_pk_bf16_f32 v86, v56, v57
    v_cvt_pk_bf16_f32 v87, v58, v59
    buffer_store_dwordx4 v[84:87], v64, s[24:27], 0 offen
    v_cvt_pk_bf16_f32 v88, v66, v67
    v_cvt_pk_bf16_f32 v89, v68, v69
    v_cvt_pk_bf16_f32 v90, v70, v71
    v_cvt_pk_bf16_f32 v91, v72, v73
    buffer_store_dwordx4 v[88:91], v65, s[24:27], 0 offen
    s_or_b64 vcc, s[34:35], s[36:37]
    s_cbranch_scc1 FINW
FIND:
    v_xor_b32 v32, 0x80000000, v83
    v_mul_f32 v33, 0xbfb8aa3b, v82
    v_mul_f32 v124, v82, v82
    s_waitcnt vmcnt(6)
    ds_read_b64_tr_b16 v[60:61], v18 offset:0
    ds_read_b64_tr_b16 v[62:63], v18 offset:256
    ds_read_b64_tr_b16 v[100:101], v18 offset:32768
    ds_read_b64_tr_b16 v[102:103], v18 offset:33024
    ds_read_b64_tr_b16 v[74:75], v18 offset:1024
    ds_read_b64_tr_b16 v[76:77], v18 offset:1280
    ds_read_b64_tr_b16 v[104:105], v18 offset:33792
    ds_read_b64_tr_b16 v[106:107], v18 offset:34048
    s_waitcnt lgkmcnt(6)
    v_mfma_f32_16x16x32_bf16 v[116:119], v[60:63], v[36:39], 0
    s_waitcnt lgkmcnt(4)
    v_mfma_f32_16x16x32_bf16 v[120:123], v[100:103], v[36:39], 0
    ds_read_b64_tr_b16 v[78:79], v18 offset:2048
    ds_read_b64_tr_b16 v[80:81], v18 offset:2304
    ds_read_b64_tr_b16 v[108:109], v18 offset:34816
    ds_read_b64_tr_b16 v[110:111], v18 offset:35072
    s_waitcnt lgkmcnt(6)
    v_mfma_f32_16x16x32_bf16 v[116:119], v[74:77], v[40:43], v[116:119]
    s_waitcnt lgkmcnt(4)
    v_mfma_f32_16x16x32_bf16 v[120:123], v[104:107], v[40:43], v[120:123]
    ds_read_b64_tr_b16 v[96:97], v18 offset:3072
    ds_read_b64_tr_b16 v[98:99], v18 offset:3328
    ds_read_b64_tr_b16 v[112:113], v18 offset:35840
    ds_read_b64_tr_b16 v[114:115], v18 offset:36096
    s_waitcnt lgkmcnt(6)
    v_mfma_f32_16x16x32_bf16 v[116:119], v[78:81], v[44:47], v[116:119]
    s_waitcnt lgkmcnt(4)
    v_mfma_f32_16x16x32_bf16 v[120:123], v[108:111], v[44:47], v[120:123]
    s_waitcnt lgkmcnt(2)
    v_mfma_f32_16x16x32_bf16 v[116:119], v[96:99], v[48:51], v[116:119]
    s_waitcnt lgkmcnt(0)
    v_mfma_f32_16x16x32_bf16 v[120:123], v[112:115], v[48:51], v[120:123]
    s_nop 5
    v_fmac_f32_dpp v116, v116, v32 quad_perm:[2,2,2,2] row_mask:0xf bank_mask:0xf
    v_fmac_f32_dpp v117, v117, v32 quad_perm:[2,2,2,2] row_mask:0xf bank_mask:0xf
    v_fmac_f32_dpp v118, v118, v32 quad_perm:[2,2,2,2] row_mask:0xf bank_mask:0xf
    v_fmac_f32_dpp v119, v119, v32 quad_perm:[2,2,2,2] row_mask:0xf bank_mask:0xf
    v_fmac_f32_dpp v120, v120, v32 quad_perm:[2,2,2,2] row_mask:0xf bank_mask:0xf
    v_fmac_f32_dpp v121, v121, v32 quad_perm:[2,2,2,2] row_mask:0xf bank_mask:0xf
    v_fmac_f32_dpp v122, v122, v32 quad_perm:[2,2,2,2] row_mask:0xf bank_mask:0xf
    v_fmac_f32_dpp v123, v123, v32 quad_perm:[2,2,2,2] row_mask:0xf bank_mask:0xf
    s_mov_b64 exec, s[56:57]
    ds_write_b128 v19, v[116:119] offset:58368
    ds_write_b128 v19, v[120:123] offset:58624
    s_mov_b64 exec, -1
    s_waitcnt lgkmcnt(0)
    s_barrier
    s_cmp_ge_u32 s2, 224
    s_cbranch_scc1 CIDLE
    ds_read_b128 v[116:119], v20 offset:58368
    ds_read_b128 v[120:123], v20 offset:58624
    s_waitcnt lgkmcnt(1)
    v_add_f32_dpp v116, v116, v116 row_ror:2 row_mask:0xf bank_mask:0xf
    v_add_f32_dpp v117, v117, v117 row_ror:2 row_mask:0xf bank_mask:0xf
    v_add_f32_dpp v118, v118, v118 row_ror:2 row_mask:0xf bank_mask:0xf
    v_add_f32_dpp v119, v119, v119 row_ror:2 row_mask:0xf bank_mask:0xf
    s_waitcnt lgkmcnt(0)
    v_add_f32_dpp v120, v120, v120 row_ror:2 row_mask:0xf bank_mask:0xf
    v_add_f32_dpp v121, v121, v121 row_ror:2 row_mask:0xf bank_mask:0xf
    v_add_f32_dpp v122, v122, v122 row_ror:2 row_mask:0xf bank_mask:0xf
    v_add_f32_dpp v123, v123, v123 row_ror:2 row_mask:0xf bank_mask:0xf
    v_add_f32_dpp v116, v116, v116 row_ror:4 row_mask:0xf bank_mask:0xf
    v_add_f32_dpp v117, v117, v117 row_ror:4 row_mask:0xf bank_mask:0xf
    v_add_f32_dpp v118, v118, v118 row_ror:4 row_mask:0xf bank_mask:0xf
    v_add_f32_dpp v119, v119, v119 row_ror:4 row_mask:0xf bank_mask:0xf
    v_add_f32_dpp v120, v120, v120 row_ror:4 row_mask:0xf bank_mask:0xf
    v_add_f32_dpp v121, v121, v121 row_ror:4 row_mask:0xf bank_mask:0xf
    v_add_f32_dpp v122, v122, v122 row_ror:4 row_mask:0xf bank_mask:0xf
    v_add_f32_dpp v123, v123, v123 row_ror:4 row_mask:0xf bank_mask:0xf
    v_add_f32_dpp v116, v116, v116 row_ror:8 row_mask:0xf bank_mask:0xf
    v_add_f32_dpp v117, v117, v117 row_ror:8 row_mask:0xf bank_mask:0xf
    v_add_f32_dpp v118, v118, v118 row_ror:8 row_mask:0xf bank_mask:0xf
    v_add_f32_dpp v119, v119, v119 row_ror:8 row_mask:0xf bank_mask:0xf
    v_add_f32_dpp v120, v120, v120 row_ror:8 row_mask:0xf bank_mask:0xf
    v_add_f32_dpp v121, v121, v121 row_ror:8 row_mask:0xf bank_mask:0xf
    v_add_f32_dpp v122, v122, v122 row_ror:8 row_mask:0xf bank_mask:0xf
    v_add_f32_dpp v123, v123, v123 row_ror:8 row_mask:0xf bank_mask:0xf
    v_mul_f32 v126, v116, v33
    v_mul_f32 v127, v117, v33
    v_mul_f32 v128, v118, v33
    v_mul_f32 v129, v119, v33
    v_exp_f32 v126, v126
    v_mul_f32 v116, v116, v120
    v_exp_f32 v127, v127
    v_mul_f32 v117, v117, v121
    v_exp_f32 v128, v128
    v_mul_f32 v118, v118, v122
    v_exp_f32 v129, v129
    v_mul_f32 v119, v119, v123
    v_add_f32 v126, 1.0, v126
    v_mul_f32 v116, v116, v124
    v_add_f32 v127, 1.0, v127
    v_mul_f32 v117, v117, v124
    v_add_f32 v128, 1.0, v128
    v_mul_f32 v118, v118, v124
    v_add_f32 v129, 1.0, v129
    v_mul_f32 v119, v119, v124
    v_rcp_f32 v126, v126
    v_rcp_f32 v127, v127
    v_rcp_f32 v128, v128
    v_rcp_f32 v129, v129
    s_waitcnt vmcnt(2)
    ds_read_b64_tr_b16 v[60:61], v24
    ds_read_b64_tr_b16 v[62:63], v25
    ds_read_b64_tr_b16 v[74:75], v26
    ds_read_b64_tr_b16 v[76:77], v27
    ds_read_b64_tr_b16 v[78:79], v28
    ds_read_b64_tr_b16 v[80:81], v29
    ds_read_b64_tr_b16 v[96:97], v30
    ds_read_b64_tr_b16 v[98:99], v31
    v_mul_f32 v116, v116, v126
    v_mul_f32 v117, v117, v127
    v_mul_f32 v118, v118, v128
    v_mul_f32 v119, v119, v129
    v_cvt_pk_bf16_f32 v126, v116, v117
    v_cvt_pk_bf16_f32 v127, v118, v119
    v_cndmask_b32 v100, 0, v126, s[40:41]
    v_cndmask_b32 v101, 0, v127, s[40:41]
    v_cndmask_b32 v102, 0, v126, s[48:49]
    v_cndmask_b32 v103, 0, v127, s[48:49]
    v_cndmask_b32 v104, 0, v126, s[50:51]
    v_cndmask_b32 v105, 0, v127, s[50:51]
    v_cndmask_b32 v106, 0, v126, s[52:53]
    v_cndmask_b32 v107, 0, v127, s[52:53]
    v_cndmask_b32 v108, 0, v126, s[54:55]
    v_cndmask_b32 v109, 0, v127, s[54:55]
    v_cndmask_b32 v110, 0, v126, s[60:61]
    v_cndmask_b32 v111, 0, v127, s[60:61]
    v_cndmask_b32 v112, 0, v126, s[62:63]
    v_cndmask_b32 v113, 0, v127, s[62:63]
    v_cndmask_b32 v114, 0, v126, s[64:65]
    v_cndmask_b32 v115, 0, v127, s[64:65]
    s_waitcnt lgkmcnt(6)
    v_mfma_f32_16x16x32_bf16 v[120:123], v[60:63], v[100:103], 0
    s_waitcnt lgkmcnt(4)
    v_mfma_f32_16x16x32_bf16 v[120:123], v[74:77], v[104:107], v[120:123]
    s_waitcnt lgkmcnt(2)
    v_mfma_f32_16x16x32_bf16 v[120:123], v[78:81], v[108:111], v[120:123]
    s_waitcnt lgkmcnt(0)
    v_mfma_f32_16x16x32_bf16 v[120:123], v[96:99], v[112:115], v[120:123]
    s_nop 7
    v_cvt_pk_bf16_f32 v126, v120, v121
    v_cvt_pk_bf16_f32 v127, v122, v123
    s_nop 0
    v_mov_b32_dpp v128, v126 quad_perm:[2,3,0,1] row_mask:0xf bank_mask:0xf
    v_mov_b32_dpp v129, v127 quad_perm:[2,3,0,1] row_mask:0xf bank_mask:0xf
    s_mov_b32 exec_lo, 0x33333333
    s_mov_b32 exec_hi, 0x33333333
    buffer_store_dwordx4 v[126:129], v21, s[8:11], s42 offen sc1
CEND:
END:
    s_endpgm
CIDLE:
    s_waitcnt vmcnt(0)
    s_branch CEND
SPECC:
    v_mfma_f32_16x16x32_bf16 v[30:33], v[4:7], v[36:39], 0
    v_mfma_f32_16x16x32_bf16 v[60:63], v[4:7], v[44:47], 0
    v_mfma_f32_16x16x32_bf16 v[72:75], v[8:11], v[48:51], 0
    v_mfma_f32_16x16x32_bf16 v[76:79], v[8:11], v[52:55], 0
    s_nop 4
    s_branch SPECD
URETRY:
    s_add_u32 s68, s68, 1
    s_cmp_ge_u32 s68, 4096
    s_cbranch_scc1 UOK
    buffer_load_dwordx4 v[60:63], v4, s[8:11], s58 offen sc1
    buffer_load_dwordx4 v[74:77], v4, s[8:11], s58 offen offset:64 sc1
    buffer_load_dword v32, v5, s[8:11], s59 offen sc1
    buffer_load_dwordx2 v[78:79], v92, s[8:11], s67 offen sc1
    buffer_load_dwordx2 v[80:81], v93, s[8:11], s67 offen sc1
    buffer_load_dwordx2 v[82:83], v22, s[8:11], s67 offen sc1
    s_waitcnt vmcnt(0)
    s_branch UCHK
FINW:
    s_mov_b64 exec, s[34:35]
    ds_write_b128 v17, v[52:55] offset:60416
    ds_write_b128 v17, v[56:59] offset:60432
    s_mov_b64 exec, s[36:37]
    ds_write_b128 v35, v[66:69] offset:60672
    ds_write_b128 v35, v[70:73] offset:60688
    s_mov_b64 exec, -1
    s_waitcnt lgkmcnt(0)
    s_nop 5
    s_branch FIND
COMM:
    s_setprio 3
    v_mov_b32 v10, 0
    s_mov_b32 s40, 2129920
    v_mov_b32 v6, -1
    v_mov_b32 v7, -1
    v_mov_b32 v8, -1
    v_mov_b32 v9, -1
    v_lshrrev_b32 v11, 2, v1
    v_and_b32 v12, 3, v1
    v_lshlrev_b32 v11, 14, v11
    v_lshl_add_u32 v11, v12, 4, v11
    v_lshlrev_b32 v15, 4, v1
    s_lshl_b32 s38, s36, 7
    s_lshl_b32 s39, s35, 6
    s_add_u32 s38, s38, s39
    s_waitcnt lgkmcnt(0)
    buffer_load_dwordx2 v[4:5], v10, s[8:11], s40 offen sc1
    buffer_store_dwordx4 v[6:9], v11, s[8:11], s38 offen sc1
    s_add_u32 s38, s38, 262144
    buffer_store_dwordx4 v[6:9], v11, s[8:11], s38 offen sc1
    s_add_u32 s38, s38, 262144
    buffer_store_dwordx4 v[6:9], v11, s[8:11], s38 offen sc1
    s_add_u32 s38, s38, 262144
    buffer_store_dwordx4 v[6:9], v11, s[8:11], s38 offen sc1
    s_add_u32 s38, s38, 262144
    buffer_store_dwordx4 v[6:9], v11, s[8:11], s38 offen sc1
    s_add_u32 s38, s38, 262144
    buffer_store_dwordx4 v[6:9], v11, s[8:11], s38 offen sc1
    s_add_u32 s38, s38, 262144
    buffer_store_dwordx4 v[6:9], v11, s[8:11], s38 offen sc1
    s_add_u32 s38, s38, 262144
    buffer_store_dwordx4 v[6:9], v11, s[8:11], s38 offen sc1
    s_mul_i32 s38, s2, 3584
    s_add_u32 s38, s38, 2228224
    buffer_store_dwordx4 v[6:9], v15, s[8:11], s38 offen offset:0 sc1
    buffer_store_dwordx4 v[6:9], v15, s[8:11], s38 offen offset:1024 sc1
    buffer_store_dwordx4 v[6:9], v15, s[8:11], s38 offen offset:2048 sc1
    buffer_store_dwordx4 v[6:9], v15, s[8:11], s38 offen offset:2560 sc1
    v_lshlrev_b32 v12, 8, v1
    v_add_u32 v11, s36, v12
    v_sub_u32 v12, s37, v12
    s_cmp_eq_u32 s35, 0
    s_cselect_b64 vcc, 0, -1
    v_cndmask_b32 v11, v11, v12, vcc
    v_and_b32 v12, 7, v11
    v_and_b32 v11, 0x7f8, v11
    v_lshl_add_u32 v13, v12, 11, v11
    s_mov_b32 s41, 2097152
    s_mov_b64 exec, 0xff
    buffer_store_dwordx2 v[6:7], v13, s[8:11], s41 offen sc1
    s_mov_b64 exec, -1
    v_lshlrev_b32 v14, 12, v1
    s_lshl_b32 s42, s2, 4
    s_add_u32 s42, s42, 2162688
    s_lshl_b32 s43, s33, 12
    s_add_u32 s43, s43, 2162688
    s_mov_b32 s44, 0
    s_lshl_b32 s38, s35, 5
    v_lshlrev_b32 v11, 2, v1
    v_add_u32 v16, s38, v11
    s_waitcnt vmcnt(13)
    v_add_u32 v4, 2, v4
    v_or_b32 v4, 1, v4
    v_readfirstlane_b32 s47, v5
    v_readfirstlane_b32 s46, v4
    s_barrier
    ds_read_b128 v[18:21], v10 offset:58176
    ds_read_b128 v[22:25], v10 offset:58192
    ds_read_b32 v26, v16 offset:58112
    ds_read_b32 v27, v11 offset:58272
    s_waitcnt lgkmcnt(3)
    v_max3_u32 v17, v18, v19, v20
    v_med3_u32 v28, v18, v19, v20
    s_waitcnt lgkmcnt(2)
    v_max3_u32 v29, v21, v22, v23
    v_med3_u32 v30, v21, v22, v23
    v_med3_u32 v12, v17, v29, v24
    v_max3_u32 v17, v17, v29, v24
    v_max3_u32 v12, v12, v28, v30
    v_max_u32 v2, v17, v25
    v_med3_u32 v3, v17, v12, v25
    s_mov_b64 exec, 0xff
    s_waitcnt vmcnt(0)
    buffer_store_dwordx4 v[2:5], v14, s[8:11], s42 offen sc1
    s_waitcnt lgkmcnt(0)
    buffer_store_dwordx2 v[26:27], v13, s[8:11], s41 offen sc1
    s_mov_b64 exec, -1
    s_barrier
    s_barrier
POLL:
    buffer_load_dwordx4 v[32:35], v15, s[8:11], s43 offen offset:0 sc1
    buffer_load_dwordx4 v[36:39], v15, s[8:11], s43 offen offset:1024 sc1
    buffer_load_dwordx4 v[40:43], v15, s[8:11], s43 offen offset:2048 sc1
    buffer_load_dwordx4 v[44:47], v15, s[8:11], s43 offen offset:3072 sc1
    s_add_u32 s44, s44, 1
    s_waitcnt vmcnt(3)
    v_cmp_eq_u64 vcc, s[46:47], v[34:35]
    s_waitcnt vmcnt(2)
    v_cmp_eq_u64 s[48:49], s[46:47], v[38:39]
    v_max_u32 v28, v33, v37
    v_max_u32 v17, v32, v36
    v_med3_u32 v28, v32, v36, v28
    s_waitcnt vmcnt(1)
    v_cmp_eq_u64 s[50:51], s[46:47], v[42:43]
    s_and_b64 vcc, vcc, s[48:49]
    s_waitcnt vmcnt(0)
    v_cmp_eq_u64 s[52:53], s[46:47], v[46:47]
    v_max_u32 v30, v41, v45
    v_max_u32 v29, v40, v44
    v_med3_u32 v30, v40, v44, v30
    s_and_b64 vcc, vcc, s[50:51]
    s_and_b64 vcc, vcc, s[52:53]
    s_cmp_eq_u64 vcc, -1
    s_cbranch_scc1 GOT
    s_cmp_lt_u32 s44, 4096
    s_cbranch_scc1 POLL
GOT:
    v_max_u32 v28, v28, v30
    v_med3_u32 v28, v17, v29, v28
    v_max_u32 v17, v17, v29
    s_nop 1
    v_mov_b32_dpp v29, v17 row_ror:8 row_mask:0xf bank_mask:0xf
    v_max_u32_dpp v30, v28, v28 row_ror:8 row_mask:0xf bank_mask:0xf
    v_med3_u32 v28, v17, v29, v30
    v_max_u32 v17, v17, v29
    s_nop 1
    v_mov_b32_dpp v29, v17 row_ror:4 row_mask:0xf bank_mask:0xf
    v_max_u32_dpp v30, v28, v28 row_ror:4 row_mask:0xf bank_mask:0xf
    v_med3_u32 v28, v17, v29, v30
    v_max_u32 v17, v17, v29
    s_nop 1
    v_mov_b32_dpp v29, v17 row_ror:2 row_mask:0xf bank_mask:0xf
    v_max_u32_dpp v30, v28, v28 row_ror:2 row_mask:0xf bank_mask:0xf
    v_med3_u32 v28, v17, v29, v30
    v_max_u32 v17, v17, v29
    s_nop 1
    v_mov_b32_dpp v29, v17 row_ror:1 row_mask:0xf bank_mask:0xf
    v_max_u32_dpp v30, v28, v28 row_ror:1 row_mask:0xf bank_mask:0xf
    v_med3_u32 v28, v17, v29, v30
    v_max_u32 v17, v17, v29
    s_nop 1
    v_mov_b32_dpp v29, v17 row_bcast:15 row_mask:0xa bank_mask:0xf
    v_max_u32_dpp v30, v28, v28 row_bcast:15 row_mask:0xa bank_mask:0xf
    v_med3_u32 v28, v17, v29, v30
    v_max_u32 v17, v17, v29
    s_nop 1
    v_mov_b32_dpp v29, v17 row_bcast:31 row_mask:0xc bank_mask:0xf
    v_max_u32_dpp v30, v28, v28 row_bcast:31 row_mask:0xc bank_mask:0xf
    v_med3_u32 v28, v17, v29, v30
    v_max_u32 v17, v17, v29
    v_and_b32 v26, 0x7ff, v17
    v_and_b32 v27, 0x7ff, v28
    s_mov_b32 exec_lo, 0
    s_brev_b32 exec_hi, 1
    ds_write_b64 v10, v[26:27] offset:58240
    s_mov_b64 exec, -1
    s_waitcnt lgkmcnt(0)
    s_barrier
    v_readlane_b32 s54, v17, 63
    v_readlane_b32 s55, v28, 63
    s_cmp_lg_u32 s2, 0
    s_cbranch_scc1 NOEP
    s_mov_b64 exec, 1
    buffer_store_dwordx2 v[4:5], v10, s[8:11], s40 offen sc1
    s_mov_b64 exec, -1
NOEP:
    s_and_b32 s56, s34, 15
    s_lshr_b32 s57, s34, 4
    s_lshl_b32 s57, s57, 10
    s_or_b32 s57, s57, s33
    s_mov_b32 s45, 0
    s_and_b32 s38, s54, 0x407
    s_cmp_eq_u32 s38, s57
    s_cselect_b32 s38, 1, 0
    s_or_b32 s45, s45, s38
    s_and_b32 s38, s55, 0x407
    s_cmp_eq_u32 s38, s57
    s_cselect_b32 s38, 2, 0
    s_or_b32 s45, s45, s38
    s_sub_u32 s38, 0, s54
    s_and_b32 s38, s38, 0x407
    s_cmp_eq_u32 s38, s57
    s_cselect_b32 s38, 4, 0
    s_or_b32 s45, s45, s38
    s_sub_u32 s38, 0, s55
    s_and_b32 s38, s38, 0x407
    s_cmp_eq_u32 s38, s57
    s_cselect_b32 s38, 8, 0
    s_or_b32 s45, s45, s38
    s_cbranch_scc0 MEND
    v_and_b32 v31, 15, v1
    v_and_b32 v11, 1, v1
    v_lshlrev_b32 v11, 4, v11
    v_mov_b32 v12, 0x3f80
    v_lshlrev_b32 v11, v11, v12
    v_lshrrev_b32 v12, 1, v31
    v_cmp_eq_u32 vcc, 0, v12
    s_nop 1
    v_cndmask_b32 v48, 0, v11, vcc
    v_cmp_eq_u32 vcc, 1, v12
    s_nop 1
    v_cndmask_b32 v49, 0, v11, vcc
    v_cmp_eq_u32 vcc, 2, v12
    s_nop 1
    v_cndmask_b32 v50, 0, v11, vcc
    v_cmp_eq_u32 vcc, 3, v12
    s_nop 1
    v_cndmask_b32 v51, 0, v11, vcc
    v_and_b32 v11, 3, v1
    v_bfe_u32 v12, v1, 4, 1
    v_lshl_add_u32 v11, v11, 1, v12
    v_lshlrev_b32 v108, 4, v11
    v_lshlrev_b32 v109, 3, v11
    s_barrier
    s_barrier
ROLE:
    s_ff1_i32_b32 s58, s45
    s_bitset0_b32 s45, s58
    s_bitcmp1_b32 s58, 0
    s_cselect_b32 s59, s55, s54
    s_cselect_b32 s62, 32, 0
    s_sub_u32 s61, 31, s56
    s_bitcmp1_b32 s58, 1
    s_cselect_b32 s61, s61, s56
    s_add_u32 s62, s62, s61
    s_mul_i32 s62, s62, 14336
    s_add_u32 s62, s62, 2228224
    s_and_b32 s60, s59, 0x7ff
    s_lshl_b32 s60, s60, 11
    s_lshl_b32 s61, s61, 6
    s_add_u32 s60, s60, s61
    s_lshl_b32 s38, s58, 7
    v_add_u32 v11, s38, v108
    ds_read_b128 v[116:119], v11 offset:60416
    s_mov_b32 s44, 0
    v_mov_b32 v110, s59
    v_ashrrev_i32 v12, 31, v110
    v_not_b32 v12, v12
    v_or_b32 v12, 0x80000000, v12
    v_xor_b32 v110, v110, v12
    v_mul_f32 v110, 0xbfb8aa3b, v110
    v_exp_f32 v110, v110
    s_nop 0
    v_add_f32 v110, 1.0, v110
    v_rcp_f32 v110, v110
RPOLL:
    s_mov_b32 s38, s62
    buffer_load_dwordx4 v[52:55], v15, s[8:11], s38 offen offset:0 sc1
    buffer_load_dwordx4 v[56:59], v15, s[8:11], s38 offen offset:1024 sc1
    buffer_load_dwordx4 v[60:63], v15, s[8:11], s38 offen offset:2048 sc1
    buffer_load_dwordx4 v[64:67], v15, s[8:11], s38 offen offset:3072 sc1
    s_add_u32 s38, s38, 4096
    buffer_load_dwordx4 v[68:71], v15, s[8:11], s38 offen offset:0 sc1
    buffer_load_dwordx4 v[72:75], v15, s[8:11], s38 offen offset:1024 sc1
    buffer_load_dwordx4 v[76:79], v15, s[8:11], s38 offen offset:2048 sc1
    buffer_load_dwordx4 v[80:83], v15, s[8:11], s38 offen offset:3072 sc1
    s_add_u32 s38, s38, 4096
    buffer_load_dwordx4 v[84:87], v15, s[8:11], s38 offen offset:0 sc1
    buffer_load_dwordx4 v[88:91], v15, s[8:11], s38 offen offset:1024 sc1
    buffer_load_dwordx4 v[92:95], v15, s[8:11], s38 offen offset:2048 sc1
    buffer_load_dwordx4 v[96:99], v15, s[8:11], s38 offen offset:3072 sc1
    s_add_u32 s38, s38, 4096
    buffer_load_dwordx4 v[100:103], v15, s[8:11], s38 offen offset:0 sc1
    buffer_load_dwordx4 v[104:107], v15, s[8:11], s38 offen offset:1024 sc1
    s_add_u32 s44, s44, 1
    s_waitcnt vmcnt(13)
    v_mfma_f32_16x16x32_bf16 v[112:115], v[48:51], v[52:55], 0
    s_waitcnt vmcnt(12)
    v_mfma_f32_16x16x32_bf16 v[112:115], v[48:51], v[56:59], v[112:115]
    s_waitcnt vmcnt(11)
    v_mfma_f32_16x16x32_bf16 v[112:115], v[48:51], v[60:63], v[112:115]
    s_waitcnt vmcnt(10)
    v_mfma_f32_16x16x32_bf16 v[112:115], v[48:51], v[64:67], v[112:115]
    s_waitcnt vmcnt(9)
    v_mfma_f32_16x16x32_bf16 v[112:115], v[48:51], v[68:71], v[112:115]
    s_waitcnt vmcnt(8)
    v_mfma_f32_16x16x32_bf16 v[112:115], v[48:51], v[72:75], v[112:115]
    s_waitcnt vmcnt(7)
    v_mfma_f32_16x16x32_bf16 v[112:115], v[48:51], v[76:79], v[112:115]
    s_waitcnt vmcnt(6)
    v_mfma_f32_16x16x32_bf16 v[112:115], v[48:51], v[80:83], v[112:115]
    s_waitcnt vmcnt(5)
    v_mfma_f32_16x16x32_bf16 v[112:115], v[48:51], v[84:87], v[112:115]
    s_waitcnt vmcnt(4)
    v_mfma_f32_16x16x32_bf16 v[112:115], v[48:51], v[88:91], v[112:115]
    s_waitcnt vmcnt(3)
    v_mfma_f32_16x16x32_bf16 v[112:115], v[48:51], v[92:95], v[112:115]
    s_waitcnt vmcnt(2)
    v_mfma_f32_16x16x32_bf16 v[112:115], v[48:51], v[96:99], v[112:115]
    s_waitcnt vmcnt(1)
    v_mfma_f32_16x16x32_bf16 v[112:115], v[48:51], v[100:103], v[112:115]
    s_waitcnt vmcnt(0)
    v_mfma_f32_16x16x32_bf16 v[112:115], v[48:51], v[104:107], v[112:115]
    s_cmp_ge_u32 s44, 4096
    s_cbranch_scc1 RGOT
    s_nop 5
    v_cmp_u_f32 vcc, v112, v112
    s_cbranch_vccnz RPOLL
RGOT:
    s_nop 5
    v_add_f32_dpp v112, v112, v112 row_ror:4 row_mask:0xf bank_mask:0xf
    v_add_f32_dpp v113, v113, v113 row_ror:4 row_mask:0xf bank_mask:0xf
    v_add_f32_dpp v114, v114, v114 row_ror:4 row_mask:0xf bank_mask:0xf
    v_add_f32_dpp v115, v115, v115 row_ror:4 row_mask:0xf bank_mask:0xf
    v_add_f32_dpp v112, v112, v112 row_ror:8 row_mask:0xf bank_mask:0xf
    v_add_f32_dpp v113, v113, v113 row_ror:8 row_mask:0xf bank_mask:0xf
    v_add_f32_dpp v114, v114, v114 row_ror:8 row_mask:0xf bank_mask:0xf
    v_add_f32_dpp v115, v115, v115 row_ror:8 row_mask:0xf bank_mask:0xf
    s_waitcnt lgkmcnt(0)
    v_fmac_f32 v116, v112, v110
    v_fmac_f32 v117, v113, v110
    v_fmac_f32 v118, v114, v110
    v_fmac_f32 v119, v115, v110
    v_cvt_pk_bf16_f32 v116, v116, v117
    v_cvt_pk_bf16_f32 v117, v118, v119
    s_mov_b64 exec, 0x000f000f
    buffer_store_dwordx2 v[116:117], v109, s[24:27], s60 offen
    s_mov_b64 exec, -1
    s_cmp_lg_u32 s45, 0
    s_nop 0
    s_cbranch_scc1 ROLE
MEND:
    s_endpgm
.section .rodata,"a"
.p2align 6
.amdhsa_kernel parallel_sum__spectral_fnet__moe_arch_mod__prompt_kernel
  .amdhsa_next_free_vgpr 144
  .amdhsa_next_free_sgpr 102
  .amdhsa_accum_offset 144
  .amdhsa_group_segment_fixed_size 0
  .amdhsa_kernarg_size 104
  .amdhsa_user_sgpr_count 2
  .amdhsa_user_sgpr_kernarg_segment_ptr 1
  .amdhsa_system_sgpr_workgroup_id_x 1
.end_amdhsa_kernel
```

```asm
; @launch grid=(256,1,1) block=(576,1,1) lds=159744
.amdgcn_target "amdgcn-amd-amdhsa--gfx950"
.text
.globl parallel_sum__spectral_fnet__moe_arch_mod__prompt_kernel
.p2align 12
.type parallel_sum__spectral_fnet__moe_arch_mod__prompt_kernel,@function
parallel_sum__spectral_fnet__moe_arch_mod__prompt_kernel:
    s_cmp_ge_u32 s2, 256
    s_cbranch_scc1 END
    s_load_dwordx2 s[4:5], s[0:1], 0
    s_load_dwordx2 s[28:29], s[0:1], 48
    s_load_dwordx2 s[8:9], s[0:1], 96
    s_load_dwordx2 s[12:13], s[0:1], 56
    s_load_dwordx2 s[16:17], s[0:1], 64
    s_load_dwordx2 s[20:21], s[0:1], 72
    s_load_dwordx2 s[24:25], s[0:1], 80
    v_lshrrev_b32 v2, 6, v0
    v_and_b32 v1, 63, v0
    s_and_b32 s33, s2, 7
    v_readfirstlane_b32 s32, v2
    s_lshr_b32 s38, s2, 4
    s_lshl3_add_u32 s36, s38, s33
    s_lshr_b32 s34, s2, 3
    s_and_b32 s35, s34, 1
    s_cmp_eq_u32 s36, 0
    s_cselect_b32 s38, 128, s36
    s_sub_u32 s37, 2048, s38
    s_mul_i32 s40, s33, 28
    s_add_u32 s40, s40, s34
    s_mov_b32 s6, 4194304
    s_mov_b32 s7, 0x00020000
    s_mov_b32 s10, 3145728
    s_mov_b32 s11, 0x00020000
    s_mov_b32 s26, 4194304
    s_mov_b32 s27, 0x00020000
    s_cmp_eq_u32 s32, 8
    s_cbranch_scc1 COMM
    s_lshl_b32 s38, s32, 8
    s_add_u32 s41, s36, s38
    s_sub_u32 s38, s37, s38
    s_cmp_eq_u32 s35, 0
    s_cselect_b32 s42, s38, s41
    s_cselect_b32 s41, s41, s38
    s_lshl_b32 s43, s32, 11
    s_lshl_b32 s38, s35, 14
    s_add_u32 s43, s43, s38
    v_and_b32 v9, 32, v1
    v_lshlrev_b32 v2, 4, v1
    v_lshrrev_b32 v5, 2, v1
    v_xor_b32 v2, v2, v9
    s_mov_b32 m0, s43
    s_lshl_b32 s38, s41, 11
    s_lshl_b32 s42, s42, 11
    s_mov_b32 s30, 2048
    s_mov_b32 s31, 0x00020000
    v_and_b32 v6, 3, v1
    v_lshlrev_b32 v9, 14, v5
    v_lshl_add_u32 v8, v6, 4, v9
    s_lshl_b32 s47, s32, 18
    s_lshl_b32 s39, s36, 7
    s_add_u32 s47, s47, s39
    s_lshl_b32 s39, s35, 6
    s_add_u32 s47, s47, s39
    v_mov_b32 v10, -1
    v_mov_b32 v11, -1
    v_mov_b32 v12, -1
    v_mov_b32 v13, -1
    v_and_b32 v3, 15, v1
    v_lshrrev_b32 v4, 4, v1
    v_and_b32 v5, 3, v5
    v_and_b32 v7, 1, v4
    s_waitcnt lgkmcnt(0)
    buffer_load_dwordx4 v2, s[4:7], s38 offen lds
    buffer_load_dwordx4 v2, s[4:7], s38 offen offset:1024 lds
    buffer_load_dwordx4 v[16:19], v2, s[28:31], 0 offen
    buffer_load_dwordx4 v[20:23], v2, s[28:31], 0 offen offset:1024
    buffer_store_dwordx4 v[10:13], v8, s[8:11], s47 offen sc1
    s_cmp_lt_u32 s2, 224
    s_cselect_b32 s14, 7340032, 0
    s_mov_b32 s15, 0x00020000
    s_mov_b32 s18, s14
    s_mov_b32 s19, 0x00020000
    s_mov_b32 s22, s14
    s_mov_b32 s23, 0x00020000
    s_lshr_b32 s49, s40, 2
    s_and_b32 s48, s40, 3
    s_lshl3_add_u32 s38, s48, s32
    s_mul_i32 s44, s38, 229376
    s_lshl_b32 s38, s49, 7
    s_add_u32 s44, s44, s38
    s_lshr_b32 s38, s32, 2
    s_lshl1_add_u32 s38, s49, s38
    s_lshl_b32 s45, s38, 16
    s_and_b32 s38, s32, 3
    s_lshl2_add_u32 s38, s48, s38
    s_lshl_b32 s38, s38, 7
    s_add_u32 s45, s45, s38
    s_lshl_b32 s46, s32, 12
    s_add_u32 s46, s46, 61440
    v_bfe_u32 v9, v1, 1, 2
    v_xor_b32 v9, v9, v7
    v_and_b32 v14, 1, v1
    v_lshlrev_b32 v14, 4, v14
    v_lshl_add_u32 v9, v9, 5, v14
    v_lshrrev_b32 v14, 3, v1
    v_lshl_add_u32 v26, v14, 11, v9
    v_mul_u32_u24 v14, 7168, v14
    v_add_u32 v24, v9, v14
    v_xor_b32 v27, 64, v26
    v_xor_b32 v25, 64, v24
    s_xor_b32 m0, s43, 16384
    s_nop 0
    buffer_load_dwordx4 v2, s[4:7], s42 offen lds
    buffer_load_dwordx4 v2, s[4:7], s42 offen offset:1024 lds
    s_add_u32 m0, s46, 0
    s_add_u32 s50, s44, 0
    buffer_load_dwordx4 v24, s[12:15], s50 offen nt lds
    s_add_u32 m0, s46, 32768
    s_add_u32 s50, s44, 0
    buffer_load_dwordx4 v24, s[16:19], s50 offen nt lds
    s_lshl_b32 s51, s35, 3
    s_cmp_eq_u32 s35, 0
    s_cselect_b32 s38, 1, 99
    v_lshrrev_b32 v2, 1, v3
    v_add_u32 v2, s51, v2
    v_and_b32 v9, 1, v3
    v_cmp_ne_u32 vcc, s38, v3
    s_nop 1
    v_cndmask_b32 v2, 16, v2, vcc
    v_cndmask_b32 v9, 0, v9, vcc
    v_cvt_f32_u32 v2, v2
    v_cvt_f32_u32 v9, v9
    v_cvt_f32_u32 v14, v4
    v_mul_f32 v2, 0x3d000000, v2
    v_mul_f32 v9, 0x3e800000, v9
    v_mul_f32 v15, 4.0, v14
    v_add_f32 v14, v15, v15
    v_fma_f32 v28, v2, v14, v9
    v_add_f32 v29, v28, v2
    v_add_f32 v30, v29, v2
    v_add_f32 v31, v30, v2
    v_add_f32 v32, v31, v2
    v_add_f32 v33, v32, v2
    v_add_f32 v34, v33, v2
    v_add_f32 v35, v34, v2
    v_cos_f32 v28, v28
    v_cos_f32 v29, v29
    s_nop 0
    v_cvt_pk_bf16_f32 v10, v28, v29
    v_cos_f32 v30, v30
    v_cos_f32 v31, v31
    s_nop 0
    v_cvt_pk_bf16_f32 v11, v30, v31
    v_cos_f32 v32, v32
    v_cos_f32 v33, v33
    s_nop 0
    v_cvt_pk_bf16_f32 v12, v32, v33
    v_cos_f32 v34, v34
    v_cos_f32 v35, v35
    s_nop 0
    v_cvt_pk_bf16_f32 v13, v34, v35
    s_add_u32 s38, s38, -1
    v_cmp_ne_u32 vcc, s38, v3
    v_mov_b32 v36, 0xc2000000
    v_mov_b32 v37, 0x3a800000
    v_cndmask_b32 v36, v36, 0, vcc
    s_add_u32 s51, s51, s32
    s_cmp_eq_u32 s51, 0
    s_cselect_b32 s52, 16, s51
    s_add_u32 s52, s52, 992
    v_lshl_add_u32 v2, v3, 5, s51
    v_mov_b32 v14, 512
    v_cmp_eq_u32 vcc, 0, v2
    s_nop 1
    v_cndmask_b32 v2, v2, v14, vcc
    v_cvt_f32_u32 v2, v2
    v_mul_f32 v2, v37, v2
    v_mul_f32 v28, v2, v15
    v_fmamk_f32 v32, v2, 0x41800000, v28
    v_add_f32 v29, v28, v2
    v_add_f32 v33, v32, v2
    v_add_f32 v30, v29, v2
    v_add_f32 v34, v33, v2
    v_add_f32 v31, v30, v2
    v_add_f32 v35, v34, v2
    v_sin_f32 v62, v28
    v_sin_f32 v63, v29
    v_cos_f32 v28, v28
    v_cos_f32 v29, v29
    v_cvt_pk_bf16_f32 v42, v62, v63
    v_cvt_pk_bf16_f32 v38, v28, v29
    v_sin_f32 v62, v30
    v_sin_f32 v63, v31
    v_cos_f32 v30, v30
    v_cos_f32 v31, v31
    v_cvt_pk_bf16_f32 v43, v62, v63
    v_cvt_pk_bf16_f32 v39, v30, v31
    v_sin_f32 v62, v32
    v_sin_f32 v63, v33
    v_cos_f32 v32, v32
    v_cos_f32 v33, v33
    v_cvt_pk_bf16_f32 v44, v62, v63
    v_cvt_pk_bf16_f32 v40, v32, v33
    v_sin_f32 v62, v34
    v_sin_f32 v63, v35
    v_cos_f32 v34, v34
    v_cos_f32 v35, v35
    v_cvt_pk_bf16_f32 v45, v62, v63
    v_cvt_pk_bf16_f32 v41, v34, v35
    v_xor_b32 v46, 0x80008000, v42
    v_xor_b32 v47, 0x80008000, v43
    v_xor_b32 v48, 0x80008000, v44
    v_xor_b32 v49, 0x80008000, v45
    v_lshrrev_b32 v2, 1, v3
    v_and_b32 v9, 1, v3
    v_cvt_f32_u32 v2, v2
    v_cvt_f32_u32 v14, v9
    v_cmp_gt_u32 vcc, 32, v1
    v_mov_b32 v62, 0xbe800000
    v_mul_f32 v2, 0x3e000000, v2
    s_cmp_eq_u32 s36, 0
    s_cbranch_scc1 BFQ0
    v_mul_f32 v9, 0x3e800000, v14
    v_cndmask_b32 v62, -v62, v62, vcc
BFGO:
    v_cvt_f32_u32 v14, v7
    v_mul_f32 v14, 4.0, v14
    v_fma_f32 v28, v2, v14, v9
    v_add_f32 v29, v28, v2
    v_add_f32 v30, v29, v2
    v_add_f32 v31, v30, v2
    v_add_f32 v32, v28, v62
    v_add_f32 v33, v29, v62
    v_add_f32 v34, v30, v62
    v_add_f32 v35, v31, v62
    v_cos_f32 v28, v28
    v_cos_f32 v29, v29
    v_cos_f32 v30, v30
    v_cos_f32 v31, v31
    v_cos_f32 v32, v32
    v_cos_f32 v33, v33
    v_cos_f32 v34, v34
    v_cos_f32 v35, v35
    v_lshl_add_u32 v62, v1, 4, s43
    v_xor_b32 v63, 16384, v62
    s_lshl_b32 s38, s32, 11
    v_lshl_add_u32 v14, v4, 9, s38
    v_lshl_add_u32 v14, v5, 6, v14
    v_lshl_add_u32 v14, v7, 5, v14
    v_lshl_add_u32 v64, v6, 3, v14
    v_xor_b32 v65, 32, v64
    s_cmp_lt_u32 s32, 4
    s_cselect_b32 s38, 0, 3
    s_lshl_b32 s39, s32, 6
    s_add_u32 s39, s39, 32768
    v_mul_u32_u24 v2, 1040, v3
    v_xor_b32 v14, s38, v4
    v_add_u32 v2, s39, v2
    v_lshl_add_u32 v66, v14, 4, v2
    v_xor_b32 v14, 2, v14
    v_lshl_add_u32 v67, v14, 4, v2
    s_lshl_b32 s38, s32, 2
    s_add_u32 s38, s38, 58112
    v_mov_b32 v68, s38
    s_lshl_b32 s39, s35, 5
    v_add_u32 v69, s39, v68
    v_mov_b32 v2, 0
    v_mov_b32 v9, 0
    v_mov_b32 v14, 0
    v_mov_b32 v75, 0
    v_mov_b32 v76, 0
    v_mov_b32 v77, 0
    s_waitcnt vmcnt(5)
    ds_read_b128 v[78:81], v62
    ds_read_b128 v[82:85], v62 offset:1024
    v_dot2c_f32_bf16 v75, 0x3f803f80, v16
    v_dot2c_f32_bf16 v75, 0x3f803f80, v17
    v_dot2c_f32_bf16 v75, 0x3f803f80, v18
    v_dot2c_f32_bf16 v75, 0x3f803f80, v19
    v_dot2c_f32_bf16 v75, 0x3f803f80, v20
    v_dot2c_f32_bf16 v75, 0x3f803f80, v21
    v_dot2c_f32_bf16 v75, 0x3f803f80, v22
    v_dot2c_f32_bf16 v75, 0x3f803f80, v23
    s_waitcnt lgkmcnt(0)
    v_dot2c_f32_bf16 v2, 0x3f803f80, v78
    v_dot2c_f32_bf16 v9, v78, v78
    v_dot2c_f32_bf16 v14, v78, v16
    v_dot2c_f32_bf16 v2, 0x3f803f80, v79
    v_dot2c_f32_bf16 v9, v79, v79
    v_dot2c_f32_bf16 v14, v79, v17
    v_dot2c_f32_bf16 v2, 0x3f803f80, v80
    v_dot2c_f32_bf16 v9, v80, v80
    v_dot2c_f32_bf16 v14, v80, v18
    v_dot2c_f32_bf16 v2, 0x3f803f80, v81
    v_dot2c_f32_bf16 v9, v81, v81
    v_dot2c_f32_bf16 v14, v81, v19
    v_dot2c_f32_bf16 v2, 0x3f803f80, v82
    v_dot2c_f32_bf16 v9, v82, v82
    v_dot2c_f32_bf16 v14, v82, v20
    v_dot2c_f32_bf16 v2, 0x3f803f80, v83
    v_dot2c_f32_bf16 v9, v83, v83
    v_dot2c_f32_bf16 v14, v83, v21
    v_dot2c_f32_bf16 v2, 0x3f803f80, v84
    v_dot2c_f32_bf16 v9, v84, v84
    v_dot2c_f32_bf16 v14, v84, v22
    v_dot2c_f32_bf16 v2, 0x3f803f80, v85
    v_dot2c_f32_bf16 v9, v85, v85
    v_dot2c_f32_bf16 v14, v85, v23
    s_nop 1
    v_permlane32_swap_b32 v2, v9
    v_permlane32_swap_b32 v14, v75
    v_add_f32 v2, v2, v9
    v_add_f32 v14, v14, v75
    s_nop 1
    v_permlane16_swap_b32 v2, v14
    v_add_f32 v2, v2, v14
    s_nop 1
    v_add_f32_dpp v2, v2, v2 row_ror:8 row_mask:0xf bank_mask:0xf
    s_nop 1
    v_add_f32_dpp v2, v2, v2 row_ror:4 row_mask:0xf bank_mask:0xf
    s_nop 1
    v_add_f32_dpp v2, v2, v2 row_ror:2 row_mask:0xf bank_mask:0xf
    s_nop 1
    v_add_f32_dpp v2, v2, v2 row_ror:1 row_mask:0xf bank_mask:0xf
    s_nop 0
    v_readlane_b32 s53, v2, 0
    v_readlane_b32 s54, v2, 32
    v_readlane_b32 s55, v2, 16
    v_readlane_b32 s56, v2, 48
    v_mul_f32 v110, s53, v37
    v_mul_f32 v9, s54, v37
    v_mov_b32 v14, s55
    v_fma_f32 v9, -v110, v110, v9
    v_fma_f32 v14, -v110, s56, v14
    v_max_f32 v9, 0, v9
    v_add_f32 v9, 0x3727c5ac, v9
    v_rsq_f32 v111, v9
    s_nop 0
    v_mul_f32 v14, v14, v111
    v_ashrrev_i32 v9, 31, v14
    v_or_b32 v9, 0x80000000, v9
    v_xor_b32 v9, v14, v9
    v_and_b32 v9, 0xfffff800, v9
    v_or_b32 v9, s41, v9
    s_mov_b64 exec, 1
    ds_write2_b32 v68, v9, v110 offset0:16 offset1:40
    ds_write_b32 v69, v111
    s_mov_b64 exec, -1
    s_waitcnt vmcnt(2)
    ds_read_b128 v[86:89], v63
    ds_read_b128 v[90:93], v63 offset:1024
    ds_read_b64_tr_b16 v[94:95], v64 offset:0
    ds_read_b64_tr_b16 v[96:97], v64 offset:256
    ds_read_b64_tr_b16 v[98:99], v65 offset:0
    ds_read_b64_tr_b16 v[100:101], v65 offset:256
    ds_read_b64_tr_b16 v[102:103], v64 offset:16384
    ds_read_b64_tr_b16 v[104:105], v64 offset:16640
    ds_read_b64_tr_b16 v[106:107], v65 offset:16384
    ds_read_b64_tr_b16 v[108:109], v65 offset:16640
    s_waitcnt lgkmcnt(10)
    s_barrier
    s_add_u32 m0, s46, 1024
    s_add_u32 s50, s44, 57344
    buffer_load_dwordx4 v25, s[12:15], s50 offen nt lds
    s_waitcnt lgkmcnt(8)
    v_dot2c_f32_bf16 v76, 0x3f803f80, v86
    v_dot2c_f32_bf16 v77, v86, v86
    v_dot2c_f32_bf16 v76, 0x3f803f80, v87
    v_dot2c_f32_bf16 v77, v87, v87
    v_dot2c_f32_bf16 v76, 0x3f803f80, v88
    v_dot2c_f32_bf16 v77, v88, v88
    v_dot2c_f32_bf16 v76, 0x3f803f80, v89
    v_dot2c_f32_bf16 v77, v89, v89
    v_dot2c_f32_bf16 v76, 0x3f803f80, v90
    v_dot2c_f32_bf16 v77, v90, v90
    v_dot2c_f32_bf16 v76, 0x3f803f80, v91
    v_dot2c_f32_bf16 v77, v91, v91
    v_dot2c_f32_bf16 v76, 0x3f803f80, v92
    v_dot2c_f32_bf16 v77, v92, v92
    v_dot2c_f32_bf16 v76, 0x3f803f80, v93
    v_dot2c_f32_bf16 v77, v93, v93
    s_nop 2
    v_permlane32_swap_b32 v76, v77
    v_mul_f32 v112, v36, v110
    v_mul_f32 v113, v36, v110
    v_mul_f32 v114, v36, v110
    v_mul_f32 v115, v36, v110
    v_add_f32 v76, v76, v77
    v_mov_b32 v77, v76
    s_waitcnt lgkmcnt(4)
    v_mfma_f32_16x16x32_bf16 v[120:123], v[94:97], v[10:13], v[112:115]
    v_permlane16_swap_b32 v76, v77
    v_mfma_f32_16x16x32_bf16 v[124:127], v[98:101], v[10:13], v[112:115]
    v_add_f32 v76, v76, v77
    s_nop 1
    v_add_f32_dpp v76, v76, v76 row_ror:8 row_mask:0xf bank_mask:0xf
    s_nop 1
    v_add_f32_dpp v76, v76, v76 row_ror:4 row_mask:0xf bank_mask:0xf
    s_nop 1
    v_add_f32_dpp v76, v76, v76 row_ror:2 row_mask:0xf bank_mask:0xf
    s_nop 1
    v_add_f32_dpp v76, v76, v76 row_ror:1 row_mask:0xf bank_mask:0xf
    s_nop 0
    v_readlane_b32 s53, v76, 0
    v_readlane_b32 s54, v76, 32
    v_cvt_pk_bf16_f32 v136, v120, v121
    v_cvt_pk_bf16_f32 v137, v122, v123
    v_cvt_pk_bf16_f32 v138, v124, v125
    v_cvt_pk_bf16_f32 v139, v126, v127
    v_mul_f32 v76, s53, v37
    v_mul_f32 v77, s54, v37
    ds_write_b128 v66, v[136:139]
    v_mul_f32 v116, v36, v76
    v_mul_f32 v117, v36, v76
    v_mul_f32 v118, v36, v76
    v_mul_f32 v119, v36, v76
    v_fma_f32 v77, -v76, v76, v77
    s_waitcnt lgkmcnt(1)
    v_mfma_f32_16x16x32_bf16 v[128:131], v[102:105], v[10:13], v[116:119]
    v_mfma_f32_16x16x32_bf16 v[132:135], v[106:109], v[10:13], v[116:119]
    v_max_f32 v77, 0, v77
    v_add_f32 v77, 0x3727c5ac, v77
    v_rsq_f32 v77, v77
    v_xor_b32 v69, 32, v69
    s_mov_b64 exec, 1
    ds_write_b32 v69, v77
    s_mov_b64 exec, -1
    v_cvt_pk_bf16_f32 v140, v128, v129
    v_cvt_pk_bf16_f32 v141, v130, v131
    v_cvt_pk_bf16_f32 v142, v132, v133
    v_cvt_pk_bf16_f32 v143, v134, v135
    ds_write_b128 v67, v[140:143] offset:512
    s_mul_i32 s38, s32, 2080
    s_add_u32 s38, s38, 32768
    v_sub_u32 v9, 4, v5
    v_and_b32 v9, 3, v9
    v_xor_b32 v9, v9, v4
    v_lshl_add_u32 v2, v3, 6, s38
    v_lshl_add_u32 v70, v9, 4, v2
    v_lshlrev_b32 v74, 4, v4
    v_lshlrev_b32 v9, 8, v4
    v_lshl_add_u32 v9, v3, 3, v9
    s_mul_i32 s38, s32, 1088
    s_add_u32 s38, s38, 49408
    v_add_u32 v71, s38, v9
    s_sub_u32 s38, 8, s32
    s_and_b32 s38, s38, 7
    s_mul_i32 s38, s38, 1088
    s_add_u32 s38, s38, 49412
    v_add_u32 v72, s38, v9
    s_lshl_b32 s38, s32, 7
    s_add_u32 s38, s38, 49408
    v_mul_u32_u24 v9, 1088, v5
    v_lshl_add_u32 v2, v4, 2, v6
    v_add_u32 v9, s38, v9
    v_lshl_add_u32 v73, v2, 3, v9
    v_lshlrev_b32 v2, 5, v3
    v_sub_u32 v2, s52, v2
    v_cvt_f32_u32 v2, v2
    v_mul_f32 v2, v37, v2
    v_mul_f32 v78, v2, v15
    v_fmamk_f32 v82, v2, 0x41800000, v78
    v_add_f32 v79, v78, v2
    v_add_f32 v83, v82, v2
    v_add_f32 v80, v79, v2
    v_add_f32 v84, v83, v2
    v_add_f32 v81, v80, v2
    v_add_f32 v85, v84, v2
    v_sin_f32 v144, v78
    v_sin_f32 v145, v79
    v_cos_f32 v78, v78
    v_cos_f32 v79, v79
    v_cvt_pk_bf16_f32 v54, v144, v145
    v_cvt_pk_bf16_f32 v50, v78, v79
    v_sin_f32 v144, v80
    v_sin_f32 v145, v81
    v_cos_f32 v80, v80
    v_cos_f32 v81, v81
    v_cvt_pk_bf16_f32 v55, v144, v145
    v_cvt_pk_bf16_f32 v51, v80, v81
    v_sin_f32 v144, v82
    v_sin_f32 v145, v83
    v_cos_f32 v82, v82
    v_cos_f32 v83, v83
    v_cvt_pk_bf16_f32 v56, v144, v145
    v_cvt_pk_bf16_f32 v52, v82, v83
    v_sin_f32 v144, v84
    v_sin_f32 v145, v85
    v_cos_f32 v84, v84
    v_cos_f32 v85, v85
    v_cvt_pk_bf16_f32 v57, v144, v145
    v_cvt_pk_bf16_f32 v53, v84, v85
    v_xor_b32 v58, 0x80008000, v50
    v_xor_b32 v59, 0x80008000, v51
    v_xor_b32 v60, 0x80008000, v52
    v_xor_b32 v61, 0x80008000, v53
    s_waitcnt lgkmcnt(0)
    s_barrier
    ds_read_b128 v[10:13], v70
    ds_read_b128 v[14:17], v70 offset:1040
    ds_read_b128 v[18:21], v74 offset:58112
    s_add_u32 m0, s46, 33792
    s_add_u32 s50, s44, 57344
    buffer_load_dwordx4 v25, s[16:19], s50 offen nt lds
    s_waitcnt lgkmcnt(1)
    s_cmp_eq_u32 s51, 0
    s_cbranch_scc1 SPECC
    v_mfma_f32_16x16x32_bf16 v[62:65], v[10:13], v[38:41], 0
    v_mfma_f32_16x16x32_bf16 v[66:69], v[10:13], v[46:49], 0
    v_mfma_f32_16x16x32_bf16 v[76:79], v[10:13], v[50:53], 0
    v_mfma_f32_16x16x32_bf16 v[80:83], v[10:13], v[54:57], 0
    v_mfma_f32_16x16x32_bf16 v[62:65], v[14:17], v[42:45], v[62:65]
    v_mfma_f32_16x16x32_bf16 v[66:69], v[14:17], v[38:41], v[66:69]
    v_mfma_f32_16x16x32_bf16 v[76:79], v[14:17], v[54:57], v[76:79]
    v_mfma_f32_16x16x32_bf16 v[80:83], v[14:17], v[58:61], v[80:83]
SPECD:
    s_waitcnt lgkmcnt(0)
    v_mul_f32 v28, v28, v18
    v_mul_f32 v29, v29, v19
    v_mul_f32 v30, v30, v20
    v_mul_f32 v31, v31, v21
    v_mul_f32 v32, v32, v18
    v_mul_f32 v33, v33, v19
    v_mul_f32 v34, v34, v20
    v_mul_f32 v35, v35, v21
    v_cvt_pk_bf16_f32 v84, v28, v29
    v_cvt_pk_bf16_f32 v85, v30, v31
    v_cvt_pk_bf16_f32 v86, v32, v33
    v_cvt_pk_bf16_f32 v87, v34, v35
    v_cvt_pk_bf16_f32 v88, v62, v63
    v_cvt_pk_bf16_f32 v89, v64, v65
    v_cvt_pk_bf16_f32 v90, v66, v67
    v_cvt_pk_bf16_f32 v91, v68, v69
    s_nop 1
    v_mfma_f32_16x16x32_bf16 v[10:13], v[84:87], v[88:91], 0
    v_cvt_pk_bf16_f32 v92, v76, v77
    v_cvt_pk_bf16_f32 v93, v78, v79
    v_cvt_pk_bf16_f32 v94, v80, v81
    v_cvt_pk_bf16_f32 v95, v82, v83
    s_nop 1
    v_mfma_f32_16x16x32_bf16 v[14:17], v[84:87], v[92:95], 0
    s_nop 0
    v_cvt_pk_bf16_f32 v88, v10, v11
    v_cvt_pk_bf16_f32 v89, v12, v13
    ds_write2_b32 v71, v88, v89 offset1:32
    s_nop 3
    v_cvt_pk_bf16_f32 v92, v14, v15
    v_cvt_pk_bf16_f32 v93, v16, v17
    ds_write2_b32 v72, v92, v93 offset1:32
    s_waitcnt lgkmcnt(0)
    s_barrier
    ds_read_b64_tr_b16 v[84:85], v73
    ds_read_b64_tr_b16 v[86:87], v73 offset:4352
    s_and_b32 s57, s34, 15
    s_lshr_b32 s58, s34, 4
    s_lshl3_add_u32 s38, s58, s32
    s_lshl_b32 s38, s38, 7
    s_add_u32 s38, s38, s33
    v_lshl_add_u32 v2, v3, 3, s38
    v_sub_u32 v9, 2048, v2
    v_and_b32 v9, 2047, v9
    s_waitcnt lgkmcnt(0)
    buffer_store_dwordx4 v[84:87], v8, s[8:11], s47 offen sc1
    s_lshl_b32 s38, s57, 6
    v_lshl_add_u32 v37, v4, 4, s38
    v_lshl_add_u32 v75, v2, 11, v37
    v_sub_u32 v37, 2032, v37
    v_lshl_add_u32 v22, v9, 11, v37
    buffer_load_dwordx4 v[98:101], v75, s[4:7], 0 offen
    buffer_load_dwordx4 v[102:105], v22, s[4:7], 0 offen
    s_add_u32 m0, s46, 2048
    s_add_u32 s50, s44, 114688
    buffer_load_dwordx4 v24, s[12:15], s50 offen nt lds
    v_and_b32 v37, 7, v2
    v_and_b32 v96, 0x7f8, v2
    v_lshl_add_u32 v23, v37, 11, v96
    v_and_b32 v37, 7, v9
    v_and_b32 v96, 0x7f8, v9
    v_lshl_add_u32 v36, v37, 11, v96
    v_cvt_f32_u32 v74, v2
    v_lshrrev_b32 v37, 5, v1
    v_lshlrev_b32 v96, 1, v7
    v_lshl_add_u32 v37, v37, 3, v96
    v_mul_f32 v74, 0x3a000000, v74
    v_cvt_f32_u32 v37, v37
    v_mul_f32 v10, 0x41800000, v74
    v_mul_f32 v12, v74, v37
    v_add_f32 v13, v12, v74
    v_fma_f32 v14, v74, 4.0, v12
    v_fma_f32 v15, v74, 4.0, v13
    v_cos_f32 v16, v12
    v_sin_f32 v38, v12
    v_cos_f32 v17, v13
    v_sin_f32 v39, v13
    v_cos_f32 v18, v14
    v_sin_f32 v40, v14
    v_cos_f32 v19, v15
    v_sin_f32 v41, v15
    v_add_f32 v12, v12, v10
    v_cvt_pk_bf16_f32 v38, v16, v38
    v_add_f32 v13, v13, v10
    v_cvt_pk_bf16_f32 v39, v17, v39
    v_add_f32 v14, v14, v10
    v_cvt_pk_bf16_f32 v40, v18, v40
    v_add_f32 v15, v15, v10
    v_cvt_pk_bf16_f32 v41, v19, v41
    v_cos_f32 v16, v12
    v_sin_f32 v42, v12
    v_cos_f32 v17, v13
    v_sin_f32 v43, v13
    v_cos_f32 v18, v14
    v_sin_f32 v44, v14
    v_cos_f32 v19, v15
    v_sin_f32 v45, v15
    v_add_f32 v12, v12, v10
    v_cvt_pk_bf16_f32 v42, v16, v42
    v_add_f32 v13, v13, v10
    v_cvt_pk_bf16_f32 v43, v17, v43
    v_add_f32 v14, v14, v10
    v_cvt_pk_bf16_f32 v44, v18, v44
    v_add_f32 v15, v15, v10
    v_cvt_pk_bf16_f32 v45, v19, v45
    s_add_u32 m0, s46, 34816
    s_add_u32 s50, s44, 114688
    buffer_load_dwordx4 v24, s[16:19], s50 offen nt lds
    v_cos_f32 v16, v12
    v_sin_f32 v46, v12
    v_cos_f32 v17, v13
    v_sin_f32 v47, v13
    v_cos_f32 v18, v14
    v_sin_f32 v48, v14
    v_cos_f32 v19, v15
    v_sin_f32 v49, v15
    v_add_f32 v12, v12, v10
    v_cvt_pk_bf16_f32 v46, v16, v46
    v_add_f32 v13, v13, v10
    v_cvt_pk_bf16_f32 v47, v17, v47
    v_add_f32 v14, v14, v10
    v_cvt_pk_bf16_f32 v48, v18, v48
    v_add_f32 v15, v15, v10
    v_cvt_pk_bf16_f32 v49, v19, v49
    v_cos_f32 v16, v12
    v_sin_f32 v50, v12
    v_cos_f32 v17, v13
    v_sin_f32 v51, v13
    v_cos_f32 v18, v14
    v_sin_f32 v52, v14
    v_cos_f32 v19, v15
    v_sin_f32 v53, v15
    v_add_f32 v12, v12, v10
    v_cvt_pk_bf16_f32 v50, v16, v50
    v_add_f32 v13, v13, v10
    v_cvt_pk_bf16_f32 v51, v17, v51
    v_add_f32 v14, v14, v10
    v_cvt_pk_bf16_f32 v52, v18, v52
    v_add_f32 v15, v15, v10
    v_cvt_pk_bf16_f32 v53, v19, v53
    s_add_u32 m0, s46, 3072
    s_add_u32 s50, s44, 172032
    buffer_load_dwordx4 v25, s[12:15], s50 offen nt lds
    v_cos_f32 v16, v12
    v_sin_f32 v54, v12
    v_cos_f32 v17, v13
    v_sin_f32 v55, v13
    v_cos_f32 v18, v14
    v_sin_f32 v56, v14
    v_cos_f32 v19, v15
    v_sin_f32 v57, v15
    v_add_f32 v12, v12, v10
    v_cvt_pk_bf16_f32 v54, v16, v54
    v_add_f32 v13, v13, v10
    v_cvt_pk_bf16_f32 v55, v17, v55
    v_add_f32 v14, v14, v10
    v_cvt_pk_bf16_f32 v56, v18, v56
    v_add_f32 v15, v15, v10
    v_cvt_pk_bf16_f32 v57, v19, v57
    v_cos_f32 v16, v12
    v_sin_f32 v58, v12
    v_cos_f32 v17, v13
    v_sin_f32 v59, v13
    v_cos_f32 v18, v14
    v_sin_f32 v60, v14
    v_cos_f32 v19, v15
    v_sin_f32 v61, v15
    v_add_f32 v12, v12, v10
    v_cvt_pk_bf16_f32 v58, v16, v58
    v_add_f32 v13, v13, v10
    v_cvt_pk_bf16_f32 v59, v17, v59
    v_add_f32 v14, v14, v10
    v_cvt_pk_bf16_f32 v60, v18, v60
    v_add_f32 v15, v15, v10
    v_cvt_pk_bf16_f32 v61, v19, v61
    s_add_u32 m0, s46, 35840
    s_add_u32 s50, s44, 172032
    buffer_load_dwordx4 v25, s[16:19], s50 offen nt lds
    v_cos_f32 v16, v12
    v_sin_f32 v62, v12
    v_cos_f32 v17, v13
    v_sin_f32 v63, v13
    v_cos_f32 v18, v14
    v_sin_f32 v64, v14
    v_cos_f32 v19, v15
    v_sin_f32 v65, v15
    v_add_f32 v12, v12, v10
    v_cvt_pk_bf16_f32 v62, v16, v62
    v_add_f32 v13, v13, v10
    v_cvt_pk_bf16_f32 v63, v17, v63
    v_add_f32 v14, v14, v10
    v_cvt_pk_bf16_f32 v64, v18, v64
    v_add_f32 v15, v15, v10
    v_cvt_pk_bf16_f32 v65, v19, v65
    v_cos_f32 v16, v12
    v_sin_f32 v66, v12
    v_cos_f32 v17, v13
    v_sin_f32 v67, v13
    v_cos_f32 v18, v14
    v_sin_f32 v68, v14
    v_cos_f32 v19, v15
    v_sin_f32 v69, v15
    v_cvt_pk_bf16_f32 v66, v16, v66
    v_cvt_pk_bf16_f32 v67, v17, v67
    v_cvt_pk_bf16_f32 v68, v18, v68
    v_cvt_pk_bf16_f32 v69, v19, v69
    v_and_b32 v37, 1, v3
    v_lshlrev_b32 v37, 31, v37
    v_or_b32 v37, 0x3f803f80, v37
    v_cmp_gt_u32 vcc, 16, v1
    s_nop 1
    v_cndmask_b32 v38, v38, v37, vcc
    s_lshl_b32 s38, s33, 18
    s_lshl_b32 s39, s32, 11
    s_add_u32 s38, s38, s39
    s_lshl_b32 s59, s57, 14
    s_add_u32 s59, s59, s38
    s_add_u32 s60, s57, 1
    s_and_b32 s60, s60, 15
    s_lshl_b32 s60, s60, 14
    s_add_u32 s60, s60, s38
    v_lshrrev_b32 v15, 2, v1
    v_and_b32 v16, 1, v1
    v_bfe_u32 v17, v1, 1, 1
    v_lshlrev_b32 v37, 7, v15
    v_lshl_add_u32 v8, v6, 4, v37
    v_lshl_add_u32 v74, v16, 4, v37
    s_mul_i32 s38, s32, 3072
    v_lshl_add_u32 v37, v15, 1, v16
    v_mul_u32_u24 v37, 96, v37
    v_add_u32 v11, s38, v37
    v_mad_u32_u24 v97, v17, 24, v11
    v_lshl_add_u32 v10, v17, 3, v11
    v_lshrrev_b32 v37, 5, v1
    v_lshl_add_u32 v96, v7, 2, v5
    v_lshl_add_u32 v37, v37, 4, v96
    v_mul_u32_u24 v37, 96, v37
    v_lshl_add_u32 v12, v6, 3, v37
    s_cmp_eq_u32 s57, 0
    s_cselect_b32 s38, 0x0908, 0
    s_xor_b32 s38, s38, 0x07060504
    v_cmp_eq_u32 vcc, 1, v17
    v_mov_b32 v37, 0x07060100
    v_mov_b32 v14, 0x07060504
    v_mov_b32 v13, s38
    v_cndmask_b32 v14, v14, v37, vcc
    v_cndmask_b32 v13, v13, v37, vcc
    v_lshrrev_b32 v37, 1, v5
    v_lshl_add_u32 v37, v7, 1, v37
    v_lshlrev_b32 v96, 10, v4
    v_lshl_add_u32 v96, v5, 7, v96
    v_lshl_add_u32 v96, v6, 3, v96
    v_lshl_add_u32 v96, v37, 5, v96
    s_add_u32 s38, s46, 65536
    v_add_u32 v19, s38, v96
    s_and_b32 s38, s32, 3
    s_lshl_b32 s38, s38, 5
    v_xor_b32 v96, s38, v96
    s_lshr_b32 s39, s32, 2
    s_lshl_b32 s38, s39, 15
    s_add_u32 s38, s38, 61440
    v_add_u32 v18, s38, v96
    v_lshlrev_b32 v37, 4, v16
    v_lshl_add_u32 v20, v4, 5, v37
    s_lshl_b32 s47, s49, 12
    s_add_u32 s47, s47, 2686976
    s_lshl_b32 s38, s48, 9
    s_add_u32 s41, s47, s38
    s_lshl_b32 s38, s39, 8
    s_add_u32 s41, s41, s38
    s_bfe_u32 s38, s32, 0x10001
    s_lshl_b32 s38, s38, 11
    s_add_u32 s41, s41, s38
    s_and_b32 s38, s32, 1
    s_lshl_b32 s38, s38, 7
    s_add_u32 s41, s41, s38
    s_cmp_lt_u32 s2, 224
    s_cselect_b32 s41, s41, 117440512
    s_lshl_b32 s38, s39, 11
    s_add_u32 s47, s47, s38
    v_lshl_add_u32 v37, v17, 8, v37
    v_lshl_add_u32 v37, v4, 6, v37
    v_and_b32 v96, 1, v5
    v_lshl_add_u32 v37, v96, 5, v37
    v_lshrrev_b32 v96, 1, v5
    v_lshl_add_u32 v21, v96, 10, v37
    v_mul_u32_u24 v37, 229376, v16
    v_lshl_add_u32 v37, v7, 5, v37
    v_lshrrev_b32 v96, 5, v1
    v_lshl_add_u32 v28, v96, 4, v37
    s_and_b32 s38, s32, 3
    s_lshl2_add_u32 s38, s48, s38
    s_mul_i32 s51, s38, 14336
    s_lshl1_add_u32 s38, s49, s39
    s_lshl_b32 s38, s38, 6
    s_add_u32 s51, s51, s38
    s_add_u32 s51, s51, 2228224
    v_lshlrev_b32 v29, 4, v1
    s_mov_b32 s52, 0x00030003
    s_mov_b32 s53, 0x00030003
    s_mov_b32 s56, 2097152
    s_mov_b32 s42, 0
    s_waitcnt vmcnt(4)
    v_lshlrev_b32 v76, 16, v98
    v_and_b32 v77, 0xffff0000, v98
    v_lshlrev_b32 v78, 16, v99
    v_and_b32 v79, 0xffff0000, v99
    v_lshlrev_b32 v80, 16, v100
    v_and_b32 v81, 0xffff0000, v100
    v_lshlrev_b32 v82, 16, v101
    v_and_b32 v83, 0xffff0000, v101
    v_lshlrev_b32 v84, 16, v102
    v_and_b32 v85, 0xffff0000, v102
    v_lshlrev_b32 v86, 16, v103
    v_and_b32 v87, 0xffff0000, v103
    v_lshlrev_b32 v88, 16, v104
    v_and_b32 v89, 0xffff0000, v104
    v_lshlrev_b32 v90, 16, v105
    v_and_b32 v91, 0xffff0000, v105
    s_barrier
    ds_read_b128 v[98:101], v29 offset:58368
    v_mov_b32 v37, 0
    ds_read_b64 v[92:93], v37 offset:58240
    buffer_load_dwordx4 v[30:33], v8, s[8:11], s59 offen sc1
    buffer_load_dwordx4 v[70:73], v8, s[8:11], s59 offen offset:64 sc1
    buffer_load_dword v15, v74, s[8:11], s60 offen sc1
    buffer_load_dwordx2 v[16:17], v23, s[8:11], s56 offen sc1
    buffer_load_dwordx2 v[34:35], v36, s[8:11], s56 offen sc1
    s_add_u32 m0, s46, 65536
    s_add_u32 s50, s45, 0
    buffer_load_dwordx4 v26, s[20:23], s50 offen nt lds
    s_add_u32 m0, s46, 66560
    s_add_u32 s50, s45, 16384
    buffer_load_dwordx4 v27, s[20:23], s50 offen nt lds
    s_waitcnt lgkmcnt(1)
    v_mov_b32_dpp v102, v98 row_shl:2 row_mask:0xf bank_mask:0xf
    v_mov_b32_dpp v103, v99 row_shl:2 row_mask:0xf bank_mask:0xf
    v_mov_b32_dpp v104, v100 row_shl:2 row_mask:0xf bank_mask:0xf
    v_mov_b32_dpp v105, v101 row_shl:2 row_mask:0xf bank_mask:0xf
    v_mov_b32_dpp v106, v98 row_shl:4 row_mask:0xf bank_mask:0xf
    v_mov_b32_dpp v107, v99 row_shl:4 row_mask:0xf bank_mask:0xf
    v_mov_b32_dpp v108, v100 row_shl:4 row_mask:0xf bank_mask:0xf
    v_mov_b32_dpp v109, v101 row_shl:4 row_mask:0xf bank_mask:0xf
    v_mov_b32_dpp v110, v98 row_shl:6 row_mask:0xf bank_mask:0xf
    v_mov_b32_dpp v111, v99 row_shl:6 row_mask:0xf bank_mask:0xf
    v_mov_b32_dpp v112, v100 row_shl:6 row_mask:0xf bank_mask:0xf
    v_mov_b32_dpp v113, v101 row_shl:6 row_mask:0xf bank_mask:0xf
    v_mov_b32_dpp v114, v98 row_shl:8 row_mask:0xf bank_mask:0xf
    v_mov_b32_dpp v115, v99 row_shl:8 row_mask:0xf bank_mask:0xf
    v_mov_b32_dpp v116, v100 row_shl:8 row_mask:0xf bank_mask:0xf
    v_mov_b32_dpp v117, v101 row_shl:8 row_mask:0xf bank_mask:0xf
    v_mov_b32_dpp v118, v98 row_shl:10 row_mask:0xf bank_mask:0xf
    v_mov_b32_dpp v119, v99 row_shl:10 row_mask:0xf bank_mask:0xf
    v_mov_b32_dpp v120, v100 row_shl:10 row_mask:0xf bank_mask:0xf
    v_mov_b32_dpp v121, v101 row_shl:10 row_mask:0xf bank_mask:0xf
    v_mov_b32_dpp v122, v98 row_shl:12 row_mask:0xf bank_mask:0xf
    v_mov_b32_dpp v123, v99 row_shl:12 row_mask:0xf bank_mask:0xf
    v_mov_b32_dpp v124, v100 row_shl:12 row_mask:0xf bank_mask:0xf
    v_mov_b32_dpp v125, v101 row_shl:12 row_mask:0xf bank_mask:0xf
    v_mov_b32_dpp v126, v98 row_shl:14 row_mask:0xf bank_mask:0xf
    v_mov_b32_dpp v127, v99 row_shl:14 row_mask:0xf bank_mask:0xf
    v_mov_b32_dpp v128, v100 row_shl:14 row_mask:0xf bank_mask:0xf
    v_mov_b32_dpp v129, v101 row_shl:14 row_mask:0xf bank_mask:0xf
    s_waitcnt vmcnt(7)
    s_barrier
    ds_read_b64_tr_b16 v[130:131], v18 offset:0
    ds_read_b64_tr_b16 v[132:133], v18 offset:512
    ds_read_b64_tr_b16 v[134:135], v18 offset:4096
    ds_read_b64_tr_b16 v[136:137], v18 offset:4608
    ds_read_b64_tr_b16 v[138:139], v18 offset:8192
    ds_read_b64_tr_b16 v[140:141], v18 offset:8704
    ds_read_b64_tr_b16 v[142:143], v18 offset:12288
    ds_read_b64_tr_b16 v[144:145], v18 offset:12800
    v_cmp_eq_u32 s[34:35], v2, v92
    v_cmp_eq_u32 vcc, v2, v93
    v_cmp_eq_u32 s[36:37], v9, v92
    v_cmp_eq_u32 s[48:49], v9, v93
    v_bfrev_b32 v37, 1
    v_lshlrev_b32 v96, 5, v4
    v_cndmask_b32 v2, 0, 64, vcc
    v_cndmask_b32 v9, 0, 64, s[48:49]
    s_waitcnt lgkmcnt(6)
    v_mfma_f32_16x16x32_bf16 v[146:149], v[130:133], v[98:101], 0
    ds_read_b64_tr_b16 v[130:131], v18 offset:16384
    ds_read_b64_tr_b16 v[132:133], v18 offset:16896
    s_waitcnt lgkmcnt(6)
    v_mfma_f32_16x16x32_bf16 v[150:153], v[134:137], v[102:105], 0
    ds_read_b64_tr_b16 v[134:135], v18 offset:20480
    ds_read_b64_tr_b16 v[136:137], v18 offset:20992
    s_waitcnt lgkmcnt(6)
    v_mfma_f32_16x16x32_bf16 v[146:149], v[138:141], v[106:109], v[146:149]
    ds_read_b64_tr_b16 v[138:139], v18 offset:24576
    ds_read_b64_tr_b16 v[140:141], v18 offset:25088
    s_waitcnt lgkmcnt(6)
    v_mfma_f32_16x16x32_bf16 v[150:153], v[142:145], v[110:113], v[150:153]
    ds_read_b64_tr_b16 v[142:143], v18 offset:28672
    ds_read_b64_tr_b16 v[144:145], v18 offset:29184
    s_waitcnt lgkmcnt(6)
    v_mfma_f32_16x16x32_bf16 v[146:149], v[130:133], v[114:117], v[146:149]
    s_waitcnt lgkmcnt(4)
    v_mfma_f32_16x16x32_bf16 v[150:153], v[134:137], v[118:121], v[150:153]
    s_waitcnt lgkmcnt(2)
    v_mfma_f32_16x16x32_bf16 v[146:149], v[138:141], v[122:125], v[146:149]
    s_waitcnt lgkmcnt(0)
    v_mfma_f32_16x16x32_bf16 v[150:153], v[142:145], v[126:129], v[150:153]
    s_or_b64 s[34:35], s[34:35], vcc
    s_or_b64 s[36:37], s[36:37], s[48:49]
    v_lshl_add_u32 v2, v2, 1, v96
    v_sub_u32 v96, 96, v96
    v_lshl_add_u32 v9, v9, 1, v96
    v_cndmask_b32 v75, v75, v37, s[34:35]
    v_cndmask_b32 v22, v22, v37, s[36:37]
    s_nop 0
    v_add_f32 v146, v146, v150
    v_add_f32 v147, v147, v151
    v_add_f32 v148, v148, v152
    v_add_f32 v149, v149, v153
    s_mov_b64 exec, s[52:53]
    buffer_store_dwordx4 v[146:149], v20, s[8:11], s41 offen sc1
    s_mov_b64 exec, -1
    s_add_u32 m0, s46, 67584
    s_add_u32 s50, s45, 32768
    buffer_load_dwordx4 v26, s[20:23], s50 offen nt lds
    s_add_u32 m0, s46, 68608
    s_add_u32 s50, s45, 49152
    buffer_load_dwordx4 v27, s[20:23], s50 offen nt lds
    s_waitcnt vmcnt(5)
UCHK:
    v_max3_u32 v37, v30, v31, v32
    v_max3_u32 v96, v70, v71, v72
    v_max3_u32 v37, v37, v33, v73
    v_max3_u32 v96, v96, v15, v16
    v_max3_u32 v37, v37, v17, v34
    v_max3_u32 v37, v37, v96, v35
    v_cmp_eq_u32 vcc, -1, v37
    s_cbranch_vccnz URETRY
UOK:
    v_perm_b32 v37, v30, v70, v13
    v_perm_b32 v70, v70, v30, v14
    ds_write_b32 v11, v15 offset:32
    v_mov_b32 v30, v37
    ds_write_b64 v97, v[32:33] offset:40
    ds_write_b64 v10, v[72:73] offset:48
    ds_write_b64 v10, v[70:71] offset:8
    ds_write_b64 v97, v[30:31]
    v_mul_f32 v17, -v16, v17
    v_add_f32 v16, 1.0, v16
    v_mul_f32 v35, -v34, v35
    v_add_f32 v34, 1.0, v34
    v_fma_f32 v76, v76, v16, v17
    v_fma_f32 v77, v77, v16, v17
    v_fma_f32 v78, v78, v16, v17
    v_fma_f32 v79, v79, v16, v17
    v_fma_f32 v80, v80, v16, v17
    v_fma_f32 v81, v81, v16, v17
    v_fma_f32 v82, v82, v16, v17
    v_fma_f32 v83, v83, v16, v17
    v_fma_f32 v84, v84, v34, v35
    v_fma_f32 v85, v85, v34, v35
    v_fma_f32 v86, v86, v34, v35
    v_fma_f32 v87, v87, v34, v35
    v_fma_f32 v88, v88, v34, v35
    v_fma_f32 v89, v89, v34, v35
    v_fma_f32 v90, v90, v34, v35
    v_fma_f32 v91, v91, v34, v35
    s_waitcnt lgkmcnt(0)
    s_barrier
    ds_read_b64_tr_b16 v[98:99], v12 offset:0
    ds_read_b64_tr_b16 v[100:101], v12 offset:768
    ds_read_b64_tr_b16 v[102:103], v12 offset:40
    ds_read_b64_tr_b16 v[104:105], v12 offset:808
    ds_read_b64_tr_b16 v[106:107], v12 offset:8
    ds_read_b64_tr_b16 v[108:109], v12 offset:776
    ds_read_b64_tr_b16 v[110:111], v12 offset:3072
    ds_read_b64_tr_b16 v[112:113], v12 offset:3840
    ds_read_b64_tr_b16 v[114:115], v12 offset:3112
    ds_read_b64_tr_b16 v[116:117], v12 offset:3880
    ds_read_b64_tr_b16 v[118:119], v12 offset:3080
    ds_read_b64_tr_b16 v[120:121], v12 offset:3848
    s_waitcnt lgkmcnt(10)
    v_mfma_f32_16x16x32_bf16 v[30:33], v[98:101], v[38:41], 0
    s_waitcnt lgkmcnt(8)
    v_mfma_f32_16x16x32_bf16 v[70:73], v[102:105], v[38:41], 0
    s_waitcnt lgkmcnt(6)
    v_mfma_f32_16x16x32_bf16 v[92:95], v[106:109], v[38:41], 0
    ds_read_b64_tr_b16 v[98:99], v12 offset:6144
    ds_read_b64_tr_b16 v[100:101], v12 offset:6912
    ds_read_b64_tr_b16 v[102:103], v12 offset:6184
    ds_read_b64_tr_b16 v[104:105], v12 offset:6952
    ds_read_b64_tr_b16 v[106:107], v12 offset:6152
    ds_read_b64_tr_b16 v[108:109], v12 offset:6920
    s_waitcnt lgkmcnt(10)
    v_mfma_f32_16x16x32_bf16 v[30:33], v[110:113], v[42:45], v[30:33]
    s_waitcnt lgkmcnt(8)
    v_mfma_f32_16x16x32_bf16 v[70:73], v[114:117], v[42:45], v[70:73]
    s_waitcnt lgkmcnt(6)
    v_mfma_f32_16x16x32_bf16 v[92:95], v[118:121], v[42:45], v[92:95]
    ds_read_b64_tr_b16 v[110:111], v12 offset:9216
    ds_read_b64_tr_b16 v[112:113], v12 offset:9984
    ds_read_b64_tr_b16 v[114:115], v12 offset:9256
    ds_read_b64_tr_b16 v[116:117], v12 offset:10024
    ds_read_b64_tr_b16 v[118:119], v12 offset:9224
    ds_read_b64_tr_b16 v[120:121], v12 offset:9992
    s_waitcnt lgkmcnt(10)
    v_mfma_f32_16x16x32_bf16 v[30:33], v[98:101], v[46:49], v[30:33]
    s_waitcnt lgkmcnt(8)
    v_mfma_f32_16x16x32_bf16 v[70:73], v[102:105], v[46:49], v[70:73]
    s_waitcnt lgkmcnt(6)
    v_mfma_f32_16x16x32_bf16 v[92:95], v[106:109], v[46:49], v[92:95]
    ds_read_b64_tr_b16 v[98:99], v12 offset:12288
    ds_read_b64_tr_b16 v[100:101], v12 offset:13056
    ds_read_b64_tr_b16 v[102:103], v12 offset:12328
    ds_read_b64_tr_b16 v[104:105], v12 offset:13096
    ds_read_b64_tr_b16 v[106:107], v12 offset:12296
    ds_read_b64_tr_b16 v[108:109], v12 offset:13064
    s_waitcnt lgkmcnt(10)
    v_mfma_f32_16x16x32_bf16 v[30:33], v[110:113], v[50:53], v[30:33]
    s_waitcnt lgkmcnt(8)
    v_mfma_f32_16x16x32_bf16 v[70:73], v[114:117], v[50:53], v[70:73]
    s_waitcnt lgkmcnt(6)
    v_mfma_f32_16x16x32_bf16 v[92:95], v[118:121], v[50:53], v[92:95]
    ds_read_b64_tr_b16 v[110:111], v12 offset:15360
    ds_read_b64_tr_b16 v[112:113], v12 offset:16128
    ds_read_b64_tr_b16 v[114:115], v12 offset:15400
    ds_read_b64_tr_b16 v[116:117], v12 offset:16168
    ds_read_b64_tr_b16 v[118:119], v12 offset:15368
    ds_read_b64_tr_b16 v[120:121], v12 offset:16136
    buffer_load_dwordx4 v[122:125], v21, s[8:11], s47 offen sc1
    buffer_load_dwordx4 v[126:129], v21, s[8:11], s47 offen offset:512 sc1
    s_waitcnt lgkmcnt(10)
    v_mfma_f32_16x16x32_bf16 v[30:33], v[98:101], v[54:57], v[30:33]
    s_waitcnt lgkmcnt(8)
    v_mfma_f32_16x16x32_bf16 v[70:73], v[102:105], v[54:57], v[70:73]
    s_waitcnt lgkmcnt(6)
    v_mfma_f32_16x16x32_bf16 v[92:95], v[106:109], v[54:57], v[92:95]
    ds_read_b64_tr_b16 v[98:99], v12 offset:18432
    ds_read_b64_tr_b16 v[100:101], v12 offset:19200
    ds_read_b64_tr_b16 v[102:103], v12 offset:18472
    ds_read_b64_tr_b16 v[104:105], v12 offset:19240
    ds_read_b64_tr_b16 v[106:107], v12 offset:18440
    ds_read_b64_tr_b16 v[108:109], v12 offset:19208
    s_waitcnt lgkmcnt(10)
    v_mfma_f32_16x16x32_bf16 v[30:33], v[110:113], v[58:61], v[30:33]
    s_waitcnt lgkmcnt(8)
    v_mfma_f32_16x16x32_bf16 v[70:73], v[114:117], v[58:61], v[70:73]
    s_waitcnt lgkmcnt(6)
    v_mfma_f32_16x16x32_bf16 v[92:95], v[118:121], v[58:61], v[92:95]
    ds_read_b64_tr_b16 v[110:111], v12 offset:21504
    ds_read_b64_tr_b16 v[112:113], v12 offset:22272
    ds_read_b64_tr_b16 v[114:115], v12 offset:21544
    ds_read_b64_tr_b16 v[116:117], v12 offset:22312
    ds_read_b64_tr_b16 v[118:119], v12 offset:21512
    ds_read_b64_tr_b16 v[120:121], v12 offset:22280
    s_waitcnt lgkmcnt(10)
    v_mfma_f32_16x16x32_bf16 v[30:33], v[98:101], v[62:65], v[30:33]
    s_waitcnt lgkmcnt(8)
    v_mfma_f32_16x16x32_bf16 v[70:73], v[102:105], v[62:65], v[70:73]
    s_waitcnt lgkmcnt(6)
    v_mfma_f32_16x16x32_bf16 v[92:95], v[106:109], v[62:65], v[92:95]
    s_waitcnt lgkmcnt(4)
    v_mfma_f32_16x16x32_bf16 v[30:33], v[110:113], v[66:69], v[30:33]
    s_waitcnt lgkmcnt(2)
    v_mfma_f32_16x16x32_bf16 v[70:73], v[114:117], v[66:69], v[70:73]
    s_waitcnt lgkmcnt(0)
    v_mfma_f32_16x16x32_bf16 v[92:95], v[118:121], v[66:69], v[92:95]
    s_nop 3
    v_add_f32 v76, v76, v30
    v_add_f32 v77, v77, v31
    v_add_f32 v78, v78, v32
    v_add_f32 v79, v79, v33
    v_add_f32 v89, v89, v33
    v_add_f32 v90, v90, v32
    v_add_f32 v91, v91, v31
    v_add_f32 v80, v80, v70
    v_add_f32 v85, v85, v73
    v_add_f32 v81, v81, v71
    v_add_f32 v86, v86, v72
    v_add_f32 v82, v82, v72
    v_add_f32 v87, v87, v71
    v_add_f32 v83, v83, v73
    v_add_f32 v88, v88, v70
    v_add_f32 v84, v84, v92
    v_cvt_pk_bf16_f32 v98, v76, v77
    v_cvt_pk_bf16_f32 v99, v78, v79
    v_cvt_pk_bf16_f32 v100, v80, v81
    v_cvt_pk_bf16_f32 v101, v82, v83
    v_cvt_pk_bf16_f32 v102, v84, v85
    v_cvt_pk_bf16_f32 v103, v86, v87
    v_cvt_pk_bf16_f32 v104, v88, v89
    v_cvt_pk_bf16_f32 v105, v90, v91
    s_or_b64 vcc, s[34:35], s[36:37]
    s_cbranch_scc1 FINW
FIND:
    s_cmp_ge_u32 s2, 224
    s_cbranch_scc1 COUT
    v_xor_b32 v107, 32, v19
    v_xor_b32 v108, 64, v19
    v_xor_b32 v109, 96, v19
    s_waitcnt vmcnt(2)
    ds_read_b64_tr_b16 v[30:31], v19 offset:0
    ds_read_b64_tr_b16 v[32:33], v19 offset:512
    ds_read_b64_tr_b16 v[38:39], v107 offset:0
    ds_read_b64_tr_b16 v[40:41], v107 offset:512
    ds_read_b64_tr_b16 v[42:43], v108 offset:0
    ds_read_b64_tr_b16 v[44:45], v108 offset:512
    ds_read_b64_tr_b16 v[46:47], v109 offset:0
    ds_read_b64_tr_b16 v[48:49], v109 offset:512
    s_mov_b32 s42, 0
    s_waitcnt vmcnt(0)
HCHK:
    v_add_f32 v122, v122, v126
    v_add_f32 v123, v123, v127
    v_add_f32 v124, v124, v128
    v_add_f32 v125, v125, v129
    v_add_f32_dpp v122, v122, v122 row_ror:8 row_mask:0xf bank_mask:0xf
    v_add_f32_dpp v123, v123, v123 row_ror:8 row_mask:0xf bank_mask:0xf
    v_add_f32_dpp v124, v124, v124 row_ror:8 row_mask:0xf bank_mask:0xf
    v_add_f32_dpp v125, v125, v125 row_ror:8 row_mask:0xf bank_mask:0xf
    v_cmp_u_f32 vcc, v122, v123
    v_cmp_u_f32 s[48:49], v124, v125
    v_mov_b32_dpp v70, v122 quad_perm:[0,1,0,1] row_mask:0xf bank_mask:0xf
    v_mov_b32_dpp v71, v123 quad_perm:[0,1,0,1] row_mask:0xf bank_mask:0xf
    v_mov_b32_dpp v72, v124 quad_perm:[0,1,0,1] row_mask:0xf bank_mask:0xf
    v_mov_b32_dpp v73, v125 quad_perm:[0,1,0,1] row_mask:0xf bank_mask:0xf
    s_or_b64 vcc, vcc, s[48:49]
    s_cbranch_scc1 HRETRY
HOK:
    v_mul_f32 v66, 0xbfb8aa3b, v70
    v_mul_f32 v67, 0xbfb8aa3b, v71
    v_mul_f32 v68, 0xbfb8aa3b, v72
    v_mul_f32 v69, 0xbfb8aa3b, v73
    v_exp_f32 v66, v66
    v_mul_f32_dpp v70, v122, v70 quad_perm:[2,3,2,3] row_mask:0xf bank_mask:0xf
    v_exp_f32 v67, v67
    v_mul_f32_dpp v71, v123, v71 quad_perm:[2,3,2,3] row_mask:0xf bank_mask:0xf
    v_exp_f32 v68, v68
    v_mul_f32_dpp v72, v124, v72 quad_perm:[2,3,2,3] row_mask:0xf bank_mask:0xf
    v_exp_f32 v69, v69
    v_mul_f32_dpp v73, v125, v73 quad_perm:[2,3,2,3] row_mask:0xf bank_mask:0xf
    v_add_f32 v66, 1.0, v66
    v_add_f32 v67, 1.0, v67
    v_add_f32 v68, 1.0, v68
    v_add_f32 v69, 1.0, v69
    v_rcp_f32 v66, v66
    v_rcp_f32 v67, v67
    v_rcp_f32 v68, v68
    v_rcp_f32 v69, v69
    v_mul_f32 v70, v70, v66
    v_mul_f32 v71, v71, v67
    v_mul_f32 v72, v72, v68
    v_mul_f32 v73, v73, v69
    v_cvt_pk_bf16_f32 v92, v70, v71
    v_cvt_pk_bf16_f32 v93, v72, v73
    s_add_u32 s47, s51, 7168
    v_mov_b32_dpp v94, v92 row_shl:4 row_mask:0xf bank_mask:0xf
    v_mov_b32_dpp v95, v93 row_shl:4 row_mask:0xf bank_mask:0xf
    s_waitcnt lgkmcnt(6)
    s_nop 0
    v_mfma_f32_16x16x32_bf16 v[50:53], v[30:33], v[92:95], 0
    s_waitcnt lgkmcnt(4)
    v_mfma_f32_16x16x32_bf16 v[54:57], v[38:41], v[92:95], 0
    s_waitcnt lgkmcnt(2)
    v_mfma_f32_16x16x32_bf16 v[58:61], v[42:45], v[92:95], 0
    s_waitcnt lgkmcnt(0)
    v_mfma_f32_16x16x32_bf16 v[62:65], v[46:49], v[92:95], 0
    s_nop 1
    v_cvt_pk_bf16_f32 v66, v50, v51
    v_cvt_pk_bf16_f32 v67, v52, v53
    v_cvt_pk_bf16_f32 v68, v54, v55
    v_cvt_pk_bf16_f32 v69, v56, v57
    s_nop 0
    v_permlane16_swap_b32 v66, v68
    v_permlane16_swap_b32 v67, v69
    s_mov_b64 exec, s[52:53]
    buffer_store_dwordx4 v[66:69], v28, s[8:11], s51 offen sc1
    s_mov_b64 exec, -1
    v_cvt_pk_bf16_f32 v70, v58, v59
    v_cvt_pk_bf16_f32 v71, v60, v61
    v_cvt_pk_bf16_f32 v72, v62, v63
    v_cvt_pk_bf16_f32 v73, v64, v65
    s_nop 0
    v_permlane16_swap_b32 v70, v72
    v_permlane16_swap_b32 v71, v73
    s_mov_b64 exec, s[52:53]
    buffer_store_dwordx4 v[70:73], v28, s[8:11], s47 offen sc1
    s_mov_b64 exec, -1
COUT:
    buffer_store_dwordx4 v[98:101], v75, s[24:27], 0 offen
    buffer_store_dwordx4 v[102:105], v22, s[24:27], 0 offen
END:
    s_endpgm
BFQ0:
    v_lshrrev_b32 v14, 5, v1
    v_cmp_eq_u32 s[100:101], v14, v9
    v_mul_f32 v9, 0x40f00000, v2
    v_cndmask_b32 v9, v9, 0, vcc
    v_cndmask_b32 v2, -v2, v2, vcc
    v_cndmask_b32 v9, -v62, v9, s[100:101]
    v_cndmask_b32 v2, 0, v2, s[100:101]
    v_cndmask_b32 v62, 0, v62, s[100:101]
    s_branch BFGO
SPECC:
    v_mfma_f32_16x16x32_bf16 v[62:65], v[10:13], v[38:41], 0
    v_mfma_f32_16x16x32_bf16 v[66:69], v[10:13], v[46:49], 0
    v_mfma_f32_16x16x32_bf16 v[76:79], v[14:17], v[50:53], 0
    v_mfma_f32_16x16x32_bf16 v[80:83], v[14:17], v[54:57], 0
    s_nop 4
    s_branch SPECD
URETRY:
    s_add_u32 s42, s42, 1
    s_cmp_ge_u32 s42, 4096
    s_cbranch_scc1 UOK
    buffer_load_dwordx4 v[30:33], v8, s[8:11], s59 offen sc1
    buffer_load_dwordx4 v[70:73], v8, s[8:11], s59 offen offset:64 sc1
    buffer_load_dword v15, v74, s[8:11], s60 offen sc1
    buffer_load_dwordx2 v[16:17], v23, s[8:11], s56 offen sc1
    buffer_load_dwordx2 v[34:35], v36, s[8:11], s56 offen sc1
    s_waitcnt vmcnt(0)
    s_branch UCHK
HRETRY:
    s_add_u32 s42, s42, 1
    s_cmp_ge_u32 s42, 4096
    s_nop 1
    s_cbranch_scc1 HOK
    buffer_load_dwordx4 v[122:125], v21, s[8:11], s47 offen sc1
    buffer_load_dwordx4 v[126:129], v21, s[8:11], s47 offen offset:512 sc1
    s_waitcnt vmcnt(0)
    s_branch HCHK
FINW:
    s_mov_b64 exec, s[34:35]
    ds_write_b128 v2, v[76:79] offset:60416
    ds_write_b128 v2, v[80:83] offset:60432
    s_mov_b64 exec, s[36:37]
    ds_write_b128 v9, v[84:87] offset:60672
    ds_write_b128 v9, v[88:91] offset:60688
    s_mov_b64 exec, -1
    s_waitcnt lgkmcnt(0)
    s_branch FIND
COMM:
    s_setprio 3
    v_mov_b32 v10, 0
    s_mov_b32 s41, 2129920
    v_mov_b32 v6, -1
    v_mov_b32 v7, -1
    v_mov_b32 v8, -1
    v_mov_b32 v9, -1
    s_lshr_b32 s46, s40, 2
    s_and_b32 s47, s40, 3
    v_lshlrev_b32 v15, 4, v1
    v_lshrrev_b32 v11, 5, v1
    v_and_b32 v12, 0x1f0, v15
    v_lshl_add_u32 v14, v11, 11, v12
    s_lshl3_add_u32 s38, s46, s47
    s_lshl_b32 s38, s38, 9
    s_add_u32 s38, s38, 2686976
    s_mul_i32 s39, s47, 57344
    s_lshl_b32 s43, s46, 7
    s_add_u32 s39, s39, s43
    s_add_u32 s39, s39, 2228224
    s_cmp_lt_u32 s2, 224
    s_cselect_b32 s38, s38, 117440512
    s_cselect_b32 s39, s39, 117440512
    v_lshrrev_b32 v11, 3, v1
    v_and_b32 v12, 0x70, v15
    v_mul_u32_u24 v11, 7168, v11
    v_add_u32 v16, v11, v12
    v_lshlrev_b32 v12, 8, v1
    v_add_u32 v11, s36, v12
    v_sub_u32 v12, s37, v12
    s_cmp_eq_u32 s35, 0
    s_cselect_b64 vcc, 0, -1
    v_cndmask_b32 v11, v11, v12, vcc
    v_and_b32 v12, 7, v11
    v_and_b32 v11, 0x7f8, v11
    v_lshl_add_u32 v13, v12, 11, v11
    s_mov_b32 s42, 2097152
    v_lshlrev_b32 v11, 3, v1
    s_waitcnt lgkmcnt(0)
    buffer_load_dwordx2 v[4:5], v10, s[8:11], s41 offen sc1
    buffer_store_dwordx4 v[6:9], v14, s[8:11], s38 offen sc1
    buffer_store_dwordx4 v[6:9], v16, s[8:11], s39 offen sc1
    s_add_u32 s39, s39, 229376
    buffer_store_dwordx4 v[6:9], v16, s[8:11], s39 offen sc1
    s_mov_b64 exec, 0xff
    buffer_store_dwordx2 v[6:7], v13, s[8:11], s42 offen sc1
    s_mov_b64 exec, -1
    ds_write_b64 v11, v[6:7] offset:60416
    v_lshlrev_b32 v14, 12, v1
    s_and_b32 s3, s2, 3
    s_lshl_b32 s43, s3, 10
    s_and_b32 s3, s2, 0xfc
    s_lshl2_add_u32 s43, s3, s43
    s_add_u32 s43, s43, 2162688
    s_lshl_b32 s44, s33, 12
    s_add_u32 s44, s44, 2162688
    s_mov_b32 s45, 0
    s_lshl_b32 s38, s35, 5
    v_lshlrev_b32 v18, 2, v1
    v_add_u32 v17, s38, v18
    v_lshrrev_b32 v11, 4, v1
    v_bfe_u32 v12, v1, 1, 3
    v_lshl_add_u32 v11, v12, 2, v11
    s_lshl_b32 s38, s47, 9
    v_lshl_add_u32 v16, v11, 4, s38
    s_mov_b32 s56, 0xaaaaaaaa
    s_mov_b32 s57, 0xaaaaaaaa
    s_waitcnt vmcnt(4)
    v_add_u32 v4, 2, v4
    v_or_b32 v4, 1, v4
    v_readfirstlane_b32 s49, v5
    v_readfirstlane_b32 s48, v4
    s_waitcnt lgkmcnt(0)
    s_barrier
    ds_read_b128 v[20:23], v10 offset:58176
    ds_read_b128 v[24:27], v10 offset:58192
    ds_read_b32 v28, v17 offset:58112
    ds_read_b32 v29, v18 offset:58272
    s_waitcnt lgkmcnt(3)
    v_max3_u32 v19, v20, v21, v22
    v_med3_u32 v30, v20, v21, v22
    s_waitcnt lgkmcnt(2)
    v_max3_u32 v31, v23, v24, v25
    v_med3_u32 v32, v23, v24, v25
    v_med3_u32 v12, v19, v31, v26
    v_max3_u32 v19, v19, v31, v26
    v_max3_u32 v12, v12, v30, v32
    v_max_u32 v2, v19, v27
    v_med3_u32 v3, v19, v12, v27
    s_mov_b64 exec, 0xff
    s_waitcnt vmcnt(0)
    buffer_store_dwordx4 v[2:5], v14, s[8:11], s43 offen sc1
    s_waitcnt lgkmcnt(0)
    buffer_store_dwordx2 v[28:29], v13, s[8:11], s42 offen sc1
    s_mov_b64 exec, -1
    v_readfirstlane_b32 s50, v2
    v_readfirstlane_b32 s51, v3
    s_barrier
    s_barrier
POLLA:
    v_mov_b32 v11, s50
    v_mov_b32 v12, s51
    s_mov_b64 s[52:53], s[50:51]
    v_cndmask_b32 v11, v11, v12, s[56:57]
    v_and_b32 v31, 0x7ff, v11
    v_and_b32 v12, 7, v11
    v_and_b32 v11, 0x7f8, v11
    v_lshl_add_u32 v32, v31, 11, v16
    v_lshl_add_u32 v11, v12, 11, v11
    buffer_load_dwordx4 v[20:23], v32, s[4:7], 0 offen
    buffer_load_dwordx2 v[28:29], v11, s[8:11], s42 offen sc1
    buffer_load_dwordx4 v[34:37], v15, s[8:11], s44 offen offset:0 sc1
    buffer_load_dwordx4 v[38:41], v15, s[8:11], s44 offen offset:1024 sc1
    buffer_load_dwordx4 v[42:45], v15, s[8:11], s44 offen offset:2048 sc1
    buffer_load_dwordx4 v[46:49], v15, s[8:11], s44 offen offset:3072 sc1
    s_mov_b64 exec, 3
    ds_write_b32 v18, v31 offset:58240
    s_mov_b64 exec, -1
    s_waitcnt vmcnt(5)
    v_lshlrev_b32 v50, 16, v20
    v_and_b32 v51, 0xffff0000, v20
    v_lshlrev_b32 v52, 16, v21
    v_and_b32 v53, 0xffff0000, v21
    v_lshlrev_b32 v54, 16, v22
    v_and_b32 v55, 0xffff0000, v22
    v_lshlrev_b32 v56, 16, v23
    v_and_b32 v57, 0xffff0000, v23
    s_waitcnt vmcnt(4)
    v_max_u32 v11, v28, v29
    v_mul_f32 v29, -v28, v29
    v_cmp_ne_u32 s[54:55], -1, v11
    v_fma_f32 v50, v50, v28, v29
    v_fma_f32 v51, v51, v28, v29
    v_fma_f32 v52, v52, v28, v29
    v_fma_f32 v53, v53, v28, v29
    v_fma_f32 v54, v54, v28, v29
    v_fma_f32 v55, v55, v28, v29
    v_fma_f32 v56, v56, v28, v29
    v_fma_f32 v57, v57, v28, v29
    v_cvt_pk_bf16_f32 v20, v50, v51
    v_cvt_pk_bf16_f32 v21, v52, v53
    v_cvt_pk_bf16_f32 v22, v54, v55
    v_cvt_pk_bf16_f32 v23, v56, v57
    ds_write_b128 v15, v[20:23] offset:58368
REDUCE:
    s_add_u32 s45, s45, 1
    s_waitcnt vmcnt(3)
    v_cmp_eq_u64 vcc, s[48:49], v[36:37]
    s_waitcnt vmcnt(2)
    v_cmp_eq_u64 s[58:59], s[48:49], v[40:41]
    v_max_u32 v30, v35, v39
    v_max_u32 v19, v34, v38
    v_med3_u32 v30, v34, v38, v30
    s_waitcnt vmcnt(1)
    v_cmp_eq_u64 s[60:61], s[48:49], v[44:45]
    s_and_b64 vcc, vcc, s[58:59]
    s_waitcnt vmcnt(0)
    v_cmp_eq_u64 s[62:63], s[48:49], v[48:49]
    v_max_u32 v32, v43, v47
    v_max_u32 v31, v42, v46
    v_med3_u32 v32, v42, v46, v32
    s_and_b64 vcc, vcc, s[60:61]
    v_max_u32 v30, v30, v32
    s_and_b64 vcc, vcc, s[62:63]
    v_med3_u32 v30, v19, v31, v30
    v_max_u32 v19, v19, v31
    v_cndmask_b32 v30, 0, v30, vcc
    v_cndmask_b32 v19, 0, v19, vcc
    s_nop 0
    v_max_u32_dpp v32, v30, v30 row_ror:8 row_mask:0xf bank_mask:0xf
    v_mov_b32_dpp v31, v19 row_ror:8 row_mask:0xf bank_mask:0xf
    v_med3_u32 v30, v19, v31, v32
    v_max_u32 v19, v19, v31
    s_nop 0
    v_max_u32_dpp v32, v30, v30 row_ror:4 row_mask:0xf bank_mask:0xf
    v_mov_b32_dpp v31, v19 row_ror:4 row_mask:0xf bank_mask:0xf
    v_med3_u32 v30, v19, v31, v32
    v_max_u32 v19, v19, v31
    s_nop 0
    v_max_u32_dpp v32, v30, v30 row_ror:2 row_mask:0xf bank_mask:0xf
    v_mov_b32_dpp v31, v19 row_ror:2 row_mask:0xf bank_mask:0xf
    v_med3_u32 v30, v19, v31, v32
    v_max_u32 v19, v19, v31
    s_nop 0
    v_max_u32_dpp v32, v30, v30 row_ror:1 row_mask:0xf bank_mask:0xf
    v_mov_b32_dpp v31, v19 row_ror:1 row_mask:0xf bank_mask:0xf
    v_med3_u32 v30, v19, v31, v32
    v_max_u32 v19, v19, v31
    s_nop 0
    v_max_u32_dpp v32, v30, v30 row_bcast:15 row_mask:0xa bank_mask:0xf
    v_mov_b32_dpp v31, v19 row_bcast:15 row_mask:0xa bank_mask:0xf
    v_med3_u32 v30, v19, v31, v32
    v_max_u32 v19, v19, v31
    s_nop 0
    v_max_u32_dpp v32, v30, v30 row_bcast:31 row_mask:0xc bank_mask:0xf
    v_mov_b32_dpp v31, v19 row_bcast:31 row_mask:0xc bank_mask:0xf
    v_med3_u32 v30, v19, v31, v32
    v_max_u32 v19, v19, v31
    s_and_b64 vcc, vcc, s[54:55]
    v_readlane_b32 s50, v19, 63
    v_readlane_b32 s51, v30, 63
    s_cmp_eq_u64 s[50:51], s[52:53]
    s_cbranch_scc0 AGAIN
    s_cmp_eq_u64 vcc, -1
    s_cbranch_scc1 GOT
    s_cmp_eq_u64 s[54:55], -1
    s_cbranch_scc0 AGAIN
    s_cmp_ge_u32 s45, 4096
    s_cbranch_scc1 GOT
    buffer_load_dwordx4 v[34:37], v15, s[8:11], s44 offen offset:0 sc1
    buffer_load_dwordx4 v[38:41], v15, s[8:11], s44 offen offset:1024 sc1
    buffer_load_dwordx4 v[42:45], v15, s[8:11], s44 offen offset:2048 sc1
    buffer_load_dwordx4 v[46:49], v15, s[8:11], s44 offen offset:3072 sc1
    s_nop 0
    s_branch REDUCE
AGAIN:
    s_cmp_lt_u32 s45, 4096
    s_cbranch_scc1 POLLA
GOT:
    s_waitcnt lgkmcnt(0)
    s_barrier
    s_cmp_lg_u32 s2, 0
    s_cbranch_scc1 NOEP
    s_mov_b64 exec, 1
    buffer_store_dwordx2 v[4:5], v10, s[8:11], s41 offen sc1
    s_mov_b64 exec, -1
NOEP:
    s_and_b32 s65, s34, 15
    s_lshr_b32 s66, s34, 4
    s_lshl_b32 s66, s66, 10
    s_or_b32 s66, s66, s33
    s_mov_b32 s64, 0
    s_and_b32 s38, s50, 0x407
    s_cmp_eq_u32 s38, s66
    s_cselect_b32 s38, 1, 0
    s_or_b32 s64, s64, s38
    s_and_b32 s38, s51, 0x407
    s_cmp_eq_u32 s38, s66
    s_cselect_b32 s38, 2, 0
    s_or_b32 s64, s64, s38
    s_sub_u32 s38, 0, s50
    s_and_b32 s38, s38, 0x407
    s_cmp_eq_u32 s38, s66
    s_cselect_b32 s38, 4, 0
    s_or_b32 s64, s64, s38
    s_sub_u32 s38, 0, s51
    s_and_b32 s38, s38, 0x407
    s_cmp_eq_u32 s38, s66
    s_cselect_b32 s38, 8, 0
    s_or_b32 s64, s64, s38
    s_cbranch_scc0 MEND
    s_barrier
    v_and_b32 v33, 15, v1
    v_and_b32 v11, 1, v1
    v_lshlrev_b32 v11, 4, v11
    v_mov_b32 v12, 0x3f80
    v_lshlrev_b32 v11, v11, v12
    v_lshrrev_b32 v12, 1, v33
    v_cmp_eq_u32 vcc, 0, v12
    s_nop 1
    v_cndmask_b32 v20, 0, v11, vcc
    v_cmp_eq_u32 vcc, 1, v12
    s_nop 1
    v_cndmask_b32 v21, 0, v11, vcc
    v_cmp_eq_u32 vcc, 2, v12
    s_nop 1
    v_cndmask_b32 v22, 0, v11, vcc
    v_cmp_eq_u32 vcc, 3, v12
    s_nop 1
    v_cndmask_b32 v23, 0, v11, vcc
    v_and_b32 v11, 3, v1
    v_bfe_u32 v12, v1, 4, 1
    v_lshl_add_u32 v11, v11, 1, v12
    v_lshlrev_b32 v24, 4, v11
    v_lshlrev_b32 v25, 3, v11
    s_barrier
ROLE:
    s_ff1_i32_b32 s67, s64
    s_bitset0_b32 s64, s67
    s_bitcmp1_b32 s67, 0
    s_cselect_b32 s68, s51, s50
    s_cselect_b32 s70, 32, 0
    s_sub_u32 s46, 31, s65
    s_bitcmp1_b32 s67, 1
    s_cselect_b32 s46, s46, s65
    s_add_u32 s70, s70, s46
    s_mul_i32 s70, s70, 7168
    s_add_u32 s70, s70, 2228224
    s_add_u32 s47, s70, 4096
    s_and_b32 s69, s68, 0x7ff
    s_lshl_b32 s69, s69, 11
    s_lshl_b32 s46, s46, 6
    s_add_u32 s69, s69, s46
    s_lshl_b32 s38, s67, 7
    v_add_u32 v11, s38, v24
    s_mov_b32 s45, 0
    v_mov_b32 v26, s68
    v_ashrrev_i32 v12, 31, v26
    v_not_b32 v12, v12
    v_or_b32 v12, 0x80000000, v12
    v_xor_b32 v26, v26, v12
    v_mul_f32 v26, 0xbfb8aa3b, v26
    v_exp_f32 v26, v26
    s_nop 0
    v_add_f32 v26, 1.0, v26
    v_rcp_f32 v26, v26
RPOLL:
    buffer_load_dwordx4 v[34:37], v15, s[8:11], s70 offen offset:0 sc1
    buffer_load_dwordx4 v[38:41], v15, s[8:11], s70 offen offset:1024 sc1
    buffer_load_dwordx4 v[42:45], v15, s[8:11], s70 offen offset:2048 sc1
    buffer_load_dwordx4 v[46:49], v15, s[8:11], s70 offen offset:3072 sc1
    buffer_load_dwordx4 v[50:53], v15, s[8:11], s47 offen offset:0 sc1
    buffer_load_dwordx4 v[54:57], v15, s[8:11], s47 offen offset:1024 sc1
    buffer_load_dwordx4 v[58:61], v15, s[8:11], s47 offen offset:2048 sc1
    s_add_u32 s45, s45, 1
    s_waitcnt vmcnt(6)
    v_mfma_f32_16x16x32_bf16 v[62:65], v[20:23], v[34:37], 0
    s_waitcnt vmcnt(5)
    v_mfma_f32_16x16x32_bf16 v[62:65], v[20:23], v[38:41], v[62:65]
    s_waitcnt vmcnt(4)
    v_mfma_f32_16x16x32_bf16 v[62:65], v[20:23], v[42:45], v[62:65]
    s_waitcnt vmcnt(3)
    v_mfma_f32_16x16x32_bf16 v[62:65], v[20:23], v[46:49], v[62:65]
    s_waitcnt vmcnt(2)
    v_mfma_f32_16x16x32_bf16 v[62:65], v[20:23], v[50:53], v[62:65]
    s_waitcnt vmcnt(1)
    v_mfma_f32_16x16x32_bf16 v[62:65], v[20:23], v[54:57], v[62:65]
    s_waitcnt vmcnt(0)
    v_mfma_f32_16x16x32_bf16 v[62:65], v[20:23], v[58:61], v[62:65]
    ds_read_b128 v[66:69], v11 offset:60416
    s_cmp_ge_u32 s45, 4096
    s_cbranch_scc1 RGOT
    s_nop 4
    v_cmp_u_f32 vcc, v62, v62
    s_cbranch_vccnz RPOLL
RGOT:
    s_nop 4
    v_add_f32_dpp v62, v62, v62 row_ror:4 row_mask:0xf bank_mask:0xf
    v_add_f32_dpp v63, v63, v63 row_ror:4 row_mask:0xf bank_mask:0xf
    v_add_f32_dpp v64, v64, v64 row_ror:4 row_mask:0xf bank_mask:0xf
    v_add_f32_dpp v65, v65, v65 row_ror:4 row_mask:0xf bank_mask:0xf
    v_add_f32_dpp v62, v62, v62 row_ror:8 row_mask:0xf bank_mask:0xf
    v_add_f32_dpp v63, v63, v63 row_ror:8 row_mask:0xf bank_mask:0xf
    v_add_f32_dpp v64, v64, v64 row_ror:8 row_mask:0xf bank_mask:0xf
    v_add_f32_dpp v65, v65, v65 row_ror:8 row_mask:0xf bank_mask:0xf
FCHK:
    s_waitcnt lgkmcnt(0)
    v_max3_u32 v12, v66, v67, v68
    v_max_u32 v12, v12, v69
    v_cmp_eq_u32 vcc, -1, v12
    s_cbranch_vccnz FRETRY
FOK:
    v_fmac_f32 v66, v62, v26
    v_fmac_f32 v67, v63, v26
    v_fmac_f32 v68, v64, v26
    v_fmac_f32 v69, v65, v26
    v_cvt_pk_bf16_f32 v66, v66, v67
    v_cvt_pk_bf16_f32 v67, v68, v69
    s_mov_b64 exec, 0x000f000f
    buffer_store_dwordx2 v[66:67], v25, s[24:27], s69 offen
    s_mov_b64 exec, -1
    s_cmp_lg_u32 s64, 0
    s_nop 0
    s_cbranch_scc1 ROLE
MEND:
    s_endpgm
FRETRY:
    s_add_u32 s45, s45, 1
    s_cmp_ge_u32 s45, 65536
    s_cbranch_scc1 FOK
    ds_read_b128 v[66:69], v11 offset:60416
    s_branch FCHK
.section .rodata,"a"
.p2align 6
.amdhsa_kernel parallel_sum__spectral_fnet__moe_arch_mod__prompt_kernel
  .amdhsa_next_free_vgpr 154
  .amdhsa_next_free_sgpr 102
  .amdhsa_accum_offset 156
  .amdhsa_group_segment_fixed_size 0
  .amdhsa_kernarg_size 104
  .amdhsa_user_sgpr_count 2
  .amdhsa_user_sgpr_kernarg_segment_ptr 1
  .amdhsa_system_sgpr_workgroup_id_x 1
.end_amdhsa_kernel
```

```asm
; @launch grid=(256,1,1) block=(640,1,1) lds=159744
.amdgcn_target "amdgcn-amd-amdhsa--gfx950"
.text
.globl parallel_sum__spectral_fnet__moe_arch_mod__prompt_kernel
.p2align 12
.type parallel_sum__spectral_fnet__moe_arch_mod__prompt_kernel,@function
parallel_sum__spectral_fnet__moe_arch_mod__prompt_kernel:
    s_cmpk_ge_u32 s2, 256
    s_cbranch_scc1 END
    v_lshrrev_b32 v2, 6, v0
    s_load_dwordx2 s[4:5], s[0:1], 0
    s_load_dwordx2 s[28:29], s[0:1], 48
    s_load_dwordx2 s[8:9], s[0:1], 96
    s_load_dwordx2 s[12:13], s[0:1], 56
    s_load_dwordx2 s[16:17], s[0:1], 64
    s_load_dwordx2 s[20:21], s[0:1], 72
    s_load_dwordx2 s[24:25], s[0:1], 80
    v_readfirstlane_b32 s32, v2
    s_lshr_b32 s34, s2, 3
    v_and_b32 v1, 63, v0
    s_lshl_b32 s38, s32, 5
    s_add_u32 s38, s38, s34
    s_cmpk_lt_u32 s38, 316
    s_cbranch_scc1 BUSY
    s_mov_b64 exec, 0
    s_cmp_eq_u32 s34, 28
    s_cbranch_scc1 PAD0
    s_cmp_eq_u32 s34, 29
    s_cbranch_scc1 PAD1
    s_cmp_eq_u32 s34, 30
    s_cbranch_scc1 PAD8
    s_branch PAD2
BUSY:
    s_and_b32 s33, s2, 7
    s_lshr_b32 s38, s2, 4
    s_lshl3_add_u32 s36, s38, s33
    s_and_b32 s35, s34, 1
    s_cmp_eq_u32 s36, 0
    s_cselect_b32 s38, 128, s36
    s_sub_u32 s37, 2048, s38
    s_mul_i32 s40, s33, 28
    s_add_u32 s40, s40, s34
    s_lshl_b32 s6, 1, 22
    s_lshl_b32 s7, 1, 17
    s_lshl_b32 s10, 27, 17
    s_mov_b32 s11, s7
    s_cmp_eq_u32 s32, 9
    s_cbranch_scc1 LOADB
    s_cmp_eq_u32 s32, 8
    s_cbranch_scc1 COMM0
    s_lshl_b32 s38, s32, 8
    s_add_u32 s41, s36, s38
    s_sub_u32 s38, s37, s38
    s_cmp_eq_u32 s35, 0
    s_cselect_b32 s42, s38, s41
    s_cselect_b32 s41, s41, s38
    s_lshl_b32 s43, s32, 11
    s_lshl_b32 s38, s35, 14
    s_add_u32 s43, s43, s38
    v_and_b32 v9, 32, v1
    v_lshlrev_b32 v8, 4, v1
    v_lshrrev_b32 v5, 2, v1
    v_xor_b32 v2, v8, v9
    s_lshl_b32 s47, s32, 8
    s_add_u32 m0, s47, 49408
    s_and_b32 s39, s32, 2
    s_lshl_b32 s39, s39, 4
    v_lshrrev_b32 v11, 2, v8
    s_movk_i32 s30, 2048
    s_mov_b32 s31, s7
    v_xor_b32 v11, s39, v11
    s_lshl_b32 s39, s41, 11
    s_lshl_b32 s42, s42, 11
    v_and_b32 v6, 3, v1
    v_and_b32 v3, 15, v1
    v_lshrrev_b32 v4, 4, v1
    v_and_b32 v5, 3, v5
    v_and_b32 v7, 1, v4
    s_lshl_b32 s48, s35, 3
    s_cmp_eq_u32 s35, 0
    s_cselect_b32 s38, 1, 63
    v_lshrrev_b32 v9, 1, v3
    v_add_u32 v9, s48, v9
    v_and_b32 v10, 1, v3
    v_cmp_ne_u32 vcc, s38, v3
    v_cvt_f32_u32 v24, v4
    s_nop 0
    v_cndmask_b32 v9, 16, v9, vcc
    v_mul_f32 v26, 4.0, v24
    v_cndmask_b32 v10, 0, v10, vcc
    v_cvt_f32_u32 v9, v9
    v_cvt_f32_u32 v10, v10
    v_add_f32 v24, v26, v26
    v_mul_f32 v9, 0x3d000000, v9
    v_mul_f32 v10, 0x3e800000, v10
    v_cos_f32 v25, v9
    v_fma_f32 v16, v9, v24, v10
    v_add_f32 v17, v16, v9
    s_waitcnt lgkmcnt(0)
    buffer_load_dword v11, s[28:31], s47 offen lds
    s_xor_b32 m0, s43, 16384
    buffer_load_dwordx4 v[28:31], v2, s[4:7], s39 offen
    buffer_load_dwordx4 v[32:35], v2, s[4:7], s39 offen offset:1024
    s_cmpk_ge_u32 s2, 224
    s_cbranch_scc1 BI0
    s_barrier
BI0:
    s_branch CMP2
COMM0:
    s_setprio 3
    v_mov_b32 v10, 0
    s_mov_b32 s41, 2392064
    v_mov_b32 v6, -1
    v_mov_b32 v7, -1
    v_mov_b32 v8, -1
    v_mov_b32 v9, -1
    s_lshr_b32 s46, s40, 2
    s_and_b32 s47, s40, 3
    v_lshlrev_b32 v15, 4, v1
    v_lshrrev_b32 v11, 5, v1
    v_and_b32 v12, 0x1f0, v15
    v_lshl_add_u32 v14, v11, 11, v12
    s_lshl3_add_u32 s38, s46, s47
    s_lshl_b32 s38, s38, 9
    s_add_u32 s38, s38, 2949120
    s_mul_i32 s39, s47, 57344
    s_lshl_b32 s43, s46, 7
    s_add_u32 s39, s39, s43
    s_add_u32 s39, s39, 2490368
    s_cmpk_lt_u32 s2, 224
    s_cselect_b32 s38, s38, 117440512
    s_cselect_b32 s39, s39, 117440512
    v_lshrrev_b32 v11, 3, v1
    v_and_b32 v12, 0x70, v15
    v_mul_u32_u24 v11, 7168, v11
    v_add_u32 v16, v11, v12
    v_lshlrev_b32 v12, 8, v1
    v_add_u32 v11, s36, v12
    v_sub_u32 v12, s37, v12
    s_cmp_eq_u32 s35, 0
    s_cselect_b64 vcc, 0, -1
    v_cndmask_b32 v13, v11, v12, vcc
    v_and_b32 v11, 7, v13
    v_and_b32 v12, 0x7f8, v13
    v_lshl_add_u32 v13, v11, 11, v12
    s_mov_b32 s42, 2359296
    v_mov_b32 v20, 0
    v_mov_b32 v21, 0
    v_mov_b32 v22, 0
    v_mov_b32 v23, 0
    ds_write_b128 v10, v[20:23] offset:58256
    s_waitcnt lgkmcnt(0)
    buffer_load_dwordx2 v[4:5], v10, s[8:11], s41 offen sc1
    s_cmpk_ge_u32 s2, 224
    s_cbranch_scc1 BI1
    s_barrier
BI1:
    s_mul_i32 s43, s36, 16384
    s_lshl_b32 s44, s35, 13
    s_add_u32 s43, s43, s44
    s_add_u32 s44, s43, 4096
    buffer_store_dwordx4 v[6:9], v15, s[8:11], s43 offen offset:0 sc1
    buffer_store_dwordx4 v[6:9], v15, s[8:11], s43 offen offset:1024 sc1
    buffer_store_dwordx4 v[6:9], v15, s[8:11], s43 offen offset:2048 sc1
    buffer_store_dwordx4 v[6:9], v15, s[8:11], s43 offen offset:3072 sc1
    buffer_store_dwordx4 v[6:9], v15, s[8:11], s44 offen offset:0 sc1
    buffer_store_dwordx4 v[6:9], v15, s[8:11], s44 offen offset:1024 sc1
    buffer_store_dwordx4 v[6:9], v15, s[8:11], s44 offen offset:2048 sc1
    buffer_store_dwordx4 v[6:9], v15, s[8:11], s44 offen offset:3072 sc1
    buffer_store_dwordx4 v[6:9], v14, s[8:11], s38 offen sc1
    buffer_store_dwordx4 v[6:9], v16, s[8:11], s39 offen sc1
    s_add_u32 s39, s39, 229376
    buffer_store_dwordx4 v[6:9], v16, s[8:11], s39 offen sc1
    s_mov_b64 exec, 0xff
    buffer_store_dwordx2 v[6:7], v13, s[8:11], s42 offen sc1
    s_mov_b64 exec, -1
    s_branch COMM
LOADB:
    s_barrier
    s_branch LOAD
RET_A_0:
    s_cmp_eq_u32 s34, 28
    s_cbranch_scc1 PAD10
    s_cmp_eq_u32 s34, 29
    s_cbranch_scc1 PAD3
    s_cmp_eq_u32 s34, 30
    s_cbranch_scc1 PAD4
    s_cmp_eq_u32 s34, 31
    s_cbranch_scc1 PAD11
RET_A_1:
    s_mov_b64 exec, -1
    s_endpgm
CMP2:
    v_cos_f32 v16, v16
    v_cos_f32 v17, v17
    v_add_f32 v25, v25, v25
    s_add_u32 s38, s38, -1
    v_cmp_ne_u32 vcc, s38, v3
    v_mov_b32 v11, 0xc2000000
    v_mov_b32 v27, 0x3a800000
    v_fma_f32 v18, v25, v17, -v16
    v_fma_f32 v19, v25, v18, -v17
    v_fma_f32 v20, v25, v19, -v18
    v_fma_f32 v21, v25, v20, -v19
    v_fma_f32 v22, v25, v21, -v20
    v_fma_f32 v23, v25, v22, -v21
    v_cndmask_b32 v11, v11, 0, vcc
    v_cvt_pk_bf16_f32 v12, v16, v17
    v_cvt_pk_bf16_f32 v13, v18, v19
    v_cvt_pk_bf16_f32 v14, v20, v21
    v_cvt_pk_bf16_f32 v15, v22, v23
PAD0:
    s_cbranch_execz RET_A_0
    s_mul_i32 s44, s36, 16384
    s_lshl3_add_u32 s38, s35, s32
    s_lshl_b32 s38, s38, 10
    s_add_u32 s44, s44, s38
    s_lshr_b32 s46, s40, 2
    s_and_b32 s45, s40, 3
    s_add_u32 s48, s48, s32
    v_lshl_add_u32 v9, v3, 5, s48
    v_mov_b32 v24, 512
    v_cmp_eq_u32 vcc, 0, v9
    s_nop 1
    v_cndmask_b32 v9, v9, v24, vcc
    v_cvt_f32_u32 v9, v9
    v_bfrev_b32 v10, 1
    v_mul_f32 v9, v27, v9
    v_mul_f32 v16, v9, v26
    v_cos_f32 v25, v9
    v_fmamk_f32 v20, v9, 0x41800000, v16
    v_add_f32 v17, v16, v9
    v_add_f32 v21, v20, v9
    v_add_f32 v25, v25, v25
    v_sin_f32 v68, v16
    v_cos_f32 v16, v16
    v_sin_f32 v69, v17
    v_cos_f32 v17, v17
    v_sin_f32 v72, v20
    v_cos_f32 v20, v20
    v_sin_f32 v73, v21
    v_cos_f32 v21, v21
    v_fma_f32 v70, v25, v69, -v68
    v_fma_f32 v18, v25, v17, -v16
    v_fma_f32 v74, v25, v73, -v72
    v_fma_f32 v22, v25, v21, -v20
    v_fma_f32 v71, v25, v70, -v69
    v_fma_f32 v19, v25, v18, -v17
    v_fma_f32 v75, v25, v74, -v73
    v_fma_f32 v23, v25, v22, -v21
    v_cvt_pk_bf16_f32 v48, v68, v69
    v_cvt_pk_bf16_f32 v44, v16, v17
    v_cvt_pk_bf16_f32 v49, v70, v71
    v_cvt_pk_bf16_f32 v45, v18, v19
    v_cvt_pk_bf16_f32 v50, v72, v73
    v_cvt_pk_bf16_f32 v46, v20, v21
    v_cvt_pk_bf16_f32 v51, v74, v75
    v_cvt_pk_bf16_f32 v47, v22, v23
    v_xor_b32_dpp v60, v48, v10 row_mirror row_mask:0xf bank_mask:0xf
    v_xor_b32 v52, 0x80008000, v48
    v_xor_b32_dpp v61, v49, v10 row_mirror row_mask:0xf bank_mask:0xf
    v_xor_b32 v53, 0x80008000, v49
    v_xor_b32_dpp v62, v50, v10 row_mirror row_mask:0xf bank_mask:0xf
    v_xor_b32 v54, 0x80008000, v50
    v_xor_b32_dpp v63, v51, v10 row_mirror row_mask:0xf bank_mask:0xf
    v_xor_b32 v55, 0x80008000, v51
    v_xor_b32_dpp v56, v44, v10 row_mirror row_mask:0xf bank_mask:0xf
    v_xor_b32_dpp v57, v45, v10 row_mirror row_mask:0xf bank_mask:0xf
    v_xor_b32_dpp v58, v46, v10 row_mirror row_mask:0xf bank_mask:0xf
    v_xor_b32_dpp v59, v47, v10 row_mirror row_mask:0xf bank_mask:0xf
    s_cmpk_lt_u32 s2, 224
    s_cbranch_scc1 NOOTH
    buffer_load_dwordx4 v2, s[4:7], s42 offen lds
    buffer_load_dwordx4 v2, s[4:7], s42 offen offset:1024 lds
NOOTH:
    s_cmp_eq_u32 s48, 0
    s_cbranch_scc0 SPEKD
    v_lshlrev_b32 v9, 5, v3
    v_sub_u32 v9, 1008, v9
    v_cvt_f32_u32 v9, v9
    v_mul_f32 v9, v27, v9
    v_mul_f32 v16, v9, v26
    v_cos_f32 v25, v9
    v_fmamk_f32 v20, v9, 0x41800000, v16
    v_add_f32 v17, v16, v9
    v_add_f32 v21, v20, v9
    v_add_f32 v25, v25, v25
    v_sin_f32 v68, v16
    v_cos_f32 v16, v16
    v_sin_f32 v69, v17
    v_cos_f32 v17, v17
    v_sin_f32 v72, v20
    v_cos_f32 v20, v20
    v_sin_f32 v73, v21
    v_cos_f32 v21, v21
    v_fma_f32 v70, v25, v69, -v68
    v_fma_f32 v18, v25, v17, -v16
    v_fma_f32 v74, v25, v73, -v72
    v_fma_f32 v22, v25, v21, -v20
    v_fma_f32 v71, v25, v70, -v69
    v_fma_f32 v19, v25, v18, -v17
    v_fma_f32 v75, v25, v74, -v73
    v_fma_f32 v23, v25, v22, -v21
    v_cvt_pk_bf16_f32 v60, v68, v69
    v_cvt_pk_bf16_f32 v56, v16, v17
    v_cvt_pk_bf16_f32 v61, v70, v71
    v_cvt_pk_bf16_f32 v57, v18, v19
    v_cvt_pk_bf16_f32 v62, v72, v73
    v_cvt_pk_bf16_f32 v58, v20, v21
    v_cvt_pk_bf16_f32 v63, v74, v75
    v_cvt_pk_bf16_f32 v59, v22, v23
SPEKD:
    v_xor_b32 v64, 0x80008000, v56
    v_xor_b32 v65, 0x80008000, v57
    v_xor_b32 v66, 0x80008000, v58
    v_xor_b32 v67, 0x80008000, v59
    v_lshrrev_b32 v9, 1, v3
    v_and_b32 v10, 1, v3
    v_cvt_f32_u32 v9, v9
    v_cvt_f32_u32 v24, v10
    v_cmp_gt_u32 vcc, 32, v1
    v_mov_b32 v68, 0xbe800000
    v_mul_f32 v9, 0x3e000000, v9
    s_cmp_eq_u32 s36, 0
    s_cbranch_scc0 BFQN
    v_lshrrev_b32 v24, 5, v1
    v_cmp_eq_u32 s[100:101], v24, v10
    v_mul_f32 v10, 0x40f00000, v9
    v_cndmask_b32 v10, v10, 0, vcc
    v_cndmask_b32 v9, -v9, v9, vcc
    v_cndmask_b32 v10, -v68, v10, s[100:101]
    v_cndmask_b32 v9, 0, v9, s[100:101]
    v_cndmask_b32 v68, 0, v68, s[100:101]
    s_branch BFGO
BFQN:
    v_mul_f32 v10, 0x3e800000, v24
    v_cndmask_b32 v68, -v68, v68, vcc
BFGO:
    v_cvt_f32_u32 v24, v7
    v_cos_f32 v25, v9
    v_mul_f32 v24, 4.0, v24
    v_fma_f32 v16, v9, v24, v10
    v_add_f32 v25, v25, v25
    v_add_f32 v17, v16, v9
    v_add_f32 v20, v16, v68
    v_add_f32 v21, v17, v68
    v_cos_f32 v16, v16
    v_cos_f32 v17, v17
    v_cos_f32 v20, v20
    v_cos_f32 v21, v21
    v_add_u32 v68, s43, v8
    v_fma_f32 v18, v25, v17, -v16
    v_fma_f32 v22, v25, v21, -v20
    v_fma_f32 v19, v25, v18, -v17
    v_fma_f32 v23, v25, v22, -v21
    v_xor_b32 v69, 16384, v68
    s_lshl_b32 s38, s32, 11
    v_lshl_add_u32 v24, v4, 9, s38
    v_lshl_add_u32 v24, v5, 6, v24
    v_lshl_add_u32 v24, v7, 5, v24
    v_lshl_add_u32 v70, v6, 3, v24
    v_xor_b32 v71, 32, v70
    s_cmp_lt_u32 s32, 4
    s_cselect_b32 s38, 0, 3
    s_lshl_b32 s39, s32, 6
    s_add_u32 s39, s39, 32768
    v_mul_u32_u24 v9, 1040, v3
    v_xor_b32 v24, s38, v4
    v_add_u32 v9, s39, v9
    v_lshl_add_u32 v72, v24, 4, v9
    v_xor_b32 v24, 2, v24
    v_lshl_add_u32 v73, v24, 4, v9
    s_lshl_b32 s38, s32, 2
    s_add_u32 s38, s38, 58112
    v_mov_b32 v74, s38
    s_lshl_b32 s39, s35, 5
    v_add_u32 v75, s39, v74
    s_mul_i32 s38, s32, 2080
    s_add_u32 s38, s38, 32768
    v_sub_u32 v24, 4, v5
    v_and_b32 v24, 3, v24
    v_xor_b32 v24, v24, v4
    v_lshl_add_u32 v9, v3, 6, s38
    v_lshl_add_u32 v76, v24, 4, v9
    v_lshlrev_b32 v80, 4, v4
PAD1:
    s_cbranch_execz RET_A_0
    v_lshlrev_b32 v24, 8, v4
    v_lshl_add_u32 v24, v3, 3, v24
    s_mul_i32 s38, s32, 1088
    s_add_u32 s38, s38, 49408
    v_add_u32 v77, s38, v24
    s_sub_u32 s38, 8, s32
    s_and_b32 s38, s38, 7
    s_mul_i32 s38, s38, 1088
    s_add_u32 s38, s38, 49412
    v_add_u32 v78, s38, v24
    s_lshl_b32 s38, s32, 7
    s_add_u32 s38, s38, 49408
    v_mul_u32_u24 v24, 1088, v5
    v_lshl_add_u32 v9, v4, 2, v6
    v_add_u32 v24, s38, v24
    v_lshl_add_u32 v79, v9, 3, v24
    v_mov_b32 v9, 0
    v_mov_b32 v10, 0
    v_mov_b32 v24, 0
    v_mov_b32 v25, 0
    v_mov_b32 v81, 0
    v_mov_b32 v82, 0
    v_mov_b32 v83, 1
    v_mov_b32 v84, 0
    s_cmpk_lt_u32 s2, 224
    s_cselect_b32 s47, 263, 7
    s_waitcnt vmcnt(0)
    ds_write_b128 v68, v[28:31]
    ds_write_b128 v68, v[32:35] offset:1024
    v_dot2c_f32_bf16 v9, 0x3f803f80, v28
    v_dot2c_f32_bf16 v10, v28, v28
    v_dot2c_f32_bf16 v9, 0x3f803f80, v29
    v_dot2c_f32_bf16 v10, v29, v29
    s_cmpk_ge_u32 s2, 224
    s_cbranch_scc1 MEETB
    s_mov_b64 exec, 1
    ds_add_rtn_u32 v85, v84, v83 offset:58256
    s_mov_b64 exec, -1
    s_waitcnt lgkmcnt(0)
    v_readfirstlane_b32 s38, v85
    s_cmp_eq_u32 s38, 7
    s_cbranch_scc1 GO0
SPIN0:
    ds_read_b32 v85, v84 offset:58256
    s_waitcnt lgkmcnt(0)
    v_cmp_eq_u32 vcc, 8, v85
    s_cbranch_vccz SPIN0
GO0:
    ds_read_b128 v[36:39], v8 offset:49408
    ds_read_b128 v[40:43], v8 offset:50432
    v_dot2c_f32_bf16 v9, 0x3f803f80, v30
    v_dot2c_f32_bf16 v10, v30, v30
    v_dot2c_f32_bf16 v9, 0x3f803f80, v31
    v_dot2c_f32_bf16 v10, v31, v31
    v_dot2c_f32_bf16 v9, 0x3f803f80, v32
    v_dot2c_f32_bf16 v10, v32, v32
    v_dot2c_f32_bf16 v9, 0x3f803f80, v33
    v_dot2c_f32_bf16 v10, v33, v33
    v_dot2c_f32_bf16 v9, 0x3f803f80, v34
    v_dot2c_f32_bf16 v10, v34, v34
    v_dot2c_f32_bf16 v9, 0x3f803f80, v35
    v_dot2c_f32_bf16 v10, v35, v35
    s_waitcnt lgkmcnt(1)
    v_dot2c_f32_bf16 v25, 0x3f803f80, v36
    v_dot2c_f32_bf16 v24, v28, v36
    v_dot2c_f32_bf16 v25, 0x3f803f80, v37
    v_dot2c_f32_bf16 v24, v29, v37
    v_dot2c_f32_bf16 v25, 0x3f803f80, v38
    v_dot2c_f32_bf16 v24, v30, v38
    v_dot2c_f32_bf16 v25, 0x3f803f80, v39
    v_dot2c_f32_bf16 v24, v31, v39
    s_waitcnt lgkmcnt(0)
    v_dot2c_f32_bf16 v25, 0x3f803f80, v40
    v_dot2c_f32_bf16 v24, v32, v40
    v_dot2c_f32_bf16 v25, 0x3f803f80, v41
    v_dot2c_f32_bf16 v24, v33, v41
    v_dot2c_f32_bf16 v25, 0x3f803f80, v42
    v_dot2c_f32_bf16 v24, v34, v42
    v_dot2c_f32_bf16 v25, 0x3f803f80, v43
    v_dot2c_f32_bf16 v24, v35, v43
    v_permlane32_swap_b32 v9, v10
    s_nop 1
    v_permlane32_swap_b32 v24, v25
    v_add_f32 v9, v9, v10
    v_add_f32 v24, v24, v25
    s_nop 1
    v_permlane16_swap_b32 v9, v24
    v_add_f32 v9, v9, v24
    s_nop 1
    v_add_f32_dpp v9, v9, v9 row_ror:8 row_mask:0xf bank_mask:0xf
    s_nop 1
    v_add_f32_dpp v9, v9, v9 row_ror:4 row_mask:0xf bank_mask:0xf
    s_nop 1
    v_add_f32_dpp v9, v9, v9 row_ror:2 row_mask:0xf bank_mask:0xf
    s_nop 1
    v_add_f32_dpp v9, v9, v9 row_ror:1 row_mask:0xf bank_mask:0xf
    s_nop 0
    v_readlane_b32 s49, v9, 0
    v_readlane_b32 s50, v9, 32
    v_readlane_b32 s51, v9, 16
    v_readlane_b32 s52, v9, 48
    v_mul_f32 v2, s49, v27
    v_mul_f32 v10, s50, v27
    v_mov_b32 v24, s51
    v_fma_f32 v10, -v2, v2, v10
    v_fma_f32 v24, -v2, s52, v24
    v_max_f32 v10, 0, v10
    v_add_f32 v10, 0x3727c5ac, v10
    v_rsq_f32 v110, v10
    s_nop 0
    v_mul_f32 v24, v24, v110
    v_ashrrev_i32 v10, 31, v24
    v_or_b32 v10, 0x80000000, v10
    v_xor_b32 v10, v24, v10
    v_and_b32 v10, 0xfffff800, v10
    v_or_b32 v10, s41, v10
    s_mov_b64 exec, 1
    ds_write2_b32 v74, v10, v2 offset0:16 offset1:40
    ds_write_b32 v75, v110
    s_mov_b64 exec, -1
    s_mov_b64 exec, 1
    ds_add_rtn_u32 v85, v84, v83 offset:58260
    s_mov_b64 exec, -1
    s_waitcnt lgkmcnt(0)
    v_readfirstlane_b32 s38, v85
    s_cmp_eq_u32 s38, s47
    s_cbranch_scc1 GO1
    s_add_u32 s47, s47, 1
SPIN1:
    ds_read_b32 v85, v84 offset:58260
    s_waitcnt lgkmcnt(0)
    v_cmp_eq_u32 vcc, s47, v85
    s_cbranch_vccz SPIN1
GO1:
    s_waitcnt vmcnt(0)
    ds_read_b128 v[86:89], v69
    ds_read_b128 v[90:93], v69 offset:1024
    ds_read_b64_tr_b16 v[94:95], v70 offset:0
    ds_read_b64_tr_b16 v[96:97], v70 offset:256
    ds_read_b64_tr_b16 v[98:99], v71 offset:0
    ds_read_b64_tr_b16 v[100:101], v71 offset:256
    ds_read_b64_tr_b16 v[102:103], v70 offset:16384
    ds_read_b64_tr_b16 v[104:105], v70 offset:16640
    ds_read_b64_tr_b16 v[106:107], v71 offset:16384
    ds_read_b64_tr_b16 v[108:109], v71 offset:16640
    s_waitcnt lgkmcnt(8)
    v_dot2c_f32_bf16 v81, 0x3f803f80, v86
    v_dot2c_f32_bf16 v82, v86, v86
    v_dot2c_f32_bf16 v81, 0x3f803f80, v87
    v_dot2c_f32_bf16 v82, v87, v87
    v_dot2c_f32_bf16 v81, 0x3f803f80, v88
    v_dot2c_f32_bf16 v82, v88, v88
    v_dot2c_f32_bf16 v81, 0x3f803f80, v89
    v_dot2c_f32_bf16 v82, v89, v89
    v_dot2c_f32_bf16 v81, 0x3f803f80, v90
    v_dot2c_f32_bf16 v82, v90, v90
    v_dot2c_f32_bf16 v81, 0x3f803f80, v91
    v_dot2c_f32_bf16 v82, v91, v91
    v_dot2c_f32_bf16 v81, 0x3f803f80, v92
    v_dot2c_f32_bf16 v82, v92, v92
    v_dot2c_f32_bf16 v81, 0x3f803f80, v93
    v_dot2c_f32_bf16 v82, v93, v93
    s_nop 2
    v_permlane32_swap_b32 v81, v82
    v_mul_f32 v112, v11, v2
    v_mul_f32 v113, v11, v2
    v_mul_f32 v114, v11, v2
    v_mul_f32 v115, v11, v2
    v_add_f32 v81, v81, v82
    v_mov_b32 v82, v81
    s_waitcnt lgkmcnt(4)
    v_mfma_f32_16x16x32_bf16 v[120:123], v[94:97], v[12:15], v[112:115]
    v_permlane16_swap_b32 v81, v82
    v_mfma_f32_16x16x32_bf16 v[124:127], v[98:101], v[12:15], v[112:115]
    v_add_f32 v81, v81, v82
    s_nop 1
    v_add_f32_dpp v81, v81, v81 row_ror:8 row_mask:0xf bank_mask:0xf
    s_nop 1
    v_add_f32_dpp v81, v81, v81 row_ror:4 row_mask:0xf bank_mask:0xf
    s_nop 1
    v_add_f32_dpp v81, v81, v81 row_ror:2 row_mask:0xf bank_mask:0xf
    s_nop 1
    v_add_f32_dpp v81, v81, v81 row_ror:1 row_mask:0xf bank_mask:0xf
    s_nop 0
    v_readlane_b32 s49, v81, 0
PAD2:
    s_cbranch_execz RET_A_0
    v_readlane_b32 s50, v81, 32
    v_cvt_pk_bf16_f32 v136, v120, v121
    v_cvt_pk_bf16_f32 v137, v122, v123
    v_cvt_pk_bf16_f32 v138, v124, v125
    v_cvt_pk_bf16_f32 v139, v126, v127
    v_mul_f32 v81, s49, v27
    v_mul_f32 v82, s50, v27
    ds_write_b128 v72, v[136:139]
    v_mul_f32 v116, v11, v81
    v_mul_f32 v117, v11, v81
    v_mul_f32 v118, v11, v81
    v_mul_f32 v119, v11, v81
    v_fma_f32 v82, -v81, v81, v82
    s_waitcnt lgkmcnt(1)
    v_mfma_f32_16x16x32_bf16 v[128:131], v[102:105], v[12:15], v[116:119]
    v_mfma_f32_16x16x32_bf16 v[132:135], v[106:109], v[12:15], v[116:119]
    v_max_f32 v82, 0, v82
    v_add_f32 v82, 0x3727c5ac, v82
    v_rsq_f32 v82, v82
    v_xor_b32 v75, 32, v75
    s_mov_b64 exec, 1
    ds_write_b32 v75, v82
    s_mov_b64 exec, -1
    v_cvt_pk_bf16_f32 v140, v128, v129
    v_cvt_pk_bf16_f32 v141, v130, v131
    v_cvt_pk_bf16_f32 v142, v132, v133
    v_cvt_pk_bf16_f32 v143, v134, v135
    ds_write_b128 v73, v[140:143] offset:512
    s_mov_b64 exec, 1
    ds_add_rtn_u32 v85, v84, v83 offset:58264
    s_mov_b64 exec, -1
    ds_read_b128 v[144:147], v76
    ds_read_b128 v[148:151], v76 offset:1040
    ds_read_b128 v[152:155], v80 offset:58112
    s_waitcnt lgkmcnt(3)
    v_readfirstlane_b32 s38, v85
    s_cmp_eq_u32 s38, 7
    s_cbranch_scc1 GO2
SPIN2:
    ds_read_b32 v85, v84 offset:58264
    ds_read_b128 v[144:147], v76
    ds_read_b128 v[148:151], v76 offset:1040
PAD3:
    s_cbranch_execz RET_A_1
    ds_read_b128 v[152:155], v80 offset:58112
    s_waitcnt lgkmcnt(3)
    v_cmp_eq_u32 vcc, 8, v85
    s_cbranch_vccz SPIN2
GO2:
    s_waitcnt lgkmcnt(1)
    s_cmp_eq_u32 s48, 0
    v_mfma_f32_16x16x32_bf16 v[10:13], v[144:147], v[44:47], 0
    v_mfma_f32_16x16x32_bf16 v[24:27], v[144:147], v[52:55], 0
    s_cbranch_scc0 SPECN
    v_mfma_f32_16x16x32_bf16 v[28:31], v[148:151], v[56:59], 0
    v_mfma_f32_16x16x32_bf16 v[32:35], v[148:151], v[60:63], 0
    s_branch SPECD
SPECN:
    v_mfma_f32_16x16x32_bf16 v[28:31], v[144:147], v[56:59], 0
    v_mfma_f32_16x16x32_bf16 v[32:35], v[144:147], v[60:63], 0
    v_mfma_f32_16x16x32_bf16 v[10:13], v[148:151], v[48:51], v[10:13]
    v_mfma_f32_16x16x32_bf16 v[24:27], v[148:151], v[44:47], v[24:27]
    v_mfma_f32_16x16x32_bf16 v[28:31], v[148:151], v[60:63], v[28:31]
    v_mfma_f32_16x16x32_bf16 v[32:35], v[148:151], v[64:67], v[32:35]
SPECD:
    s_waitcnt lgkmcnt(0)
    v_mul_f32 v16, v16, v152
    v_mul_f32 v17, v17, v153
    v_mul_f32 v18, v18, v154
    v_mul_f32 v19, v19, v155
    v_mul_f32 v20, v20, v152
    v_mul_f32 v21, v21, v153
    v_mul_f32 v22, v22, v154
    v_mul_f32 v23, v23, v155
    v_cvt_pk_bf16_f32 v36, v16, v17
    v_cvt_pk_bf16_f32 v37, v18, v19
    v_cvt_pk_bf16_f32 v38, v20, v21
    v_cvt_pk_bf16_f32 v39, v22, v23
    v_cvt_pk_bf16_f32 v40, v10, v11
    v_cvt_pk_bf16_f32 v41, v12, v13
    v_cvt_pk_bf16_f32 v42, v24, v25
    v_cvt_pk_bf16_f32 v43, v26, v27
    s_nop 1
    v_mfma_f32_16x16x32_bf16 v[144:147], v[36:39], v[40:43], 0
    v_cvt_pk_bf16_f32 v68, v28, v29
    v_cvt_pk_bf16_f32 v69, v30, v31
    v_cvt_pk_bf16_f32 v70, v32, v33
    v_cvt_pk_bf16_f32 v71, v34, v35
    s_nop 1
    v_mfma_f32_16x16x32_bf16 v[148:151], v[36:39], v[68:71], 0
    s_nop 0
    v_cvt_pk_bf16_f32 v40, v144, v145
    v_cvt_pk_bf16_f32 v41, v146, v147
    ds_write2_b32 v77, v40, v41 offset1:32
    s_nop 3
    v_cvt_pk_bf16_f32 v68, v148, v149
    v_cvt_pk_bf16_f32 v69, v150, v151
    ds_write2_b32 v78, v68, v69 offset1:32
    s_mov_b64 exec, 1
    ds_add_rtn_u32 v85, v84, v83 offset:58268
    s_mov_b64 exec, -1
    ds_read_b64_tr_b16 v[36:37], v79
    ds_read_b64_tr_b16 v[38:39], v79 offset:4352
    s_waitcnt lgkmcnt(2)
    v_readfirstlane_b32 s38, v85
    s_cmp_eq_u32 s38, 7
    s_cbranch_scc1 GO3
SPIN3:
    ds_read_b32 v85, v84 offset:58268
    ds_read_b64_tr_b16 v[36:37], v79
    ds_read_b64_tr_b16 v[38:39], v79 offset:4352
    s_waitcnt lgkmcnt(2)
    v_cmp_eq_u32 vcc, 8, v85
    s_cbranch_vccz SPIN3
GO3:
    s_and_b32 s47, s34, 15
    s_lshr_b32 s53, s34, 4
    s_lshl3_add_u32 s38, s53, s32
    s_lshl_b32 s38, s38, 7
    s_add_u32 s38, s38, s33
    v_lshl_add_u32 v2, v3, 3, s38
    v_sub_u32 v9, 2048, v2
    v_and_b32 v9, 2047, v9
    s_waitcnt lgkmcnt(0)
    buffer_store_dwordx4 v[36:39], v8, s[8:11], s44 offen sc1
    s_lshl_b32 s38, s47, 6
    v_lshl_add_u32 v73, v4, 4, s38
    v_lshl_add_u32 v81, v2, 11, v73
    v_sub_u32 v73, 2032, v73
    v_lshl_add_u32 v14, v9, 11, v73
    v_and_b32 v73, 7, v2
    v_and_b32 v74, 0x7f8, v2
    v_lshl_add_u32 v15, v73, 11, v74
    v_and_b32 v73, 7, v9
    v_and_b32 v74, 0x7f8, v9
    v_lshl_add_u32 v72, v73, 11, v74
    v_cvt_f32_u32 v75, v2
    v_lshrrev_b32 v73, 5, v1
    v_add_u32 v74, v7, v7
    v_lshl_add_u32 v73, v73, 3, v74
    v_mul_f32 v75, 0x3a000000, v75
    v_cvt_f32_u32 v73, v73
    v_mul_f32 v74, 0x41800000, v75
    v_mul_f32 v10, v75, v73
    v_cos_f32 v80, v74
    v_add_f32 v11, v10, v75
    v_fma_f32 v12, v75, 4.0, v10
    v_fma_f32 v13, v75, 4.0, v11
    v_add_f32 v80, v80, v80
    v_add_f32 v20, v10, v74
    v_add_f32 v21, v11, v74
    v_add_f32 v22, v12, v74
    v_add_f32 v23, v13, v74
    v_sin_f32 v16, v10
    v_cos_f32 v10, v10
    v_sin_f32 v17, v11
    v_cos_f32 v11, v11
    v_sin_f32 v18, v12
    v_cos_f32 v12, v12
    v_sin_f32 v19, v13
    v_cos_f32 v13, v13
    v_sin_f32 v24, v20
    v_cos_f32 v20, v20
    v_sin_f32 v25, v21
    v_cos_f32 v21, v21
    v_sin_f32 v26, v22
    v_cos_f32 v22, v22
    v_sin_f32 v27, v23
    v_cos_f32 v23, v23
    v_cvt_pk_bf16_f32 v40, v10, v16
    v_fma_f32 v10, v80, v20, -v10
    v_fma_f32 v16, v80, v24, -v16
    v_cvt_pk_bf16_f32 v41, v11, v17
    v_fma_f32 v11, v80, v21, -v11
    v_fma_f32 v17, v80, v25, -v17
    v_cvt_pk_bf16_f32 v42, v12, v18
    v_fma_f32 v12, v80, v22, -v12
    v_fma_f32 v18, v80, v26, -v18
    v_cvt_pk_bf16_f32 v43, v13, v19
    v_fma_f32 v13, v80, v23, -v13
    v_fma_f32 v19, v80, v27, -v19
    v_cvt_pk_bf16_f32 v44, v20, v24
    v_fma_f32 v20, v80, v10, -v20
    v_fma_f32 v24, v80, v16, -v24
    v_cvt_pk_bf16_f32 v45, v21, v25
    v_fma_f32 v21, v80, v11, -v21
    v_fma_f32 v25, v80, v17, -v25
    v_cvt_pk_bf16_f32 v46, v22, v26
    v_fma_f32 v22, v80, v12, -v22
    v_fma_f32 v26, v80, v18, -v26
    v_cvt_pk_bf16_f32 v47, v23, v27
    v_fma_f32 v23, v80, v13, -v23
    v_fma_f32 v27, v80, v19, -v27
    v_cvt_pk_bf16_f32 v48, v10, v16
    v_fma_f32 v10, v80, v20, -v10
    v_fma_f32 v16, v80, v24, -v16
    v_cvt_pk_bf16_f32 v49, v11, v17
    v_fma_f32 v11, v80, v21, -v11
    v_fma_f32 v17, v80, v25, -v17
    v_cvt_pk_bf16_f32 v50, v12, v18
    v_fma_f32 v12, v80, v22, -v12
    v_fma_f32 v18, v80, v26, -v18
    v_cvt_pk_bf16_f32 v51, v13, v19
    v_fma_f32 v13, v80, v23, -v13
    v_fma_f32 v19, v80, v27, -v19
    v_cvt_pk_bf16_f32 v52, v20, v24
    v_fma_f32 v20, v80, v10, -v20
    v_fma_f32 v24, v80, v16, -v24
    v_cvt_pk_bf16_f32 v53, v21, v25
PAD4:
    s_cbranch_execz RET_A_1
    v_fma_f32 v21, v80, v11, -v21
    v_fma_f32 v25, v80, v17, -v25
    v_cvt_pk_bf16_f32 v54, v22, v26
    v_fma_f32 v22, v80, v12, -v22
    v_fma_f32 v26, v80, v18, -v26
    v_cvt_pk_bf16_f32 v55, v23, v27
    v_fma_f32 v23, v80, v13, -v23
    v_fma_f32 v27, v80, v19, -v27
    v_cvt_pk_bf16_f32 v56, v10, v16
    v_fma_f32 v10, v80, v20, -v10
    v_fma_f32 v16, v80, v24, -v16
    v_cvt_pk_bf16_f32 v57, v11, v17
    v_fma_f32 v11, v80, v21, -v11
    v_fma_f32 v17, v80, v25, -v17
    v_cvt_pk_bf16_f32 v58, v12, v18
    v_fma_f32 v12, v80, v22, -v12
    v_fma_f32 v18, v80, v26, -v18
    v_cvt_pk_bf16_f32 v59, v13, v19
    v_fma_f32 v13, v80, v23, -v13
    v_fma_f32 v19, v80, v27, -v19
    v_cvt_pk_bf16_f32 v60, v20, v24
    v_fma_f32 v20, v80, v10, -v20
    v_fma_f32 v24, v80, v16, -v24
    v_cvt_pk_bf16_f32 v61, v21, v25
    v_fma_f32 v21, v80, v11, -v21
    v_fma_f32 v25, v80, v17, -v25
    v_cvt_pk_bf16_f32 v62, v22, v26
    v_fma_f32 v22, v80, v12, -v22
    v_fma_f32 v26, v80, v18, -v26
    v_cvt_pk_bf16_f32 v63, v23, v27
    v_fma_f32 v23, v80, v13, -v23
    v_fma_f32 v27, v80, v19, -v27
    v_cvt_pk_bf16_f32 v64, v10, v16
    v_cvt_pk_bf16_f32 v65, v11, v17
    v_cvt_pk_bf16_f32 v66, v12, v18
    v_cvt_pk_bf16_f32 v67, v13, v19
    v_cvt_pk_bf16_f32 v68, v20, v24
    v_cvt_pk_bf16_f32 v69, v21, v25
    v_cvt_pk_bf16_f32 v70, v22, v26
    v_cvt_pk_bf16_f32 v71, v23, v27
    v_and_b32 v73, 1, v3
    v_cmp_gt_u32 vcc, 16, v1
    v_lshlrev_b32 v73, 31, v73
    v_or_b32 v73, 0x3f803f80, v73
    v_cndmask_b32 v40, v40, v73, vcc
    s_barrier
    s_lshl_b32 s38, s33, 10
    s_mul_i32 s39, s32, 262144
    s_add_u32 s38, s38, s39
    s_lshl_b32 s54, s47, 6
    s_add_u32 s55, s54, 64
    s_add_u32 s54, s54, s38
    s_and_b32 s55, s55, 1023
    s_add_u32 s41, s54, 8192
    s_add_u32 s55, s55, s38
    v_lshrrev_b32 v18, 2, v1
    v_and_b32 v19, 1, v1
    v_bfe_u32 v20, v1, 1, 1
    v_mul_u32_u24 v73, 16384, v18
    v_lshl_add_u32 v75, v6, 4, v73
    v_lshl_add_u32 v80, v19, 4, v73
    s_mul_i32 s38, s32, 3072
    v_lshl_add_u32 v73, v18, 1, v19
    v_mul_u32_u24 v73, 96, v73
    v_add_u32 v12, s38, v73
    v_mad_u32_u24 v10, v20, 24, v12
    v_lshl_add_u32 v11, v20, 3, v12
    v_lshrrev_b32 v73, 5, v1
    v_lshl_add_u32 v74, v7, 2, v5
    v_lshl_add_u32 v73, v73, 4, v74
    v_mul_u32_u24 v73, 96, v73
    v_lshl_add_u32 v13, v6, 3, v73
    s_cmp_eq_u32 s47, 0
    s_cselect_b32 s38, 0x0908, 0
    s_xor_b32 s38, s38, 0x07060504
    v_cmp_eq_u32 vcc, 1, v20
    v_mov_b32 v73, 0x07060100
    v_mov_b32 v17, 0x07060504
    v_mov_b32 v16, s38
    v_cndmask_b32 v17, v17, v73, vcc
    v_cndmask_b32 v16, v16, v73, vcc
    v_lshrrev_b32 v73, 1, v5
    v_lshl_add_u32 v73, v7, 1, v73
    v_lshlrev_b32 v74, 10, v4
    v_lshl_add_u32 v74, v5, 7, v74
    v_lshl_add_u32 v74, v6, 3, v74
    v_lshl_add_u32 v74, v73, 5, v74
    s_lshl_b32 s38, s32, 12
    s_add_u32 s38, s38, 126976
    v_add_u32 v22, s38, v74
    s_and_b32 s38, s32, 3
    s_lshl_b32 s38, s38, 5
    v_xor_b32 v74, s38, v74
    s_lshr_b32 s39, s32, 2
    s_lshl_b32 s38, s39, 15
    s_add_u32 s38, s38, 61440
    v_add_u32 v21, s38, v74
    v_lshlrev_b32 v73, 4, v19
    v_lshl_add_u32 v23, v4, 5, v73
    s_lshl_b32 s52, s46, 12
    s_add_u32 s52, s52, 2949120
    s_lshl_b32 s38, s45, 9
    s_add_u32 s44, s52, s38
    s_lshl_b32 s38, s39, 8
    s_add_u32 s44, s44, s38
    s_bfe_u32 s38, s32, 0x10001
    s_lshl_b32 s38, s38, 11
    s_add_u32 s44, s44, s38
    s_and_b32 s38, s32, 1
    s_lshl_b32 s38, s38, 7
    s_add_u32 s44, s44, s38
    s_cmp_lt_u32 s2, 224
    s_cselect_b32 s44, s44, 117440512
    s_lshl_b32 s38, s39, 11
    s_add_u32 s52, s52, s38
    v_lshl_add_u32 v73, v20, 8, v73
    v_lshl_add_u32 v73, v4, 6, v73
    v_and_b32 v74, 1, v5
    v_lshl_add_u32 v73, v74, 5, v73
    v_lshrrev_b32 v74, 1, v5
    v_lshl_add_u32 v24, v74, 10, v73
    v_mul_u32_u24 v73, 229376, v19
    v_lshl_add_u32 v73, v7, 5, v73
    v_lshrrev_b32 v74, 5, v1
    v_lshl_add_u32 v25, v74, 4, v73
    s_and_b32 s38, s32, 3
    s_lshl2_add_u32 s38, s45, s38
    s_mul_i32 s42, s38, 14336
    s_lshl1_add_u32 s38, s46, s39
    s_lshl_b32 s38, s38, 6
    s_add_u32 s42, s42, s38
    s_add_u32 s42, s42, 2490368
    s_mov_b32 s50, 0x00030003
    s_mov_b32 s51, 0x00030003
    s_mov_b32 s43, 2359296
    s_mov_b32 s48, 0
    s_mov_b32 s26, s6
    s_mov_b32 s27, s7
    v_mov_b32 v73, 0
    s_mov_b64 exec, 0
    s_cmp_eq_u32 s32, 0
    s_cbranch_scc1 PAD5
    s_cmp_eq_u32 s32, 1
    s_cbranch_scc1 PAD6
    s_cmp_eq_u32 s32, 2
    s_cbranch_scc1 PAD7
    s_cmp_eq_u32 s32, 3
    s_cbranch_scc1 PAD9
RET_B_0:
    s_mov_b64 exec, -1
    s_barrier
    s_barrier
    ds_read_b128 v[90:93], v8 offset:58368
    ds_read_b64_tr_b16 v[76:77], v21 offset:0
    ds_read_b64_tr_b16 v[78:79], v21 offset:512
    ds_read_b64 v[36:37], v73 offset:58240
    ds_read_b64_tr_b16 v[122:123], v21 offset:4096
    ds_read_b64_tr_b16 v[124:125], v21 offset:4608
    ds_read_b64_tr_b16 v[126:127], v21 offset:8192
    ds_read_b64_tr_b16 v[128:129], v21 offset:8704
    ds_read_b64_tr_b16 v[130:131], v21 offset:12288
    ds_read_b64_tr_b16 v[132:133], v21 offset:12800
PAD5:
    s_cbranch_execz RET_B_0
    s_waitcnt lgkmcnt(9)
    v_mov_b32_dpp v94, v90 row_shl:2 row_mask:0xf bank_mask:0xf
    v_mov_b32_dpp v95, v91 row_shl:2 row_mask:0xf bank_mask:0xf
    v_mov_b32_dpp v96, v92 row_shl:2 row_mask:0xf bank_mask:0xf
    v_mov_b32_dpp v97, v93 row_shl:2 row_mask:0xf bank_mask:0xf
    s_waitcnt lgkmcnt(7)
    v_mfma_f32_16x16x32_bf16 v[134:137], v[76:79], v[90:93], 0
    ds_read_b64_tr_b16 v[76:77], v21 offset:16384
    ds_read_b64_tr_b16 v[78:79], v21 offset:16896
    v_mov_b32_dpp v98, v90 row_shl:4 row_mask:0xf bank_mask:0xf
    v_mov_b32_dpp v99, v91 row_shl:4 row_mask:0xf bank_mask:0xf
    v_mov_b32_dpp v100, v92 row_shl:4 row_mask:0xf bank_mask:0xf
    v_mov_b32_dpp v101, v93 row_shl:4 row_mask:0xf bank_mask:0xf
    s_waitcnt lgkmcnt(6)
    v_mfma_f32_16x16x32_bf16 v[138:141], v[122:125], v[94:97], 0
    ds_read_b64_tr_b16 v[122:123], v21 offset:20480
    ds_read_b64_tr_b16 v[124:125], v21 offset:20992
    v_mov_b32_dpp v102, v90 row_shl:6 row_mask:0xf bank_mask:0xf
    v_mov_b32_dpp v103, v91 row_shl:6 row_mask:0xf bank_mask:0xf
    v_mov_b32_dpp v104, v92 row_shl:6 row_mask:0xf bank_mask:0xf
    v_mov_b32_dpp v105, v93 row_shl:6 row_mask:0xf bank_mask:0xf
    s_waitcnt lgkmcnt(6)
    v_mfma_f32_16x16x32_bf16 v[134:137], v[126:129], v[98:101], v[134:137]
    ds_read_b64_tr_b16 v[126:127], v21 offset:24576
    ds_read_b64_tr_b16 v[128:129], v21 offset:25088
    v_mov_b32_dpp v106, v90 row_shl:8 row_mask:0xf bank_mask:0xf
    v_mov_b32_dpp v107, v91 row_shl:8 row_mask:0xf bank_mask:0xf
    v_mov_b32_dpp v108, v92 row_shl:8 row_mask:0xf bank_mask:0xf
    v_mov_b32_dpp v109, v93 row_shl:8 row_mask:0xf bank_mask:0xf
    s_waitcnt lgkmcnt(6)
    v_mfma_f32_16x16x32_bf16 v[138:141], v[130:133], v[102:105], v[138:141]
    ds_read_b64_tr_b16 v[130:131], v21 offset:28672
    ds_read_b64_tr_b16 v[132:133], v21 offset:29184
    v_mov_b32_dpp v110, v90 row_shl:10 row_mask:0xf bank_mask:0xf
    v_mov_b32_dpp v111, v91 row_shl:10 row_mask:0xf bank_mask:0xf
    v_mov_b32_dpp v112, v92 row_shl:10 row_mask:0xf bank_mask:0xf
    v_mov_b32_dpp v113, v93 row_shl:10 row_mask:0xf bank_mask:0xf
    s_waitcnt lgkmcnt(6)
    v_mfma_f32_16x16x32_bf16 v[134:137], v[76:79], v[106:109], v[134:137]
    v_mov_b32_dpp v114, v90 row_shl:12 row_mask:0xf bank_mask:0xf
    v_mov_b32_dpp v115, v91 row_shl:12 row_mask:0xf bank_mask:0xf
    v_mov_b32_dpp v116, v92 row_shl:12 row_mask:0xf bank_mask:0xf
    v_mov_b32_dpp v117, v93 row_shl:12 row_mask:0xf bank_mask:0xf
    s_waitcnt lgkmcnt(4)
    v_mfma_f32_16x16x32_bf16 v[138:141], v[122:125], v[110:113], v[138:141]
    v_mov_b32_dpp v118, v90 row_shl:14 row_mask:0xf bank_mask:0xf
    v_mov_b32_dpp v119, v91 row_shl:14 row_mask:0xf bank_mask:0xf
    v_mov_b32_dpp v120, v92 row_shl:14 row_mask:0xf bank_mask:0xf
    v_mov_b32_dpp v121, v93 row_shl:14 row_mask:0xf bank_mask:0xf
    s_waitcnt lgkmcnt(2)
    v_mfma_f32_16x16x32_bf16 v[134:137], v[126:129], v[114:117], v[134:137]
    s_waitcnt lgkmcnt(0)
    v_mfma_f32_16x16x32_bf16 v[138:141], v[130:133], v[118:121], v[138:141]
    v_cmp_eq_u32 s[34:35], v2, v36
    v_cmp_eq_u32 vcc, v2, v37
    v_cmp_eq_u32 s[36:37], v9, v36
    v_cmp_eq_u32 s[46:47], v9, v37
    v_bfrev_b32 v73, 1
    v_lshlrev_b32 v74, 5, v4
    v_cndmask_b32 v2, 0, 64, vcc
    v_cndmask_b32 v9, 0, 64, s[46:47]
    v_add_f32 v134, v134, v138
    v_add_f32 v135, v135, v139
    v_add_f32 v136, v136, v140
    v_add_f32 v137, v137, v141
    s_mov_b64 exec, s[50:51]
    buffer_store_dwordx4 v[134:137], v23, s[8:11], s44 offen sc1
    s_mov_b64 exec, -1
    buffer_load_dwordx4 v[26:29], v75, s[8:11], s54 offen sc1
    buffer_load_dwordx4 v[30:33], v75, s[8:11], s41 offen sc1
    buffer_load_dword v20, v80, s[8:11], s55 offen sc1
    buffer_load_dwordx2 v[18:19], v15, s[8:11], s43 offen sc1
    buffer_load_dwordx2 v[34:35], v72, s[8:11], s43 offen sc1
    s_or_b64 s[34:35], s[34:35], vcc
    s_or_b64 s[36:37], s[36:37], s[46:47]
    v_lshl_add_u32 v2, v2, 1, v74
    v_sub_u32 v74, 96, v74
    v_lshl_add_u32 v9, v9, 1, v74
    v_cndmask_b32 v81, v81, v73, s[34:35]
    v_cndmask_b32 v14, v14, v73, s[36:37]
    s_waitcnt vmcnt(0)
UCHK:
    v_max3_u32 v73, v26, v27, v28
    v_max3_u32 v74, v30, v31, v32
    v_max3_u32 v73, v73, v29, v33
    v_max3_u32 v74, v74, v20, v18
    v_max3_u32 v73, v73, v19, v34
    v_max3_u32 v73, v73, v74, v35
    v_cmp_eq_u32 vcc, -1, v73
    s_cbranch_vccnz URETRY
UOK:
    v_perm_b32 v73, v26, v30, v16
    v_perm_b32 v30, v30, v26, v17
    ds_write_b32 v12, v20 offset:32
    v_mov_b32 v26, v73
    ds_write_b64 v10, v[28:29] offset:40
    ds_write_b64 v11, v[32:33] offset:48
    ds_write_b64 v11, v[30:31] offset:8
    ds_write_b64 v10, v[26:27]
    s_waitcnt lgkmcnt(0)
    s_barrier
    ds_read_b64_tr_b16 v[94:95], v13 offset:0
    ds_read_b64_tr_b16 v[96:97], v13 offset:768
    ds_read_b64_tr_b16 v[98:99], v13 offset:40
    ds_read_b64_tr_b16 v[100:101], v13 offset:808
    ds_read_b64_tr_b16 v[102:103], v13 offset:8
    ds_read_b64_tr_b16 v[104:105], v13 offset:776
    ds_read_b64_tr_b16 v[106:107], v13 offset:3072
    ds_read_b64_tr_b16 v[108:109], v13 offset:3840
    ds_read_b64_tr_b16 v[110:111], v13 offset:3112
    ds_read_b64_tr_b16 v[112:113], v13 offset:3880
    ds_read_b64_tr_b16 v[114:115], v13 offset:3080
    ds_read_b64_tr_b16 v[116:117], v13 offset:3848
    buffer_load_dwordx4 v[36:39], v24, s[8:11], s52 offen sc1
    buffer_load_dwordx4 v[76:79], v24, s[8:11], s52 offen offset:512 sc1
    s_cmp_ge_u32 s2, 224
    s_cbranch_scc1 NODN
    v_mov_b32 v134, 0
    v_xor_b32 v135, 32, v22
    v_xor_b32 v136, 64, v22
    v_xor_b32 v137, 96, v22
    ds_read_b32 v8, v134 offset:58252
    ds_read_b64_tr_b16 v[118:119], v22 offset:0
    ds_read_b64_tr_b16 v[120:121], v22 offset:512
    ds_read_b64_tr_b16 v[122:123], v135 offset:0
    ds_read_b64_tr_b16 v[124:125], v135 offset:512
    ds_read_b64_tr_b16 v[126:127], v136 offset:0
    ds_read_b64_tr_b16 v[128:129], v136 offset:512
    ds_read_b64_tr_b16 v[130:131], v137 offset:0
    ds_read_b64_tr_b16 v[132:133], v137 offset:512
    s_mov_b32 s48, 0
    s_waitcnt vmcnt(0)
HCHK:
    v_add_f32 v36, v36, v76
    v_add_f32 v37, v37, v77
    v_add_f32 v38, v38, v78
    v_add_f32 v39, v39, v79
    v_add_f32_dpp v36, v36, v36 row_ror:8 row_mask:0xf bank_mask:0xf
    v_add_f32_dpp v37, v37, v37 row_ror:8 row_mask:0xf bank_mask:0xf
    v_add_f32_dpp v38, v38, v38 row_ror:8 row_mask:0xf bank_mask:0xf
    v_add_f32_dpp v39, v39, v39 row_ror:8 row_mask:0xf bank_mask:0xf
    v_cmp_u_f32 vcc, v36, v37
    v_cmp_u_f32 s[46:47], v38, v39
    v_mov_b32_dpp v158, v36 quad_perm:[0,1,0,1] row_mask:0xf bank_mask:0xf
    v_mov_b32_dpp v159, v37 quad_perm:[0,1,0,1] row_mask:0xf bank_mask:0xf
    v_mov_b32_dpp v160, v38 quad_perm:[0,1,0,1] row_mask:0xf bank_mask:0xf
    v_mov_b32_dpp v161, v39 quad_perm:[0,1,0,1] row_mask:0xf bank_mask:0xf
    s_or_b64 vcc, vcc, s[46:47]
    s_cbranch_scc1 HRETRY
HOK:
    v_mul_f32 v154, 0xbfb8aa3b, v158
PAD6:
    s_cbranch_execz RET_B_0
    v_mul_f32 v155, 0xbfb8aa3b, v159
    v_mul_f32 v156, 0xbfb8aa3b, v160
    v_mul_f32 v157, 0xbfb8aa3b, v161
    v_exp_f32 v154, v154
    v_mul_f32_dpp v158, v36, v158 quad_perm:[2,3,2,3] row_mask:0xf bank_mask:0xf
    v_exp_f32 v155, v155
    v_mul_f32_dpp v159, v37, v159 quad_perm:[2,3,2,3] row_mask:0xf bank_mask:0xf
    v_exp_f32 v156, v156
    v_mul_f32_dpp v160, v38, v160 quad_perm:[2,3,2,3] row_mask:0xf bank_mask:0xf
    v_exp_f32 v157, v157
    v_mul_f32_dpp v161, v39, v161 quad_perm:[2,3,2,3] row_mask:0xf bank_mask:0xf
    v_add_f32 v154, 1.0, v154
    v_add_f32 v155, 1.0, v155
    v_add_f32 v156, 1.0, v156
    v_add_f32 v157, 1.0, v157
    v_rcp_f32 v154, v154
    v_rcp_f32 v155, v155
    v_rcp_f32 v156, v156
    v_rcp_f32 v157, v157
    s_mov_b32 s48, 0
    s_waitcnt lgkmcnt(8)
DCHK:
    v_cmp_eq_u32 vcc, -1, v8
    s_cbranch_vccnz DRETRY
DOK:
    v_mul_f32 v158, v158, v154
    v_mul_f32 v159, v159, v155
    v_mul_f32 v160, v160, v156
    v_mul_f32 v161, v161, v157
    v_cvt_pk_bf16_f32 v162, v158, v159
    v_cvt_pk_bf16_f32 v163, v160, v161
    s_add_u32 s52, s42, 7168
    v_mov_b32_dpp v164, v162 row_shl:4 row_mask:0xf bank_mask:0xf
    v_mov_b32_dpp v165, v163 row_shl:4 row_mask:0xf bank_mask:0xf
    s_waitcnt lgkmcnt(6)
    s_nop 0
    v_mfma_f32_16x16x32_bf16 v[138:141], v[118:121], v[162:165], 0
    s_waitcnt lgkmcnt(4)
    v_mfma_f32_16x16x32_bf16 v[142:145], v[122:125], v[162:165], 0
    s_waitcnt lgkmcnt(2)
    v_mfma_f32_16x16x32_bf16 v[146:149], v[126:129], v[162:165], 0
    s_waitcnt lgkmcnt(0)
    v_mfma_f32_16x16x32_bf16 v[150:153], v[130:133], v[162:165], 0
    s_nop 1
    v_cvt_pk_bf16_f32 v154, v138, v139
    v_cvt_pk_bf16_f32 v155, v140, v141
    v_cvt_pk_bf16_f32 v156, v142, v143
    v_cvt_pk_bf16_f32 v157, v144, v145
    s_nop 0
    v_permlane16_swap_b32 v154, v156
    v_permlane16_swap_b32 v155, v157
    s_mov_b64 exec, s[50:51]
    buffer_store_dwordx4 v[154:157], v25, s[8:11], s42 offen sc1
    s_mov_b64 exec, -1
    v_cvt_pk_bf16_f32 v158, v146, v147
    v_cvt_pk_bf16_f32 v159, v148, v149
    v_cvt_pk_bf16_f32 v160, v150, v151
    v_cvt_pk_bf16_f32 v161, v152, v153
    s_nop 0
    v_permlane16_swap_b32 v158, v160
    v_permlane16_swap_b32 v159, v161
    s_mov_b64 exec, s[50:51]
    buffer_store_dwordx4 v[158:161], v25, s[8:11], s52 offen sc1
    s_mov_b64 exec, -1
DNJ:
    s_barrier
    buffer_load_dwordx4 v[82:85], v81, s[4:7], 0 offen
    buffer_load_dwordx4 v[86:89], v14, s[4:7], 0 offen
    v_mfma_f32_16x16x32_bf16 v[26:29], v[94:97], v[40:43], 0
    v_mfma_f32_16x16x32_bf16 v[30:33], v[98:101], v[40:43], 0
    v_mfma_f32_16x16x32_bf16 v[90:93], v[102:105], v[40:43], 0
    ds_read_b64_tr_b16 v[94:95], v13 offset:6144
    ds_read_b64_tr_b16 v[96:97], v13 offset:6912
    ds_read_b64_tr_b16 v[98:99], v13 offset:6184
    ds_read_b64_tr_b16 v[100:101], v13 offset:6952
    ds_read_b64_tr_b16 v[102:103], v13 offset:6152
    ds_read_b64_tr_b16 v[104:105], v13 offset:6920
    v_mfma_f32_16x16x32_bf16 v[26:29], v[106:109], v[44:47], v[26:29]
    v_mfma_f32_16x16x32_bf16 v[30:33], v[110:113], v[44:47], v[30:33]
    v_mfma_f32_16x16x32_bf16 v[90:93], v[114:117], v[44:47], v[90:93]
    ds_read_b64_tr_b16 v[106:107], v13 offset:9216
    ds_read_b64_tr_b16 v[108:109], v13 offset:9984
    ds_read_b64_tr_b16 v[110:111], v13 offset:9256
    ds_read_b64_tr_b16 v[112:113], v13 offset:10024
    ds_read_b64_tr_b16 v[114:115], v13 offset:9224
    ds_read_b64_tr_b16 v[116:117], v13 offset:9992
    s_waitcnt lgkmcnt(10)
    v_mfma_f32_16x16x32_bf16 v[26:29], v[94:97], v[48:51], v[26:29]
    s_waitcnt lgkmcnt(8)
    v_mfma_f32_16x16x32_bf16 v[30:33], v[98:101], v[48:51], v[30:33]
    s_waitcnt lgkmcnt(6)
    v_mfma_f32_16x16x32_bf16 v[90:93], v[102:105], v[48:51], v[90:93]
    ds_read_b64_tr_b16 v[94:95], v13 offset:12288
    ds_read_b64_tr_b16 v[96:97], v13 offset:13056
    ds_read_b64_tr_b16 v[98:99], v13 offset:12328
    ds_read_b64_tr_b16 v[100:101], v13 offset:13096
    ds_read_b64_tr_b16 v[102:103], v13 offset:12296
    ds_read_b64_tr_b16 v[104:105], v13 offset:13064
    s_waitcnt lgkmcnt(10)
    v_mfma_f32_16x16x32_bf16 v[26:29], v[106:109], v[52:55], v[26:29]
    s_waitcnt lgkmcnt(8)
    v_mfma_f32_16x16x32_bf16 v[30:33], v[110:113], v[52:55], v[30:33]
    s_waitcnt lgkmcnt(6)
    v_mfma_f32_16x16x32_bf16 v[90:93], v[114:117], v[52:55], v[90:93]
    ds_read_b64_tr_b16 v[106:107], v13 offset:15360
    ds_read_b64_tr_b16 v[108:109], v13 offset:16128
    ds_read_b64_tr_b16 v[110:111], v13 offset:15400
    ds_read_b64_tr_b16 v[112:113], v13 offset:16168
    ds_read_b64_tr_b16 v[114:115], v13 offset:15368
    ds_read_b64_tr_b16 v[116:117], v13 offset:16136
    s_waitcnt lgkmcnt(10)
    v_mfma_f32_16x16x32_bf16 v[26:29], v[94:97], v[56:59], v[26:29]
    s_waitcnt lgkmcnt(8)
    v_mfma_f32_16x16x32_bf16 v[30:33], v[98:101], v[56:59], v[30:33]
    s_waitcnt lgkmcnt(6)
    v_mfma_f32_16x16x32_bf16 v[90:93], v[102:105], v[56:59], v[90:93]
    ds_read_b64_tr_b16 v[94:95], v13 offset:18432
    ds_read_b64_tr_b16 v[96:97], v13 offset:19200
    ds_read_b64_tr_b16 v[98:99], v13 offset:18472
    ds_read_b64_tr_b16 v[100:101], v13 offset:19240
    ds_read_b64_tr_b16 v[102:103], v13 offset:18440
    ds_read_b64_tr_b16 v[104:105], v13 offset:19208
    s_waitcnt lgkmcnt(10)
    v_mfma_f32_16x16x32_bf16 v[26:29], v[106:109], v[60:63], v[26:29]
    s_waitcnt lgkmcnt(8)
    v_mfma_f32_16x16x32_bf16 v[30:33], v[110:113], v[60:63], v[30:33]
    s_waitcnt lgkmcnt(6)
    v_mfma_f32_16x16x32_bf16 v[90:93], v[114:117], v[60:63], v[90:93]
    ds_read_b64_tr_b16 v[106:107], v13 offset:21504
    ds_read_b64_tr_b16 v[108:109], v13 offset:22272
    ds_read_b64_tr_b16 v[110:111], v13 offset:21544
    ds_read_b64_tr_b16 v[112:113], v13 offset:22312
    ds_read_b64_tr_b16 v[114:115], v13 offset:21512
    ds_read_b64_tr_b16 v[116:117], v13 offset:22280
    s_waitcnt vmcnt(0)
    v_lshlrev_b32 v36, 16, v82
    v_and_b32 v37, 0xffff0000, v82
    v_lshlrev_b32 v38, 16, v83
    v_and_b32 v39, 0xffff0000, v83
    v_lshlrev_b32 v40, 16, v84
    v_and_b32 v41, 0xffff0000, v84
    v_lshlrev_b32 v42, 16, v85
    v_and_b32 v43, 0xffff0000, v85
    v_lshlrev_b32 v44, 16, v86
    v_and_b32 v45, 0xffff0000, v86
    v_lshlrev_b32 v46, 16, v87
    v_and_b32 v47, 0xffff0000, v87
    v_lshlrev_b32 v48, 16, v88
    v_and_b32 v49, 0xffff0000, v88
    v_lshlrev_b32 v50, 16, v89
    v_and_b32 v51, 0xffff0000, v89
    v_mul_f32 v19, -v18, v19
    v_add_f32 v18, 1.0, v18
    v_mul_f32 v35, -v34, v35
    v_add_f32 v34, 1.0, v34
    v_fma_f32 v36, v36, v18, v19
    v_fma_f32 v37, v37, v18, v19
    v_fma_f32 v38, v38, v18, v19
    v_fma_f32 v39, v39, v18, v19
    v_fma_f32 v40, v40, v18, v19
    v_fma_f32 v41, v41, v18, v19
PAD7:
    s_cbranch_execz RET_B_0
    v_fma_f32 v42, v42, v18, v19
    v_fma_f32 v43, v43, v18, v19
    v_fma_f32 v44, v44, v34, v35
    v_fma_f32 v45, v45, v34, v35
    v_fma_f32 v46, v46, v34, v35
    v_fma_f32 v47, v47, v34, v35
    v_fma_f32 v48, v48, v34, v35
    v_fma_f32 v49, v49, v34, v35
    v_fma_f32 v50, v50, v34, v35
    v_fma_f32 v51, v51, v34, v35
    s_waitcnt lgkmcnt(10)
    v_mfma_f32_16x16x32_bf16 v[26:29], v[94:97], v[64:67], v[26:29]
    s_waitcnt lgkmcnt(8)
    v_mfma_f32_16x16x32_bf16 v[30:33], v[98:101], v[64:67], v[30:33]
    s_waitcnt lgkmcnt(6)
    v_mfma_f32_16x16x32_bf16 v[90:93], v[102:105], v[64:67], v[90:93]
    s_waitcnt lgkmcnt(4)
    v_mfma_f32_16x16x32_bf16 v[26:29], v[106:109], v[68:71], v[26:29]
    s_waitcnt lgkmcnt(2)
    v_mfma_f32_16x16x32_bf16 v[30:33], v[110:113], v[68:71], v[30:33]
    s_waitcnt lgkmcnt(0)
    v_mfma_f32_16x16x32_bf16 v[90:93], v[114:117], v[68:71], v[90:93]
    s_nop 3
    v_add_f32 v36, v36, v26
    v_add_f32 v37, v37, v27
    v_add_f32 v38, v38, v28
    v_add_f32 v39, v39, v29
    v_add_f32 v49, v49, v29
    v_add_f32 v50, v50, v28
    v_add_f32 v51, v51, v27
    v_add_f32 v40, v40, v30
    v_add_f32 v45, v45, v33
    v_add_f32 v41, v41, v31
    v_add_f32 v46, v46, v32
    v_add_f32 v42, v42, v32
    v_add_f32 v47, v47, v31
    v_add_f32 v43, v43, v33
    v_add_f32 v48, v48, v30
    v_add_f32 v44, v44, v90
    v_cvt_pk_bf16_f32 v16, v36, v37
    v_cvt_pk_bf16_f32 v17, v38, v39
    v_cvt_pk_bf16_f32 v18, v40, v41
    v_cvt_pk_bf16_f32 v19, v42, v43
    v_cvt_pk_bf16_f32 v52, v44, v45
    v_cvt_pk_bf16_f32 v53, v46, v47
    v_cvt_pk_bf16_f32 v54, v48, v49
    v_cvt_pk_bf16_f32 v55, v50, v51
    s_or_b64 vcc, s[34:35], s[36:37]
    s_cbranch_scc1 FINW
FIND:
COUT:
    buffer_store_dwordx4 v[16:19], v81, s[24:27], 0 offen
    buffer_store_dwordx4 v[52:55], v14, s[24:27], 0 offen
END:
    s_endpgm
URETRY:
    s_add_u32 s48, s48, 1
    s_cmp_ge_u32 s48, 4096
    s_cbranch_scc1 UOK
    buffer_load_dwordx4 v[26:29], v75, s[8:11], s54 offen sc1
    buffer_load_dwordx4 v[30:33], v75, s[8:11], s41 offen sc1
    buffer_load_dword v20, v80, s[8:11], s55 offen sc1
    buffer_load_dwordx2 v[18:19], v15, s[8:11], s43 offen sc1
    buffer_load_dwordx2 v[34:35], v72, s[8:11], s43 offen sc1
    s_waitcnt vmcnt(0)
    s_branch UCHK
HRETRY:
    s_add_u32 s48, s48, 1
    s_cmp_ge_u32 s48, 4096
    s_cbranch_scc1 HOK
    buffer_load_dwordx4 v[36:39], v24, s[8:11], s52 offen sc1
    buffer_load_dwordx4 v[76:79], v24, s[8:11], s52 offen offset:512 sc1
    s_waitcnt vmcnt(0)
    s_branch HCHK
DRETRY:
    s_add_u32 s48, s48, 1
    s_cmp_ge_u32 s48, 65536
    s_nop 1
    s_cbranch_scc1 DOK
    ds_read_b32 v8, v134 offset:58252
    ds_read_b64_tr_b16 v[118:119], v22 offset:0
    ds_read_b64_tr_b16 v[120:121], v22 offset:512
    ds_read_b64_tr_b16 v[122:123], v135 offset:0
    ds_read_b64_tr_b16 v[124:125], v135 offset:512
    ds_read_b64_tr_b16 v[126:127], v136 offset:0
    ds_read_b64_tr_b16 v[128:129], v136 offset:512
    ds_read_b64_tr_b16 v[130:131], v137 offset:0
    ds_read_b64_tr_b16 v[132:133], v137 offset:512
    s_waitcnt lgkmcnt(0)
    s_branch DCHK
NODN:
    s_waitcnt vmcnt(0) lgkmcnt(0)
    s_branch DNJ
MEETB:
    s_barrier
    s_nop 1
    s_branch GO0
FINW:
    s_mov_b64 exec, s[34:35]
    ds_write_b128 v2, v[36:39] offset:60416
    ds_write_b128 v2, v[40:43] offset:60432
    s_mov_b64 exec, s[36:37]
    ds_write_b128 v9, v[44:47] offset:60672
    ds_write_b128 v9, v[48:51] offset:60688
    s_mov_b64 exec, -1
    s_waitcnt lgkmcnt(0)
    s_branch FIND
COMM:
PAD8:
    s_cbranch_execz RET_A_0
    v_lshlrev_b32 v11, 3, v1
    ds_write_b64 v11, v[6:7] offset:60416
    s_mov_b32 s26, s6
    s_mov_b32 s27, s7
    v_lshlrev_b32 v14, 12, v1
    s_and_b32 s3, s2, 3
    s_lshl_b32 s43, s3, 10
    s_and_b32 s3, s2, 0xfc
    s_lshl2_add_u32 s43, s3, s43
    s_add_u32 s43, s43, 3407872
    s_lshl_b32 s44, s33, 12
    s_add_u32 s44, s44, 3407872
    s_mov_b32 s45, 0
    s_lshl_b32 s38, s35, 5
    v_lshlrev_b32 v18, 2, v1
    v_add_u32 v17, s38, v18
    v_lshrrev_b32 v11, 4, v1
    v_bfe_u32 v12, v1, 1, 3
    v_lshl_add_u32 v11, v12, 2, v11
    s_lshl_b32 s38, s47, 9
    v_lshl_add_u32 v16, v11, 4, s38
    s_mov_b32 s56, 0xaaaaaaaa
    s_mov_b32 s57, 0xaaaaaaaa
    s_cmpk_lt_u32 s2, 224
    s_cbranch_scc1 CB0
    s_barrier
CB0:
    s_waitcnt vmcnt(12)
    v_add_u32 v4, 2, v4
    v_or_b32 v4, 1, v4
    v_readfirstlane_b32 s49, v5
    v_readfirstlane_b32 s48, v4
    s_waitcnt lgkmcnt(0)
CSPIN:
    ds_read_b32 v12, v10 offset:58260
    ds_read_b128 v[24:27], v10 offset:58176
    ds_read_b128 v[28:31], v10 offset:58192
    ds_read_b32 v20, v17 offset:58112
    ds_read_b32 v21, v18 offset:58272
    s_waitcnt lgkmcnt(4)
    v_and_b32 v12, 0xff, v12
    v_cmp_eq_u32 vcc, 8, v12
    s_cbranch_vccz CSPIN
    s_waitcnt lgkmcnt(3)
    v_max3_u32 v19, v24, v25, v26
    v_med3_u32 v23, v24, v25, v26
    s_waitcnt lgkmcnt(2)
    v_max3_u32 v32, v27, v28, v29
    v_med3_u32 v33, v27, v28, v29
    v_med3_u32 v12, v19, v32, v30
    v_max3_u32 v19, v19, v32, v30
    v_max3_u32 v12, v12, v23, v33
    v_max_u32 v2, v19, v31
    v_med3_u32 v3, v19, v12, v31
    s_mov_b64 exec, 0xff
    s_waitcnt vmcnt(0)
    buffer_store_dwordx4 v[2:5], v14, s[8:11], s43 offen sc1
    s_waitcnt lgkmcnt(0)
    buffer_store_dwordx2 v[20:21], v13, s[8:11], s42 offen sc1
    s_mov_b64 exec, -1
    v_readfirstlane_b32 s50, v2
    v_readfirstlane_b32 s51, v3
    s_barrier
    buffer_load_dwordx4 v[34:37], v15, s[8:11], s44 offen offset:0 sc1
    buffer_load_dwordx4 v[38:41], v15, s[8:11], s44 offen offset:1024 sc1
    buffer_load_dwordx4 v[42:45], v15, s[8:11], s44 offen offset:2048 sc1
    buffer_load_dwordx4 v[46:49], v15, s[8:11], s44 offen offset:3072 sc1
    s_mov_b64 s[54:55], 0
    s_mov_b64 s[52:53], -1
REDUCE:
    s_add_u32 s45, s45, 1
    s_waitcnt vmcnt(3)
    v_cmp_eq_u64 vcc, s[48:49], v[36:37]
    s_waitcnt vmcnt(2)
    v_cmp_eq_u64 s[58:59], s[48:49], v[40:41]
    v_max_u32 v23, v35, v39
    v_max_u32 v19, v34, v38
    v_med3_u32 v23, v34, v38, v23
    s_waitcnt vmcnt(1)
    v_cmp_eq_u64 s[60:61], s[48:49], v[44:45]
    s_and_b64 vcc, vcc, s[58:59]
    s_waitcnt vmcnt(0)
    v_cmp_eq_u64 s[62:63], s[48:49], v[48:49]
    v_max_u32 v33, v43, v47
    v_max_u32 v32, v42, v46
    v_med3_u32 v33, v42, v46, v33
    s_and_b64 vcc, vcc, s[60:61]
    v_max_u32 v23, v23, v33
    s_and_b64 vcc, vcc, s[62:63]
    v_med3_u32 v23, v19, v32, v23
    v_max_u32 v19, v19, v32
    v_cndmask_b32 v23, 0, v23, vcc
    v_cndmask_b32 v19, 0, v19, vcc
    s_nop 0
    v_max_u32_dpp v33, v23, v23 row_ror:8 row_mask:0xf bank_mask:0xf
    v_mov_b32_dpp v32, v19 row_ror:8 row_mask:0xf bank_mask:0xf
    v_med3_u32 v23, v19, v32, v33
    v_max_u32 v19, v19, v32
    s_nop 0
    v_max_u32_dpp v33, v23, v23 row_ror:4 row_mask:0xf bank_mask:0xf
    v_mov_b32_dpp v32, v19 row_ror:4 row_mask:0xf bank_mask:0xf
    v_med3_u32 v23, v19, v32, v33
    v_max_u32 v19, v19, v32
    s_nop 0
    v_max_u32_dpp v33, v23, v23 row_ror:2 row_mask:0xf bank_mask:0xf
    v_mov_b32_dpp v32, v19 row_ror:2 row_mask:0xf bank_mask:0xf
    v_med3_u32 v23, v19, v32, v33
    v_max_u32 v19, v19, v32
    s_nop 0
    v_max_u32_dpp v33, v23, v23 row_ror:1 row_mask:0xf bank_mask:0xf
    v_mov_b32_dpp v32, v19 row_ror:1 row_mask:0xf bank_mask:0xf
    v_med3_u32 v23, v19, v32, v33
    v_max_u32 v19, v19, v32
    s_nop 0
    v_max_u32_dpp v33, v23, v23 row_bcast:15 row_mask:0xa bank_mask:0xf
    v_mov_b32_dpp v32, v19 row_bcast:15 row_mask:0xa bank_mask:0xf
    v_med3_u32 v23, v19, v32, v33
    v_max_u32 v19, v19, v32
    s_nop 0
    v_max_u32_dpp v33, v23, v23 row_bcast:31 row_mask:0xc bank_mask:0xf
    v_mov_b32_dpp v32, v19 row_bcast:31 row_mask:0xc bank_mask:0xf
    v_med3_u32 v23, v19, v32, v33
    v_max_u32 v19, v19, v32
    s_nop 0
    v_readlane_b32 s50, v19, 63
    v_readlane_b32 s51, v23, 63
    s_cmp_eq_u64 vcc, -1
    s_cbranch_scc0 NOTALL
    s_cmp_eq_u64 s[50:51], s[52:53]
    s_cbranch_scc1 SAME
FINAL:
    v_mov_b32 v11, s50
    v_mov_b32 v12, s51
    v_cndmask_b32 v11, v11, v12, s[56:57]
    v_and_b32 v32, 0x7ff, v11
    v_lshl_add_u32 v33, v32, 11, v16
    buffer_load_dwordx4 v[24:27], v33, s[4:7], 0 offen
    v_and_b32 v12, 7, v11
    v_and_b32 v11, 0x7f8, v11
    v_lshl_add_u32 v11, v12, 11, v11
    buffer_load_dwordx2 v[20:21], v11, s[8:11], s42 offen sc1
    s_barrier
    s_mov_b64 exec, 3
    ds_write_b32 v18, v32 offset:58240
    s_mov_b64 exec, -1
    s_waitcnt vmcnt(1)
    v_lshlrev_b32 v50, 16, v24
    v_and_b32 v51, 0xffff0000, v24
    v_lshlrev_b32 v52, 16, v25
    v_and_b32 v53, 0xffff0000, v25
    v_lshlrev_b32 v54, 16, v26
    v_and_b32 v55, 0xffff0000, v26
    v_lshlrev_b32 v56, 16, v27
    v_and_b32 v57, 0xffff0000, v27
SCHK:
    s_waitcnt vmcnt(0)
    v_max_u32 v12, v20, v21
    v_mul_f32 v21, -v20, v21
    v_cmp_eq_u32 vcc, -1, v12
    s_cbranch_vccnz SRETRY
SOK:
    v_fma_f32 v50, v50, v20, v21
    v_fma_f32 v51, v51, v20, v21
    v_fma_f32 v52, v52, v20, v21
    v_fma_f32 v53, v53, v20, v21
    v_fma_f32 v54, v54, v20, v21
    v_fma_f32 v55, v55, v20, v21
    v_fma_f32 v56, v56, v20, v21
    v_fma_f32 v57, v57, v20, v21
    v_cvt_pk_bf16_f32 v24, v50, v51
    v_cvt_pk_bf16_f32 v25, v52, v53
    v_cvt_pk_bf16_f32 v26, v54, v55
    v_cvt_pk_bf16_f32 v27, v56, v57
    ds_write_b128 v15, v[24:27] offset:58368
GOT:
PAD9:
    s_cbranch_execz RET_B_0
    s_waitcnt lgkmcnt(0)
    s_barrier
    s_cmp_lg_u32 s2, 0
    s_cbranch_scc1 NOEP
    s_mov_b64 exec, 1
    buffer_store_dword v4, v10, s[8:11], s41 offen sc1
    s_mov_b64 exec, -1
NOEP:
    s_and_b32 s59, s34, 15
    s_lshr_b32 s60, s34, 4
    s_lshl_b32 s60, s60, 10
    s_or_b32 s60, s60, s33
    s_mov_b32 s58, 0
    s_and_b32 s38, s50, 0x407
    s_cmp_eq_u32 s38, s60
    s_cselect_b32 s38, 1, 0
    s_or_b32 s58, s58, s38
    s_and_b32 s38, s51, 0x407
    s_cmp_eq_u32 s38, s60
    s_cselect_b32 s38, 2, 0
    s_or_b32 s58, s58, s38
    s_sub_u32 s38, 0, s50
    s_and_b32 s38, s38, 0x407
    s_cmp_eq_u32 s38, s60
    s_cselect_b32 s38, 4, 0
    s_or_b32 s58, s58, s38
    s_sub_u32 s38, 0, s51
    s_and_b32 s38, s38, 0x407
    s_cmp_eq_u32 s38, s60
    s_cselect_b32 s38, 8, 0
    s_or_b32 s58, s58, s38
    s_cbranch_scc0 MEND
    v_and_b32 v28, 15, v1
    v_and_b32 v11, 1, v1
    v_lshlrev_b32 v11, 4, v11
    v_mov_b32 v12, 0x3f80
    v_lshlrev_b32 v11, v11, v12
    v_lshrrev_b32 v12, 1, v28
    v_cmp_eq_u32 vcc, 0, v12
    s_nop 1
    v_cndmask_b32 v24, 0, v11, vcc
    v_cmp_eq_u32 vcc, 1, v12
    s_nop 1
    v_cndmask_b32 v25, 0, v11, vcc
    v_cmp_eq_u32 vcc, 2, v12
    s_nop 1
    v_cndmask_b32 v26, 0, v11, vcc
    v_cmp_eq_u32 vcc, 3, v12
    s_nop 1
    v_cndmask_b32 v27, 0, v11, vcc
    v_and_b32 v11, 3, v1
    v_bfe_u32 v12, v1, 4, 1
    v_lshl_add_u32 v11, v11, 1, v12
    v_lshlrev_b32 v29, 4, v11
    v_lshlrev_b32 v30, 3, v11
    s_barrier
    s_barrier
ROLE:
    s_ff1_i32_b32 s61, s58
    s_bitset0_b32 s58, s61
    s_bitcmp1_b32 s61, 0
    s_cselect_b32 s62, s51, s50
    s_cselect_b32 s64, 32, 0
    s_sub_u32 s46, 31, s59
    s_bitcmp1_b32 s61, 1
    s_cselect_b32 s46, s46, s59
    s_add_u32 s64, s64, s46
    s_mul_i32 s64, s64, 7168
    s_add_u32 s64, s64, 2490368
    s_add_u32 s47, s64, 4096
    s_and_b32 s63, s62, 0x7ff
    s_lshl_b32 s63, s63, 11
    s_lshl_b32 s46, s46, 6
    s_add_u32 s63, s63, s46
    s_lshl_b32 s38, s61, 7
    v_add_u32 v11, s38, v29
    s_mov_b32 s45, 0
    v_mov_b32 v31, s62
    v_ashrrev_i32 v12, 31, v31
    v_not_b32 v12, v12
    v_or_b32 v12, 0x80000000, v12
    v_xor_b32 v31, v31, v12
    v_mul_f32 v31, 0xbfb8aa3b, v31
    v_exp_f32 v31, v31
    s_nop 0
    v_add_f32 v31, 1.0, v31
    v_rcp_f32 v31, v31
RPOLL:
    buffer_load_dwordx4 v[34:37], v15, s[8:11], s64 offen offset:0 sc1
    buffer_load_dwordx4 v[38:41], v15, s[8:11], s64 offen offset:1024 sc1
    buffer_load_dwordx4 v[42:45], v15, s[8:11], s64 offen offset:2048 sc1
    buffer_load_dwordx4 v[46:49], v15, s[8:11], s64 offen offset:3072 sc1
    buffer_load_dwordx4 v[50:53], v15, s[8:11], s47 offen offset:0 sc1
    buffer_load_dwordx4 v[54:57], v15, s[8:11], s47 offen offset:1024 sc1
    buffer_load_dwordx4 v[58:61], v15, s[8:11], s47 offen offset:2048 sc1
    s_add_u32 s45, s45, 1
    s_waitcnt vmcnt(6)
    v_mfma_f32_16x16x32_bf16 v[62:65], v[24:27], v[34:37], 0
    s_waitcnt vmcnt(5)
    v_mfma_f32_16x16x32_bf16 v[62:65], v[24:27], v[38:41], v[62:65]
    s_waitcnt vmcnt(4)
    v_mfma_f32_16x16x32_bf16 v[62:65], v[24:27], v[42:45], v[62:65]
    s_waitcnt vmcnt(3)
    v_mfma_f32_16x16x32_bf16 v[62:65], v[24:27], v[46:49], v[62:65]
    s_waitcnt vmcnt(2)
    v_mfma_f32_16x16x32_bf16 v[62:65], v[24:27], v[50:53], v[62:65]
    s_waitcnt vmcnt(1)
    v_mfma_f32_16x16x32_bf16 v[62:65], v[24:27], v[54:57], v[62:65]
    s_waitcnt vmcnt(0)
    v_mfma_f32_16x16x32_bf16 v[62:65], v[24:27], v[58:61], v[62:65]
    ds_read_b128 v[66:69], v11 offset:60416
    s_cmp_ge_u32 s45, 4096
    s_cbranch_scc1 RGOT
    s_nop 4
    v_cmp_u_f32 vcc, v62, v62
    s_cbranch_vccnz RPOLL
RGOT:
    s_nop 4
    v_add_f32_dpp v62, v62, v62 row_ror:4 row_mask:0xf bank_mask:0xf
    v_add_f32_dpp v63, v63, v63 row_ror:4 row_mask:0xf bank_mask:0xf
    v_add_f32_dpp v64, v64, v64 row_ror:4 row_mask:0xf bank_mask:0xf
    v_add_f32_dpp v65, v65, v65 row_ror:4 row_mask:0xf bank_mask:0xf
    v_add_f32_dpp v62, v62, v62 row_ror:8 row_mask:0xf bank_mask:0xf
    v_add_f32_dpp v63, v63, v63 row_ror:8 row_mask:0xf bank_mask:0xf
    v_add_f32_dpp v64, v64, v64 row_ror:8 row_mask:0xf bank_mask:0xf
    v_add_f32_dpp v65, v65, v65 row_ror:8 row_mask:0xf bank_mask:0xf
FCHK:
    s_waitcnt lgkmcnt(0)
    v_max3_u32 v12, v66, v67, v68
    v_max_u32 v12, v12, v69
    v_cmp_eq_u32 vcc, -1, v12
    s_cbranch_vccnz FRETRY
FOK:
    v_fmac_f32 v66, v62, v31
    v_fmac_f32 v67, v63, v31
    v_fmac_f32 v68, v64, v31
    v_fmac_f32 v69, v65, v31
    v_cvt_pk_bf16_f32 v66, v66, v67
    v_cvt_pk_bf16_f32 v67, v68, v69
    s_mov_b64 exec, 0x000f000f
    buffer_store_dwordx2 v[66:67], v30, s[24:27], s63 offen
    s_mov_b64 exec, -1
    s_cmp_lg_u32 s58, 0
    s_nop 0
    s_cbranch_scc1 ROLE
MEND:
    s_endpgm
FRETRY:
    s_add_u32 s45, s45, 1
    s_cmp_ge_u32 s45, 65536
    s_cbranch_scc1 FOK
    ds_read_b128 v[66:69], v11 offset:60416
    s_branch FCHK
NOTALL:
    s_cmp_ge_u32 s45, 4096
    s_cbranch_scc1 FINAL
    s_cmp_eq_u64 s[50:51], s[52:53]
    s_cselect_b64 vcc, s[54:55], 0
    s_cmp_eq_u64 vcc, -1
    s_cbranch_scc0 POLLA
    buffer_load_dwordx4 v[34:37], v15, s[8:11], s44 offen offset:0 sc1
    buffer_load_dwordx4 v[38:41], v15, s[8:11], s44 offen offset:1024 sc1
    buffer_load_dwordx4 v[42:45], v15, s[8:11], s44 offen offset:2048 sc1
    buffer_load_dwordx4 v[46:49], v15, s[8:11], s44 offen offset:3072 sc1
    s_nop 0
    s_branch REDUCE
POLLA:
    v_mov_b32 v11, s50
    v_mov_b32 v12, s51
    s_mov_b64 s[52:53], s[50:51]
    v_cndmask_b32 v11, v11, v12, s[56:57]
    v_and_b32 v32, 0x7ff, v11
    v_lshl_add_u32 v33, v32, 11, v16
    buffer_load_dwordx4 v[24:27], v33, s[4:7], 0 offen
    v_and_b32 v12, 7, v11
    v_and_b32 v11, 0x7f8, v11
    v_lshl_add_u32 v11, v12, 11, v11
    buffer_load_dwordx2 v[20:21], v11, s[8:11], s42 offen sc1
    buffer_load_dwordx4 v[34:37], v15, s[8:11], s44 offen offset:0 sc1
    buffer_load_dwordx4 v[38:41], v15, s[8:11], s44 offen offset:1024 sc1
    buffer_load_dwordx4 v[42:45], v15, s[8:11], s44 offen offset:2048 sc1
    buffer_load_dwordx4 v[46:49], v15, s[8:11], s44 offen offset:3072 sc1
    s_mov_b64 exec, 3
    ds_write_b32 v18, v32 offset:58240
    s_mov_b64 exec, -1
    s_waitcnt vmcnt(5)
    v_lshlrev_b32 v50, 16, v24
    v_and_b32 v51, 0xffff0000, v24
    v_lshlrev_b32 v52, 16, v25
    v_and_b32 v53, 0xffff0000, v25
    v_lshlrev_b32 v54, 16, v26
    v_and_b32 v55, 0xffff0000, v26
    v_lshlrev_b32 v56, 16, v27
    v_and_b32 v57, 0xffff0000, v27
    s_waitcnt vmcnt(4)
    v_max_u32 v11, v20, v21
    v_mul_f32 v21, -v20, v21
    v_cmp_ne_u32 s[54:55], -1, v11
    v_fma_f32 v50, v50, v20, v21
    v_fma_f32 v51, v51, v20, v21
    v_fma_f32 v52, v52, v20, v21
    v_fma_f32 v53, v53, v20, v21
    v_fma_f32 v54, v54, v20, v21
    v_fma_f32 v55, v55, v20, v21
    v_fma_f32 v56, v56, v20, v21
    v_fma_f32 v57, v57, v20, v21
    v_cvt_pk_bf16_f32 v24, v50, v51
    v_cvt_pk_bf16_f32 v25, v52, v53
    v_cvt_pk_bf16_f32 v26, v54, v55
    v_cvt_pk_bf16_f32 v27, v56, v57
    ds_write_b128 v15, v[24:27] offset:58368
    s_nop 0
    s_branch REDUCE
SAME:
    s_cmp_eq_u64 s[54:55], -1
    s_cbranch_scc0 FINAL
    s_barrier
    s_branch GOT
SRETRY:
    s_add_u32 s45, s45, 1
    s_cmp_ge_u32 s45, 8192
    s_cbranch_scc1 SOK
    buffer_load_dwordx2 v[20:21], v11, s[8:11], s42 offen sc1
    s_branch SCHK
LOAD:
    s_lshl_b32 s14, 7, 20
    s_mov_b32 s15, s7
    s_mov_b64 s[18:19], s[14:15]
    s_lshr_b32 s41, s40, 2
    s_and_b32 s42, s40, 3
    s_mul_i32 s43, s42, 1835008
    s_lshl_b32 s38, s41, 7
    s_add_u32 s43, s43, s38
    v_bfe_u32 v10, v1, 1, 2
    v_bfe_u32 v11, v1, 4, 1
    v_xor_b32 v10, v10, v11
    v_and_b32 v11, 1, v1
    v_lshlrev_b32 v11, 4, v11
    v_lshl_add_u32 v10, v10, 5, v11
    v_lshrrev_b32 v11, 3, v1
    v_mul_u32_u24 v2, 7168, v11
    v_add_u32 v2, v10, v2
    v_xor_b32 v3, 64, v2
    v_add_u32 v4, 112640, v2
    v_add_u32 v5, 168960, v3
    v_add_u32 v3, 56320, v3
    s_cmp_eq_u32 s35, 0
    s_cselect_b32 s46, s37, s36
    s_cselect_b32 s47, -1, 1
    s_cselect_b32 s48, 16384, 0
    s_lshl_b32 s47, s47, 19
    s_lshl_b32 s46, s46, 11
    v_and_b32 v12, 32, v1
    v_lshlrev_b32 v6, 4, v1
    v_xor_b32 v12, v12, v6
    s_waitcnt lgkmcnt(0)
    s_add_u32 m0, s48, 0
    s_nop 0
    buffer_load_dwordx4 v12, s[4:7], s46 offen offset:0 lds
    buffer_load_dwordx4 v12, s[4:7], s46 offen offset:1024 lds
    s_add_u32 m0, s48, 2048
    s_add_u32 s46, s46, s47
    buffer_load_dwordx4 v12, s[4:7], s46 offen offset:0 lds
    buffer_load_dwordx4 v12, s[4:7], s46 offen offset:1024 lds
    s_add_u32 m0, s48, 4096
    s_add_u32 s46, s46, s47
    buffer_load_dwordx4 v12, s[4:7], s46 offen offset:0 lds
    buffer_load_dwordx4 v12, s[4:7], s46 offen offset:1024 lds
    s_add_u32 m0, s48, 6144
    s_add_u32 s46, s46, s47
    buffer_load_dwordx4 v12, s[4:7], s46 offen offset:0 lds
    buffer_load_dwordx4 v12, s[4:7], s46 offen offset:1024 lds
    s_add_u32 m0, s48, 8192
    s_add_u32 s46, s46, s47
    buffer_load_dwordx4 v12, s[4:7], s46 offen offset:0 lds
    buffer_load_dwordx4 v12, s[4:7], s46 offen offset:1024 lds
    s_add_u32 m0, s48, 10240
    s_add_u32 s46, s46, s47
    buffer_load_dwordx4 v12, s[4:7], s46 offen offset:0 lds
    buffer_load_dwordx4 v12, s[4:7], s46 offen offset:1024 lds
    s_add_u32 m0, s48, 12288
    s_add_u32 s46, s46, s47
    buffer_load_dwordx4 v12, s[4:7], s46 offen offset:0 lds
    buffer_load_dwordx4 v12, s[4:7], s46 offen offset:1024 lds
    s_add_u32 m0, s48, 14336
    s_add_u32 s46, s46, s47
    buffer_load_dwordx4 v12, s[4:7], s46 offen offset:0 lds
    buffer_load_dwordx4 v12, s[4:7], s46 offen offset:1024 lds
    s_mov_b32 m0, 61440
    s_add_u32 s45, s43, 0
    buffer_load_dwordx4 v2, s[12:15], s45 offen offset:0 nt lds
    buffer_load_dwordx4 v3, s[12:15], s45 offen offset:1024 nt lds
    buffer_load_dwordx4 v4, s[12:15], s45 offen offset:2048 nt lds
    buffer_load_dwordx4 v5, s[12:15], s45 offen offset:3072 nt lds
    s_mov_b32 m0, 94208
    s_nop 0
    buffer_load_dwordx4 v2, s[16:19], s45 offen offset:0 nt lds
    buffer_load_dwordx4 v3, s[16:19], s45 offen offset:1024 nt lds
    buffer_load_dwordx4 v4, s[16:19], s45 offen offset:2048 nt lds
    buffer_load_dwordx4 v5, s[16:19], s45 offen offset:3072 nt lds
    s_mov_b32 m0, 65536
    s_add_u32 s45, s43, 229376
    buffer_load_dwordx4 v2, s[12:15], s45 offen offset:0 nt lds
    buffer_load_dwordx4 v3, s[12:15], s45 offen offset:1024 nt lds
    buffer_load_dwordx4 v4, s[12:15], s45 offen offset:2048 nt lds
    buffer_load_dwordx4 v5, s[12:15], s45 offen offset:3072 nt lds
    v_mov_b32 v12, 256
    s_mov_b64 s[22:23], s[14:15]
    s_lshl_b32 s44, s41, 17
    s_lshl_b32 s38, s42, 9
    s_add_u32 s44, s44, s38
    v_lshl_add_u32 v6, v11, 11, v10
    v_xor_b32 v7, 64, v6
    v_add_u32 v8, 30720, v6
    v_add_u32 v9, 46080, v7
    v_add_u32 v7, 15360, v7
    v_mov_b32 v10, -1
    v_mov_b32 v11, 0
    ds_write_b32 v11, v10 offset:58252
    s_waitcnt vmcnt(12)
    s_mov_b64 exec, 1
    ds_add_u32 v11, v12 offset:58260
    s_mov_b64 exec, -1
    s_mov_b32 m0, 98304
    s_nop 0
    buffer_load_dwordx4 v2, s[16:19], s45 offen offset:0 nt lds
    buffer_load_dwordx4 v3, s[16:19], s45 offen offset:1024 nt lds
    buffer_load_dwordx4 v4, s[16:19], s45 offen offset:2048 nt lds
    buffer_load_dwordx4 v5, s[16:19], s45 offen offset:3072 nt lds
    s_mov_b32 m0, 69632
    s_add_u32 s45, s43, 458752
    buffer_load_dwordx4 v2, s[12:15], s45 offen offset:0 nt lds
    buffer_load_dwordx4 v3, s[12:15], s45 offen offset:1024 nt lds
    buffer_load_dwordx4 v4, s[12:15], s45 offen offset:2048 nt lds
    buffer_load_dwordx4 v5, s[12:15], s45 offen offset:3072 nt lds
    s_mov_b32 m0, 102400
    s_waitcnt vmcnt(19)
    buffer_load_dwordx4 v2, s[16:19], s45 offen offset:0 nt lds
    s_waitcnt vmcnt(19)
    buffer_load_dwordx4 v3, s[16:19], s45 offen offset:1024 nt lds
    s_waitcnt vmcnt(19)
    buffer_load_dwordx4 v4, s[16:19], s45 offen offset:2048 nt lds
    s_waitcnt vmcnt(19)
    buffer_load_dwordx4 v5, s[16:19], s45 offen offset:3072 nt lds
    s_mov_b32 m0, 73728
    s_add_u32 s45, s43, 688128
    s_waitcnt vmcnt(19)
    buffer_load_dwordx4 v2, s[12:15], s45 offen offset:0 nt lds
    s_waitcnt vmcnt(19)
    buffer_load_dwordx4 v3, s[12:15], s45 offen offset:1024 nt lds
    s_waitcnt vmcnt(19)
    buffer_load_dwordx4 v4, s[12:15], s45 offen offset:2048 nt lds
    s_waitcnt vmcnt(19)
    buffer_load_dwordx4 v5, s[12:15], s45 offen offset:3072 nt lds
    s_mov_b32 m0, 106496
    s_waitcnt vmcnt(19)
    buffer_load_dwordx4 v2, s[16:19], s45 offen offset:0 nt lds
    s_waitcnt vmcnt(19)
    buffer_load_dwordx4 v3, s[16:19], s45 offen offset:1024 nt lds
    s_waitcnt vmcnt(19)
    buffer_load_dwordx4 v4, s[16:19], s45 offen offset:2048 nt lds
    s_waitcnt vmcnt(19)
    buffer_load_dwordx4 v5, s[16:19], s45 offen offset:3072 nt lds
    s_mov_b32 m0, 77824
    s_add_u32 s45, s43, 917504
    s_waitcnt vmcnt(19)
    buffer_load_dwordx4 v2, s[12:15], s45 offen offset:0 nt lds
    s_waitcnt vmcnt(19)
    buffer_load_dwordx4 v3, s[12:15], s45 offen offset:1024 nt lds
    s_waitcnt vmcnt(19)
    buffer_load_dwordx4 v4, s[12:15], s45 offen offset:2048 nt lds
    s_waitcnt vmcnt(19)
    buffer_load_dwordx4 v5, s[12:15], s45 offen offset:3072 nt lds
    s_mov_b32 m0, 110592
    s_waitcnt vmcnt(19)
    buffer_load_dwordx4 v2, s[16:19], s45 offen offset:0 nt lds
    s_waitcnt vmcnt(19)
    buffer_load_dwordx4 v3, s[16:19], s45 offen offset:1024 nt lds
    s_waitcnt vmcnt(19)
    buffer_load_dwordx4 v4, s[16:19], s45 offen offset:2048 nt lds
    s_waitcnt vmcnt(19)
PAD10:
    s_cbranch_execz RET_A_1
    buffer_load_dwordx4 v5, s[16:19], s45 offen offset:3072 nt lds
    s_mov_b32 m0, 81920
    s_add_u32 s45, s43, 1146880
    s_waitcnt vmcnt(19)
    buffer_load_dwordx4 v2, s[12:15], s45 offen offset:0 nt lds
    s_waitcnt vmcnt(19)
    buffer_load_dwordx4 v3, s[12:15], s45 offen offset:1024 nt lds
    s_waitcnt vmcnt(19)
    buffer_load_dwordx4 v4, s[12:15], s45 offen offset:2048 nt lds
    s_waitcnt vmcnt(19)
    buffer_load_dwordx4 v5, s[12:15], s45 offen offset:3072 nt lds
    s_mov_b32 m0, 114688
    s_waitcnt vmcnt(19)
    buffer_load_dwordx4 v2, s[16:19], s45 offen offset:0 nt lds
    s_waitcnt vmcnt(19)
    buffer_load_dwordx4 v3, s[16:19], s45 offen offset:1024 nt lds
    s_waitcnt vmcnt(19)
    buffer_load_dwordx4 v4, s[16:19], s45 offen offset:2048 nt lds
    s_waitcnt vmcnt(19)
    buffer_load_dwordx4 v5, s[16:19], s45 offen offset:3072 nt lds
    s_mov_b32 m0, 86016
    s_add_u32 s45, s43, 1376256
    s_waitcnt vmcnt(19)
    buffer_load_dwordx4 v2, s[12:15], s45 offen offset:0 nt lds
    s_waitcnt vmcnt(19)
    buffer_load_dwordx4 v3, s[12:15], s45 offen offset:1024 nt lds
    s_waitcnt vmcnt(19)
    buffer_load_dwordx4 v4, s[12:15], s45 offen offset:2048 nt lds
    s_waitcnt vmcnt(19)
    buffer_load_dwordx4 v5, s[12:15], s45 offen offset:3072 nt lds
    s_mov_b32 m0, 118784
    s_waitcnt vmcnt(19)
    buffer_load_dwordx4 v2, s[16:19], s45 offen offset:0 nt lds
    s_waitcnt vmcnt(19)
    buffer_load_dwordx4 v3, s[16:19], s45 offen offset:1024 nt lds
    s_waitcnt vmcnt(19)
    buffer_load_dwordx4 v4, s[16:19], s45 offen offset:2048 nt lds
    s_waitcnt vmcnt(19)
    buffer_load_dwordx4 v5, s[16:19], s45 offen offset:3072 nt lds
    s_mov_b32 m0, 90112
    s_add_u32 s45, s43, 1605632
    s_waitcnt vmcnt(19)
    buffer_load_dwordx4 v2, s[12:15], s45 offen offset:0 nt lds
    s_waitcnt vmcnt(19)
    buffer_load_dwordx4 v3, s[12:15], s45 offen offset:1024 nt lds
    s_waitcnt vmcnt(19)
    buffer_load_dwordx4 v4, s[12:15], s45 offen offset:2048 nt lds
    s_waitcnt vmcnt(19)
    buffer_load_dwordx4 v5, s[12:15], s45 offen offset:3072 nt lds
    s_mov_b32 m0, 122880
PAD11:
    s_cbranch_execz RET_A_1
    s_waitcnt vmcnt(19)
    buffer_load_dwordx4 v2, s[16:19], s45 offen offset:0 nt lds
    s_waitcnt vmcnt(19)
    buffer_load_dwordx4 v3, s[16:19], s45 offen offset:1024 nt lds
    s_waitcnt vmcnt(19)
    buffer_load_dwordx4 v4, s[16:19], s45 offen offset:2048 nt lds
    s_waitcnt vmcnt(19)
    buffer_load_dwordx4 v5, s[16:19], s45 offen offset:3072 nt lds
    s_waitcnt lgkmcnt(0)
    s_barrier
    s_barrier
    s_mov_b32 m0, 126976
    s_add_u32 s45, s44, 0
    buffer_load_dwordx4 v6, s[20:23], s45 offen offset:0 nt lds
    buffer_load_dwordx4 v7, s[20:23], s45 offen offset:1024 nt lds
    buffer_load_dwordx4 v8, s[20:23], s45 offen offset:2048 nt lds
    buffer_load_dwordx4 v9, s[20:23], s45 offen offset:3072 nt lds
    s_mov_b32 m0, 131072
    s_add_u32 s45, s44, 128
    buffer_load_dwordx4 v6, s[20:23], s45 offen offset:0 nt lds
    buffer_load_dwordx4 v7, s[20:23], s45 offen offset:1024 nt lds
    buffer_load_dwordx4 v8, s[20:23], s45 offen offset:2048 nt lds
    buffer_load_dwordx4 v9, s[20:23], s45 offen offset:3072 nt lds
    s_mov_b32 m0, 135168
    s_add_u32 s45, s44, 256
    buffer_load_dwordx4 v6, s[20:23], s45 offen offset:0 nt lds
    buffer_load_dwordx4 v7, s[20:23], s45 offen offset:1024 nt lds
    buffer_load_dwordx4 v8, s[20:23], s45 offen offset:2048 nt lds
    buffer_load_dwordx4 v9, s[20:23], s45 offen offset:3072 nt lds
    s_mov_b32 m0, 139264
    s_add_u32 s45, s44, 384
    buffer_load_dwordx4 v6, s[20:23], s45 offen offset:0 nt lds
    buffer_load_dwordx4 v7, s[20:23], s45 offen offset:1024 nt lds
    buffer_load_dwordx4 v8, s[20:23], s45 offen offset:2048 nt lds
    buffer_load_dwordx4 v9, s[20:23], s45 offen offset:3072 nt lds
    s_mov_b32 m0, 143360
    s_add_u32 s45, s44, 65536
    buffer_load_dwordx4 v6, s[20:23], s45 offen offset:0 nt lds
    buffer_load_dwordx4 v7, s[20:23], s45 offen offset:1024 nt lds
    buffer_load_dwordx4 v8, s[20:23], s45 offen offset:2048 nt lds
    buffer_load_dwordx4 v9, s[20:23], s45 offen offset:3072 nt lds
    s_mov_b32 m0, 147456
    s_add_u32 s45, s44, 65664
    buffer_load_dwordx4 v6, s[20:23], s45 offen offset:0 nt lds
    buffer_load_dwordx4 v7, s[20:23], s45 offen offset:1024 nt lds
    buffer_load_dwordx4 v8, s[20:23], s45 offen offset:2048 nt lds
    buffer_load_dwordx4 v9, s[20:23], s45 offen offset:3072 nt lds
    s_mov_b32 m0, 151552
    s_add_u32 s45, s44, 65792
    buffer_load_dwordx4 v6, s[20:23], s45 offen offset:0 nt lds
    buffer_load_dwordx4 v7, s[20:23], s45 offen offset:1024 nt lds
    buffer_load_dwordx4 v8, s[20:23], s45 offen offset:2048 nt lds
    buffer_load_dwordx4 v9, s[20:23], s45 offen offset:3072 nt lds
    s_mov_b32 m0, 155648
    s_add_u32 s45, s44, 65920
    buffer_load_dwordx4 v6, s[20:23], s45 offen offset:0 nt lds
    buffer_load_dwordx4 v7, s[20:23], s45 offen offset:1024 nt lds
    buffer_load_dwordx4 v8, s[20:23], s45 offen offset:2048 nt lds
    buffer_load_dwordx4 v9, s[20:23], s45 offen offset:3072 nt lds
    s_waitcnt vmcnt(32)
    s_barrier
    s_barrier
    s_waitcnt vmcnt(0)
    ds_write_b32 v11, v11 offset:58252
    s_endpgm
.section .rodata,"a"
.p2align 6
.amdhsa_kernel parallel_sum__spectral_fnet__moe_arch_mod__prompt_kernel
  .amdhsa_next_free_vgpr 166
  .amdhsa_next_free_sgpr 102
  .amdhsa_accum_offset 168
  .amdhsa_group_segment_fixed_size 0
  .amdhsa_kernarg_size 104
  .amdhsa_user_sgpr_count 2
  .amdhsa_user_sgpr_kernarg_segment_ptr 1
  .amdhsa_system_sgpr_workgroup_id_x 1
.end_amdhsa_kernel
```

```asm
; @launch grid=(256,1,1) block=(640,1,1) lds=159744
.amdgcn_target "amdgcn-amd-amdhsa--gfx950"
.text
.globl parallel_sum__spectral_fnet__moe_arch_mod__prompt_kernel
.p2align 12
.type parallel_sum__spectral_fnet__moe_arch_mod__prompt_kernel,@function
parallel_sum__spectral_fnet__moe_arch_mod__prompt_kernel:
    s_cmpk_ge_u32 s2, 256
    s_cbranch_scc1 END
    v_lshrrev_b32 v2, 6, v0
    s_load_dwordx2 s[4:5], s[0:1], 0
    s_load_dwordx2 s[28:29], s[0:1], 48
    s_load_dwordx2 s[8:9], s[0:1], 96
    s_load_dwordx2 s[12:13], s[0:1], 56
    s_load_dwordx2 s[16:17], s[0:1], 64
    s_load_dwordx2 s[20:21], s[0:1], 72
    s_load_dwordx2 s[24:25], s[0:1], 80
    v_readfirstlane_b32 s32, v2
    s_lshr_b32 s34, s2, 3
    v_and_b32 v1, 63, v0
    s_lshl_b32 s38, s32, 5
    s_add_u32 s38, s38, s34
    s_cmpk_lt_u32 s38, 316
    s_cbranch_scc1 BUSY
    s_mov_b64 exec, 0
    s_cmp_eq_u32 s34, 28
    s_cbranch_scc1 PAD0
    s_cmp_eq_u32 s34, 29
    s_cbranch_scc1 PAD1
    s_cmp_eq_u32 s34, 30
    s_cbranch_scc1 PAD8
    s_branch PAD2
BUSY:
    s_and_b32 s33, s2, 7
    s_lshr_b32 s38, s2, 4
    s_lshl3_add_u32 s36, s38, s33
    s_and_b32 s35, s34, 1
    s_cmp_eq_u32 s36, 0
    s_cselect_b32 s38, 128, s36
    s_sub_u32 s37, 2048, s38
    s_mul_i32 s40, s33, 28
    s_add_u32 s40, s40, s34
    s_lshl_b32 s6, 1, 22
    s_lshl_b32 s7, 1, 17
    s_lshl_b32 s10, 27, 17
    s_mov_b32 s11, s7
    s_cmp_eq_u32 s32, 9
    s_cbranch_scc1 LOADB
    s_cmp_eq_u32 s32, 8
    s_cbranch_scc1 COMM0
    s_lshl_b32 s38, s32, 8
    s_add_u32 s41, s36, s38
    s_sub_u32 s38, s37, s38
    s_cmp_eq_u32 s35, 0
    s_cselect_b32 s42, s38, s41
    s_cselect_b32 s41, s41, s38
    s_lshl_b32 s43, s32, 11
    s_lshl_b32 s38, s35, 14
    s_add_u32 s43, s43, s38
    v_and_b32 v9, 32, v1
    v_lshlrev_b32 v8, 4, v1
    v_lshrrev_b32 v5, 2, v1
    v_xor_b32 v2, v8, v9
    s_lshl_b32 s47, s32, 8
    s_add_u32 m0, s47, 49408
    s_and_b32 s39, s32, 2
    s_lshl_b32 s39, s39, 4
    v_lshrrev_b32 v11, 2, v8
    s_movk_i32 s30, 2048
    s_mov_b32 s31, s7
    v_xor_b32 v11, s39, v11
    s_lshl_b32 s39, s41, 11
    s_lshl_b32 s42, s42, 11
    v_and_b32 v6, 3, v1
    v_and_b32 v3, 15, v1
    v_lshrrev_b32 v4, 4, v1
    v_and_b32 v5, 3, v5
    v_and_b32 v7, 1, v4
    s_lshl_b32 s48, s35, 3
    s_cmp_eq_u32 s35, 0
    s_cselect_b32 s38, 1, 63
    v_lshrrev_b32 v9, 1, v3
    v_add_u32 v9, s48, v9
    v_and_b32 v10, 1, v3
    v_cmp_ne_u32 vcc, s38, v3
    v_cvt_f32_u32 v24, v4
    s_nop 0
    v_cndmask_b32 v9, 16, v9, vcc
    v_mul_f32 v26, 4.0, v24
    v_cndmask_b32 v10, 0, v10, vcc
    v_cvt_f32_u32 v9, v9
    v_cvt_f32_u32 v10, v10
    v_add_f32 v24, v26, v26
    v_mul_f32 v9, 0x3d000000, v9
    v_mul_f32 v10, 0x3e800000, v10
    v_cos_f32 v25, v9
    v_fma_f32 v16, v9, v24, v10
    v_add_f32 v17, v16, v9
    s_waitcnt lgkmcnt(0)
    buffer_load_dword v11, s[28:31], s47 offen lds
    s_xor_b32 m0, s43, 16384
    buffer_load_dwordx4 v[28:31], v2, s[4:7], s39 offen
    buffer_load_dwordx4 v[32:35], v2, s[4:7], s39 offen offset:1024
    s_cmpk_ge_u32 s2, 224
    s_cbranch_scc1 BI0
    s_barrier
BI0:
    s_branch CMP2
COMM0:
    s_setprio 3
    v_mov_b32 v10, 0
    s_mov_b32 s41, 2392064
    v_mov_b32 v6, -1
    v_mov_b32 v7, -1
    v_mov_b32 v8, -1
    v_mov_b32 v9, -1
    s_lshr_b32 s46, s40, 2
    s_and_b32 s47, s40, 3
    v_lshlrev_b32 v15, 4, v1
    v_lshrrev_b32 v11, 5, v1
    v_and_b32 v12, 0x1f0, v15
    v_lshl_add_u32 v14, v11, 11, v12
    s_lshl3_add_u32 s38, s46, s47
    s_lshl_b32 s38, s38, 9
    s_add_u32 s38, s38, 2949120
    s_mul_i32 s39, s47, 57344
    s_lshl_b32 s43, s46, 7
    s_add_u32 s39, s39, s43
    s_add_u32 s39, s39, 2490368
    s_cmpk_lt_u32 s2, 224
    s_cselect_b32 s38, s38, 117440512
    s_cselect_b32 s39, s39, 117440512
    v_lshrrev_b32 v11, 3, v1
    v_and_b32 v12, 0x70, v15
    v_mul_u32_u24 v11, 7168, v11
    v_add_u32 v16, v11, v12
    v_lshlrev_b32 v12, 8, v1
    v_add_u32 v11, s36, v12
    v_sub_u32 v12, s37, v12
    s_cmp_eq_u32 s35, 0
    s_cselect_b64 vcc, 0, -1
    v_cndmask_b32 v13, v11, v12, vcc
    v_and_b32 v11, 7, v13
    v_and_b32 v12, 0x7f8, v13
    v_lshl_add_u32 v13, v11, 11, v12
    s_mov_b32 s42, 2359296
    v_mov_b32 v20, 0
    v_mov_b32 v21, 0
    v_mov_b32 v22, 0
    v_mov_b32 v23, 0
    ds_write_b128 v10, v[20:23] offset:58256
    s_waitcnt lgkmcnt(0)
    buffer_load_dwordx2 v[4:5], v10, s[8:11], s41 offen sc1
    s_cmpk_ge_u32 s2, 224
    s_cbranch_scc1 BI1
    s_barrier
BI1:
    s_mul_i32 s43, s36, 16384
    s_lshl_b32 s44, s35, 13
    s_add_u32 s43, s43, s44
    s_add_u32 s44, s43, 4096
    buffer_store_dwordx4 v[6:9], v15, s[8:11], s43 offen offset:0 sc1
    buffer_store_dwordx4 v[6:9], v15, s[8:11], s43 offen offset:1024 sc1
    buffer_store_dwordx4 v[6:9], v15, s[8:11], s43 offen offset:2048 sc1
    buffer_store_dwordx4 v[6:9], v15, s[8:11], s43 offen offset:3072 sc1
    buffer_store_dwordx4 v[6:9], v15, s[8:11], s44 offen offset:0 sc1
    buffer_store_dwordx4 v[6:9], v15, s[8:11], s44 offen offset:1024 sc1
    buffer_store_dwordx4 v[6:9], v15, s[8:11], s44 offen offset:2048 sc1
    buffer_store_dwordx4 v[6:9], v15, s[8:11], s44 offen offset:3072 sc1
    buffer_store_dwordx4 v[6:9], v14, s[8:11], s38 offen sc1
    buffer_store_dwordx4 v[6:9], v16, s[8:11], s39 offen sc1
    s_add_u32 s39, s39, 229376
    buffer_store_dwordx4 v[6:9], v16, s[8:11], s39 offen sc1
    s_mov_b64 exec, 0xff
    buffer_store_dwordx2 v[6:7], v13, s[8:11], s42 offen sc1
    s_mov_b64 exec, -1
    s_branch COMM
LOADB:
    s_barrier
    s_branch LOAD
RET_A_0:
    s_cmp_eq_u32 s34, 28
    s_cbranch_scc1 PAD10
    s_cmp_eq_u32 s34, 29
    s_cbranch_scc1 PAD3
    s_cmp_eq_u32 s34, 30
    s_cbranch_scc1 PAD4
    s_cmp_eq_u32 s34, 31
    s_cbranch_scc1 PAD11
RET_A_1:
    s_mov_b64 exec, -1
    s_endpgm
CMP2:
    v_cos_f32 v16, v16
    v_cos_f32 v17, v17
    v_add_f32 v25, v25, v25
    s_add_u32 s38, s38, -1
    v_cmp_ne_u32 vcc, s38, v3
    v_mov_b32 v11, 0xc2000000
    v_mov_b32 v27, 0x3a800000
    v_fma_f32 v18, v25, v17, -v16
    v_fma_f32 v19, v25, v18, -v17
    v_fma_f32 v20, v25, v19, -v18
    v_fma_f32 v21, v25, v20, -v19
    v_fma_f32 v22, v25, v21, -v20
    v_fma_f32 v23, v25, v22, -v21
    v_cndmask_b32 v11, v11, 0, vcc
    v_cvt_pk_bf16_f32 v12, v16, v17
    v_cvt_pk_bf16_f32 v13, v18, v19
    v_cvt_pk_bf16_f32 v14, v20, v21
    v_cvt_pk_bf16_f32 v15, v22, v23
PAD0:
    s_cbranch_execz RET_A_0
    s_mul_i32 s44, s36, 16384
    s_lshl3_add_u32 s38, s35, s32
    s_lshl_b32 s38, s38, 10
    s_add_u32 s44, s44, s38
    s_lshr_b32 s46, s40, 2
    s_and_b32 s45, s40, 3
    s_add_u32 s48, s48, s32
    v_lshl_add_u32 v9, v3, 5, s48
    v_mov_b32 v24, 512
    v_cmp_eq_u32 vcc, 0, v9
    s_nop 1
    v_cndmask_b32 v9, v9, v24, vcc
    v_cvt_f32_u32 v9, v9
    v_bfrev_b32 v10, 1
    v_mul_f32 v9, v27, v9
    v_mul_f32 v16, v9, v26
    v_cos_f32 v25, v9
    v_fmamk_f32 v20, v9, 0x41800000, v16
    v_add_f32 v17, v16, v9
    v_add_f32 v21, v20, v9
    v_add_f32 v25, v25, v25
    v_sin_f32 v68, v16
    v_cos_f32 v16, v16
    v_sin_f32 v69, v17
    v_cos_f32 v17, v17
    v_sin_f32 v72, v20
    v_cos_f32 v20, v20
    v_sin_f32 v73, v21
    v_cos_f32 v21, v21
    v_fma_f32 v70, v25, v69, -v68
    v_fma_f32 v18, v25, v17, -v16
    v_fma_f32 v74, v25, v73, -v72
    v_fma_f32 v22, v25, v21, -v20
    v_fma_f32 v71, v25, v70, -v69
    v_fma_f32 v19, v25, v18, -v17
    v_fma_f32 v75, v25, v74, -v73
    v_fma_f32 v23, v25, v22, -v21
    v_cvt_pk_bf16_f32 v48, v68, v69
    v_cvt_pk_bf16_f32 v44, v16, v17
    v_cvt_pk_bf16_f32 v49, v70, v71
    v_cvt_pk_bf16_f32 v45, v18, v19
    v_cvt_pk_bf16_f32 v50, v72, v73
    v_cvt_pk_bf16_f32 v46, v20, v21
    v_cvt_pk_bf16_f32 v51, v74, v75
    v_cvt_pk_bf16_f32 v47, v22, v23
    v_xor_b32_dpp v60, v48, v10 row_mirror row_mask:0xf bank_mask:0xf
    v_xor_b32 v52, 0x80008000, v48
    v_xor_b32_dpp v61, v49, v10 row_mirror row_mask:0xf bank_mask:0xf
    v_xor_b32 v53, 0x80008000, v49
    v_xor_b32_dpp v62, v50, v10 row_mirror row_mask:0xf bank_mask:0xf
    v_xor_b32 v54, 0x80008000, v50
    v_xor_b32_dpp v63, v51, v10 row_mirror row_mask:0xf bank_mask:0xf
    v_xor_b32 v55, 0x80008000, v51
    v_xor_b32_dpp v56, v44, v10 row_mirror row_mask:0xf bank_mask:0xf
    v_xor_b32_dpp v57, v45, v10 row_mirror row_mask:0xf bank_mask:0xf
    v_xor_b32_dpp v58, v46, v10 row_mirror row_mask:0xf bank_mask:0xf
    v_xor_b32_dpp v59, v47, v10 row_mirror row_mask:0xf bank_mask:0xf
    s_cmpk_lt_u32 s2, 224
    s_cbranch_scc1 NOOTH
    buffer_load_dwordx4 v2, s[4:7], s42 offen lds
    buffer_load_dwordx4 v2, s[4:7], s42 offen offset:1024 lds
NOOTH:
    s_cmp_eq_u32 s48, 0
    s_cbranch_scc0 SPEKD
    v_lshlrev_b32 v9, 5, v3
    v_sub_u32 v9, 1008, v9
    v_cvt_f32_u32 v9, v9
    v_mul_f32 v9, v27, v9
    v_mul_f32 v16, v9, v26
    v_cos_f32 v25, v9
    v_fmamk_f32 v20, v9, 0x41800000, v16
    v_add_f32 v17, v16, v9
    v_add_f32 v21, v20, v9
    v_add_f32 v25, v25, v25
    v_sin_f32 v68, v16
    v_cos_f32 v16, v16
    v_sin_f32 v69, v17
    v_cos_f32 v17, v17
    v_sin_f32 v72, v20
    v_cos_f32 v20, v20
    v_sin_f32 v73, v21
    v_cos_f32 v21, v21
    v_fma_f32 v70, v25, v69, -v68
    v_fma_f32 v18, v25, v17, -v16
    v_fma_f32 v74, v25, v73, -v72
    v_fma_f32 v22, v25, v21, -v20
    v_fma_f32 v71, v25, v70, -v69
    v_fma_f32 v19, v25, v18, -v17
    v_fma_f32 v75, v25, v74, -v73
    v_fma_f32 v23, v25, v22, -v21
    v_cvt_pk_bf16_f32 v60, v68, v69
    v_cvt_pk_bf16_f32 v56, v16, v17
    v_cvt_pk_bf16_f32 v61, v70, v71
    v_cvt_pk_bf16_f32 v57, v18, v19
    v_cvt_pk_bf16_f32 v62, v72, v73
    v_cvt_pk_bf16_f32 v58, v20, v21
    v_cvt_pk_bf16_f32 v63, v74, v75
    v_cvt_pk_bf16_f32 v59, v22, v23
SPEKD:
    v_xor_b32 v64, 0x80008000, v56
    v_xor_b32 v65, 0x80008000, v57
    v_xor_b32 v66, 0x80008000, v58
    v_xor_b32 v67, 0x80008000, v59
    v_lshrrev_b32 v9, 1, v3
    v_and_b32 v10, 1, v3
    v_cvt_f32_u32 v9, v9
    v_cvt_f32_u32 v24, v10
    v_cmp_gt_u32 vcc, 32, v1
    v_mov_b32 v68, 0xbe800000
    v_mul_f32 v9, 0x3e000000, v9
    s_cmp_eq_u32 s36, 0
    s_cbranch_scc0 BFQN
    v_lshrrev_b32 v24, 5, v1
    v_cmp_eq_u32 s[100:101], v24, v10
    v_mul_f32 v10, 0x40f00000, v9
    v_cndmask_b32 v10, v10, 0, vcc
    v_cndmask_b32 v9, -v9, v9, vcc
    v_cndmask_b32 v10, -v68, v10, s[100:101]
    v_cndmask_b32 v9, 0, v9, s[100:101]
    v_cndmask_b32 v68, 0, v68, s[100:101]
    s_branch BFGO
BFQN:
    v_mul_f32 v10, 0x3e800000, v24
    v_cndmask_b32 v68, -v68, v68, vcc
BFGO:
    v_cvt_f32_u32 v24, v7
    v_cos_f32 v25, v9
    v_mul_f32 v24, 4.0, v24
    v_fma_f32 v16, v9, v24, v10
    v_add_f32 v25, v25, v25
    v_add_f32 v17, v16, v9
    v_add_f32 v20, v16, v68
    v_add_f32 v21, v17, v68
    v_cos_f32 v16, v16
    v_cos_f32 v17, v17
    v_cos_f32 v20, v20
    v_cos_f32 v21, v21
    v_add_u32 v68, s43, v8
    v_fma_f32 v18, v25, v17, -v16
    v_fma_f32 v22, v25, v21, -v20
    v_fma_f32 v19, v25, v18, -v17
    v_fma_f32 v23, v25, v22, -v21
    v_xor_b32 v69, 16384, v68
    s_lshl_b32 s38, s32, 11
    v_lshl_add_u32 v24, v4, 9, s38
    v_lshl_add_u32 v24, v5, 6, v24
    v_lshl_add_u32 v24, v7, 5, v24
    v_lshl_add_u32 v70, v6, 3, v24
    v_xor_b32 v71, 32, v70
    s_cmp_lt_u32 s32, 4
    s_cselect_b32 s38, 0, 3
    s_lshl_b32 s39, s32, 6
    s_add_u32 s39, s39, 32768
    v_mul_u32_u24 v9, 1040, v3
    v_xor_b32 v24, s38, v4
    v_add_u32 v9, s39, v9
    v_lshl_add_u32 v72, v24, 4, v9
    v_xor_b32 v24, 2, v24
    v_lshl_add_u32 v73, v24, 4, v9
    s_lshl_b32 s38, s32, 2
    s_add_u32 s38, s38, 58112
    v_mov_b32 v74, s38
    s_lshl_b32 s39, s35, 5
    v_add_u32 v75, s39, v74
    s_mul_i32 s38, s32, 2080
    s_add_u32 s38, s38, 32768
    v_sub_u32 v24, 4, v5
    v_and_b32 v24, 3, v24
    v_xor_b32 v24, v24, v4
    v_lshl_add_u32 v9, v3, 6, s38
    v_lshl_add_u32 v76, v24, 4, v9
    v_lshlrev_b32 v80, 4, v4
PAD1:
    s_cbranch_execz RET_A_0
    v_lshlrev_b32 v24, 8, v4
    v_lshl_add_u32 v24, v3, 3, v24
    s_mul_i32 s38, s32, 1088
    s_add_u32 s38, s38, 49408
    v_add_u32 v77, s38, v24
    s_sub_u32 s38, 8, s32
    s_and_b32 s38, s38, 7
    s_mul_i32 s38, s38, 1088
    s_add_u32 s38, s38, 49412
    v_add_u32 v78, s38, v24
    s_lshl_b32 s38, s32, 7
    s_add_u32 s38, s38, 49408
    v_mul_u32_u24 v24, 1088, v5
    v_lshl_add_u32 v9, v4, 2, v6
    v_add_u32 v24, s38, v24
    v_lshl_add_u32 v79, v9, 3, v24
    v_mov_b32 v9, 0
    v_mov_b32 v10, 0
    v_mov_b32 v24, 0
    v_mov_b32 v25, 0
    v_mov_b32 v81, 0
    v_mov_b32 v82, 0
    v_mov_b32 v83, 1
    v_mov_b32 v84, 0
    s_cmpk_lt_u32 s2, 224
    s_cselect_b32 s47, 263, 7
    s_waitcnt vmcnt(0)
    ds_write_b128 v68, v[28:31]
    ds_write_b128 v68, v[32:35] offset:1024
    v_dot2c_f32_bf16 v9, 0x3f803f80, v28
    v_dot2c_f32_bf16 v10, v28, v28
    v_dot2c_f32_bf16 v9, 0x3f803f80, v29
    v_dot2c_f32_bf16 v10, v29, v29
    s_cmpk_ge_u32 s2, 224
    s_cbranch_scc1 MEETB
    s_mov_b64 exec, 1
    ds_add_rtn_u32 v85, v84, v83 offset:58256
    s_mov_b64 exec, -1
    s_waitcnt lgkmcnt(0)
    v_readfirstlane_b32 s38, v85
    s_cmp_eq_u32 s38, 7
    s_cbranch_scc1 GO0
SPIN0:
    ds_read_b32 v85, v84 offset:58256
    s_waitcnt lgkmcnt(0)
    v_cmp_eq_u32 vcc, 8, v85
    s_cbranch_vccz SPIN0
GO0:
    ds_read_b128 v[36:39], v8 offset:49408
    ds_read_b128 v[40:43], v8 offset:50432
    v_dot2c_f32_bf16 v9, 0x3f803f80, v30
    v_dot2c_f32_bf16 v10, v30, v30
    v_dot2c_f32_bf16 v9, 0x3f803f80, v31
    v_dot2c_f32_bf16 v10, v31, v31
    v_dot2c_f32_bf16 v9, 0x3f803f80, v32
    v_dot2c_f32_bf16 v10, v32, v32
    v_dot2c_f32_bf16 v9, 0x3f803f80, v33
    v_dot2c_f32_bf16 v10, v33, v33
    v_dot2c_f32_bf16 v9, 0x3f803f80, v34
    v_dot2c_f32_bf16 v10, v34, v34
    v_dot2c_f32_bf16 v9, 0x3f803f80, v35
    v_dot2c_f32_bf16 v10, v35, v35
    s_waitcnt lgkmcnt(1)
    v_dot2c_f32_bf16 v25, 0x3f803f80, v36
    v_dot2c_f32_bf16 v24, v28, v36
    v_dot2c_f32_bf16 v25, 0x3f803f80, v37
    v_dot2c_f32_bf16 v24, v29, v37
    v_dot2c_f32_bf16 v25, 0x3f803f80, v38
    v_dot2c_f32_bf16 v24, v30, v38
    v_dot2c_f32_bf16 v25, 0x3f803f80, v39
    v_dot2c_f32_bf16 v24, v31, v39
    s_waitcnt lgkmcnt(0)
    v_dot2c_f32_bf16 v25, 0x3f803f80, v40
    v_dot2c_f32_bf16 v24, v32, v40
    v_dot2c_f32_bf16 v25, 0x3f803f80, v41
    v_dot2c_f32_bf16 v24, v33, v41
    v_dot2c_f32_bf16 v25, 0x3f803f80, v42
    v_dot2c_f32_bf16 v24, v34, v42
    v_dot2c_f32_bf16 v25, 0x3f803f80, v43
    v_dot2c_f32_bf16 v24, v35, v43
    v_permlane32_swap_b32 v9, v10
    s_nop 1
    v_permlane32_swap_b32 v24, v25
    v_add_f32 v9, v9, v10
    v_add_f32 v24, v24, v25
    s_nop 1
    v_permlane16_swap_b32 v9, v24
    v_add_f32 v9, v9, v24
    s_nop 1
    v_add_f32_dpp v9, v9, v9 row_ror:8 row_mask:0xf bank_mask:0xf
    s_nop 1
    v_add_f32_dpp v9, v9, v9 row_ror:4 row_mask:0xf bank_mask:0xf
    s_nop 1
    v_add_f32_dpp v9, v9, v9 row_ror:2 row_mask:0xf bank_mask:0xf
    s_nop 1
    v_add_f32_dpp v9, v9, v9 row_ror:1 row_mask:0xf bank_mask:0xf
    s_nop 0
    v_readlane_b32 s49, v9, 0
    v_readlane_b32 s50, v9, 32
    v_readlane_b32 s51, v9, 16
    v_readlane_b32 s52, v9, 48
    v_mul_f32 v2, s49, v27
    v_mul_f32 v10, s50, v27
    v_mov_b32 v24, s51
    v_fma_f32 v10, -v2, v2, v10
    v_fma_f32 v24, -v2, s52, v24
    v_max_f32 v10, 0, v10
    v_add_f32 v10, 0x3727c5ac, v10
    v_rsq_f32 v110, v10
    s_nop 0
    v_mul_f32 v24, v24, v110
    v_ashrrev_i32 v10, 31, v24
    v_or_b32 v10, 0x80000000, v10
    v_xor_b32 v10, v24, v10
    v_and_b32 v10, 0xfffff800, v10
    v_or_b32 v10, s41, v10
    s_mov_b64 exec, 1
    ds_write2_b32 v74, v10, v2 offset0:16 offset1:40
    ds_write_b32 v75, v110
    s_mov_b64 exec, -1
    s_mov_b64 exec, 1
    ds_add_rtn_u32 v85, v84, v83 offset:58260
    s_mov_b64 exec, -1
    s_waitcnt lgkmcnt(0)
    v_readfirstlane_b32 s38, v85
    s_cmp_eq_u32 s38, s47
    s_cbranch_scc1 GO1
    s_add_u32 s47, s47, 1
SPIN1:
    ds_read_b32 v85, v84 offset:58260
    s_waitcnt lgkmcnt(0)
    v_cmp_eq_u32 vcc, s47, v85
    s_cbranch_vccz SPIN1
GO1:
    s_waitcnt vmcnt(0)
    ds_read_b128 v[86:89], v69
    ds_read_b128 v[90:93], v69 offset:1024
    ds_read_b64_tr_b16 v[94:95], v70 offset:0
    ds_read_b64_tr_b16 v[96:97], v70 offset:256
    ds_read_b64_tr_b16 v[98:99], v71 offset:0
    ds_read_b64_tr_b16 v[100:101], v71 offset:256
    ds_read_b64_tr_b16 v[102:103], v70 offset:16384
    ds_read_b64_tr_b16 v[104:105], v70 offset:16640
    ds_read_b64_tr_b16 v[106:107], v71 offset:16384
    ds_read_b64_tr_b16 v[108:109], v71 offset:16640
    s_waitcnt lgkmcnt(8)
    v_dot2c_f32_bf16 v81, 0x3f803f80, v86
    v_dot2c_f32_bf16 v82, v86, v86
    v_dot2c_f32_bf16 v81, 0x3f803f80, v87
    v_dot2c_f32_bf16 v82, v87, v87
    v_dot2c_f32_bf16 v81, 0x3f803f80, v88
    v_dot2c_f32_bf16 v82, v88, v88
    v_dot2c_f32_bf16 v81, 0x3f803f80, v89
    v_dot2c_f32_bf16 v82, v89, v89
    v_dot2c_f32_bf16 v81, 0x3f803f80, v90
    v_dot2c_f32_bf16 v82, v90, v90
    v_dot2c_f32_bf16 v81, 0x3f803f80, v91
    v_dot2c_f32_bf16 v82, v91, v91
    v_dot2c_f32_bf16 v81, 0x3f803f80, v92
    v_dot2c_f32_bf16 v82, v92, v92
    v_dot2c_f32_bf16 v81, 0x3f803f80, v93
    v_dot2c_f32_bf16 v82, v93, v93
    s_nop 2
    v_permlane32_swap_b32 v81, v82
    v_mul_f32 v112, v11, v2
    v_mul_f32 v113, v11, v2
    v_mul_f32 v114, v11, v2
    v_mul_f32 v115, v11, v2
    v_add_f32 v81, v81, v82
    v_mov_b32 v82, v81
    s_waitcnt lgkmcnt(4)
    v_mfma_f32_16x16x32_bf16 v[120:123], v[94:97], v[12:15], v[112:115]
    v_permlane16_swap_b32 v81, v82
    v_mfma_f32_16x16x32_bf16 v[124:127], v[98:101], v[12:15], v[112:115]
    v_add_f32 v81, v81, v82
    s_nop 1
    v_add_f32_dpp v81, v81, v81 row_ror:8 row_mask:0xf bank_mask:0xf
    s_nop 1
    v_add_f32_dpp v81, v81, v81 row_ror:4 row_mask:0xf bank_mask:0xf
    s_nop 1
    v_add_f32_dpp v81, v81, v81 row_ror:2 row_mask:0xf bank_mask:0xf
    s_nop 1
    v_add_f32_dpp v81, v81, v81 row_ror:1 row_mask:0xf bank_mask:0xf
    s_nop 0
    v_readlane_b32 s49, v81, 0
PAD2:
    s_cbranch_execz RET_A_0
    v_readlane_b32 s50, v81, 32
    v_cvt_pk_bf16_f32 v136, v120, v121
    v_cvt_pk_bf16_f32 v137, v122, v123
    v_cvt_pk_bf16_f32 v138, v124, v125
    v_cvt_pk_bf16_f32 v139, v126, v127
    v_mul_f32 v81, s49, v27
    v_mul_f32 v82, s50, v27
    ds_write_b128 v72, v[136:139]
    v_mul_f32 v116, v11, v81
    v_mul_f32 v117, v11, v81
    v_mul_f32 v118, v11, v81
    v_mul_f32 v119, v11, v81
    v_fma_f32 v82, -v81, v81, v82
    s_waitcnt lgkmcnt(1)
    v_mfma_f32_16x16x32_bf16 v[128:131], v[102:105], v[12:15], v[116:119]
    v_mfma_f32_16x16x32_bf16 v[132:135], v[106:109], v[12:15], v[116:119]
    v_max_f32 v82, 0, v82
    v_add_f32 v82, 0x3727c5ac, v82
    v_rsq_f32 v82, v82
    v_xor_b32 v75, 32, v75
    s_mov_b64 exec, 1
    ds_write_b32 v75, v82
    s_mov_b64 exec, -1
    v_cvt_pk_bf16_f32 v140, v128, v129
    v_cvt_pk_bf16_f32 v141, v130, v131
    v_cvt_pk_bf16_f32 v142, v132, v133
    v_cvt_pk_bf16_f32 v143, v134, v135
    ds_write_b128 v73, v[140:143] offset:512
    s_mov_b64 exec, 1
    ds_add_rtn_u32 v85, v84, v83 offset:58264
    s_mov_b64 exec, -1
    ds_read_b128 v[144:147], v76
    ds_read_b128 v[148:151], v76 offset:1040
    ds_read_b128 v[152:155], v80 offset:58112
    s_waitcnt lgkmcnt(3)
    v_readfirstlane_b32 s38, v85
    s_cmp_eq_u32 s38, 7
    s_cbranch_scc1 GO2
SPIN2:
    ds_read_b32 v85, v84 offset:58264
    ds_read_b128 v[144:147], v76
    ds_read_b128 v[148:151], v76 offset:1040
PAD3:
    s_cbranch_execz RET_A_1
    ds_read_b128 v[152:155], v80 offset:58112
    s_waitcnt lgkmcnt(3)
    v_cmp_eq_u32 vcc, 8, v85
    s_cbranch_vccz SPIN2
GO2:
    s_waitcnt lgkmcnt(1)
    s_cmp_eq_u32 s48, 0
    v_mfma_f32_16x16x32_bf16 v[10:13], v[144:147], v[44:47], 0
    v_mfma_f32_16x16x32_bf16 v[24:27], v[144:147], v[52:55], 0
    s_cbranch_scc0 SPECN
    v_mfma_f32_16x16x32_bf16 v[28:31], v[148:151], v[56:59], 0
    v_mfma_f32_16x16x32_bf16 v[32:35], v[148:151], v[60:63], 0
    s_branch SPECD
SPECN:
    v_mfma_f32_16x16x32_bf16 v[28:31], v[144:147], v[56:59], 0
    v_mfma_f32_16x16x32_bf16 v[32:35], v[144:147], v[60:63], 0
    v_mfma_f32_16x16x32_bf16 v[10:13], v[148:151], v[48:51], v[10:13]
    v_mfma_f32_16x16x32_bf16 v[24:27], v[148:151], v[44:47], v[24:27]
    v_mfma_f32_16x16x32_bf16 v[28:31], v[148:151], v[60:63], v[28:31]
    v_mfma_f32_16x16x32_bf16 v[32:35], v[148:151], v[64:67], v[32:35]
SPECD:
    s_waitcnt lgkmcnt(0)
    v_mul_f32 v16, v16, v152
    v_mul_f32 v17, v17, v153
    v_mul_f32 v18, v18, v154
    v_mul_f32 v19, v19, v155
    v_mul_f32 v20, v20, v152
    v_mul_f32 v21, v21, v153
    v_mul_f32 v22, v22, v154
    v_mul_f32 v23, v23, v155
    v_cvt_pk_bf16_f32 v36, v16, v17
    v_cvt_pk_bf16_f32 v37, v18, v19
    v_cvt_pk_bf16_f32 v38, v20, v21
    v_cvt_pk_bf16_f32 v39, v22, v23
    v_cvt_pk_bf16_f32 v40, v10, v11
    v_cvt_pk_bf16_f32 v41, v12, v13
    v_cvt_pk_bf16_f32 v42, v24, v25
    v_cvt_pk_bf16_f32 v43, v26, v27
    s_nop 1
    v_mfma_f32_16x16x32_bf16 v[144:147], v[36:39], v[40:43], 0
    v_cvt_pk_bf16_f32 v68, v28, v29
    v_cvt_pk_bf16_f32 v69, v30, v31
    v_cvt_pk_bf16_f32 v70, v32, v33
    v_cvt_pk_bf16_f32 v71, v34, v35
    s_nop 1
    v_mfma_f32_16x16x32_bf16 v[148:151], v[36:39], v[68:71], 0
    s_nop 0
    v_cvt_pk_bf16_f32 v40, v144, v145
    v_cvt_pk_bf16_f32 v41, v146, v147
    ds_write2_b32 v77, v40, v41 offset1:32
    s_nop 3
    v_cvt_pk_bf16_f32 v68, v148, v149
    v_cvt_pk_bf16_f32 v69, v150, v151
    ds_write2_b32 v78, v68, v69 offset1:32
    s_mov_b64 exec, 1
    ds_add_rtn_u32 v85, v84, v83 offset:58268
    s_mov_b64 exec, -1
    ds_read_b64_tr_b16 v[36:37], v79
    ds_read_b64_tr_b16 v[38:39], v79 offset:4352
    s_waitcnt lgkmcnt(2)
    v_readfirstlane_b32 s38, v85
    s_cmp_eq_u32 s38, 7
    s_cbranch_scc1 GO3
SPIN3:
    ds_read_b32 v85, v84 offset:58268
    ds_read_b64_tr_b16 v[36:37], v79
    ds_read_b64_tr_b16 v[38:39], v79 offset:4352
    s_waitcnt lgkmcnt(2)
    v_cmp_eq_u32 vcc, 8, v85
    s_cbranch_vccz SPIN3
GO3:
    s_and_b32 s47, s34, 15
    s_lshr_b32 s53, s34, 4
    s_lshl3_add_u32 s38, s53, s32
    s_lshl_b32 s38, s38, 7
    s_add_u32 s38, s38, s33
    v_lshl_add_u32 v2, v3, 3, s38
    v_sub_u32 v9, 2048, v2
    v_and_b32 v9, 2047, v9
    s_waitcnt lgkmcnt(0)
    buffer_store_dwordx4 v[36:39], v8, s[8:11], s44 offen sc1
    s_lshl_b32 s38, s47, 6
    v_lshl_add_u32 v73, v4, 4, s38
    v_lshl_add_u32 v81, v2, 11, v73
    v_sub_u32 v73, 2032, v73
    v_lshl_add_u32 v14, v9, 11, v73
    v_and_b32 v73, 7, v2
    v_and_b32 v74, 0x7f8, v2
    v_lshl_add_u32 v15, v73, 11, v74
    v_and_b32 v73, 7, v9
    v_and_b32 v74, 0x7f8, v9
    v_lshl_add_u32 v72, v73, 11, v74
    v_cvt_f32_u32 v75, v2
    v_lshrrev_b32 v73, 5, v1
    v_add_u32 v74, v7, v7
    v_lshl_add_u32 v73, v73, 3, v74
    v_mul_f32 v75, 0x3a000000, v75
    v_cvt_f32_u32 v73, v73
    v_mul_f32 v74, 0x41800000, v75
    v_mul_f32 v10, v75, v73
    v_cos_f32 v80, v74
    v_add_f32 v11, v10, v75
    v_fma_f32 v12, v75, 4.0, v10
    v_fma_f32 v13, v75, 4.0, v11
    v_add_f32 v80, v80, v80
    v_add_f32 v20, v10, v74
    v_add_f32 v21, v11, v74
    v_add_f32 v22, v12, v74
    v_add_f32 v23, v13, v74
    v_sin_f32 v16, v10
    v_cos_f32 v10, v10
    v_sin_f32 v17, v11
    v_cos_f32 v11, v11
    v_sin_f32 v18, v12
    v_cos_f32 v12, v12
    v_sin_f32 v19, v13
    v_cos_f32 v13, v13
    v_sin_f32 v24, v20
    v_cos_f32 v20, v20
    v_sin_f32 v25, v21
    v_cos_f32 v21, v21
    v_sin_f32 v26, v22
    v_cos_f32 v22, v22
    v_sin_f32 v27, v23
    v_cos_f32 v23, v23
    v_cvt_pk_bf16_f32 v40, v10, v16
    v_fma_f32 v10, v80, v20, -v10
    v_fma_f32 v16, v80, v24, -v16
    v_cvt_pk_bf16_f32 v41, v11, v17
    v_fma_f32 v11, v80, v21, -v11
    v_fma_f32 v17, v80, v25, -v17
    v_cvt_pk_bf16_f32 v42, v12, v18
    v_fma_f32 v12, v80, v22, -v12
    v_fma_f32 v18, v80, v26, -v18
    v_cvt_pk_bf16_f32 v43, v13, v19
    v_fma_f32 v13, v80, v23, -v13
    v_fma_f32 v19, v80, v27, -v19
    v_cvt_pk_bf16_f32 v44, v20, v24
    v_fma_f32 v20, v80, v10, -v20
    v_fma_f32 v24, v80, v16, -v24
    v_cvt_pk_bf16_f32 v45, v21, v25
    v_fma_f32 v21, v80, v11, -v21
    v_fma_f32 v25, v80, v17, -v25
    v_cvt_pk_bf16_f32 v46, v22, v26
    v_fma_f32 v22, v80, v12, -v22
    v_fma_f32 v26, v80, v18, -v26
    v_cvt_pk_bf16_f32 v47, v23, v27
    v_fma_f32 v23, v80, v13, -v23
    v_fma_f32 v27, v80, v19, -v27
    v_cvt_pk_bf16_f32 v48, v10, v16
    v_fma_f32 v10, v80, v20, -v10
    v_fma_f32 v16, v80, v24, -v16
    v_cvt_pk_bf16_f32 v49, v11, v17
    v_fma_f32 v11, v80, v21, -v11
    v_fma_f32 v17, v80, v25, -v17
    v_cvt_pk_bf16_f32 v50, v12, v18
    v_fma_f32 v12, v80, v22, -v12
    v_fma_f32 v18, v80, v26, -v18
    v_cvt_pk_bf16_f32 v51, v13, v19
    v_fma_f32 v13, v80, v23, -v13
    v_fma_f32 v19, v80, v27, -v19
    v_cvt_pk_bf16_f32 v52, v20, v24
    v_fma_f32 v20, v80, v10, -v20
    v_fma_f32 v24, v80, v16, -v24
    v_cvt_pk_bf16_f32 v53, v21, v25
PAD4:
    s_cbranch_execz RET_A_1
    v_fma_f32 v21, v80, v11, -v21
    v_fma_f32 v25, v80, v17, -v25
    v_cvt_pk_bf16_f32 v54, v22, v26
    v_fma_f32 v22, v80, v12, -v22
    v_fma_f32 v26, v80, v18, -v26
    v_cvt_pk_bf16_f32 v55, v23, v27
    v_fma_f32 v23, v80, v13, -v23
    v_fma_f32 v27, v80, v19, -v27
    v_cvt_pk_bf16_f32 v56, v10, v16
    v_fma_f32 v10, v80, v20, -v10
    v_fma_f32 v16, v80, v24, -v16
    v_cvt_pk_bf16_f32 v57, v11, v17
    v_fma_f32 v11, v80, v21, -v11
    v_fma_f32 v17, v80, v25, -v17
    v_cvt_pk_bf16_f32 v58, v12, v18
    v_fma_f32 v12, v80, v22, -v12
    v_fma_f32 v18, v80, v26, -v18
    v_cvt_pk_bf16_f32 v59, v13, v19
    v_fma_f32 v13, v80, v23, -v13
    v_fma_f32 v19, v80, v27, -v19
    v_cvt_pk_bf16_f32 v60, v20, v24
    v_fma_f32 v20, v80, v10, -v20
    v_fma_f32 v24, v80, v16, -v24
    v_cvt_pk_bf16_f32 v61, v21, v25
    v_fma_f32 v21, v80, v11, -v21
    v_fma_f32 v25, v80, v17, -v25
    v_cvt_pk_bf16_f32 v62, v22, v26
    v_fma_f32 v22, v80, v12, -v22
    v_fma_f32 v26, v80, v18, -v26
    v_cvt_pk_bf16_f32 v63, v23, v27
    v_fma_f32 v23, v80, v13, -v23
    v_fma_f32 v27, v80, v19, -v27
    v_cvt_pk_bf16_f32 v64, v10, v16
    v_cvt_pk_bf16_f32 v65, v11, v17
    v_cvt_pk_bf16_f32 v66, v12, v18
    v_cvt_pk_bf16_f32 v67, v13, v19
    v_cvt_pk_bf16_f32 v68, v20, v24
    v_cvt_pk_bf16_f32 v69, v21, v25
    v_cvt_pk_bf16_f32 v70, v22, v26
    v_cvt_pk_bf16_f32 v71, v23, v27
    v_and_b32 v73, 1, v3
    v_cmp_gt_u32 vcc, 16, v1
    v_lshlrev_b32 v73, 31, v73
    v_or_b32 v73, 0x3f803f80, v73
    v_cndmask_b32 v40, v40, v73, vcc
    s_barrier
    s_lshl_b32 s38, s33, 10
    s_mul_i32 s39, s32, 262144
    s_add_u32 s38, s38, s39
    s_lshl_b32 s54, s47, 6
    s_add_u32 s55, s54, 64
    s_add_u32 s54, s54, s38
    s_and_b32 s55, s55, 1023
    s_add_u32 s41, s54, 8192
    s_add_u32 s55, s55, s38
    v_lshrrev_b32 v18, 2, v1
    v_and_b32 v19, 1, v1
    v_bfe_u32 v20, v1, 1, 1
    v_mul_u32_u24 v73, 16384, v18
    v_lshl_add_u32 v75, v6, 4, v73
    v_lshl_add_u32 v80, v19, 4, v73
    s_mul_i32 s38, s32, 3072
    v_lshl_add_u32 v73, v18, 1, v19
    v_mul_u32_u24 v73, 96, v73
    v_add_u32 v12, s38, v73
    v_mad_u32_u24 v10, v20, 24, v12
    v_lshl_add_u32 v11, v20, 3, v12
    v_lshrrev_b32 v73, 5, v1
    v_lshl_add_u32 v74, v7, 2, v5
    v_lshl_add_u32 v73, v73, 4, v74
    v_mul_u32_u24 v73, 96, v73
    v_lshl_add_u32 v13, v6, 3, v73
    s_cmp_eq_u32 s47, 0
    s_cselect_b32 s38, 0x0908, 0
    s_xor_b32 s38, s38, 0x07060504
    v_cmp_eq_u32 vcc, 1, v20
    v_mov_b32 v73, 0x07060100
    v_mov_b32 v17, 0x07060504
    v_mov_b32 v16, s38
    v_cndmask_b32 v17, v17, v73, vcc
    v_cndmask_b32 v16, v16, v73, vcc
    v_lshrrev_b32 v73, 1, v5
    v_lshl_add_u32 v73, v7, 1, v73
    v_lshlrev_b32 v74, 10, v4
    v_lshl_add_u32 v74, v5, 7, v74
    v_lshl_add_u32 v74, v6, 3, v74
    v_lshl_add_u32 v74, v73, 5, v74
    s_lshl_b32 s38, s32, 12
    s_add_u32 s38, s38, 126976
    v_add_u32 v22, s38, v74
    s_and_b32 s38, s32, 3
    s_lshl_b32 s38, s38, 5
    v_xor_b32 v74, s38, v74
    s_lshr_b32 s39, s32, 2
    s_lshl_b32 s38, s39, 15
    s_add_u32 s38, s38, 61440
    v_add_u32 v21, s38, v74
    v_lshlrev_b32 v73, 4, v19
    v_lshl_add_u32 v23, v4, 5, v73
    s_lshl_b32 s52, s46, 12
    s_add_u32 s52, s52, 2949120
    s_lshl_b32 s38, s45, 9
    s_add_u32 s44, s52, s38
    s_lshl_b32 s38, s39, 8
    s_add_u32 s44, s44, s38
    s_bfe_u32 s38, s32, 0x10001
    s_lshl_b32 s38, s38, 11
    s_add_u32 s44, s44, s38
    s_and_b32 s38, s32, 1
    s_lshl_b32 s38, s38, 7
    s_add_u32 s44, s44, s38
    s_cmp_lt_u32 s2, 224
    s_cselect_b32 s44, s44, 117440512
    s_lshl_b32 s38, s39, 11
    s_add_u32 s52, s52, s38
    v_lshl_add_u32 v73, v20, 8, v73
    v_lshl_add_u32 v73, v4, 6, v73
    v_and_b32 v74, 1, v5
    v_lshl_add_u32 v73, v74, 5, v73
    v_lshrrev_b32 v74, 1, v5
    v_lshl_add_u32 v24, v74, 10, v73
    v_mul_u32_u24 v73, 229376, v19
    v_lshl_add_u32 v73, v7, 5, v73
    v_lshrrev_b32 v74, 5, v1
    v_lshl_add_u32 v25, v74, 4, v73
    s_and_b32 s38, s32, 3
    s_lshl2_add_u32 s38, s45, s38
    s_mul_i32 s42, s38, 14336
    s_lshl1_add_u32 s38, s46, s39
    s_lshl_b32 s38, s38, 6
    s_add_u32 s42, s42, s38
    s_add_u32 s42, s42, 2490368
    s_mov_b32 s50, 0x00030003
    s_mov_b32 s51, 0x00030003
    s_mov_b32 s43, 2359296
    s_mov_b32 s48, 0
    s_mov_b32 s26, s6
    s_mov_b32 s27, s7
    v_mov_b32 v73, 0
    s_mov_b64 exec, 0
    s_cmp_eq_u32 s32, 0
    s_cbranch_scc1 PAD5
    s_cmp_eq_u32 s32, 1
    s_cbranch_scc1 PAD6
    s_cmp_eq_u32 s32, 2
    s_cbranch_scc1 PAD7
    s_cmp_eq_u32 s32, 3
    s_cbranch_scc1 PAD9
RET_B_0:
    s_mov_b64 exec, -1
    s_barrier
    s_barrier
    ds_read_b128 v[90:93], v8 offset:58368
    ds_read_b64_tr_b16 v[76:77], v21 offset:0
    ds_read_b64_tr_b16 v[78:79], v21 offset:512
    ds_read_b64 v[36:37], v73 offset:58240
    ds_read_b64_tr_b16 v[122:123], v21 offset:4096
    ds_read_b64_tr_b16 v[124:125], v21 offset:4608
    ds_read_b64_tr_b16 v[126:127], v21 offset:8192
    ds_read_b64_tr_b16 v[128:129], v21 offset:8704
    ds_read_b64_tr_b16 v[130:131], v21 offset:12288
    ds_read_b64_tr_b16 v[132:133], v21 offset:12800
PAD5:
    s_cbranch_execz RET_B_0
    s_waitcnt lgkmcnt(9)
    v_mov_b32_dpp v94, v90 row_shl:2 row_mask:0xf bank_mask:0xf
    v_mov_b32_dpp v95, v91 row_shl:2 row_mask:0xf bank_mask:0xf
    v_mov_b32_dpp v96, v92 row_shl:2 row_mask:0xf bank_mask:0xf
    v_mov_b32_dpp v97, v93 row_shl:2 row_mask:0xf bank_mask:0xf
    s_waitcnt lgkmcnt(7)
    v_mfma_f32_16x16x32_bf16 v[134:137], v[76:79], v[90:93], 0
    ds_read_b64_tr_b16 v[76:77], v21 offset:16384
    ds_read_b64_tr_b16 v[78:79], v21 offset:16896
    v_mov_b32_dpp v98, v90 row_shl:4 row_mask:0xf bank_mask:0xf
    v_mov_b32_dpp v99, v91 row_shl:4 row_mask:0xf bank_mask:0xf
    v_mov_b32_dpp v100, v92 row_shl:4 row_mask:0xf bank_mask:0xf
    v_mov_b32_dpp v101, v93 row_shl:4 row_mask:0xf bank_mask:0xf
    s_waitcnt lgkmcnt(6)
    v_mfma_f32_16x16x32_bf16 v[138:141], v[122:125], v[94:97], 0
    ds_read_b64_tr_b16 v[122:123], v21 offset:20480
    ds_read_b64_tr_b16 v[124:125], v21 offset:20992
    v_mov_b32_dpp v102, v90 row_shl:6 row_mask:0xf bank_mask:0xf
    v_mov_b32_dpp v103, v91 row_shl:6 row_mask:0xf bank_mask:0xf
    v_mov_b32_dpp v104, v92 row_shl:6 row_mask:0xf bank_mask:0xf
    v_mov_b32_dpp v105, v93 row_shl:6 row_mask:0xf bank_mask:0xf
    s_waitcnt lgkmcnt(6)
    v_mfma_f32_16x16x32_bf16 v[134:137], v[126:129], v[98:101], v[134:137]
    ds_read_b64_tr_b16 v[126:127], v21 offset:24576
    ds_read_b64_tr_b16 v[128:129], v21 offset:25088
    v_mov_b32_dpp v106, v90 row_shl:8 row_mask:0xf bank_mask:0xf
    v_mov_b32_dpp v107, v91 row_shl:8 row_mask:0xf bank_mask:0xf
    v_mov_b32_dpp v108, v92 row_shl:8 row_mask:0xf bank_mask:0xf
    v_mov_b32_dpp v109, v93 row_shl:8 row_mask:0xf bank_mask:0xf
    s_waitcnt lgkmcnt(6)
    v_mfma_f32_16x16x32_bf16 v[138:141], v[130:133], v[102:105], v[138:141]
    ds_read_b64_tr_b16 v[130:131], v21 offset:28672
    ds_read_b64_tr_b16 v[132:133], v21 offset:29184
    v_mov_b32_dpp v110, v90 row_shl:10 row_mask:0xf bank_mask:0xf
    v_mov_b32_dpp v111, v91 row_shl:10 row_mask:0xf bank_mask:0xf
    v_mov_b32_dpp v112, v92 row_shl:10 row_mask:0xf bank_mask:0xf
    v_mov_b32_dpp v113, v93 row_shl:10 row_mask:0xf bank_mask:0xf
    s_waitcnt lgkmcnt(6)
    v_mfma_f32_16x16x32_bf16 v[134:137], v[76:79], v[106:109], v[134:137]
    v_mov_b32_dpp v114, v90 row_shl:12 row_mask:0xf bank_mask:0xf
    v_mov_b32_dpp v115, v91 row_shl:12 row_mask:0xf bank_mask:0xf
    v_mov_b32_dpp v116, v92 row_shl:12 row_mask:0xf bank_mask:0xf
    v_mov_b32_dpp v117, v93 row_shl:12 row_mask:0xf bank_mask:0xf
    s_waitcnt lgkmcnt(4)
    v_mfma_f32_16x16x32_bf16 v[138:141], v[122:125], v[110:113], v[138:141]
    v_mov_b32_dpp v118, v90 row_shl:14 row_mask:0xf bank_mask:0xf
    v_mov_b32_dpp v119, v91 row_shl:14 row_mask:0xf bank_mask:0xf
    v_mov_b32_dpp v120, v92 row_shl:14 row_mask:0xf bank_mask:0xf
    v_mov_b32_dpp v121, v93 row_shl:14 row_mask:0xf bank_mask:0xf
    s_waitcnt lgkmcnt(2)
    v_mfma_f32_16x16x32_bf16 v[134:137], v[126:129], v[114:117], v[134:137]
    s_waitcnt lgkmcnt(0)
    v_mfma_f32_16x16x32_bf16 v[138:141], v[130:133], v[118:121], v[138:141]
    v_cmp_eq_u32 s[34:35], v2, v36
    v_cmp_eq_u32 vcc, v2, v37
    v_cmp_eq_u32 s[36:37], v9, v36
    v_cmp_eq_u32 s[46:47], v9, v37
    v_lshlrev_b32 v74, 5, v4
    v_cndmask_b32 v2, 0, 64, vcc
    v_cndmask_b32 v9, 0, 64, s[46:47]
    s_nop 0
    v_add_f32 v134, v134, v138
    v_add_f32 v135, v135, v139
    v_add_f32 v136, v136, v140
    v_add_f32 v137, v137, v141
    s_mov_b64 exec, s[50:51]
    buffer_store_dwordx4 v[134:137], v23, s[8:11], s44 offen sc1
    s_mov_b64 exec, -1
    buffer_load_dwordx4 v[26:29], v75, s[8:11], s54 offen sc1
    buffer_load_dwordx4 v[30:33], v75, s[8:11], s41 offen sc1
    buffer_load_dword v20, v80, s[8:11], s55 offen sc1
    buffer_load_dwordx2 v[18:19], v15, s[8:11], s43 offen sc1
    buffer_load_dwordx2 v[34:35], v72, s[8:11], s43 offen sc1
    s_or_b64 s[34:35], s[34:35], vcc
    s_or_b64 s[36:37], s[36:37], s[46:47]
    v_lshl_add_u32 v2, v2, 1, v74
    v_sub_u32 v74, 96, v74
    v_lshl_add_u32 v9, v9, 1, v74
    s_waitcnt vmcnt(0)
UCHK:
    v_max3_u32 v73, v26, v27, v28
    v_max3_u32 v74, v30, v31, v32
    v_max3_u32 v73, v73, v29, v33
    v_max3_u32 v74, v74, v20, v18
    v_max3_u32 v73, v73, v19, v34
    v_max3_u32 v73, v73, v74, v35
    v_cmp_eq_u32 vcc, -1, v73
    s_cbranch_vccnz URETRY
UOK:
    v_perm_b32 v73, v26, v30, v16
    v_perm_b32 v30, v30, v26, v17
    ds_write_b32 v12, v20 offset:32
    v_mov_b32 v26, v73
    ds_write_b64 v10, v[28:29] offset:40
    ds_write_b64 v11, v[32:33] offset:48
    ds_write_b64 v11, v[30:31] offset:8
    ds_write_b64 v10, v[26:27]
    s_waitcnt lgkmcnt(0)
    s_barrier
    ds_read_b64_tr_b16 v[76:77], v13 offset:0
    ds_read_b64_tr_b16 v[78:79], v13 offset:768
    ds_read_b64_tr_b16 v[98:99], v13 offset:40
    ds_read_b64_tr_b16 v[100:101], v13 offset:808
    ds_read_b64_tr_b16 v[102:103], v13 offset:8
    ds_read_b64_tr_b16 v[104:105], v13 offset:776
    ds_read_b64_tr_b16 v[106:107], v13 offset:3072
    ds_read_b64_tr_b16 v[108:109], v13 offset:3840
    ds_read_b64_tr_b16 v[110:111], v13 offset:3112
    ds_read_b64_tr_b16 v[112:113], v13 offset:3880
    ds_read_b64_tr_b16 v[114:115], v13 offset:3080
    ds_read_b64_tr_b16 v[116:117], v13 offset:3848
    buffer_load_dwordx4 v[90:93], v24, s[8:11], s52 offen sc1
    buffer_load_dwordx4 v[94:97], v24, s[8:11], s52 offen offset:512 sc1
    s_cmp_ge_u32 s2, 224
    s_cbranch_scc1 NODN
    v_mov_b32 v134, 0
    v_xor_b32 v135, 32, v22
    v_xor_b32 v136, 64, v22
    v_xor_b32 v137, 96, v22
    ds_read_b32 v8, v134 offset:58252
    ds_read_b64_tr_b16 v[118:119], v22 offset:0
    ds_read_b64_tr_b16 v[120:121], v22 offset:512
    ds_read_b64_tr_b16 v[122:123], v135 offset:0
    ds_read_b64_tr_b16 v[124:125], v135 offset:512
    ds_read_b64_tr_b16 v[126:127], v136 offset:0
    ds_read_b64_tr_b16 v[128:129], v136 offset:512
    ds_read_b64_tr_b16 v[130:131], v137 offset:0
    ds_read_b64_tr_b16 v[132:133], v137 offset:512
    s_mov_b32 s48, 0
    s_waitcnt vmcnt(0)
HCHK:
    v_add_f32 v90, v90, v94
    v_add_f32 v91, v91, v95
    v_add_f32 v92, v92, v96
    v_add_f32 v93, v93, v97
    v_add_f32_dpp v90, v90, v90 row_ror:8 row_mask:0xf bank_mask:0xf
    v_add_f32_dpp v91, v91, v91 row_ror:8 row_mask:0xf bank_mask:0xf
    v_add_f32_dpp v92, v92, v92 row_ror:8 row_mask:0xf bank_mask:0xf
    v_add_f32_dpp v93, v93, v93 row_ror:8 row_mask:0xf bank_mask:0xf
    v_cmp_u_f32 vcc, v90, v91
    v_cmp_u_f32 s[46:47], v92, v93
    v_mov_b32_dpp v158, v90 quad_perm:[0,1,0,1] row_mask:0xf bank_mask:0xf
    v_mov_b32_dpp v159, v91 quad_perm:[0,1,0,1] row_mask:0xf bank_mask:0xf
    v_mov_b32_dpp v160, v92 quad_perm:[0,1,0,1] row_mask:0xf bank_mask:0xf
    v_mov_b32_dpp v161, v93 quad_perm:[0,1,0,1] row_mask:0xf bank_mask:0xf
    s_or_b64 vcc, vcc, s[46:47]
    s_cbranch_scc1 HRETRY
HOK:
    v_mul_f32 v154, 0xbfb8aa3b, v158
    v_mul_f32 v155, 0xbfb8aa3b, v159
    v_mul_f32 v156, 0xbfb8aa3b, v160
PAD6:
    s_cbranch_execz RET_B_0
    v_mul_f32 v157, 0xbfb8aa3b, v161
    v_exp_f32 v154, v154
    v_mul_f32_dpp v158, v90, v158 quad_perm:[2,3,2,3] row_mask:0xf bank_mask:0xf
    v_exp_f32 v155, v155
    v_mul_f32_dpp v159, v91, v159 quad_perm:[2,3,2,3] row_mask:0xf bank_mask:0xf
    v_exp_f32 v156, v156
    v_mul_f32_dpp v160, v92, v160 quad_perm:[2,3,2,3] row_mask:0xf bank_mask:0xf
    v_exp_f32 v157, v157
    v_mul_f32_dpp v161, v93, v161 quad_perm:[2,3,2,3] row_mask:0xf bank_mask:0xf
    v_add_f32 v154, 1.0, v154
    v_add_f32 v155, 1.0, v155
    v_add_f32 v156, 1.0, v156
    v_add_f32 v157, 1.0, v157
    v_rcp_f32 v154, v154
    v_rcp_f32 v155, v155
    v_rcp_f32 v156, v156
    v_rcp_f32 v157, v157
    s_mov_b32 s48, 0
    s_waitcnt lgkmcnt(8)
DCHK:
    v_cmp_eq_u32 vcc, -1, v8
    s_cbranch_vccnz DRETRY
DOK:
    v_mul_f32 v158, v158, v154
    v_mul_f32 v159, v159, v155
    v_mul_f32 v160, v160, v156
    v_mul_f32 v161, v161, v157
    v_cvt_pk_bf16_f32 v162, v158, v159
    v_cvt_pk_bf16_f32 v163, v160, v161
    s_add_u32 s52, s42, 7168
    v_mov_b32_dpp v164, v162 row_shl:4 row_mask:0xf bank_mask:0xf
    v_mov_b32_dpp v165, v163 row_shl:4 row_mask:0xf bank_mask:0xf
    s_waitcnt lgkmcnt(6)
    s_nop 0
    v_mfma_f32_16x16x32_bf16 v[138:141], v[118:121], v[162:165], 0
    s_waitcnt lgkmcnt(4)
    v_mfma_f32_16x16x32_bf16 v[142:145], v[122:125], v[162:165], 0
    s_waitcnt lgkmcnt(2)
    v_mfma_f32_16x16x32_bf16 v[146:149], v[126:129], v[162:165], 0
    s_waitcnt lgkmcnt(0)
    v_mfma_f32_16x16x32_bf16 v[150:153], v[130:133], v[162:165], 0
    s_nop 1
    v_cvt_pk_bf16_f32 v154, v138, v139
    v_cvt_pk_bf16_f32 v155, v140, v141
    v_cvt_pk_bf16_f32 v156, v142, v143
    v_cvt_pk_bf16_f32 v157, v144, v145
    s_nop 0
    v_permlane16_swap_b32 v154, v156
    v_permlane16_swap_b32 v155, v157
    s_mov_b64 exec, s[50:51]
    buffer_store_dwordx4 v[154:157], v25, s[8:11], s42 offen sc1
    s_mov_b64 exec, -1
    v_cvt_pk_bf16_f32 v158, v146, v147
    v_cvt_pk_bf16_f32 v159, v148, v149
    v_cvt_pk_bf16_f32 v160, v150, v151
    v_cvt_pk_bf16_f32 v161, v152, v153
    s_nop 0
    v_permlane16_swap_b32 v158, v160
    v_permlane16_swap_b32 v159, v161
    s_mov_b64 exec, s[50:51]
    buffer_store_dwordx4 v[158:161], v25, s[8:11], s52 offen sc1
    s_mov_b64 exec, -1
DNJ:
    s_barrier
    buffer_load_dwordx4 v[82:85], v81, s[4:7], 0 offen
    buffer_load_dwordx4 v[86:89], v14, s[4:7], 0 offen
    v_mfma_f32_16x16x32_bf16 v[26:29], v[76:79], v[40:43], 0
    v_mfma_f32_16x16x32_bf16 v[30:33], v[98:101], v[40:43], 0
    v_mfma_f32_16x16x32_bf16 v[36:39], v[102:105], v[40:43], 0
    ds_read_b64_tr_b16 v[76:77], v13 offset:6144
    ds_read_b64_tr_b16 v[78:79], v13 offset:6912
    ds_read_b64_tr_b16 v[98:99], v13 offset:6184
    ds_read_b64_tr_b16 v[100:101], v13 offset:6952
    ds_read_b64_tr_b16 v[102:103], v13 offset:6152
    ds_read_b64_tr_b16 v[104:105], v13 offset:6920
    v_mfma_f32_16x16x32_bf16 v[26:29], v[106:109], v[44:47], v[26:29]
    v_mfma_f32_16x16x32_bf16 v[30:33], v[110:113], v[44:47], v[30:33]
    v_mfma_f32_16x16x32_bf16 v[36:39], v[114:117], v[44:47], v[36:39]
    ds_read_b64_tr_b16 v[106:107], v13 offset:9216
    ds_read_b64_tr_b16 v[108:109], v13 offset:9984
    ds_read_b64_tr_b16 v[110:111], v13 offset:9256
    ds_read_b64_tr_b16 v[112:113], v13 offset:10024
    ds_read_b64_tr_b16 v[114:115], v13 offset:9224
    ds_read_b64_tr_b16 v[116:117], v13 offset:9992
    s_waitcnt lgkmcnt(10)
    v_mfma_f32_16x16x32_bf16 v[26:29], v[76:79], v[48:51], v[26:29]
    s_waitcnt lgkmcnt(8)
    v_mfma_f32_16x16x32_bf16 v[30:33], v[98:101], v[48:51], v[30:33]
    s_waitcnt lgkmcnt(6)
    v_mfma_f32_16x16x32_bf16 v[36:39], v[102:105], v[48:51], v[36:39]
    ds_read_b64_tr_b16 v[76:77], v13 offset:12288
    ds_read_b64_tr_b16 v[78:79], v13 offset:13056
    ds_read_b64_tr_b16 v[98:99], v13 offset:12328
    ds_read_b64_tr_b16 v[100:101], v13 offset:13096
    ds_read_b64_tr_b16 v[102:103], v13 offset:12296
    ds_read_b64_tr_b16 v[104:105], v13 offset:13064
    s_waitcnt lgkmcnt(10)
    v_mfma_f32_16x16x32_bf16 v[26:29], v[106:109], v[52:55], v[26:29]
    s_waitcnt lgkmcnt(8)
    v_mfma_f32_16x16x32_bf16 v[30:33], v[110:113], v[52:55], v[30:33]
    s_waitcnt lgkmcnt(6)
    v_mfma_f32_16x16x32_bf16 v[36:39], v[114:117], v[52:55], v[36:39]
    ds_read_b64_tr_b16 v[106:107], v13 offset:15360
    ds_read_b64_tr_b16 v[108:109], v13 offset:16128
    ds_read_b64_tr_b16 v[110:111], v13 offset:15400
    ds_read_b64_tr_b16 v[112:113], v13 offset:16168
    ds_read_b64_tr_b16 v[114:115], v13 offset:15368
    ds_read_b64_tr_b16 v[116:117], v13 offset:16136
    s_waitcnt lgkmcnt(10)
    v_mfma_f32_16x16x32_bf16 v[26:29], v[76:79], v[56:59], v[26:29]
    s_waitcnt lgkmcnt(8)
    v_mfma_f32_16x16x32_bf16 v[30:33], v[98:101], v[56:59], v[30:33]
    s_waitcnt lgkmcnt(6)
    v_mfma_f32_16x16x32_bf16 v[36:39], v[102:105], v[56:59], v[36:39]
    ds_read_b64_tr_b16 v[76:77], v13 offset:18432
    ds_read_b64_tr_b16 v[78:79], v13 offset:19200
    ds_read_b64_tr_b16 v[98:99], v13 offset:18472
    ds_read_b64_tr_b16 v[100:101], v13 offset:19240
    ds_read_b64_tr_b16 v[102:103], v13 offset:18440
    ds_read_b64_tr_b16 v[104:105], v13 offset:19208
    s_waitcnt lgkmcnt(10)
    v_mfma_f32_16x16x32_bf16 v[26:29], v[106:109], v[60:63], v[26:29]
    s_waitcnt lgkmcnt(8)
    v_mfma_f32_16x16x32_bf16 v[30:33], v[110:113], v[60:63], v[30:33]
    s_waitcnt lgkmcnt(6)
    v_mfma_f32_16x16x32_bf16 v[36:39], v[114:117], v[60:63], v[36:39]
    ds_read_b64_tr_b16 v[106:107], v13 offset:21504
    ds_read_b64_tr_b16 v[108:109], v13 offset:22272
    ds_read_b64_tr_b16 v[110:111], v13 offset:21544
    ds_read_b64_tr_b16 v[112:113], v13 offset:22312
    ds_read_b64_tr_b16 v[114:115], v13 offset:21512
    ds_read_b64_tr_b16 v[116:117], v13 offset:22280
    s_waitcnt vmcnt(0)
    v_lshlrev_b32 v40, 16, v82
    v_and_b32 v41, 0xffff0000, v82
    v_lshlrev_b32 v42, 16, v83
    v_and_b32 v43, 0xffff0000, v83
    v_lshlrev_b32 v44, 16, v84
    v_and_b32 v45, 0xffff0000, v84
    v_lshlrev_b32 v46, 16, v85
    v_and_b32 v47, 0xffff0000, v85
    v_lshlrev_b32 v48, 16, v86
    v_and_b32 v49, 0xffff0000, v86
    v_lshlrev_b32 v50, 16, v87
    v_and_b32 v51, 0xffff0000, v87
    v_lshlrev_b32 v52, 16, v88
    v_and_b32 v53, 0xffff0000, v88
    v_lshlrev_b32 v54, 16, v89
    v_and_b32 v55, 0xffff0000, v89
    v_mul_f32 v19, -v18, v19
    v_add_f32 v18, 1.0, v18
    v_mul_f32 v35, -v34, v35
    v_add_f32 v34, 1.0, v34
    v_fma_f32 v40, v40, v18, v19
    v_fma_f32 v41, v41, v18, v19
    v_fma_f32 v42, v42, v18, v19
    v_fma_f32 v43, v43, v18, v19
    v_fma_f32 v44, v44, v18, v19
    v_fma_f32 v45, v45, v18, v19
    v_fma_f32 v46, v46, v18, v19
    v_fma_f32 v47, v47, v18, v19
PAD7:
    s_cbranch_execz RET_B_0
    v_fma_f32 v48, v48, v34, v35
    v_fma_f32 v49, v49, v34, v35
    v_fma_f32 v50, v50, v34, v35
    v_fma_f32 v51, v51, v34, v35
    v_fma_f32 v52, v52, v34, v35
    v_fma_f32 v53, v53, v34, v35
    v_fma_f32 v54, v54, v34, v35
    v_fma_f32 v55, v55, v34, v35
    s_waitcnt lgkmcnt(10)
    v_mfma_f32_16x16x32_bf16 v[26:29], v[76:79], v[64:67], v[26:29]
    s_waitcnt lgkmcnt(8)
    v_mfma_f32_16x16x32_bf16 v[30:33], v[98:101], v[64:67], v[30:33]
    s_waitcnt lgkmcnt(6)
    v_mfma_f32_16x16x32_bf16 v[36:39], v[102:105], v[64:67], v[36:39]
    s_waitcnt lgkmcnt(4)
    v_mfma_f32_16x16x32_bf16 v[26:29], v[106:109], v[68:71], v[26:29]
    s_waitcnt lgkmcnt(2)
    v_mfma_f32_16x16x32_bf16 v[30:33], v[110:113], v[68:71], v[30:33]
    s_waitcnt lgkmcnt(0)
    v_mfma_f32_16x16x32_bf16 v[36:39], v[114:117], v[68:71], v[36:39]
    v_bfrev_b32 v73, 1
    v_cndmask_b32 v81, v81, v73, s[34:35]
    v_cndmask_b32 v14, v14, v73, s[36:37]
    s_nop 0
    v_add_f32 v40, v40, v26
    v_add_f32 v41, v41, v27
    v_add_f32 v42, v42, v28
    v_add_f32 v43, v43, v29
    v_add_f32 v53, v53, v29
    v_add_f32 v54, v54, v28
    v_add_f32 v55, v55, v27
    v_add_f32 v44, v44, v30
    v_add_f32 v49, v49, v33
    v_add_f32 v45, v45, v31
    v_add_f32 v50, v50, v32
    v_add_f32 v46, v46, v32
    v_add_f32 v51, v51, v31
    v_add_f32 v47, v47, v33
    v_add_f32 v52, v52, v30
    v_add_f32 v48, v48, v36
    v_cvt_pk_bf16_f32 v16, v40, v41
    v_cvt_pk_bf16_f32 v17, v42, v43
    v_cvt_pk_bf16_f32 v18, v44, v45
    v_cvt_pk_bf16_f32 v19, v46, v47
    v_cvt_pk_bf16_f32 v56, v48, v49
    v_cvt_pk_bf16_f32 v57, v50, v51
    v_cvt_pk_bf16_f32 v58, v52, v53
    v_cvt_pk_bf16_f32 v59, v54, v55
    s_or_b64 vcc, s[34:35], s[36:37]
    s_cbranch_scc1 FINW
FIND:
COUT:
    buffer_store_dwordx4 v[16:19], v81, s[24:27], 0 offen
    buffer_store_dwordx4 v[56:59], v14, s[24:27], 0 offen
END:
    s_endpgm
URETRY:
    s_add_u32 s48, s48, 1
    s_cmp_ge_u32 s48, 4096
    s_cbranch_scc1 UOK
    buffer_load_dwordx4 v[26:29], v75, s[8:11], s54 offen sc1
    buffer_load_dwordx4 v[30:33], v75, s[8:11], s41 offen sc1
    buffer_load_dword v20, v80, s[8:11], s55 offen sc1
    buffer_load_dwordx2 v[18:19], v15, s[8:11], s43 offen sc1
    buffer_load_dwordx2 v[34:35], v72, s[8:11], s43 offen sc1
    s_waitcnt vmcnt(0)
    s_branch UCHK
HRETRY:
    s_add_u32 s48, s48, 1
    s_cmp_ge_u32 s48, 4096
    s_cbranch_scc1 HOK
    buffer_load_dwordx4 v[90:93], v24, s[8:11], s52 offen sc1
    buffer_load_dwordx4 v[94:97], v24, s[8:11], s52 offen offset:512 sc1
    s_waitcnt vmcnt(0)
    s_branch HCHK
DRETRY:
    s_add_u32 s48, s48, 1
    s_cmp_ge_u32 s48, 65536
    s_nop 1
    s_cbranch_scc1 DOK
    ds_read_b32 v8, v134 offset:58252
    ds_read_b64_tr_b16 v[118:119], v22 offset:0
    ds_read_b64_tr_b16 v[120:121], v22 offset:512
    ds_read_b64_tr_b16 v[122:123], v135 offset:0
    ds_read_b64_tr_b16 v[124:125], v135 offset:512
    ds_read_b64_tr_b16 v[126:127], v136 offset:0
    ds_read_b64_tr_b16 v[128:129], v136 offset:512
    ds_read_b64_tr_b16 v[130:131], v137 offset:0
    ds_read_b64_tr_b16 v[132:133], v137 offset:512
    s_waitcnt lgkmcnt(0)
    s_branch DCHK
NODN:
    s_waitcnt vmcnt(0) lgkmcnt(0)
    s_branch DNJ
MEETB:
    s_barrier
    s_nop 1
    s_branch GO0
FINW:
    s_mov_b64 exec, s[34:35]
    ds_write_b128 v2, v[40:43] offset:60416
    ds_write_b128 v2, v[44:47] offset:60432
    s_mov_b64 exec, s[36:37]
    ds_write_b128 v9, v[48:51] offset:60672
    ds_write_b128 v9, v[52:55] offset:60688
    s_mov_b64 exec, -1
    s_waitcnt lgkmcnt(0)
    s_branch FIND
COMM:
PAD8:
    s_cbranch_execz RET_A_0
    v_lshlrev_b32 v11, 3, v1
    ds_write_b64 v11, v[6:7] offset:60416
    s_mov_b32 s26, s6
    s_mov_b32 s27, s7
    v_lshlrev_b32 v14, 12, v1
    s_and_b32 s3, s2, 3
    s_lshl_b32 s43, s3, 10
    s_and_b32 s3, s2, 0xfc
    s_lshl2_add_u32 s43, s3, s43
    s_add_u32 s43, s43, 3407872
    s_lshl_b32 s44, s33, 12
    s_add_u32 s44, s44, 3407872
    s_mov_b32 s45, 0
    s_lshl_b32 s38, s35, 5
    v_lshlrev_b32 v18, 2, v1
    v_add_u32 v17, s38, v18
    v_lshrrev_b32 v11, 4, v1
    v_bfe_u32 v12, v1, 1, 3
    v_lshl_add_u32 v11, v12, 2, v11
    s_lshl_b32 s38, s47, 9
    v_lshl_add_u32 v16, v11, 4, s38
    s_mov_b32 s56, 0xaaaaaaaa
    s_mov_b32 s57, 0xaaaaaaaa
    s_cmpk_lt_u32 s2, 224
    s_cbranch_scc1 CB0
    s_barrier
CB0:
    s_waitcnt vmcnt(12)
    v_add_u32 v4, 2, v4
    v_or_b32 v4, 1, v4
    v_readfirstlane_b32 s49, v5
    v_readfirstlane_b32 s48, v4
    s_waitcnt lgkmcnt(0)
CSPIN:
    ds_read_b32 v12, v10 offset:58260
    ds_read_b128 v[24:27], v10 offset:58176
    ds_read_b128 v[28:31], v10 offset:58192
    ds_read_b32 v20, v17 offset:58112
    ds_read_b32 v21, v18 offset:58272
    s_waitcnt lgkmcnt(4)
    v_and_b32 v12, 0xff, v12
    v_cmp_eq_u32 vcc, 8, v12
    s_cbranch_vccz CSPIN
    s_waitcnt lgkmcnt(3)
    v_max3_u32 v19, v24, v25, v26
    v_med3_u32 v23, v24, v25, v26
    s_waitcnt lgkmcnt(2)
    v_max3_u32 v32, v27, v28, v29
    v_med3_u32 v33, v27, v28, v29
    v_med3_u32 v12, v19, v32, v30
    v_max3_u32 v19, v19, v32, v30
    v_max3_u32 v12, v12, v23, v33
    v_max_u32 v2, v19, v31
    v_med3_u32 v3, v19, v12, v31
    s_mov_b64 exec, 0xff
    s_waitcnt vmcnt(0)
    buffer_store_dwordx4 v[2:5], v14, s[8:11], s43 offen sc1
    s_waitcnt lgkmcnt(0)
    buffer_store_dwordx2 v[20:21], v13, s[8:11], s42 offen sc1
    s_mov_b64 exec, -1
    v_readfirstlane_b32 s50, v2
    v_readfirstlane_b32 s51, v3
    s_barrier
    buffer_load_dwordx4 v[34:37], v15, s[8:11], s44 offen offset:0 sc1
    buffer_load_dwordx4 v[38:41], v15, s[8:11], s44 offen offset:1024 sc1
    buffer_load_dwordx4 v[42:45], v15, s[8:11], s44 offen offset:2048 sc1
    buffer_load_dwordx4 v[46:49], v15, s[8:11], s44 offen offset:3072 sc1
    s_mov_b64 s[54:55], 0
    s_mov_b64 s[52:53], -1
REDUCE:
    s_add_u32 s45, s45, 1
    s_waitcnt vmcnt(3)
    v_cmp_eq_u64 vcc, s[48:49], v[36:37]
    s_waitcnt vmcnt(2)
    v_cmp_eq_u64 s[58:59], s[48:49], v[40:41]
    v_max_u32 v23, v35, v39
    v_max_u32 v19, v34, v38
    v_med3_u32 v23, v34, v38, v23
    s_waitcnt vmcnt(1)
    v_cmp_eq_u64 s[60:61], s[48:49], v[44:45]
    s_and_b64 vcc, vcc, s[58:59]
    s_waitcnt vmcnt(0)
    v_cmp_eq_u64 s[62:63], s[48:49], v[48:49]
    v_max_u32 v33, v43, v47
    v_max_u32 v32, v42, v46
    v_med3_u32 v33, v42, v46, v33
    s_and_b64 vcc, vcc, s[60:61]
    v_max_u32 v23, v23, v33
    s_and_b64 vcc, vcc, s[62:63]
    v_med3_u32 v23, v19, v32, v23
    v_max_u32 v19, v19, v32
    v_cndmask_b32 v23, 0, v23, vcc
    v_cndmask_b32 v19, 0, v19, vcc
    s_nop 0
    v_max_u32_dpp v33, v23, v23 row_ror:8 row_mask:0xf bank_mask:0xf
    v_mov_b32_dpp v32, v19 row_ror:8 row_mask:0xf bank_mask:0xf
    v_med3_u32 v23, v19, v32, v33
    v_max_u32 v19, v19, v32
    s_nop 0
    v_max_u32_dpp v33, v23, v23 row_ror:4 row_mask:0xf bank_mask:0xf
    v_mov_b32_dpp v32, v19 row_ror:4 row_mask:0xf bank_mask:0xf
    v_med3_u32 v23, v19, v32, v33
    v_max_u32 v19, v19, v32
    s_nop 0
    v_max_u32_dpp v33, v23, v23 row_ror:2 row_mask:0xf bank_mask:0xf
    v_mov_b32_dpp v32, v19 row_ror:2 row_mask:0xf bank_mask:0xf
    v_med3_u32 v23, v19, v32, v33
    v_max_u32 v19, v19, v32
    s_nop 0
    v_max_u32_dpp v33, v23, v23 row_ror:1 row_mask:0xf bank_mask:0xf
    v_mov_b32_dpp v32, v19 row_ror:1 row_mask:0xf bank_mask:0xf
    v_med3_u32 v23, v19, v32, v33
    v_max_u32 v19, v19, v32
    s_nop 0
    v_max_u32_dpp v33, v23, v23 row_bcast:15 row_mask:0xa bank_mask:0xf
    v_mov_b32_dpp v32, v19 row_bcast:15 row_mask:0xa bank_mask:0xf
    v_med3_u32 v23, v19, v32, v33
    v_max_u32 v19, v19, v32
    s_nop 0
    v_max_u32_dpp v33, v23, v23 row_bcast:31 row_mask:0xc bank_mask:0xf
    v_mov_b32_dpp v32, v19 row_bcast:31 row_mask:0xc bank_mask:0xf
    v_med3_u32 v23, v19, v32, v33
    v_max_u32 v19, v19, v32
    s_nop 0
    v_readlane_b32 s50, v19, 63
    v_readlane_b32 s51, v23, 63
    s_cmp_eq_u64 vcc, -1
    s_cbranch_scc0 NOTALL
    s_cmp_eq_u64 s[50:51], s[52:53]
    s_cbranch_scc1 SAME
FINAL:
    v_mov_b32 v11, s50
    v_mov_b32 v12, s51
    v_cndmask_b32 v11, v11, v12, s[56:57]
    v_and_b32 v32, 0x7ff, v11
    v_lshl_add_u32 v33, v32, 11, v16
    buffer_load_dwordx4 v[24:27], v33, s[4:7], 0 offen
    v_and_b32 v12, 7, v11
    v_and_b32 v11, 0x7f8, v11
    v_lshl_add_u32 v11, v12, 11, v11
    buffer_load_dwordx2 v[20:21], v11, s[8:11], s42 offen sc1
    s_barrier
    s_mov_b64 exec, 3
    ds_write_b32 v18, v32 offset:58240
    s_mov_b64 exec, -1
    s_waitcnt vmcnt(1)
    v_lshlrev_b32 v50, 16, v24
    v_and_b32 v51, 0xffff0000, v24
    v_lshlrev_b32 v52, 16, v25
    v_and_b32 v53, 0xffff0000, v25
    v_lshlrev_b32 v54, 16, v26
    v_and_b32 v55, 0xffff0000, v26
    v_lshlrev_b32 v56, 16, v27
    v_and_b32 v57, 0xffff0000, v27
SCHK:
    s_waitcnt vmcnt(0)
    v_max_u32 v12, v20, v21
    v_mul_f32 v21, -v20, v21
    v_cmp_eq_u32 vcc, -1, v12
    s_cbranch_vccnz SRETRY
SOK:
    v_fma_f32 v50, v50, v20, v21
    v_fma_f32 v51, v51, v20, v21
    v_fma_f32 v52, v52, v20, v21
    v_fma_f32 v53, v53, v20, v21
    v_fma_f32 v54, v54, v20, v21
    v_fma_f32 v55, v55, v20, v21
    v_fma_f32 v56, v56, v20, v21
    v_fma_f32 v57, v57, v20, v21
    v_cvt_pk_bf16_f32 v24, v50, v51
    v_cvt_pk_bf16_f32 v25, v52, v53
    v_cvt_pk_bf16_f32 v26, v54, v55
    v_cvt_pk_bf16_f32 v27, v56, v57
    ds_write_b128 v15, v[24:27] offset:58368
GOT:
PAD9:
    s_cbranch_execz RET_B_0
    s_waitcnt lgkmcnt(0)
    s_barrier
    s_cmp_lg_u32 s2, 0
    s_cbranch_scc1 NOEP
    s_mov_b64 exec, 1
    buffer_store_dword v4, v10, s[8:11], s41 offen sc1
    s_mov_b64 exec, -1
NOEP:
    s_and_b32 s59, s34, 15
    s_lshr_b32 s60, s34, 4
    s_lshl_b32 s60, s60, 10
    s_or_b32 s60, s60, s33
    s_mov_b32 s58, 0
    s_and_b32 s38, s50, 0x407
    s_cmp_eq_u32 s38, s60
    s_cselect_b32 s38, 1, 0
    s_or_b32 s58, s58, s38
    s_and_b32 s38, s51, 0x407
    s_cmp_eq_u32 s38, s60
    s_cselect_b32 s38, 2, 0
    s_or_b32 s58, s58, s38
    s_sub_u32 s38, 0, s50
    s_and_b32 s38, s38, 0x407
    s_cmp_eq_u32 s38, s60
    s_cselect_b32 s38, 4, 0
    s_or_b32 s58, s58, s38
    s_sub_u32 s38, 0, s51
    s_and_b32 s38, s38, 0x407
    s_cmp_eq_u32 s38, s60
    s_cselect_b32 s38, 8, 0
    s_or_b32 s58, s58, s38
    s_cbranch_scc0 MEND
    v_and_b32 v28, 15, v1
    v_and_b32 v11, 1, v1
    v_lshlrev_b32 v11, 4, v11
    v_mov_b32 v12, 0x3f80
    v_lshlrev_b32 v11, v11, v12
    v_lshrrev_b32 v12, 1, v28
    v_cmp_eq_u32 vcc, 0, v12
    s_nop 1
    v_cndmask_b32 v24, 0, v11, vcc
    v_cmp_eq_u32 vcc, 1, v12
    s_nop 1
    v_cndmask_b32 v25, 0, v11, vcc
    v_cmp_eq_u32 vcc, 2, v12
    s_nop 1
    v_cndmask_b32 v26, 0, v11, vcc
    v_cmp_eq_u32 vcc, 3, v12
    s_nop 1
    v_cndmask_b32 v27, 0, v11, vcc
    v_and_b32 v11, 3, v1
    v_bfe_u32 v12, v1, 4, 1
    v_lshl_add_u32 v11, v11, 1, v12
    v_lshlrev_b32 v29, 4, v11
    v_lshlrev_b32 v30, 3, v11
    s_barrier
    s_barrier
ROLE:
    s_ff1_i32_b32 s61, s58
    s_bitset0_b32 s58, s61
    s_bitcmp1_b32 s61, 0
    s_cselect_b32 s62, s51, s50
    s_cselect_b32 s64, 32, 0
    s_sub_u32 s46, 31, s59
    s_bitcmp1_b32 s61, 1
    s_cselect_b32 s46, s46, s59
    s_add_u32 s64, s64, s46
    s_mul_i32 s64, s64, 7168
    s_add_u32 s64, s64, 2490368
    s_add_u32 s47, s64, 4096
    s_and_b32 s63, s62, 0x7ff
    s_lshl_b32 s63, s63, 11
    s_lshl_b32 s46, s46, 6
    s_add_u32 s63, s63, s46
    s_lshl_b32 s38, s61, 7
    v_add_u32 v11, s38, v29
    s_mov_b32 s45, 0
    v_mov_b32 v31, s62
    v_ashrrev_i32 v12, 31, v31
    v_not_b32 v12, v12
    v_or_b32 v12, 0x80000000, v12
    v_xor_b32 v31, v31, v12
    v_mul_f32 v31, 0xbfb8aa3b, v31
    v_exp_f32 v31, v31
    s_nop 0
    v_add_f32 v31, 1.0, v31
    v_rcp_f32 v31, v31
RPOLL:
    buffer_load_dwordx4 v[34:37], v15, s[8:11], s64 offen offset:0 sc1
    buffer_load_dwordx4 v[38:41], v15, s[8:11], s64 offen offset:1024 sc1
    buffer_load_dwordx4 v[42:45], v15, s[8:11], s64 offen offset:2048 sc1
    buffer_load_dwordx4 v[46:49], v15, s[8:11], s64 offen offset:3072 sc1
    buffer_load_dwordx4 v[50:53], v15, s[8:11], s47 offen offset:0 sc1
    buffer_load_dwordx4 v[54:57], v15, s[8:11], s47 offen offset:1024 sc1
    buffer_load_dwordx4 v[58:61], v15, s[8:11], s47 offen offset:2048 sc1
    s_add_u32 s45, s45, 1
    s_waitcnt vmcnt(6)
    v_mfma_f32_16x16x32_bf16 v[62:65], v[24:27], v[34:37], 0
    s_waitcnt vmcnt(5)
    v_mfma_f32_16x16x32_bf16 v[62:65], v[24:27], v[38:41], v[62:65]
    s_waitcnt vmcnt(4)
    v_mfma_f32_16x16x32_bf16 v[62:65], v[24:27], v[42:45], v[62:65]
    s_waitcnt vmcnt(3)
    v_mfma_f32_16x16x32_bf16 v[62:65], v[24:27], v[46:49], v[62:65]
    s_waitcnt vmcnt(2)
    v_mfma_f32_16x16x32_bf16 v[62:65], v[24:27], v[50:53], v[62:65]
    s_waitcnt vmcnt(1)
    v_mfma_f32_16x16x32_bf16 v[62:65], v[24:27], v[54:57], v[62:65]
    s_waitcnt vmcnt(0)
    v_mfma_f32_16x16x32_bf16 v[62:65], v[24:27], v[58:61], v[62:65]
    ds_read_b128 v[66:69], v11 offset:60416
    s_cmp_ge_u32 s45, 4096
    s_cbranch_scc1 RGOT
    s_nop 4
    v_cmp_u_f32 vcc, v62, v62
    s_cbranch_vccnz RPOLL
RGOT:
    s_nop 4
    v_add_f32_dpp v62, v62, v62 row_ror:4 row_mask:0xf bank_mask:0xf
    v_add_f32_dpp v63, v63, v63 row_ror:4 row_mask:0xf bank_mask:0xf
    v_add_f32_dpp v64, v64, v64 row_ror:4 row_mask:0xf bank_mask:0xf
    v_add_f32_dpp v65, v65, v65 row_ror:4 row_mask:0xf bank_mask:0xf
    v_add_f32_dpp v62, v62, v62 row_ror:8 row_mask:0xf bank_mask:0xf
    v_add_f32_dpp v63, v63, v63 row_ror:8 row_mask:0xf bank_mask:0xf
    v_add_f32_dpp v64, v64, v64 row_ror:8 row_mask:0xf bank_mask:0xf
    v_add_f32_dpp v65, v65, v65 row_ror:8 row_mask:0xf bank_mask:0xf
FCHK:
    s_waitcnt lgkmcnt(0)
    v_max3_u32 v12, v66, v67, v68
    v_max_u32 v12, v12, v69
    v_cmp_eq_u32 vcc, -1, v12
    s_cbranch_vccnz FRETRY
FOK:
    v_fmac_f32 v66, v62, v31
    v_fmac_f32 v67, v63, v31
    v_fmac_f32 v68, v64, v31
    v_fmac_f32 v69, v65, v31
    v_cvt_pk_bf16_f32 v66, v66, v67
    v_cvt_pk_bf16_f32 v67, v68, v69
    s_mov_b64 exec, 0x000f000f
    buffer_store_dwordx2 v[66:67], v30, s[24:27], s63 offen
    s_mov_b64 exec, -1
    s_cmp_lg_u32 s58, 0
    s_nop 0
    s_cbranch_scc1 ROLE
MEND:
    s_endpgm
FRETRY:
    s_add_u32 s45, s45, 1
    s_cmp_ge_u32 s45, 65536
    s_cbranch_scc1 FOK
    ds_read_b128 v[66:69], v11 offset:60416
    s_branch FCHK
NOTALL:
    s_cmp_ge_u32 s45, 4096
    s_cbranch_scc1 FINAL
    s_cmp_eq_u64 s[50:51], s[52:53]
    s_cselect_b64 vcc, s[54:55], 0
    s_cmp_eq_u64 vcc, -1
    s_cbranch_scc0 POLLA
    buffer_load_dwordx4 v[34:37], v15, s[8:11], s44 offen offset:0 sc1
    buffer_load_dwordx4 v[38:41], v15, s[8:11], s44 offen offset:1024 sc1
    buffer_load_dwordx4 v[42:45], v15, s[8:11], s44 offen offset:2048 sc1
    buffer_load_dwordx4 v[46:49], v15, s[8:11], s44 offen offset:3072 sc1
    s_nop 0
    s_branch REDUCE
POLLA:
    v_mov_b32 v11, s50
    v_mov_b32 v12, s51
    s_mov_b64 s[52:53], s[50:51]
    v_cndmask_b32 v11, v11, v12, s[56:57]
    v_and_b32 v32, 0x7ff, v11
    v_lshl_add_u32 v33, v32, 11, v16
    buffer_load_dwordx4 v[24:27], v33, s[4:7], 0 offen
    v_and_b32 v12, 7, v11
    v_and_b32 v11, 0x7f8, v11
    v_lshl_add_u32 v11, v12, 11, v11
    buffer_load_dwordx2 v[20:21], v11, s[8:11], s42 offen sc1
    buffer_load_dwordx4 v[34:37], v15, s[8:11], s44 offen offset:0 sc1
    buffer_load_dwordx4 v[38:41], v15, s[8:11], s44 offen offset:1024 sc1
    buffer_load_dwordx4 v[42:45], v15, s[8:11], s44 offen offset:2048 sc1
    buffer_load_dwordx4 v[46:49], v15, s[8:11], s44 offen offset:3072 sc1
    s_mov_b64 exec, 3
    ds_write_b32 v18, v32 offset:58240
    s_mov_b64 exec, -1
    s_waitcnt vmcnt(5)
    v_lshlrev_b32 v50, 16, v24
    v_and_b32 v51, 0xffff0000, v24
    v_lshlrev_b32 v52, 16, v25
    v_and_b32 v53, 0xffff0000, v25
    v_lshlrev_b32 v54, 16, v26
    v_and_b32 v55, 0xffff0000, v26
    v_lshlrev_b32 v56, 16, v27
    v_and_b32 v57, 0xffff0000, v27
    s_waitcnt vmcnt(4)
    v_max_u32 v11, v20, v21
    v_mul_f32 v21, -v20, v21
    v_cmp_ne_u32 s[54:55], -1, v11
    v_fma_f32 v50, v50, v20, v21
    v_fma_f32 v51, v51, v20, v21
    v_fma_f32 v52, v52, v20, v21
    v_fma_f32 v53, v53, v20, v21
    v_fma_f32 v54, v54, v20, v21
    v_fma_f32 v55, v55, v20, v21
    v_fma_f32 v56, v56, v20, v21
    v_fma_f32 v57, v57, v20, v21
    v_cvt_pk_bf16_f32 v24, v50, v51
    v_cvt_pk_bf16_f32 v25, v52, v53
    v_cvt_pk_bf16_f32 v26, v54, v55
    v_cvt_pk_bf16_f32 v27, v56, v57
    ds_write_b128 v15, v[24:27] offset:58368
    s_nop 0
    s_branch REDUCE
SAME:
    s_cmp_eq_u64 s[54:55], -1
    s_cbranch_scc0 FINAL
    s_barrier
    s_branch GOT
SRETRY:
    s_add_u32 s45, s45, 1
    s_cmp_ge_u32 s45, 8192
    s_cbranch_scc1 SOK
    buffer_load_dwordx2 v[20:21], v11, s[8:11], s42 offen sc1
    s_branch SCHK
LOAD:
    s_lshl_b32 s14, 7, 20
    s_mov_b32 s15, s7
    s_mov_b64 s[18:19], s[14:15]
    s_lshr_b32 s41, s40, 2
    s_and_b32 s42, s40, 3
    s_mul_i32 s43, s42, 1835008
    s_lshl_b32 s38, s41, 7
    s_add_u32 s43, s43, s38
    v_bfe_u32 v10, v1, 1, 2
    v_bfe_u32 v11, v1, 4, 1
    v_xor_b32 v10, v10, v11
    v_and_b32 v11, 1, v1
    v_lshlrev_b32 v11, 4, v11
    v_lshl_add_u32 v10, v10, 5, v11
    v_lshrrev_b32 v11, 3, v1
    v_mul_u32_u24 v2, 7168, v11
    v_add_u32 v2, v10, v2
    v_xor_b32 v3, 64, v2
    v_add_u32 v4, 112640, v2
    v_add_u32 v5, 168960, v3
    v_add_u32 v3, 56320, v3
    s_cmp_eq_u32 s35, 0
    s_cselect_b32 s46, s37, s36
    s_cselect_b32 s47, -1, 1
    s_cselect_b32 s48, 16384, 0
    s_lshl_b32 s47, s47, 19
    s_lshl_b32 s46, s46, 11
    v_and_b32 v12, 32, v1
    v_lshlrev_b32 v6, 4, v1
    v_xor_b32 v12, v12, v6
    s_waitcnt lgkmcnt(0)
    s_add_u32 m0, s48, 0
    s_nop 0
    buffer_load_dwordx4 v12, s[4:7], s46 offen offset:0 lds
    buffer_load_dwordx4 v12, s[4:7], s46 offen offset:1024 lds
    s_add_u32 m0, s48, 2048
    s_add_u32 s46, s46, s47
    buffer_load_dwordx4 v12, s[4:7], s46 offen offset:0 lds
    buffer_load_dwordx4 v12, s[4:7], s46 offen offset:1024 lds
    s_add_u32 m0, s48, 4096
    s_add_u32 s46, s46, s47
    buffer_load_dwordx4 v12, s[4:7], s46 offen offset:0 lds
    buffer_load_dwordx4 v12, s[4:7], s46 offen offset:1024 lds
    s_add_u32 m0, s48, 6144
    s_add_u32 s46, s46, s47
    buffer_load_dwordx4 v12, s[4:7], s46 offen offset:0 lds
    buffer_load_dwordx4 v12, s[4:7], s46 offen offset:1024 lds
    s_add_u32 m0, s48, 8192
    s_add_u32 s46, s46, s47
    buffer_load_dwordx4 v12, s[4:7], s46 offen offset:0 lds
    buffer_load_dwordx4 v12, s[4:7], s46 offen offset:1024 lds
    s_add_u32 m0, s48, 10240
    s_add_u32 s46, s46, s47
    buffer_load_dwordx4 v12, s[4:7], s46 offen offset:0 lds
    buffer_load_dwordx4 v12, s[4:7], s46 offen offset:1024 lds
    s_add_u32 m0, s48, 12288
    s_add_u32 s46, s46, s47
    buffer_load_dwordx4 v12, s[4:7], s46 offen offset:0 lds
    buffer_load_dwordx4 v12, s[4:7], s46 offen offset:1024 lds
    s_add_u32 m0, s48, 14336
    s_add_u32 s46, s46, s47
    buffer_load_dwordx4 v12, s[4:7], s46 offen offset:0 lds
    buffer_load_dwordx4 v12, s[4:7], s46 offen offset:1024 lds
    s_mov_b32 m0, 61440
    s_add_u32 s45, s43, 0
    buffer_load_dwordx4 v2, s[12:15], s45 offen offset:0 nt lds
    buffer_load_dwordx4 v3, s[12:15], s45 offen offset:1024 nt lds
    buffer_load_dwordx4 v4, s[12:15], s45 offen offset:2048 nt lds
    buffer_load_dwordx4 v5, s[12:15], s45 offen offset:3072 nt lds
    s_mov_b32 m0, 94208
    s_nop 0
    buffer_load_dwordx4 v2, s[16:19], s45 offen offset:0 nt lds
    buffer_load_dwordx4 v3, s[16:19], s45 offen offset:1024 nt lds
    buffer_load_dwordx4 v4, s[16:19], s45 offen offset:2048 nt lds
    buffer_load_dwordx4 v5, s[16:19], s45 offen offset:3072 nt lds
    s_mov_b32 m0, 65536
    s_add_u32 s45, s43, 229376
    buffer_load_dwordx4 v2, s[12:15], s45 offen offset:0 nt lds
    buffer_load_dwordx4 v3, s[12:15], s45 offen offset:1024 nt lds
    buffer_load_dwordx4 v4, s[12:15], s45 offen offset:2048 nt lds
    buffer_load_dwordx4 v5, s[12:15], s45 offen offset:3072 nt lds
    v_mov_b32 v12, 256
    s_mov_b64 s[22:23], s[14:15]
    s_lshl_b32 s44, s41, 17
    s_lshl_b32 s38, s42, 9
    s_add_u32 s44, s44, s38
    v_lshl_add_u32 v6, v11, 11, v10
    v_xor_b32 v7, 64, v6
    v_add_u32 v8, 30720, v6
    v_add_u32 v9, 46080, v7
    v_add_u32 v7, 15360, v7
    v_mov_b32 v10, -1
    v_mov_b32 v11, 0
    ds_write_b32 v11, v10 offset:58252
    s_waitcnt vmcnt(12)
    s_mov_b64 exec, 1
    ds_add_u32 v11, v12 offset:58260
    s_mov_b64 exec, -1
    s_mov_b32 m0, 98304
    s_nop 0
    buffer_load_dwordx4 v2, s[16:19], s45 offen offset:0 nt lds
    buffer_load_dwordx4 v3, s[16:19], s45 offen offset:1024 nt lds
    buffer_load_dwordx4 v4, s[16:19], s45 offen offset:2048 nt lds
    buffer_load_dwordx4 v5, s[16:19], s45 offen offset:3072 nt lds
    s_mov_b32 m0, 69632
    s_add_u32 s45, s43, 458752
    buffer_load_dwordx4 v2, s[12:15], s45 offen offset:0 nt lds
    buffer_load_dwordx4 v3, s[12:15], s45 offen offset:1024 nt lds
    buffer_load_dwordx4 v4, s[12:15], s45 offen offset:2048 nt lds
    buffer_load_dwordx4 v5, s[12:15], s45 offen offset:3072 nt lds
    s_mov_b32 m0, 102400
    s_waitcnt vmcnt(19)
    buffer_load_dwordx4 v2, s[16:19], s45 offen offset:0 nt lds
    s_waitcnt vmcnt(19)
    buffer_load_dwordx4 v3, s[16:19], s45 offen offset:1024 nt lds
    s_waitcnt vmcnt(19)
    buffer_load_dwordx4 v4, s[16:19], s45 offen offset:2048 nt lds
    s_waitcnt vmcnt(19)
    buffer_load_dwordx4 v5, s[16:19], s45 offen offset:3072 nt lds
    s_mov_b32 m0, 73728
    s_add_u32 s45, s43, 688128
    s_waitcnt vmcnt(19)
    buffer_load_dwordx4 v2, s[12:15], s45 offen offset:0 nt lds
    s_waitcnt vmcnt(19)
    buffer_load_dwordx4 v3, s[12:15], s45 offen offset:1024 nt lds
    s_waitcnt vmcnt(19)
    buffer_load_dwordx4 v4, s[12:15], s45 offen offset:2048 nt lds
    s_waitcnt vmcnt(19)
    buffer_load_dwordx4 v5, s[12:15], s45 offen offset:3072 nt lds
    s_mov_b32 m0, 106496
    s_waitcnt vmcnt(19)
    buffer_load_dwordx4 v2, s[16:19], s45 offen offset:0 nt lds
    s_waitcnt vmcnt(19)
    buffer_load_dwordx4 v3, s[16:19], s45 offen offset:1024 nt lds
    s_waitcnt vmcnt(19)
    buffer_load_dwordx4 v4, s[16:19], s45 offen offset:2048 nt lds
    s_waitcnt vmcnt(19)
    buffer_load_dwordx4 v5, s[16:19], s45 offen offset:3072 nt lds
    s_mov_b32 m0, 77824
    s_add_u32 s45, s43, 917504
    s_waitcnt vmcnt(19)
    buffer_load_dwordx4 v2, s[12:15], s45 offen offset:0 nt lds
    s_waitcnt vmcnt(19)
    buffer_load_dwordx4 v3, s[12:15], s45 offen offset:1024 nt lds
    s_waitcnt vmcnt(19)
    buffer_load_dwordx4 v4, s[12:15], s45 offen offset:2048 nt lds
    s_waitcnt vmcnt(19)
    buffer_load_dwordx4 v5, s[12:15], s45 offen offset:3072 nt lds
    s_mov_b32 m0, 110592
    s_waitcnt vmcnt(19)
    buffer_load_dwordx4 v2, s[16:19], s45 offen offset:0 nt lds
    s_waitcnt vmcnt(19)
    buffer_load_dwordx4 v3, s[16:19], s45 offen offset:1024 nt lds
    s_waitcnt vmcnt(19)
    buffer_load_dwordx4 v4, s[16:19], s45 offen offset:2048 nt lds
PAD10:
    s_cbranch_execz RET_A_1
    s_waitcnt vmcnt(19)
    buffer_load_dwordx4 v5, s[16:19], s45 offen offset:3072 nt lds
    s_mov_b32 m0, 81920
    s_add_u32 s45, s43, 1146880
    s_waitcnt vmcnt(19)
    buffer_load_dwordx4 v2, s[12:15], s45 offen offset:0 nt lds
    s_waitcnt vmcnt(19)
    buffer_load_dwordx4 v3, s[12:15], s45 offen offset:1024 nt lds
    s_waitcnt vmcnt(19)
    buffer_load_dwordx4 v4, s[12:15], s45 offen offset:2048 nt lds
    s_waitcnt vmcnt(19)
    buffer_load_dwordx4 v5, s[12:15], s45 offen offset:3072 nt lds
    s_mov_b32 m0, 114688
    s_waitcnt vmcnt(19)
    buffer_load_dwordx4 v2, s[16:19], s45 offen offset:0 nt lds
    s_waitcnt vmcnt(19)
    buffer_load_dwordx4 v3, s[16:19], s45 offen offset:1024 nt lds
    s_waitcnt vmcnt(19)
    buffer_load_dwordx4 v4, s[16:19], s45 offen offset:2048 nt lds
    s_waitcnt vmcnt(19)
    buffer_load_dwordx4 v5, s[16:19], s45 offen offset:3072 nt lds
    s_mov_b32 m0, 86016
    s_add_u32 s45, s43, 1376256
    s_waitcnt vmcnt(19)
    buffer_load_dwordx4 v2, s[12:15], s45 offen offset:0 nt lds
    s_waitcnt vmcnt(19)
    buffer_load_dwordx4 v3, s[12:15], s45 offen offset:1024 nt lds
    s_waitcnt vmcnt(19)
    buffer_load_dwordx4 v4, s[12:15], s45 offen offset:2048 nt lds
    s_waitcnt vmcnt(19)
    buffer_load_dwordx4 v5, s[12:15], s45 offen offset:3072 nt lds
    s_mov_b32 m0, 118784
    s_waitcnt vmcnt(19)
    buffer_load_dwordx4 v2, s[16:19], s45 offen offset:0 nt lds
    s_waitcnt vmcnt(19)
    buffer_load_dwordx4 v3, s[16:19], s45 offen offset:1024 nt lds
    s_waitcnt vmcnt(19)
    buffer_load_dwordx4 v4, s[16:19], s45 offen offset:2048 nt lds
    s_waitcnt vmcnt(19)
    buffer_load_dwordx4 v5, s[16:19], s45 offen offset:3072 nt lds
    s_waitcnt lgkmcnt(0)
    s_barrier
    s_mov_b32 m0, 90112
    s_add_u32 s45, s43, 1605632
    s_waitcnt vmcnt(19)
    buffer_load_dwordx4 v2, s[12:15], s45 offen offset:0 nt lds
    s_waitcnt vmcnt(19)
    buffer_load_dwordx4 v3, s[12:15], s45 offen offset:1024 nt lds
    s_waitcnt vmcnt(19)
    buffer_load_dwordx4 v4, s[12:15], s45 offen offset:2048 nt lds
    s_waitcnt vmcnt(19)
PAD11:
    s_cbranch_execz RET_A_1
    buffer_load_dwordx4 v5, s[12:15], s45 offen offset:3072 nt lds
    s_mov_b32 m0, 122880
    s_waitcnt vmcnt(19)
    buffer_load_dwordx4 v2, s[16:19], s45 offen offset:0 nt lds
    s_waitcnt vmcnt(19)
    buffer_load_dwordx4 v3, s[16:19], s45 offen offset:1024 nt lds
    s_waitcnt vmcnt(19)
    buffer_load_dwordx4 v4, s[16:19], s45 offen offset:2048 nt lds
    s_waitcnt vmcnt(19)
    buffer_load_dwordx4 v5, s[16:19], s45 offen offset:3072 nt lds
    s_barrier
    s_mov_b32 m0, 126976
    s_add_u32 s45, s44, 0
    buffer_load_dwordx4 v6, s[20:23], s45 offen offset:0 nt lds
    buffer_load_dwordx4 v7, s[20:23], s45 offen offset:1024 nt lds
    buffer_load_dwordx4 v8, s[20:23], s45 offen offset:2048 nt lds
    buffer_load_dwordx4 v9, s[20:23], s45 offen offset:3072 nt lds
    s_mov_b32 m0, 131072
    s_add_u32 s45, s44, 128
    buffer_load_dwordx4 v6, s[20:23], s45 offen offset:0 nt lds
    buffer_load_dwordx4 v7, s[20:23], s45 offen offset:1024 nt lds
    buffer_load_dwordx4 v8, s[20:23], s45 offen offset:2048 nt lds
    buffer_load_dwordx4 v9, s[20:23], s45 offen offset:3072 nt lds
    s_mov_b32 m0, 135168
    s_add_u32 s45, s44, 256
    buffer_load_dwordx4 v6, s[20:23], s45 offen offset:0 nt lds
    buffer_load_dwordx4 v7, s[20:23], s45 offen offset:1024 nt lds
    buffer_load_dwordx4 v8, s[20:23], s45 offen offset:2048 nt lds
    buffer_load_dwordx4 v9, s[20:23], s45 offen offset:3072 nt lds
    s_mov_b32 m0, 139264
    s_add_u32 s45, s44, 384
    buffer_load_dwordx4 v6, s[20:23], s45 offen offset:0 nt lds
    buffer_load_dwordx4 v7, s[20:23], s45 offen offset:1024 nt lds
    buffer_load_dwordx4 v8, s[20:23], s45 offen offset:2048 nt lds
    buffer_load_dwordx4 v9, s[20:23], s45 offen offset:3072 nt lds
    s_mov_b32 m0, 143360
    s_add_u32 s45, s44, 65536
    buffer_load_dwordx4 v6, s[20:23], s45 offen offset:0 nt lds
    buffer_load_dwordx4 v7, s[20:23], s45 offen offset:1024 nt lds
    buffer_load_dwordx4 v8, s[20:23], s45 offen offset:2048 nt lds
    buffer_load_dwordx4 v9, s[20:23], s45 offen offset:3072 nt lds
    s_mov_b32 m0, 147456
    s_add_u32 s45, s44, 65664
    buffer_load_dwordx4 v6, s[20:23], s45 offen offset:0 nt lds
    buffer_load_dwordx4 v7, s[20:23], s45 offen offset:1024 nt lds
    buffer_load_dwordx4 v8, s[20:23], s45 offen offset:2048 nt lds
    buffer_load_dwordx4 v9, s[20:23], s45 offen offset:3072 nt lds
    s_mov_b32 m0, 151552
    s_add_u32 s45, s44, 65792
    buffer_load_dwordx4 v6, s[20:23], s45 offen offset:0 nt lds
    buffer_load_dwordx4 v7, s[20:23], s45 offen offset:1024 nt lds
    buffer_load_dwordx4 v8, s[20:23], s45 offen offset:2048 nt lds
    buffer_load_dwordx4 v9, s[20:23], s45 offen offset:3072 nt lds
    s_mov_b32 m0, 155648
    s_add_u32 s45, s44, 65920
    buffer_load_dwordx4 v6, s[20:23], s45 offen offset:0 nt lds
    buffer_load_dwordx4 v7, s[20:23], s45 offen offset:1024 nt lds
    buffer_load_dwordx4 v8, s[20:23], s45 offen offset:2048 nt lds
    buffer_load_dwordx4 v9, s[20:23], s45 offen offset:3072 nt lds
    s_waitcnt vmcnt(32)
    s_barrier
    s_barrier
    s_waitcnt vmcnt(0)
    ds_write_b32 v11, v11 offset:58252
    s_endpgm
.section .rodata,"a"
.p2align 6
.amdhsa_kernel parallel_sum__spectral_fnet__moe_arch_mod__prompt_kernel
  .amdhsa_next_free_vgpr 166
  .amdhsa_next_free_sgpr 102
  .amdhsa_accum_offset 168
  .amdhsa_group_segment_fixed_size 0
  .amdhsa_kernarg_size 104
  .amdhsa_user_sgpr_count 2
  .amdhsa_user_sgpr_kernarg_segment_ptr 1
  .amdhsa_system_sgpr_workgroup_id_x 1
.end_amdhsa_kernel
```

```asm
; @launch grid=(256,1,1) block=(640,1,1) lds=159744
.amdgcn_target "amdgcn-amd-amdhsa--gfx950"
.text
.globl parallel_sum__spectral_fnet__moe_arch_mod__prompt_kernel
.p2align 12
.type parallel_sum__spectral_fnet__moe_arch_mod__prompt_kernel,@function
parallel_sum__spectral_fnet__moe_arch_mod__prompt_kernel:
    s_cmpk_ge_u32 s2, 256
    s_cbranch_scc1 END
    v_lshrrev_b32 v2, 6, v0
    s_load_dwordx2 s[4:5], s[0:1], 0
    s_load_dwordx2 s[28:29], s[0:1], 48
    s_load_dwordx2 s[8:9], s[0:1], 96
    s_load_dwordx2 s[12:13], s[0:1], 56
    s_load_dwordx2 s[16:17], s[0:1], 64
    s_load_dwordx2 s[20:21], s[0:1], 72
    s_load_dwordx2 s[24:25], s[0:1], 80
    v_readfirstlane_b32 s32, v2
    s_lshr_b32 s34, s2, 3
    v_and_b32 v1, 63, v0
    s_lshl_b32 s38, s32, 5
    s_add_u32 s38, s38, s34
    s_cmpk_lt_u32 s38, 316
    s_cbranch_scc1 BUSY
    s_mov_b64 exec, 0
    s_cmp_eq_u32 s34, 28
    s_cbranch_scc1 PAD0
    s_cmp_eq_u32 s34, 29
    s_cbranch_scc1 PAD1
    s_cmp_eq_u32 s34, 30
    s_cbranch_scc1 PAD8
    s_branch PAD2
BUSY:
    s_and_b32 s33, s2, 7
    s_lshr_b32 s38, s2, 4
    s_lshl3_add_u32 s36, s38, s33
    s_and_b32 s35, s34, 1
    s_cmp_eq_u32 s36, 0
    s_cselect_b32 s38, 128, s36
    s_sub_u32 s37, 2048, s38
    s_mul_i32 s40, s33, 28
    s_add_u32 s40, s40, s34
    s_lshl_b32 s6, 1, 22
    s_lshl_b32 s7, 1, 17
    s_lshl_b32 s10, 27, 17
    s_mov_b32 s11, s7
    s_cmp_eq_u32 s32, 9
    s_cbranch_scc1 LOADB
    s_cmp_eq_u32 s32, 8
    s_cbranch_scc1 COMM0
    s_lshl_b32 s38, s32, 8
    s_add_u32 s41, s36, s38
    s_sub_u32 s38, s37, s38
    s_cmp_eq_u32 s35, 0
    s_cselect_b32 s42, s38, s41
    s_cselect_b32 s41, s41, s38
    s_lshl_b32 s43, s32, 11
    s_lshl_b32 s38, s35, 14
    s_add_u32 s43, s43, s38
    v_and_b32 v9, 32, v1
    v_lshlrev_b32 v8, 4, v1
    v_lshrrev_b32 v5, 2, v1
    v_xor_b32 v2, v8, v9
    s_lshl_b32 s47, s32, 8
    s_add_u32 m0, s47, 49408
    s_and_b32 s39, s32, 2
    s_lshl_b32 s39, s39, 4
    v_lshrrev_b32 v11, 2, v8
    s_movk_i32 s30, 2048
    s_mov_b32 s31, s7
    v_xor_b32 v11, s39, v11
    s_lshl_b32 s39, s41, 11
    s_lshl_b32 s42, s42, 11
    v_and_b32 v6, 3, v1
    v_and_b32 v3, 15, v1
    v_lshrrev_b32 v4, 4, v1
    v_and_b32 v5, 3, v5
    v_and_b32 v7, 1, v4
    s_lshl_b32 s48, s35, 3
    s_cmp_eq_u32 s35, 0
    s_cselect_b32 s38, 1, 63
    v_lshrrev_b32 v9, 1, v3
    v_add_u32 v9, s48, v9
    v_and_b32 v10, 1, v3
    v_cmp_ne_u32 vcc, s38, v3
    v_cvt_f32_u32 v24, v4
    s_nop 0
    v_cndmask_b32 v9, 16, v9, vcc
    v_mul_f32 v26, 4.0, v24
    v_cndmask_b32 v10, 0, v10, vcc
    v_cvt_f32_u32 v9, v9
    v_cvt_f32_u32 v10, v10
    v_add_f32 v24, v26, v26
    v_mul_f32 v9, 0x3d000000, v9
    v_mul_f32 v10, 0x3e800000, v10
    v_cos_f32 v25, v9
    v_fma_f32 v16, v9, v24, v10
    v_add_f32 v17, v16, v9
    s_waitcnt lgkmcnt(0)
    buffer_load_dword v11, s[28:31], s47 offen lds
    s_xor_b32 m0, s43, 16384
    buffer_load_dwordx4 v[28:31], v2, s[4:7], s39 offen
    buffer_load_dwordx4 v[32:35], v2, s[4:7], s39 offen offset:1024
    s_cmpk_ge_u32 s2, 224
    s_cbranch_scc1 BI0
    s_barrier
BI0:
    s_branch CMP2
COMM0:
    s_setprio 3
    v_mov_b32 v10, 0
    s_mov_b32 s41, 2392064
    v_mov_b32 v6, -1
    v_mov_b32 v7, -1
    v_mov_b32 v8, -1
    v_mov_b32 v9, -1
    s_lshr_b32 s46, s40, 2
    s_and_b32 s47, s40, 3
    v_lshlrev_b32 v15, 4, v1
    v_lshrrev_b32 v11, 5, v1
    v_and_b32 v12, 0x1f0, v15
    v_lshl_add_u32 v14, v11, 11, v12
    s_lshl3_add_u32 s38, s46, s47
    s_lshl_b32 s38, s38, 9
    s_add_u32 s38, s38, 2949120
    s_mul_i32 s39, s47, 57344
    s_lshl_b32 s43, s46, 7
    s_add_u32 s39, s39, s43
    s_add_u32 s39, s39, 2490368
    s_cmpk_lt_u32 s2, 224
    s_cselect_b32 s38, s38, 117440512
    s_cselect_b32 s39, s39, 117440512
    v_lshrrev_b32 v11, 3, v1
    v_and_b32 v12, 0x70, v15
    v_mul_u32_u24 v11, 7168, v11
    v_add_u32 v16, v11, v12
    v_lshlrev_b32 v12, 8, v1
    v_add_u32 v11, s36, v12
    v_sub_u32 v12, s37, v12
    s_cmp_eq_u32 s35, 0
    s_cselect_b64 vcc, 0, -1
    v_cndmask_b32 v13, v11, v12, vcc
    v_and_b32 v11, 7, v13
    v_and_b32 v12, 0x7f8, v13
    v_lshl_add_u32 v13, v11, 11, v12
    s_mov_b32 s42, 2359296
    v_mov_b32 v20, 0
    v_mov_b32 v21, 0
    v_mov_b32 v22, 0
    v_mov_b32 v23, 0
    ds_write_b128 v10, v[20:23] offset:58256
    s_waitcnt lgkmcnt(0)
    buffer_load_dwordx2 v[4:5], v10, s[8:11], s41 offen sc1
    s_cmpk_ge_u32 s2, 224
    s_cbranch_scc1 BI1
    s_barrier
BI1:
    s_mul_i32 s43, s36, 16384
    s_lshl_b32 s44, s35, 13
    s_add_u32 s43, s43, s44
    s_add_u32 s44, s43, 4096
    buffer_store_dwordx4 v[6:9], v15, s[8:11], s43 offen offset:0 sc1
    buffer_store_dwordx4 v[6:9], v15, s[8:11], s43 offen offset:1024 sc1
    buffer_store_dwordx4 v[6:9], v15, s[8:11], s43 offen offset:2048 sc1
    buffer_store_dwordx4 v[6:9], v15, s[8:11], s43 offen offset:3072 sc1
    buffer_store_dwordx4 v[6:9], v15, s[8:11], s44 offen offset:0 sc1
    buffer_store_dwordx4 v[6:9], v15, s[8:11], s44 offen offset:1024 sc1
    buffer_store_dwordx4 v[6:9], v15, s[8:11], s44 offen offset:2048 sc1
    buffer_store_dwordx4 v[6:9], v15, s[8:11], s44 offen offset:3072 sc1
    buffer_store_dwordx4 v[6:9], v14, s[8:11], s38 offen sc1
    buffer_store_dwordx4 v[6:9], v16, s[8:11], s39 offen sc1
    s_add_u32 s39, s39, 229376
    buffer_store_dwordx4 v[6:9], v16, s[8:11], s39 offen sc1
    s_mov_b64 exec, 0xff
    buffer_store_dwordx2 v[6:7], v13, s[8:11], s42 offen sc1
    s_mov_b64 exec, -1
    s_branch COMM
LOADB:
    s_barrier
    s_branch LOAD
RET_A_0:
    s_cmp_eq_u32 s34, 28
    s_cbranch_scc1 PAD10
    s_cmp_eq_u32 s34, 29
    s_cbranch_scc1 PAD3
    s_cmp_eq_u32 s34, 30
    s_cbranch_scc1 PAD9
    s_cmp_eq_u32 s34, 31
    s_cbranch_scc1 PAD4
RET_A_1:
    s_cmp_eq_u32 s34, 28
    s_cbranch_scc1 PAD11
RET_A_2:
    s_mov_b64 exec, -1
    s_endpgm
CMP2:
    v_cos_f32 v16, v16
    v_cos_f32 v17, v17
    v_add_f32 v25, v25, v25
    s_add_u32 s38, s38, -1
    v_cmp_ne_u32 vcc, s38, v3
    v_mov_b32 v11, 0xc2000000
    v_mov_b32 v27, 0x3a800000
    v_fma_f32 v18, v25, v17, -v16
    v_fma_f32 v19, v25, v18, -v17
    v_fma_f32 v20, v25, v19, -v18
    v_fma_f32 v21, v25, v20, -v19
    v_fma_f32 v22, v25, v21, -v20
    v_fma_f32 v23, v25, v22, -v21
    v_cndmask_b32 v11, v11, 0, vcc
    v_cvt_pk_bf16_f32 v12, v16, v17
    v_cvt_pk_bf16_f32 v13, v18, v19
    v_cvt_pk_bf16_f32 v14, v20, v21
PAD0:
    s_cbranch_execz RET_A_0
    v_cvt_pk_bf16_f32 v15, v22, v23
    s_mul_i32 s44, s36, 16384
    s_lshl3_add_u32 s38, s35, s32
    s_lshl_b32 s38, s38, 10
    s_add_u32 s44, s44, s38
    s_lshr_b32 s46, s40, 2
    s_and_b32 s45, s40, 3
    s_add_u32 s48, s48, s32
    v_lshl_add_u32 v9, v3, 5, s48
    v_mov_b32 v24, 512
    v_cmp_eq_u32 vcc, 0, v9
    s_nop 1
    v_cndmask_b32 v9, v9, v24, vcc
    v_cvt_f32_u32 v9, v9
    v_bfrev_b32 v10, 1
    v_mul_f32 v9, v27, v9
    v_mul_f32 v16, v9, v26
    v_cos_f32 v25, v9
    v_fmamk_f32 v20, v9, 0x41800000, v16
    v_add_f32 v17, v16, v9
    v_add_f32 v21, v20, v9
    v_add_f32 v25, v25, v25
    v_sin_f32 v68, v16
    v_cos_f32 v16, v16
    v_sin_f32 v69, v17
    v_cos_f32 v17, v17
    v_sin_f32 v72, v20
    v_cos_f32 v20, v20
    v_sin_f32 v73, v21
    v_cos_f32 v21, v21
    v_fma_f32 v70, v25, v69, -v68
    v_fma_f32 v18, v25, v17, -v16
    v_fma_f32 v74, v25, v73, -v72
    v_fma_f32 v22, v25, v21, -v20
    v_fma_f32 v71, v25, v70, -v69
    v_fma_f32 v19, v25, v18, -v17
    v_fma_f32 v75, v25, v74, -v73
    v_fma_f32 v23, v25, v22, -v21
    v_cvt_pk_bf16_f32 v48, v68, v69
    v_cvt_pk_bf16_f32 v44, v16, v17
    v_cvt_pk_bf16_f32 v49, v70, v71
    v_cvt_pk_bf16_f32 v45, v18, v19
    v_cvt_pk_bf16_f32 v50, v72, v73
    v_cvt_pk_bf16_f32 v46, v20, v21
    v_cvt_pk_bf16_f32 v51, v74, v75
    v_cvt_pk_bf16_f32 v47, v22, v23
    v_xor_b32_dpp v60, v48, v10 row_mirror row_mask:0xf bank_mask:0xf
    v_xor_b32 v52, 0x80008000, v48
    v_xor_b32_dpp v61, v49, v10 row_mirror row_mask:0xf bank_mask:0xf
    v_xor_b32 v53, 0x80008000, v49
    v_xor_b32_dpp v62, v50, v10 row_mirror row_mask:0xf bank_mask:0xf
    v_xor_b32 v54, 0x80008000, v50
    v_xor_b32_dpp v63, v51, v10 row_mirror row_mask:0xf bank_mask:0xf
    v_xor_b32 v55, 0x80008000, v51
    v_xor_b32_dpp v56, v44, v10 row_mirror row_mask:0xf bank_mask:0xf
    v_xor_b32_dpp v57, v45, v10 row_mirror row_mask:0xf bank_mask:0xf
    v_xor_b32_dpp v58, v46, v10 row_mirror row_mask:0xf bank_mask:0xf
    v_xor_b32_dpp v59, v47, v10 row_mirror row_mask:0xf bank_mask:0xf
    s_cmpk_lt_u32 s2, 224
    s_cbranch_scc1 NOOTH
    buffer_load_dwordx4 v2, s[4:7], s42 offen lds
    buffer_load_dwordx4 v2, s[4:7], s42 offen offset:1024 lds
NOOTH:
    s_cmp_eq_u32 s48, 0
    s_cbranch_scc0 SPEKD
    v_lshlrev_b32 v9, 5, v3
    v_sub_u32 v9, 1008, v9
    v_cvt_f32_u32 v9, v9
    v_mul_f32 v9, v27, v9
    v_mul_f32 v16, v9, v26
    v_cos_f32 v25, v9
    v_fmamk_f32 v20, v9, 0x41800000, v16
    v_add_f32 v17, v16, v9
    v_add_f32 v21, v20, v9
    v_add_f32 v25, v25, v25
    v_sin_f32 v68, v16
    v_cos_f32 v16, v16
    v_sin_f32 v69, v17
    v_cos_f32 v17, v17
    v_sin_f32 v72, v20
    v_cos_f32 v20, v20
    v_sin_f32 v73, v21
    v_cos_f32 v21, v21
    v_fma_f32 v70, v25, v69, -v68
    v_fma_f32 v18, v25, v17, -v16
    v_fma_f32 v74, v25, v73, -v72
    v_fma_f32 v22, v25, v21, -v20
    v_fma_f32 v71, v25, v70, -v69
    v_fma_f32 v19, v25, v18, -v17
    v_fma_f32 v75, v25, v74, -v73
    v_fma_f32 v23, v25, v22, -v21
    v_cvt_pk_bf16_f32 v60, v68, v69
    v_cvt_pk_bf16_f32 v56, v16, v17
    v_cvt_pk_bf16_f32 v61, v70, v71
    v_cvt_pk_bf16_f32 v57, v18, v19
    v_cvt_pk_bf16_f32 v62, v72, v73
    v_cvt_pk_bf16_f32 v58, v20, v21
    v_cvt_pk_bf16_f32 v63, v74, v75
    v_cvt_pk_bf16_f32 v59, v22, v23
SPEKD:
    v_xor_b32 v64, 0x80008000, v56
    v_xor_b32 v65, 0x80008000, v57
    v_xor_b32 v66, 0x80008000, v58
    v_xor_b32 v67, 0x80008000, v59
    v_lshrrev_b32 v9, 1, v3
    v_and_b32 v10, 1, v3
    v_cvt_f32_u32 v9, v9
    v_cvt_f32_u32 v24, v10
    v_cmp_gt_u32 vcc, 32, v1
    v_mov_b32 v68, 0xbe800000
    v_mul_f32 v9, 0x3e000000, v9
    s_cmp_eq_u32 s36, 0
    s_cbranch_scc0 BFQN
    v_lshrrev_b32 v24, 5, v1
    v_cmp_eq_u32 s[100:101], v24, v10
    v_mul_f32 v10, 0x40f00000, v9
    v_cndmask_b32 v10, v10, 0, vcc
    v_cndmask_b32 v9, -v9, v9, vcc
    v_cndmask_b32 v10, -v68, v10, s[100:101]
    v_cndmask_b32 v9, 0, v9, s[100:101]
    v_cndmask_b32 v68, 0, v68, s[100:101]
    s_branch BFGO
BFQN:
    v_mul_f32 v10, 0x3e800000, v24
    v_cndmask_b32 v68, -v68, v68, vcc
BFGO:
    v_cvt_f32_u32 v24, v7
    v_cos_f32 v25, v9
    v_mul_f32 v24, 4.0, v24
    v_fma_f32 v16, v9, v24, v10
    v_add_f32 v25, v25, v25
    v_add_f32 v17, v16, v9
    v_add_f32 v20, v16, v68
    v_add_f32 v21, v17, v68
    v_cos_f32 v16, v16
    v_cos_f32 v17, v17
    v_cos_f32 v20, v20
    v_cos_f32 v21, v21
    v_add_u32 v68, s43, v8
    v_fma_f32 v18, v25, v17, -v16
    v_fma_f32 v22, v25, v21, -v20
    v_fma_f32 v19, v25, v18, -v17
    v_fma_f32 v23, v25, v22, -v21
    v_xor_b32 v69, 16384, v68
    s_lshl_b32 s38, s32, 11
    v_lshl_add_u32 v24, v4, 9, s38
    v_lshl_add_u32 v24, v5, 6, v24
    v_lshl_add_u32 v24, v7, 5, v24
    v_lshl_add_u32 v70, v6, 3, v24
    v_xor_b32 v71, 32, v70
    s_cmp_lt_u32 s32, 4
    s_cselect_b32 s38, 0, 3
    s_lshl_b32 s39, s32, 6
    s_add_u32 s39, s39, 32768
    v_mul_u32_u24 v9, 1040, v3
    v_xor_b32 v24, s38, v4
    v_add_u32 v9, s39, v9
    v_lshl_add_u32 v72, v24, 4, v9
    v_xor_b32 v24, 2, v24
    v_lshl_add_u32 v73, v24, 4, v9
    s_lshl_b32 s38, s32, 2
    s_add_u32 s38, s38, 58112
    v_mov_b32 v74, s38
    s_lshl_b32 s39, s35, 5
    v_add_u32 v75, s39, v74
    s_mul_i32 s38, s32, 2080
    s_add_u32 s38, s38, 32768
    v_sub_u32 v24, 4, v5
    v_and_b32 v24, 3, v24
    v_xor_b32 v24, v24, v4
    v_lshl_add_u32 v9, v3, 6, s38
    v_lshl_add_u32 v76, v24, 4, v9
PAD1:
    s_cbranch_execz RET_A_0
    v_lshlrev_b32 v80, 4, v4
    v_lshlrev_b32 v24, 8, v4
    v_lshl_add_u32 v24, v3, 3, v24
    s_mul_i32 s38, s32, 1088
    s_add_u32 s38, s38, 49408
    v_add_u32 v77, s38, v24
    s_sub_u32 s38, 8, s32
    s_and_b32 s38, s38, 7
    s_mul_i32 s38, s38, 1088
    s_add_u32 s38, s38, 49412
    v_add_u32 v78, s38, v24
    s_lshl_b32 s38, s32, 7
    s_add_u32 s38, s38, 49408
    v_mul_u32_u24 v24, 1088, v5
    v_lshl_add_u32 v9, v4, 2, v6
    v_add_u32 v24, s38, v24
    v_lshl_add_u32 v79, v9, 3, v24
    v_mov_b32 v9, 0
    v_mov_b32 v10, 0
    v_mov_b32 v24, 0
    v_mov_b32 v25, 0
    v_mov_b32 v81, 0
    v_mov_b32 v82, 0
    v_mov_b32 v83, 1
    v_mov_b32 v84, 0
    s_cmpk_lt_u32 s2, 224
    s_cselect_b32 s47, 263, 7
    s_waitcnt vmcnt(0)
    ds_write_b128 v68, v[28:31]
    ds_write_b128 v68, v[32:35] offset:1024
    v_dot2c_f32_bf16 v9, 0x3f803f80, v28
    v_dot2c_f32_bf16 v10, v28, v28
    v_dot2c_f32_bf16 v9, 0x3f803f80, v29
    v_dot2c_f32_bf16 v10, v29, v29
    s_cmpk_ge_u32 s2, 224
    s_cbranch_scc1 MEETB
    s_mov_b64 exec, 1
    ds_add_rtn_u32 v85, v84, v83 offset:58256
    s_mov_b64 exec, -1
    s_waitcnt lgkmcnt(0)
    v_readfirstlane_b32 s38, v85
    s_cmp_eq_u32 s38, 7
    s_cbranch_scc1 GO0
SPIN0:
    ds_read_b32 v85, v84 offset:58256
    s_waitcnt lgkmcnt(0)
    v_cmp_eq_u32 vcc, 8, v85
    s_cbranch_vccz SPIN0
GO0:
    ds_read_b128 v[36:39], v8 offset:49408
    ds_read_b128 v[40:43], v8 offset:50432
    v_dot2c_f32_bf16 v9, 0x3f803f80, v30
    v_dot2c_f32_bf16 v10, v30, v30
    v_dot2c_f32_bf16 v9, 0x3f803f80, v31
    v_dot2c_f32_bf16 v10, v31, v31
    v_dot2c_f32_bf16 v9, 0x3f803f80, v32
    v_dot2c_f32_bf16 v10, v32, v32
    v_dot2c_f32_bf16 v9, 0x3f803f80, v33
    v_dot2c_f32_bf16 v10, v33, v33
    v_dot2c_f32_bf16 v9, 0x3f803f80, v34
    v_dot2c_f32_bf16 v10, v34, v34
    v_dot2c_f32_bf16 v9, 0x3f803f80, v35
    v_dot2c_f32_bf16 v10, v35, v35
    s_waitcnt lgkmcnt(1)
    v_dot2c_f32_bf16 v25, 0x3f803f80, v36
    v_dot2c_f32_bf16 v24, v28, v36
    v_dot2c_f32_bf16 v25, 0x3f803f80, v37
    v_dot2c_f32_bf16 v24, v29, v37
    v_dot2c_f32_bf16 v25, 0x3f803f80, v38
    v_dot2c_f32_bf16 v24, v30, v38
    v_dot2c_f32_bf16 v25, 0x3f803f80, v39
    v_dot2c_f32_bf16 v24, v31, v39
    s_waitcnt lgkmcnt(0)
    v_dot2c_f32_bf16 v25, 0x3f803f80, v40
    v_dot2c_f32_bf16 v24, v32, v40
    v_dot2c_f32_bf16 v25, 0x3f803f80, v41
    v_dot2c_f32_bf16 v24, v33, v41
    v_dot2c_f32_bf16 v25, 0x3f803f80, v42
    v_dot2c_f32_bf16 v24, v34, v42
    v_dot2c_f32_bf16 v25, 0x3f803f80, v43
    v_dot2c_f32_bf16 v24, v35, v43
    v_permlane32_swap_b32 v9, v10
    s_nop 1
    v_permlane32_swap_b32 v24, v25
    v_add_f32 v9, v9, v10
    v_add_f32 v24, v24, v25
    s_nop 1
    v_permlane16_swap_b32 v9, v24
    v_add_f32 v9, v9, v24
    s_nop 1
    v_add_f32_dpp v9, v9, v9 row_ror:8 row_mask:0xf bank_mask:0xf
    s_nop 1
    v_add_f32_dpp v9, v9, v9 row_ror:4 row_mask:0xf bank_mask:0xf
    s_nop 1
    v_add_f32_dpp v9, v9, v9 row_ror:2 row_mask:0xf bank_mask:0xf
    s_nop 1
    v_add_f32_dpp v9, v9, v9 row_ror:1 row_mask:0xf bank_mask:0xf
    s_nop 0
    v_readlane_b32 s49, v9, 0
    v_readlane_b32 s50, v9, 32
    v_readlane_b32 s51, v9, 16
    v_readlane_b32 s52, v9, 48
    v_mul_f32 v2, s49, v27
    v_mul_f32 v10, s50, v27
    v_mov_b32 v24, s51
    v_fma_f32 v10, -v2, v2, v10
    v_fma_f32 v24, -v2, s52, v24
    v_max_f32 v10, 0, v10
    v_add_f32 v10, 0x3727c5ac, v10
    v_rsq_f32 v110, v10
    s_nop 0
    v_mul_f32 v24, v24, v110
    v_ashrrev_i32 v10, 31, v24
    v_or_b32 v10, 0x80000000, v10
    v_xor_b32 v10, v24, v10
    v_and_b32 v10, 0xfffff800, v10
    v_or_b32 v10, s41, v10
    s_mov_b64 exec, 1
    ds_write2_b32 v74, v10, v2 offset0:16 offset1:40
    ds_write_b32 v75, v110
    s_mov_b64 exec, -1
    s_mov_b64 exec, 1
    ds_add_rtn_u32 v85, v84, v83 offset:58260
    s_mov_b64 exec, -1
    s_waitcnt lgkmcnt(0)
    v_readfirstlane_b32 s38, v85
    s_cmp_eq_u32 s38, s47
    s_cbranch_scc1 GO1
    s_add_u32 s47, s47, 1
SPIN1:
    ds_read_b32 v85, v84 offset:58260
    s_waitcnt lgkmcnt(0)
    v_cmp_eq_u32 vcc, s47, v85
    s_cbranch_vccz SPIN1
GO1:
    s_waitcnt vmcnt(0)
    ds_read_b128 v[86:89], v69
    ds_read_b128 v[90:93], v69 offset:1024
    ds_read_b64_tr_b16 v[94:95], v70 offset:0
    ds_read_b64_tr_b16 v[96:97], v70 offset:256
    ds_read_b64_tr_b16 v[98:99], v71 offset:0
    ds_read_b64_tr_b16 v[100:101], v71 offset:256
    ds_read_b64_tr_b16 v[102:103], v70 offset:16384
    ds_read_b64_tr_b16 v[104:105], v70 offset:16640
    ds_read_b64_tr_b16 v[106:107], v71 offset:16384
    ds_read_b64_tr_b16 v[108:109], v71 offset:16640
    s_waitcnt lgkmcnt(8)
    v_dot2c_f32_bf16 v81, 0x3f803f80, v86
    v_dot2c_f32_bf16 v82, v86, v86
    v_dot2c_f32_bf16 v81, 0x3f803f80, v87
    v_dot2c_f32_bf16 v82, v87, v87
    v_dot2c_f32_bf16 v81, 0x3f803f80, v88
    v_dot2c_f32_bf16 v82, v88, v88
    v_dot2c_f32_bf16 v81, 0x3f803f80, v89
    v_dot2c_f32_bf16 v82, v89, v89
    v_dot2c_f32_bf16 v81, 0x3f803f80, v90
    v_dot2c_f32_bf16 v82, v90, v90
    v_dot2c_f32_bf16 v81, 0x3f803f80, v91
    v_dot2c_f32_bf16 v82, v91, v91
    v_dot2c_f32_bf16 v81, 0x3f803f80, v92
    v_dot2c_f32_bf16 v82, v92, v92
    v_dot2c_f32_bf16 v81, 0x3f803f80, v93
    v_dot2c_f32_bf16 v82, v93, v93
    s_nop 2
    v_permlane32_swap_b32 v81, v82
    v_mul_f32 v112, v11, v2
    v_mul_f32 v113, v11, v2
    v_mul_f32 v114, v11, v2
    v_mul_f32 v115, v11, v2
    v_add_f32 v81, v81, v82
    v_mov_b32 v82, v81
    s_waitcnt lgkmcnt(4)
    v_mfma_f32_16x16x32_bf16 v[120:123], v[94:97], v[12:15], v[112:115]
    v_permlane16_swap_b32 v81, v82
    v_mfma_f32_16x16x32_bf16 v[124:127], v[98:101], v[12:15], v[112:115]
    v_add_f32 v81, v81, v82
    s_nop 1
    v_add_f32_dpp v81, v81, v81 row_ror:8 row_mask:0xf bank_mask:0xf
    s_nop 1
    v_add_f32_dpp v81, v81, v81 row_ror:4 row_mask:0xf bank_mask:0xf
    s_nop 1
    v_add_f32_dpp v81, v81, v81 row_ror:2 row_mask:0xf bank_mask:0xf
    s_nop 1
    v_add_f32_dpp v81, v81, v81 row_ror:1 row_mask:0xf bank_mask:0xf
    s_nop 0
PAD2:
    s_cbranch_execz RET_A_0
    v_readlane_b32 s49, v81, 0
    v_readlane_b32 s50, v81, 32
    v_cvt_pk_bf16_f32 v136, v120, v121
    v_cvt_pk_bf16_f32 v137, v122, v123
    v_cvt_pk_bf16_f32 v138, v124, v125
    v_cvt_pk_bf16_f32 v139, v126, v127
    v_mul_f32 v81, s49, v27
    v_mul_f32 v82, s50, v27
    ds_write_b128 v72, v[136:139]
    v_mul_f32 v116, v11, v81
    v_mul_f32 v117, v11, v81
    v_mul_f32 v118, v11, v81
    v_mul_f32 v119, v11, v81
    v_fma_f32 v82, -v81, v81, v82
    s_waitcnt lgkmcnt(1)
    v_mfma_f32_16x16x32_bf16 v[128:131], v[102:105], v[12:15], v[116:119]
    v_mfma_f32_16x16x32_bf16 v[132:135], v[106:109], v[12:15], v[116:119]
    v_max_f32 v82, 0, v82
    v_add_f32 v82, 0x3727c5ac, v82
    v_rsq_f32 v82, v82
    v_xor_b32 v75, 32, v75
    s_mov_b64 exec, 1
    ds_write_b32 v75, v82
    s_mov_b64 exec, -1
    v_cvt_pk_bf16_f32 v140, v128, v129
    v_cvt_pk_bf16_f32 v141, v130, v131
    v_cvt_pk_bf16_f32 v142, v132, v133
    v_cvt_pk_bf16_f32 v143, v134, v135
    ds_write_b128 v73, v[140:143] offset:512
    s_mov_b64 exec, 1
    ds_add_rtn_u32 v85, v84, v83 offset:58264
    s_mov_b64 exec, -1
    ds_read_b128 v[144:147], v76
    ds_read_b128 v[148:151], v76 offset:1040
    ds_read_b128 v[152:155], v80 offset:58112
    s_waitcnt lgkmcnt(3)
    v_readfirstlane_b32 s38, v85
    s_cmp_eq_u32 s38, 7
    s_cbranch_scc1 GO2
SPIN2:
    ds_read_b32 v85, v84 offset:58264
    ds_read_b128 v[144:147], v76
PAD3:
    s_cbranch_execz RET_A_1
    ds_read_b128 v[148:151], v76 offset:1040
    ds_read_b128 v[152:155], v80 offset:58112
    s_waitcnt lgkmcnt(3)
    v_cmp_eq_u32 vcc, 8, v85
    s_cbranch_vccz SPIN2
GO2:
    s_waitcnt lgkmcnt(1)
    s_cmp_eq_u32 s48, 0
    v_mfma_f32_16x16x32_bf16 v[10:13], v[144:147], v[44:47], 0
    v_mfma_f32_16x16x32_bf16 v[24:27], v[144:147], v[52:55], 0
    s_cbranch_scc0 SPECN
    v_mfma_f32_16x16x32_bf16 v[28:31], v[148:151], v[56:59], 0
    v_mfma_f32_16x16x32_bf16 v[32:35], v[148:151], v[60:63], 0
    s_branch SPECD
SPECN:
    v_mfma_f32_16x16x32_bf16 v[28:31], v[144:147], v[56:59], 0
    v_mfma_f32_16x16x32_bf16 v[32:35], v[144:147], v[60:63], 0
    v_mfma_f32_16x16x32_bf16 v[10:13], v[148:151], v[48:51], v[10:13]
    v_mfma_f32_16x16x32_bf16 v[24:27], v[148:151], v[44:47], v[24:27]
    v_mfma_f32_16x16x32_bf16 v[28:31], v[148:151], v[60:63], v[28:31]
    v_mfma_f32_16x16x32_bf16 v[32:35], v[148:151], v[64:67], v[32:35]
SPECD:
    s_waitcnt lgkmcnt(0)
    v_mul_f32 v16, v16, v152
    v_mul_f32 v17, v17, v153
    v_mul_f32 v18, v18, v154
    v_mul_f32 v19, v19, v155
    v_mul_f32 v20, v20, v152
    v_mul_f32 v21, v21, v153
    v_mul_f32 v22, v22, v154
    v_mul_f32 v23, v23, v155
    v_cvt_pk_bf16_f32 v36, v16, v17
    v_cvt_pk_bf16_f32 v37, v18, v19
    v_cvt_pk_bf16_f32 v38, v20, v21
    v_cvt_pk_bf16_f32 v39, v22, v23
    v_cvt_pk_bf16_f32 v40, v10, v11
    v_cvt_pk_bf16_f32 v41, v12, v13
    v_cvt_pk_bf16_f32 v42, v24, v25
    v_cvt_pk_bf16_f32 v43, v26, v27
    s_nop 1
    v_mfma_f32_16x16x32_bf16 v[144:147], v[36:39], v[40:43], 0
    v_cvt_pk_bf16_f32 v68, v28, v29
    v_cvt_pk_bf16_f32 v69, v30, v31
    v_cvt_pk_bf16_f32 v70, v32, v33
    v_cvt_pk_bf16_f32 v71, v34, v35
    s_nop 1
    v_mfma_f32_16x16x32_bf16 v[148:151], v[36:39], v[68:71], 0
    s_nop 0
    v_cvt_pk_bf16_f32 v40, v144, v145
    v_cvt_pk_bf16_f32 v41, v146, v147
    ds_write2_b32 v77, v40, v41 offset1:32
    s_nop 3
    v_cvt_pk_bf16_f32 v68, v148, v149
    v_cvt_pk_bf16_f32 v69, v150, v151
    ds_write2_b32 v78, v68, v69 offset1:32
    s_mov_b64 exec, 1
    ds_add_rtn_u32 v85, v84, v83 offset:58268
    s_mov_b64 exec, -1
    ds_read_b64_tr_b16 v[36:37], v79
    ds_read_b64_tr_b16 v[38:39], v79 offset:4352
    s_waitcnt lgkmcnt(2)
    v_readfirstlane_b32 s38, v85
    s_cmp_eq_u32 s38, 7
    s_cbranch_scc1 GO3
SPIN3:
    ds_read_b32 v85, v84 offset:58268
    ds_read_b64_tr_b16 v[36:37], v79
    ds_read_b64_tr_b16 v[38:39], v79 offset:4352
    s_waitcnt lgkmcnt(2)
    v_cmp_eq_u32 vcc, 8, v85
    s_cbranch_vccz SPIN3
GO3:
    s_and_b32 s47, s34, 15
    s_lshr_b32 s53, s34, 4
    s_lshl3_add_u32 s38, s53, s32
    s_lshl_b32 s38, s38, 7
    s_add_u32 s38, s38, s33
    v_lshl_add_u32 v2, v3, 3, s38
    v_sub_u32 v9, 2048, v2
    v_and_b32 v9, 2047, v9
    s_waitcnt lgkmcnt(0)
    buffer_store_dwordx4 v[36:39], v8, s[8:11], s44 offen sc1
    s_lshl_b32 s38, s47, 6
    v_lshl_add_u32 v73, v4, 4, s38
    v_lshl_add_u32 v81, v2, 11, v73
    v_sub_u32 v73, 2032, v73
    v_lshl_add_u32 v14, v9, 11, v73
    v_and_b32 v73, 7, v2
    v_and_b32 v74, 0x7f8, v2
    v_lshl_add_u32 v15, v73, 11, v74
    v_and_b32 v73, 7, v9
    v_and_b32 v74, 0x7f8, v9
    v_lshl_add_u32 v72, v73, 11, v74
    v_cvt_f32_u32 v75, v2
    v_lshrrev_b32 v73, 5, v1
    v_add_u32 v74, v7, v7
    v_lshl_add_u32 v73, v73, 3, v74
    v_mul_f32 v75, 0x3a000000, v75
    v_cvt_f32_u32 v73, v73
    v_mul_f32 v74, 0x41800000, v75
    v_mul_f32 v10, v75, v73
    v_cos_f32 v80, v74
    v_add_f32 v11, v10, v75
    v_fma_f32 v12, v75, 4.0, v10
    v_fma_f32 v13, v75, 4.0, v11
    v_add_f32 v80, v80, v80
    v_add_f32 v20, v10, v74
    v_add_f32 v21, v11, v74
    v_add_f32 v22, v12, v74
    v_add_f32 v23, v13, v74
    v_sin_f32 v16, v10
    v_cos_f32 v10, v10
    v_sin_f32 v17, v11
    v_cos_f32 v11, v11
    v_sin_f32 v18, v12
    v_cos_f32 v12, v12
    v_sin_f32 v19, v13
    v_cos_f32 v13, v13
    v_sin_f32 v24, v20
    v_cos_f32 v20, v20
    v_sin_f32 v25, v21
    v_cos_f32 v21, v21
    v_sin_f32 v26, v22
    v_cos_f32 v22, v22
    v_sin_f32 v27, v23
    v_cos_f32 v23, v23
    v_cvt_pk_bf16_f32 v40, v10, v16
    v_fma_f32 v10, v80, v20, -v10
    v_fma_f32 v16, v80, v24, -v16
    v_cvt_pk_bf16_f32 v41, v11, v17
    v_fma_f32 v11, v80, v21, -v11
    v_fma_f32 v17, v80, v25, -v17
    v_cvt_pk_bf16_f32 v42, v12, v18
    v_fma_f32 v12, v80, v22, -v12
    v_fma_f32 v18, v80, v26, -v18
    v_cvt_pk_bf16_f32 v43, v13, v19
    v_fma_f32 v13, v80, v23, -v13
    v_fma_f32 v19, v80, v27, -v19
    v_cvt_pk_bf16_f32 v44, v20, v24
    v_fma_f32 v20, v80, v10, -v20
    v_fma_f32 v24, v80, v16, -v24
    v_cvt_pk_bf16_f32 v45, v21, v25
    v_fma_f32 v21, v80, v11, -v21
    v_fma_f32 v25, v80, v17, -v25
    v_cvt_pk_bf16_f32 v46, v22, v26
    v_fma_f32 v22, v80, v12, -v22
    v_fma_f32 v26, v80, v18, -v26
    v_cvt_pk_bf16_f32 v47, v23, v27
    v_fma_f32 v23, v80, v13, -v23
    v_fma_f32 v27, v80, v19, -v27
    v_cvt_pk_bf16_f32 v48, v10, v16
    v_fma_f32 v10, v80, v20, -v10
    v_fma_f32 v16, v80, v24, -v16
    v_cvt_pk_bf16_f32 v49, v11, v17
    v_fma_f32 v11, v80, v21, -v11
    v_fma_f32 v17, v80, v25, -v17
    v_cvt_pk_bf16_f32 v50, v12, v18
    v_fma_f32 v12, v80, v22, -v12
    v_fma_f32 v18, v80, v26, -v18
    v_cvt_pk_bf16_f32 v51, v13, v19
    v_fma_f32 v13, v80, v23, -v13
    v_fma_f32 v19, v80, v27, -v19
    v_cvt_pk_bf16_f32 v52, v20, v24
    v_fma_f32 v20, v80, v10, -v20
    v_fma_f32 v24, v80, v16, -v24
PAD4:
    s_cbranch_execz RET_A_1
    v_cvt_pk_bf16_f32 v53, v21, v25
    v_fma_f32 v21, v80, v11, -v21
    v_fma_f32 v25, v80, v17, -v25
    v_cvt_pk_bf16_f32 v54, v22, v26
    v_fma_f32 v22, v80, v12, -v22
    v_fma_f32 v26, v80, v18, -v26
    v_cvt_pk_bf16_f32 v55, v23, v27
    v_fma_f32 v23, v80, v13, -v23
    v_fma_f32 v27, v80, v19, -v27
    v_cvt_pk_bf16_f32 v56, v10, v16
    v_fma_f32 v10, v80, v20, -v10
    v_fma_f32 v16, v80, v24, -v16
    v_cvt_pk_bf16_f32 v57, v11, v17
    v_fma_f32 v11, v80, v21, -v11
    v_fma_f32 v17, v80, v25, -v17
    v_cvt_pk_bf16_f32 v58, v12, v18
    v_fma_f32 v12, v80, v22, -v12
    v_fma_f32 v18, v80, v26, -v18
    v_cvt_pk_bf16_f32 v59, v13, v19
    v_fma_f32 v13, v80, v23, -v13
    v_fma_f32 v19, v80, v27, -v19
    v_cvt_pk_bf16_f32 v60, v20, v24
    v_fma_f32 v20, v80, v10, -v20
    v_fma_f32 v24, v80, v16, -v24
    v_cvt_pk_bf16_f32 v61, v21, v25
    v_fma_f32 v21, v80, v11, -v21
    v_fma_f32 v25, v80, v17, -v25
    v_cvt_pk_bf16_f32 v62, v22, v26
    v_fma_f32 v22, v80, v12, -v22
    v_fma_f32 v26, v80, v18, -v26
    v_cvt_pk_bf16_f32 v63, v23, v27
    v_fma_f32 v23, v80, v13, -v23
    v_fma_f32 v27, v80, v19, -v27
    v_cvt_pk_bf16_f32 v64, v10, v16
    v_cvt_pk_bf16_f32 v65, v11, v17
    v_cvt_pk_bf16_f32 v66, v12, v18
    v_cvt_pk_bf16_f32 v67, v13, v19
    v_cvt_pk_bf16_f32 v68, v20, v24
    v_cvt_pk_bf16_f32 v69, v21, v25
    v_cvt_pk_bf16_f32 v70, v22, v26
    v_cvt_pk_bf16_f32 v71, v23, v27
    v_and_b32 v73, 1, v3
    v_cmp_gt_u32 vcc, 16, v1
    v_lshlrev_b32 v73, 31, v73
    v_or_b32 v73, 0x3f803f80, v73
    v_cndmask_b32 v40, v40, v73, vcc
    s_barrier
    s_lshl_b32 s38, s33, 10
    s_mul_i32 s39, s32, 262144
    s_add_u32 s38, s38, s39
    s_lshl_b32 s54, s47, 6
    s_add_u32 s55, s54, 64
    s_add_u32 s54, s54, s38
    s_and_b32 s55, s55, 1023
    s_add_u32 s41, s54, 8192
    s_add_u32 s55, s55, s38
    v_lshrrev_b32 v18, 2, v1
    v_and_b32 v19, 1, v1
    v_bfe_u32 v20, v1, 1, 1
    v_mul_u32_u24 v73, 16384, v18
    v_lshl_add_u32 v75, v6, 4, v73
    v_lshl_add_u32 v80, v19, 4, v73
    s_mul_i32 s38, s32, 3072
    v_lshl_add_u32 v73, v18, 1, v19
    v_mul_u32_u24 v73, 96, v73
    v_add_u32 v12, s38, v73
    v_mad_u32_u24 v10, v20, 24, v12
    v_lshl_add_u32 v11, v20, 3, v12
    v_lshrrev_b32 v73, 5, v1
    v_lshl_add_u32 v74, v7, 2, v5
    v_lshl_add_u32 v73, v73, 4, v74
    v_mul_u32_u24 v73, 96, v73
    v_lshl_add_u32 v13, v6, 3, v73
    s_cmp_eq_u32 s47, 0
    s_cselect_b32 s38, 0x0908, 0
    s_xor_b32 s38, s38, 0x07060504
    v_cmp_eq_u32 vcc, 1, v20
    v_mov_b32 v73, 0x07060100
    v_mov_b32 v17, 0x07060504
    v_mov_b32 v16, s38
    v_cndmask_b32 v17, v17, v73, vcc
    v_cndmask_b32 v16, v16, v73, vcc
    v_lshrrev_b32 v73, 1, v5
    v_lshl_add_u32 v73, v7, 1, v73
    v_lshlrev_b32 v74, 10, v4
    v_lshl_add_u32 v74, v5, 7, v74
    v_lshl_add_u32 v74, v6, 3, v74
    v_lshl_add_u32 v74, v73, 5, v74
    s_lshl_b32 s38, s32, 12
    s_add_u32 s38, s38, 126976
    v_add_u32 v22, s38, v74
    s_and_b32 s38, s32, 3
    s_lshl_b32 s38, s38, 5
    v_xor_b32 v74, s38, v74
    s_lshr_b32 s39, s32, 2
    s_lshl_b32 s38, s39, 15
    s_add_u32 s38, s38, 61440
    v_add_u32 v21, s38, v74
    v_lshlrev_b32 v73, 4, v19
    v_lshl_add_u32 v23, v4, 5, v73
    s_lshl_b32 s52, s46, 12
    s_add_u32 s52, s52, 2949120
    s_lshl_b32 s38, s45, 9
    s_add_u32 s44, s52, s38
    s_lshl_b32 s38, s39, 8
    s_add_u32 s44, s44, s38
    s_bfe_u32 s38, s32, 0x10001
    s_lshl_b32 s38, s38, 11
    s_add_u32 s44, s44, s38
    s_and_b32 s38, s32, 1
    s_lshl_b32 s38, s38, 7
    s_add_u32 s44, s44, s38
    s_cmp_lt_u32 s2, 224
    s_cselect_b32 s44, s44, 117440512
    s_lshl_b32 s38, s39, 11
    s_add_u32 s52, s52, s38
    v_lshl_add_u32 v73, v20, 8, v73
    v_lshl_add_u32 v73, v4, 6, v73
    v_and_b32 v74, 1, v5
    v_lshl_add_u32 v73, v74, 5, v73
    v_lshrrev_b32 v74, 1, v5
    v_lshl_add_u32 v24, v74, 10, v73
    v_mul_u32_u24 v73, 229376, v19
    v_lshl_add_u32 v73, v7, 5, v73
    v_lshrrev_b32 v74, 5, v1
    v_lshl_add_u32 v25, v74, 4, v73
    s_and_b32 s38, s32, 3
    s_lshl2_add_u32 s38, s45, s38
    s_mul_i32 s42, s38, 14336
    s_lshl1_add_u32 s38, s46, s39
    s_lshl_b32 s38, s38, 6
    s_add_u32 s42, s42, s38
    s_add_u32 s42, s42, 2490368
    s_mov_b32 s50, 0x00030003
    s_mov_b32 s51, 0x00030003
    s_mov_b32 s43, 2359296
    s_mov_b32 s48, 0
    s_mov_b32 s26, s6
    s_mov_b32 s27, s7
    v_mov_b32 v73, 0
    s_mov_b64 exec, 0
    s_cmp_eq_u32 s32, 0
    s_cbranch_scc1 PAD5
    s_cmp_eq_u32 s32, 1
    s_cbranch_scc1 PAD6
    s_cmp_eq_u32 s32, 2
    s_cbranch_scc1 PAD7
RET_B_0:
    s_mov_b64 exec, -1
    s_barrier
    s_barrier
    ds_read_b128 v[90:93], v8 offset:58368
    ds_read_b64_tr_b16 v[76:77], v21 offset:0
    ds_read_b64_tr_b16 v[78:79], v21 offset:512
    ds_read_b64 v[36:37], v73 offset:58240
    ds_read_b64_tr_b16 v[122:123], v21 offset:4096
    ds_read_b64_tr_b16 v[124:125], v21 offset:4608
    ds_read_b64_tr_b16 v[126:127], v21 offset:8192
    ds_read_b64_tr_b16 v[128:129], v21 offset:8704
    ds_read_b64_tr_b16 v[130:131], v21 offset:12288
    ds_read_b64_tr_b16 v[132:133], v21 offset:12800
PAD5:
    s_cbranch_execz RET_B_0
    s_waitcnt lgkmcnt(9)
    v_mov_b32_dpp v94, v90 row_shl:2 row_mask:0xf bank_mask:0xf
    v_mov_b32_dpp v95, v91 row_shl:2 row_mask:0xf bank_mask:0xf
    v_mov_b32_dpp v96, v92 row_shl:2 row_mask:0xf bank_mask:0xf
    v_mov_b32_dpp v97, v93 row_shl:2 row_mask:0xf bank_mask:0xf
    s_waitcnt lgkmcnt(7)
    v_mfma_f32_16x16x32_bf16 v[134:137], v[76:79], v[90:93], 0
    ds_read_b64_tr_b16 v[76:77], v21 offset:16384
    ds_read_b64_tr_b16 v[78:79], v21 offset:16896
    v_mov_b32_dpp v98, v90 row_shl:4 row_mask:0xf bank_mask:0xf
    v_mov_b32_dpp v99, v91 row_shl:4 row_mask:0xf bank_mask:0xf
    v_mov_b32_dpp v100, v92 row_shl:4 row_mask:0xf bank_mask:0xf
    v_mov_b32_dpp v101, v93 row_shl:4 row_mask:0xf bank_mask:0xf
    s_waitcnt lgkmcnt(6)
    v_mfma_f32_16x16x32_bf16 v[138:141], v[122:125], v[94:97], 0
    ds_read_b64_tr_b16 v[122:123], v21 offset:20480
    ds_read_b64_tr_b16 v[124:125], v21 offset:20992
    v_mov_b32_dpp v102, v90 row_shl:6 row_mask:0xf bank_mask:0xf
    v_mov_b32_dpp v103, v91 row_shl:6 row_mask:0xf bank_mask:0xf
    v_mov_b32_dpp v104, v92 row_shl:6 row_mask:0xf bank_mask:0xf
    v_mov_b32_dpp v105, v93 row_shl:6 row_mask:0xf bank_mask:0xf
    s_waitcnt lgkmcnt(6)
    v_mfma_f32_16x16x32_bf16 v[134:137], v[126:129], v[98:101], v[134:137]
    ds_read_b64_tr_b16 v[126:127], v21 offset:24576
    ds_read_b64_tr_b16 v[128:129], v21 offset:25088
    v_mov_b32_dpp v106, v90 row_shl:8 row_mask:0xf bank_mask:0xf
    v_mov_b32_dpp v107, v91 row_shl:8 row_mask:0xf bank_mask:0xf
    v_mov_b32_dpp v108, v92 row_shl:8 row_mask:0xf bank_mask:0xf
    v_mov_b32_dpp v109, v93 row_shl:8 row_mask:0xf bank_mask:0xf
    s_waitcnt lgkmcnt(6)
    v_mfma_f32_16x16x32_bf16 v[138:141], v[130:133], v[102:105], v[138:141]
    ds_read_b64_tr_b16 v[130:131], v21 offset:28672
    ds_read_b64_tr_b16 v[132:133], v21 offset:29184
    v_mov_b32_dpp v110, v90 row_shl:10 row_mask:0xf bank_mask:0xf
    v_mov_b32_dpp v111, v91 row_shl:10 row_mask:0xf bank_mask:0xf
    v_mov_b32_dpp v112, v92 row_shl:10 row_mask:0xf bank_mask:0xf
    v_mov_b32_dpp v113, v93 row_shl:10 row_mask:0xf bank_mask:0xf
    s_waitcnt lgkmcnt(6)
    v_mfma_f32_16x16x32_bf16 v[134:137], v[76:79], v[106:109], v[134:137]
    v_mov_b32_dpp v114, v90 row_shl:12 row_mask:0xf bank_mask:0xf
    v_mov_b32_dpp v115, v91 row_shl:12 row_mask:0xf bank_mask:0xf
    v_mov_b32_dpp v116, v92 row_shl:12 row_mask:0xf bank_mask:0xf
    v_mov_b32_dpp v117, v93 row_shl:12 row_mask:0xf bank_mask:0xf
    s_waitcnt lgkmcnt(4)
    v_mfma_f32_16x16x32_bf16 v[138:141], v[122:125], v[110:113], v[138:141]
    v_mov_b32_dpp v118, v90 row_shl:14 row_mask:0xf bank_mask:0xf
    v_mov_b32_dpp v119, v91 row_shl:14 row_mask:0xf bank_mask:0xf
    v_mov_b32_dpp v120, v92 row_shl:14 row_mask:0xf bank_mask:0xf
    v_mov_b32_dpp v121, v93 row_shl:14 row_mask:0xf bank_mask:0xf
    s_waitcnt lgkmcnt(2)
    v_mfma_f32_16x16x32_bf16 v[134:137], v[126:129], v[114:117], v[134:137]
    s_waitcnt lgkmcnt(0)
    v_mfma_f32_16x16x32_bf16 v[138:141], v[130:133], v[118:121], v[138:141]
    v_cmp_eq_u32 s[34:35], v2, v36
    v_cmp_eq_u32 vcc, v2, v37
    v_cmp_eq_u32 s[36:37], v9, v36
    v_cmp_eq_u32 s[46:47], v9, v37
    v_lshlrev_b32 v74, 5, v4
    v_cndmask_b32 v2, 0, 64, vcc
    v_cndmask_b32 v9, 0, 64, s[46:47]
    s_nop 0
    v_add_f32 v134, v134, v138
    v_add_f32 v135, v135, v139
    v_add_f32 v136, v136, v140
    v_add_f32 v137, v137, v141
    s_mov_b64 exec, s[50:51]
    buffer_store_dwordx4 v[134:137], v23, s[8:11], s44 offen sc1
    s_mov_b64 exec, -1
    s_barrier
    buffer_load_dwordx4 v[26:29], v75, s[8:11], s54 offen
    buffer_load_dwordx4 v[30:33], v75, s[8:11], s41 offen
    buffer_load_dword v20, v80, s[8:11], s55 offen
    buffer_load_dwordx2 v[18:19], v15, s[8:11], s43 offen sc1
    buffer_load_dwordx2 v[34:35], v72, s[8:11], s43 offen sc1
    s_or_b64 s[34:35], s[34:35], vcc
    s_or_b64 s[36:37], s[36:37], s[46:47]
    v_lshl_add_u32 v2, v2, 1, v74
    v_sub_u32 v74, 96, v74
    v_lshl_add_u32 v9, v9, 1, v74
    s_waitcnt vmcnt(0)
UCHK:
    v_max3_u32 v73, v26, v27, v28
    v_max3_u32 v74, v30, v31, v32
    v_max3_u32 v73, v73, v29, v33
    v_max3_u32 v74, v74, v20, v18
    v_max3_u32 v73, v73, v19, v34
    v_max3_u32 v73, v73, v74, v35
    v_cmp_eq_u32 vcc, -1, v73
    s_cbranch_vccnz URETRY
UOK:
    buffer_load_dwordx4 v[90:93], v24, s[8:11], s52 offen
    buffer_load_dwordx4 v[94:97], v24, s[8:11], s52 offen offset:512
    v_perm_b32 v73, v26, v30, v16
    v_perm_b32 v30, v30, v26, v17
    ds_write_b32 v12, v20 offset:32
    v_mov_b32 v26, v73
    ds_write_b64 v10, v[28:29] offset:40
    ds_write_b64 v11, v[32:33] offset:48
    ds_write_b64 v11, v[30:31] offset:8
    ds_write_b64 v10, v[26:27]
    s_cmp_ge_u32 s2, 224
    s_cbranch_scc1 NODN
    v_mov_b32 v106, 0
    v_xor_b32 v107, 32, v22
    v_xor_b32 v108, 64, v22
    v_xor_b32 v109, 96, v22
    ds_read_b32 v8, v106 offset:58252
    ds_read_b64_tr_b16 v[36:37], v22 offset:0
    ds_read_b64_tr_b16 v[38:39], v22 offset:512
    ds_read_b64_tr_b16 v[76:77], v107 offset:0
    ds_read_b64_tr_b16 v[78:79], v107 offset:512
    ds_read_b64_tr_b16 v[98:99], v108 offset:0
    ds_read_b64_tr_b16 v[100:101], v108 offset:512
    ds_read_b64_tr_b16 v[102:103], v109 offset:0
    ds_read_b64_tr_b16 v[104:105], v109 offset:512
    s_mov_b32 s48, 0
    s_waitcnt vmcnt(0)
HCHK:
    v_add_f32 v90, v90, v94
    v_add_f32 v91, v91, v95
    v_add_f32 v92, v92, v96
    v_add_f32 v93, v93, v97
    v_add_f32_dpp v90, v90, v90 row_ror:8 row_mask:0xf bank_mask:0xf
    v_add_f32_dpp v91, v91, v91 row_ror:8 row_mask:0xf bank_mask:0xf
    v_add_f32_dpp v92, v92, v92 row_ror:8 row_mask:0xf bank_mask:0xf
    v_add_f32_dpp v93, v93, v93 row_ror:8 row_mask:0xf bank_mask:0xf
    v_cmp_u_f32 vcc, v90, v91
    v_cmp_u_f32 s[46:47], v92, v93
    v_mov_b32_dpp v130, v90 quad_perm:[0,1,0,1] row_mask:0xf bank_mask:0xf
    v_mov_b32_dpp v131, v91 quad_perm:[0,1,0,1] row_mask:0xf bank_mask:0xf
    v_mov_b32_dpp v132, v92 quad_perm:[0,1,0,1] row_mask:0xf bank_mask:0xf
    v_mov_b32_dpp v133, v93 quad_perm:[0,1,0,1] row_mask:0xf bank_mask:0xf
    s_or_b64 vcc, vcc, s[46:47]
    s_cbranch_scc1 HRETRY
HOK:
    buffer_load_dwordx4 v[82:85], v81, s[4:7], 0 offen
    buffer_load_dwordx4 v[86:89], v14, s[4:7], 0 offen
    v_mul_f32 v126, 0xbfb8aa3b, v130
    v_mul_f32 v127, 0xbfb8aa3b, v131
    v_mul_f32 v128, 0xbfb8aa3b, v132
    v_mul_f32 v129, 0xbfb8aa3b, v133
    v_exp_f32 v126, v126
    v_mul_f32_dpp v130, v90, v130 quad_perm:[2,3,2,3] row_mask:0xf bank_mask:0xf
    v_exp_f32 v127, v127
    v_mul_f32_dpp v131, v91, v131 quad_perm:[2,3,2,3] row_mask:0xf bank_mask:0xf
    v_exp_f32 v128, v128
    v_mul_f32_dpp v132, v92, v132 quad_perm:[2,3,2,3] row_mask:0xf bank_mask:0xf
    v_exp_f32 v129, v129
    v_mul_f32_dpp v133, v93, v133 quad_perm:[2,3,2,3] row_mask:0xf bank_mask:0xf
    v_add_f32 v126, 1.0, v126
    v_add_f32 v127, 1.0, v127
    v_add_f32 v128, 1.0, v128
    v_add_f32 v129, 1.0, v129
    v_rcp_f32 v126, v126
    v_rcp_f32 v127, v127
    v_rcp_f32 v128, v128
PAD6:
    s_cbranch_execz RET_B_0
    v_rcp_f32 v129, v129
    s_mov_b32 s48, 0
    s_waitcnt lgkmcnt(8)
DCHK:
    v_cmp_eq_u32 vcc, -1, v8
    s_cbranch_vccnz DRETRY
DOK:
    v_mul_f32 v130, v130, v126
    v_mul_f32 v131, v131, v127
    v_mul_f32 v132, v132, v128
    v_mul_f32 v133, v133, v129
    v_cvt_pk_bf16_f32 v138, v130, v131
    v_cvt_pk_bf16_f32 v139, v132, v133
    s_add_u32 s52, s42, 7168
    v_mov_b32_dpp v140, v138 row_shl:4 row_mask:0xf bank_mask:0xf
    v_mov_b32_dpp v141, v139 row_shl:4 row_mask:0xf bank_mask:0xf
    s_waitcnt lgkmcnt(6)
    s_nop 0
    v_mfma_f32_16x16x32_bf16 v[110:113], v[36:39], v[138:141], 0
    s_waitcnt lgkmcnt(4)
    v_mfma_f32_16x16x32_bf16 v[114:117], v[76:79], v[138:141], 0
    s_waitcnt lgkmcnt(2)
    v_mfma_f32_16x16x32_bf16 v[118:121], v[98:101], v[138:141], 0
    s_waitcnt lgkmcnt(0)
    v_mfma_f32_16x16x32_bf16 v[122:125], v[102:105], v[138:141], 0
    s_nop 1
    v_cvt_pk_bf16_f32 v126, v110, v111
    v_cvt_pk_bf16_f32 v127, v112, v113
    v_cvt_pk_bf16_f32 v128, v114, v115
    v_cvt_pk_bf16_f32 v129, v116, v117
    s_nop 0
    v_permlane16_swap_b32 v126, v128
    v_permlane16_swap_b32 v127, v129
    s_mov_b64 exec, s[50:51]
    buffer_store_dwordx4 v[126:129], v25, s[8:11], s42 offen sc1
    s_mov_b64 exec, -1
    v_cvt_pk_bf16_f32 v130, v118, v119
    v_cvt_pk_bf16_f32 v131, v120, v121
    v_cvt_pk_bf16_f32 v132, v122, v123
    v_cvt_pk_bf16_f32 v133, v124, v125
    s_nop 0
    v_permlane16_swap_b32 v130, v132
    v_permlane16_swap_b32 v131, v133
    s_mov_b64 exec, s[50:51]
    buffer_store_dwordx4 v[130:133], v25, s[8:11], s52 offen sc1
    s_mov_b64 exec, -1
DNJ:
    s_barrier
    ds_read_b64_tr_b16 v[76:77], v13 offset:0
    ds_read_b64_tr_b16 v[78:79], v13 offset:768
    ds_read_b64_tr_b16 v[90:91], v13 offset:40
    ds_read_b64_tr_b16 v[92:93], v13 offset:808
    ds_read_b64_tr_b16 v[94:95], v13 offset:8
    ds_read_b64_tr_b16 v[96:97], v13 offset:776
    ds_read_b64_tr_b16 v[98:99], v13 offset:3072
    ds_read_b64_tr_b16 v[100:101], v13 offset:3840
    ds_read_b64_tr_b16 v[102:103], v13 offset:3112
    ds_read_b64_tr_b16 v[104:105], v13 offset:3880
    ds_read_b64_tr_b16 v[106:107], v13 offset:3080
    ds_read_b64_tr_b16 v[108:109], v13 offset:3848
    s_waitcnt lgkmcnt(10)
    v_mfma_f32_16x16x32_bf16 v[26:29], v[76:79], v[40:43], 0
    s_waitcnt lgkmcnt(8)
    v_mfma_f32_16x16x32_bf16 v[30:33], v[90:93], v[40:43], 0
    s_waitcnt lgkmcnt(6)
    v_mfma_f32_16x16x32_bf16 v[36:39], v[94:97], v[40:43], 0
    ds_read_b64_tr_b16 v[76:77], v13 offset:6144
    ds_read_b64_tr_b16 v[78:79], v13 offset:6912
    ds_read_b64_tr_b16 v[90:91], v13 offset:6184
    ds_read_b64_tr_b16 v[92:93], v13 offset:6952
    ds_read_b64_tr_b16 v[94:95], v13 offset:6152
    ds_read_b64_tr_b16 v[96:97], v13 offset:6920
    s_waitcnt lgkmcnt(10)
    v_mfma_f32_16x16x32_bf16 v[26:29], v[98:101], v[44:47], v[26:29]
    s_waitcnt lgkmcnt(8)
    v_mfma_f32_16x16x32_bf16 v[30:33], v[102:105], v[44:47], v[30:33]
    s_waitcnt lgkmcnt(6)
    v_mfma_f32_16x16x32_bf16 v[36:39], v[106:109], v[44:47], v[36:39]
    ds_read_b64_tr_b16 v[98:99], v13 offset:9216
    ds_read_b64_tr_b16 v[100:101], v13 offset:9984
    ds_read_b64_tr_b16 v[102:103], v13 offset:9256
    ds_read_b64_tr_b16 v[104:105], v13 offset:10024
    ds_read_b64_tr_b16 v[106:107], v13 offset:9224
    ds_read_b64_tr_b16 v[108:109], v13 offset:9992
    s_waitcnt lgkmcnt(10)
    v_mfma_f32_16x16x32_bf16 v[26:29], v[76:79], v[48:51], v[26:29]
    s_waitcnt lgkmcnt(8)
    v_mfma_f32_16x16x32_bf16 v[30:33], v[90:93], v[48:51], v[30:33]
    s_waitcnt lgkmcnt(6)
    v_mfma_f32_16x16x32_bf16 v[36:39], v[94:97], v[48:51], v[36:39]
    ds_read_b64_tr_b16 v[76:77], v13 offset:12288
    ds_read_b64_tr_b16 v[78:79], v13 offset:13056
    ds_read_b64_tr_b16 v[90:91], v13 offset:12328
    ds_read_b64_tr_b16 v[92:93], v13 offset:13096
    ds_read_b64_tr_b16 v[94:95], v13 offset:12296
    ds_read_b64_tr_b16 v[96:97], v13 offset:13064
    s_waitcnt lgkmcnt(10)
    v_mfma_f32_16x16x32_bf16 v[26:29], v[98:101], v[52:55], v[26:29]
    s_waitcnt lgkmcnt(8)
    v_mfma_f32_16x16x32_bf16 v[30:33], v[102:105], v[52:55], v[30:33]
    s_waitcnt lgkmcnt(6)
    v_mfma_f32_16x16x32_bf16 v[36:39], v[106:109], v[52:55], v[36:39]
    ds_read_b64_tr_b16 v[98:99], v13 offset:15360
    ds_read_b64_tr_b16 v[100:101], v13 offset:16128
    ds_read_b64_tr_b16 v[102:103], v13 offset:15400
    ds_read_b64_tr_b16 v[104:105], v13 offset:16168
    ds_read_b64_tr_b16 v[106:107], v13 offset:15368
    ds_read_b64_tr_b16 v[108:109], v13 offset:16136
    s_waitcnt lgkmcnt(10)
    v_mfma_f32_16x16x32_bf16 v[26:29], v[76:79], v[56:59], v[26:29]
    s_waitcnt lgkmcnt(8)
    v_mfma_f32_16x16x32_bf16 v[30:33], v[90:93], v[56:59], v[30:33]
    s_waitcnt lgkmcnt(6)
    v_mfma_f32_16x16x32_bf16 v[36:39], v[94:97], v[56:59], v[36:39]
    ds_read_b64_tr_b16 v[76:77], v13 offset:18432
    ds_read_b64_tr_b16 v[78:79], v13 offset:19200
    ds_read_b64_tr_b16 v[90:91], v13 offset:18472
    ds_read_b64_tr_b16 v[92:93], v13 offset:19240
    ds_read_b64_tr_b16 v[94:95], v13 offset:18440
    ds_read_b64_tr_b16 v[96:97], v13 offset:19208
    s_waitcnt lgkmcnt(10)
    v_mfma_f32_16x16x32_bf16 v[26:29], v[98:101], v[60:63], v[26:29]
    s_waitcnt lgkmcnt(8)
    v_mfma_f32_16x16x32_bf16 v[30:33], v[102:105], v[60:63], v[30:33]
    s_waitcnt lgkmcnt(6)
    v_mfma_f32_16x16x32_bf16 v[36:39], v[106:109], v[60:63], v[36:39]
    ds_read_b64_tr_b16 v[98:99], v13 offset:21504
    ds_read_b64_tr_b16 v[100:101], v13 offset:22272
    ds_read_b64_tr_b16 v[102:103], v13 offset:21544
    ds_read_b64_tr_b16 v[104:105], v13 offset:22312
    ds_read_b64_tr_b16 v[106:107], v13 offset:21512
    ds_read_b64_tr_b16 v[108:109], v13 offset:22280
    s_waitcnt vmcnt(2)
    v_lshlrev_b32 v40, 16, v82
    v_and_b32 v41, 0xffff0000, v82
    v_lshlrev_b32 v42, 16, v83
    v_and_b32 v43, 0xffff0000, v83
    v_lshlrev_b32 v44, 16, v84
    v_and_b32 v45, 0xffff0000, v84
    v_lshlrev_b32 v46, 16, v85
    v_and_b32 v47, 0xffff0000, v85
    v_lshlrev_b32 v48, 16, v86
    v_and_b32 v49, 0xffff0000, v86
    v_lshlrev_b32 v50, 16, v87
    v_and_b32 v51, 0xffff0000, v87
    v_lshlrev_b32 v52, 16, v88
    v_and_b32 v53, 0xffff0000, v88
    v_lshlrev_b32 v54, 16, v89
    v_and_b32 v55, 0xffff0000, v89
    v_mul_f32 v19, -v18, v19
    v_add_f32 v18, 1.0, v18
    v_mul_f32 v35, -v34, v35
    v_add_f32 v34, 1.0, v34
    v_fma_f32 v40, v40, v18, v19
    v_fma_f32 v41, v41, v18, v19
    v_fma_f32 v42, v42, v18, v19
    v_fma_f32 v43, v43, v18, v19
    v_fma_f32 v44, v44, v18, v19
PAD7:
    s_cbranch_execz RET_B_0
    v_fma_f32 v45, v45, v18, v19
    v_fma_f32 v46, v46, v18, v19
    v_fma_f32 v47, v47, v18, v19
    v_fma_f32 v48, v48, v34, v35
    v_fma_f32 v49, v49, v34, v35
    v_fma_f32 v50, v50, v34, v35
    v_fma_f32 v51, v51, v34, v35
    v_fma_f32 v52, v52, v34, v35
    v_fma_f32 v53, v53, v34, v35
    v_fma_f32 v54, v54, v34, v35
    v_fma_f32 v55, v55, v34, v35
    s_waitcnt lgkmcnt(10)
    v_mfma_f32_16x16x32_bf16 v[26:29], v[76:79], v[64:67], v[26:29]
    s_waitcnt lgkmcnt(8)
    v_mfma_f32_16x16x32_bf16 v[30:33], v[90:93], v[64:67], v[30:33]
    s_waitcnt lgkmcnt(6)
    v_mfma_f32_16x16x32_bf16 v[36:39], v[94:97], v[64:67], v[36:39]
    s_waitcnt lgkmcnt(4)
    v_mfma_f32_16x16x32_bf16 v[26:29], v[98:101], v[68:71], v[26:29]
    s_waitcnt lgkmcnt(2)
    v_mfma_f32_16x16x32_bf16 v[30:33], v[102:105], v[68:71], v[30:33]
    s_waitcnt lgkmcnt(0)
    v_mfma_f32_16x16x32_bf16 v[36:39], v[106:109], v[68:71], v[36:39]
    v_bfrev_b32 v73, 1
    v_cndmask_b32 v81, v81, v73, s[34:35]
    v_cndmask_b32 v14, v14, v73, s[36:37]
    s_nop 0
    v_add_f32 v40, v40, v26
    v_add_f32 v41, v41, v27
    v_add_f32 v42, v42, v28
    v_add_f32 v43, v43, v29
    v_add_f32 v53, v53, v29
    v_add_f32 v54, v54, v28
    v_add_f32 v55, v55, v27
    v_add_f32 v44, v44, v30
    v_add_f32 v49, v49, v33
    v_add_f32 v45, v45, v31
    v_add_f32 v50, v50, v32
    v_add_f32 v46, v46, v32
    v_add_f32 v51, v51, v31
    v_add_f32 v47, v47, v33
    v_add_f32 v52, v52, v30
    v_add_f32 v48, v48, v36
    v_cvt_pk_bf16_f32 v16, v40, v41
    v_cvt_pk_bf16_f32 v17, v42, v43
    v_cvt_pk_bf16_f32 v18, v44, v45
    v_cvt_pk_bf16_f32 v19, v46, v47
    v_cvt_pk_bf16_f32 v56, v48, v49
    v_cvt_pk_bf16_f32 v57, v50, v51
    v_cvt_pk_bf16_f32 v58, v52, v53
    v_cvt_pk_bf16_f32 v59, v54, v55
    s_or_b64 vcc, s[34:35], s[36:37]
    s_cbranch_scc1 FINW
FIND:
COUT:
    buffer_store_dwordx4 v[16:19], v81, s[24:27], 0 offen
    buffer_store_dwordx4 v[56:59], v14, s[24:27], 0 offen
END:
    s_endpgm
URETRY:
    s_add_u32 s48, s48, 1
    s_cmp_ge_u32 s48, 4096
    s_cbranch_scc1 UOK
    buffer_load_dwordx4 v[26:29], v75, s[8:11], s54 offen sc1
    buffer_load_dwordx4 v[30:33], v75, s[8:11], s41 offen sc1
    buffer_load_dword v20, v80, s[8:11], s55 offen sc1
    buffer_load_dwordx2 v[18:19], v15, s[8:11], s43 offen sc1
    buffer_load_dwordx2 v[34:35], v72, s[8:11], s43 offen sc1
    s_waitcnt vmcnt(0)
    s_branch UCHK
HRETRY:
    s_add_u32 s48, s48, 1
    s_cmp_ge_u32 s48, 4096
    s_cbranch_scc1 HOK
    buffer_load_dwordx4 v[90:93], v24, s[8:11], s52 offen sc1
    buffer_load_dwordx4 v[94:97], v24, s[8:11], s52 offen offset:512 sc1
    s_waitcnt vmcnt(0)
    s_branch HCHK
DRETRY:
    s_add_u32 s48, s48, 1
    s_cmp_ge_u32 s48, 65536
    s_nop 1
    s_cbranch_scc1 DOK
    ds_read_b32 v8, v106 offset:58252
    ds_read_b64_tr_b16 v[36:37], v22 offset:0
    ds_read_b64_tr_b16 v[38:39], v22 offset:512
    ds_read_b64_tr_b16 v[76:77], v107 offset:0
    ds_read_b64_tr_b16 v[78:79], v107 offset:512
    ds_read_b64_tr_b16 v[98:99], v108 offset:0
    ds_read_b64_tr_b16 v[100:101], v108 offset:512
    ds_read_b64_tr_b16 v[102:103], v109 offset:0
    ds_read_b64_tr_b16 v[104:105], v109 offset:512
    s_waitcnt lgkmcnt(0)
    s_branch DCHK
NODN:
    buffer_load_dwordx4 v[82:85], v81, s[4:7], 0 offen
    buffer_load_dwordx4 v[86:89], v14, s[4:7], 0 offen
    s_waitcnt vmcnt(0) lgkmcnt(0)
    s_branch DNJ
MEETB:
    s_barrier
    s_nop 1
    s_branch GO0
FINW:
    s_mov_b64 exec, s[34:35]
    ds_write_b128 v2, v[40:43] offset:60416
    ds_write_b128 v2, v[44:47] offset:60432
    s_mov_b64 exec, s[36:37]
    ds_write_b128 v9, v[48:51] offset:60672
    ds_write_b128 v9, v[52:55] offset:60688
    s_mov_b64 exec, -1
    s_waitcnt lgkmcnt(0)
    s_branch FIND
COMM:
PAD8:
    s_cbranch_execz RET_A_0
    v_lshlrev_b32 v11, 3, v1
    ds_write_b64 v11, v[6:7] offset:60416
    s_mov_b32 s26, s6
    s_mov_b32 s27, s7
    v_lshlrev_b32 v14, 12, v1
    s_and_b32 s3, s2, 3
    s_lshl_b32 s43, s3, 10
    s_and_b32 s3, s2, 0xfc
    s_lshl2_add_u32 s43, s3, s43
    s_add_u32 s43, s43, 3407872
    s_lshl_b32 s44, s33, 12
    s_add_u32 s44, s44, 3407872
    s_mov_b32 s45, 0
    s_lshl_b32 s38, s35, 5
    v_lshlrev_b32 v18, 2, v1
    v_add_u32 v17, s38, v18
    v_lshrrev_b32 v11, 4, v1
    v_bfe_u32 v12, v1, 1, 3
    v_lshl_add_u32 v11, v12, 2, v11
    s_lshl_b32 s38, s47, 9
    v_lshl_add_u32 v16, v11, 4, s38
    s_mov_b32 s56, 0xaaaaaaaa
    s_mov_b32 s57, 0xaaaaaaaa
    s_cmpk_lt_u32 s2, 224
    s_cbranch_scc1 CB0
    s_barrier
CB0:
    s_waitcnt vmcnt(12)
    v_add_u32 v4, 2, v4
    v_or_b32 v4, 1, v4
    v_readfirstlane_b32 s49, v5
    v_readfirstlane_b32 s48, v4
    s_waitcnt lgkmcnt(0)
CSPIN:
    ds_read_b32 v12, v10 offset:58260
    ds_read_b128 v[24:27], v10 offset:58176
    ds_read_b128 v[28:31], v10 offset:58192
    ds_read_b32 v20, v17 offset:58112
    ds_read_b32 v21, v18 offset:58272
    s_waitcnt lgkmcnt(4)
    v_and_b32 v12, 0xff, v12
    v_cmp_eq_u32 vcc, 8, v12
    s_cbranch_vccz CSPIN
    s_waitcnt lgkmcnt(3)
    v_max3_u32 v19, v24, v25, v26
    v_med3_u32 v23, v24, v25, v26
    s_waitcnt lgkmcnt(2)
    v_max3_u32 v32, v27, v28, v29
    v_med3_u32 v33, v27, v28, v29
    v_med3_u32 v12, v19, v32, v30
    v_max3_u32 v19, v19, v32, v30
    v_max3_u32 v12, v12, v23, v33
    v_max_u32 v2, v19, v31
    v_med3_u32 v3, v19, v12, v31
    s_mov_b64 exec, 0xff
    s_waitcnt vmcnt(0)
    buffer_store_dwordx4 v[2:5], v14, s[8:11], s43 offen sc1
    s_waitcnt lgkmcnt(0)
    buffer_store_dwordx2 v[20:21], v13, s[8:11], s42 offen sc1
    s_mov_b64 exec, -1
    v_readfirstlane_b32 s50, v2
    v_readfirstlane_b32 s51, v3
    s_barrier
    buffer_load_dwordx4 v[34:37], v15, s[8:11], s44 offen offset:0 sc1
    buffer_load_dwordx4 v[38:41], v15, s[8:11], s44 offen offset:1024 sc1
    buffer_load_dwordx4 v[42:45], v15, s[8:11], s44 offen offset:2048 sc1
    buffer_load_dwordx4 v[46:49], v15, s[8:11], s44 offen offset:3072 sc1
    s_mov_b64 s[54:55], 0
    s_mov_b64 s[52:53], -1
REDUCE:
    s_add_u32 s45, s45, 1
    s_waitcnt vmcnt(3)
    v_cmp_eq_u64 vcc, s[48:49], v[36:37]
    s_waitcnt vmcnt(2)
    v_cmp_eq_u64 s[58:59], s[48:49], v[40:41]
    v_max_u32 v23, v35, v39
    v_max_u32 v19, v34, v38
    v_med3_u32 v23, v34, v38, v23
    s_waitcnt vmcnt(1)
    v_cmp_eq_u64 s[60:61], s[48:49], v[44:45]
    s_and_b64 vcc, vcc, s[58:59]
    s_waitcnt vmcnt(0)
    v_cmp_eq_u64 s[62:63], s[48:49], v[48:49]
    v_max_u32 v33, v43, v47
    v_max_u32 v32, v42, v46
    v_med3_u32 v33, v42, v46, v33
    s_and_b64 vcc, vcc, s[60:61]
    v_max_u32 v23, v23, v33
    s_and_b64 vcc, vcc, s[62:63]
    v_med3_u32 v23, v19, v32, v23
    v_max_u32 v19, v19, v32
    v_cndmask_b32 v23, 0, v23, vcc
    v_cndmask_b32 v19, 0, v19, vcc
    s_nop 0
    v_max_u32_dpp v33, v23, v23 row_ror:8 row_mask:0xf bank_mask:0xf
    v_mov_b32_dpp v32, v19 row_ror:8 row_mask:0xf bank_mask:0xf
    v_med3_u32 v23, v19, v32, v33
    v_max_u32 v19, v19, v32
    s_nop 0
    v_max_u32_dpp v33, v23, v23 row_ror:4 row_mask:0xf bank_mask:0xf
    v_mov_b32_dpp v32, v19 row_ror:4 row_mask:0xf bank_mask:0xf
    v_med3_u32 v23, v19, v32, v33
    v_max_u32 v19, v19, v32
    s_nop 0
    v_max_u32_dpp v33, v23, v23 row_ror:2 row_mask:0xf bank_mask:0xf
    v_mov_b32_dpp v32, v19 row_ror:2 row_mask:0xf bank_mask:0xf
    v_med3_u32 v23, v19, v32, v33
    v_max_u32 v19, v19, v32
    s_nop 0
    v_max_u32_dpp v33, v23, v23 row_ror:1 row_mask:0xf bank_mask:0xf
    v_mov_b32_dpp v32, v19 row_ror:1 row_mask:0xf bank_mask:0xf
    v_med3_u32 v23, v19, v32, v33
    v_max_u32 v19, v19, v32
    s_nop 0
    v_max_u32_dpp v33, v23, v23 row_bcast:15 row_mask:0xa bank_mask:0xf
    v_mov_b32_dpp v32, v19 row_bcast:15 row_mask:0xa bank_mask:0xf
    v_med3_u32 v23, v19, v32, v33
    v_max_u32 v19, v19, v32
    s_nop 0
    v_max_u32_dpp v33, v23, v23 row_bcast:31 row_mask:0xc bank_mask:0xf
    v_mov_b32_dpp v32, v19 row_bcast:31 row_mask:0xc bank_mask:0xf
    v_med3_u32 v23, v19, v32, v33
    v_max_u32 v19, v19, v32
    s_nop 0
    v_readlane_b32 s50, v19, 63
    v_readlane_b32 s51, v23, 63
    s_cmp_eq_u64 vcc, -1
    s_cbranch_scc0 NOTALL
    s_cmp_eq_u64 s[50:51], s[52:53]
    s_cbranch_scc1 SAME
FINAL:
    v_mov_b32 v11, s50
    v_mov_b32 v12, s51
    v_cndmask_b32 v11, v11, v12, s[56:57]
    v_and_b32 v32, 0x7ff, v11
    v_lshl_add_u32 v33, v32, 11, v16
    buffer_load_dwordx4 v[24:27], v33, s[4:7], 0 offen
    v_and_b32 v12, 7, v11
    v_and_b32 v11, 0x7f8, v11
    v_lshl_add_u32 v11, v12, 11, v11
    buffer_load_dwordx2 v[20:21], v11, s[8:11], s42 offen sc1
    s_barrier
    s_mov_b64 exec, 3
    ds_write_b32 v18, v32 offset:58240
    s_mov_b64 exec, -1
    s_waitcnt vmcnt(1)
    v_lshlrev_b32 v50, 16, v24
    v_and_b32 v51, 0xffff0000, v24
    v_lshlrev_b32 v52, 16, v25
    v_and_b32 v53, 0xffff0000, v25
    v_lshlrev_b32 v54, 16, v26
    v_and_b32 v55, 0xffff0000, v26
    v_lshlrev_b32 v56, 16, v27
    v_and_b32 v57, 0xffff0000, v27
SCHK:
    s_waitcnt vmcnt(0)
    v_max_u32 v12, v20, v21
    v_mul_f32 v21, -v20, v21
    v_cmp_eq_u32 vcc, -1, v12
    s_cbranch_vccnz SRETRY
SOK:
    v_fma_f32 v50, v50, v20, v21
    v_fma_f32 v51, v51, v20, v21
    v_fma_f32 v52, v52, v20, v21
    v_fma_f32 v53, v53, v20, v21
    v_fma_f32 v54, v54, v20, v21
    v_fma_f32 v55, v55, v20, v21
    v_fma_f32 v56, v56, v20, v21
    v_fma_f32 v57, v57, v20, v21
PAD9:
    s_cbranch_execz RET_A_1
    v_cvt_pk_bf16_f32 v24, v50, v51
    v_cvt_pk_bf16_f32 v25, v52, v53
    v_cvt_pk_bf16_f32 v26, v54, v55
    v_cvt_pk_bf16_f32 v27, v56, v57
    ds_write_b128 v15, v[24:27] offset:58368
GOT:
    s_waitcnt lgkmcnt(0)
    s_barrier
    s_cmp_lg_u32 s2, 0
    s_cbranch_scc1 NOEP
    s_mov_b64 exec, 1
    buffer_store_dword v4, v10, s[8:11], s41 offen sc1
    s_mov_b64 exec, -1
NOEP:
    s_and_b32 s59, s34, 15
    s_lshr_b32 s60, s34, 4
    s_lshl_b32 s60, s60, 10
    s_or_b32 s60, s60, s33
    s_mov_b32 s58, 0
    s_and_b32 s38, s50, 0x407
    s_cmp_eq_u32 s38, s60
    s_cselect_b32 s38, 1, 0
    s_or_b32 s58, s58, s38
    s_and_b32 s38, s51, 0x407
    s_cmp_eq_u32 s38, s60
    s_cselect_b32 s38, 2, 0
    s_or_b32 s58, s58, s38
    s_sub_u32 s38, 0, s50
    s_and_b32 s38, s38, 0x407
    s_cmp_eq_u32 s38, s60
    s_cselect_b32 s38, 4, 0
    s_or_b32 s58, s58, s38
    s_sub_u32 s38, 0, s51
    s_and_b32 s38, s38, 0x407
    s_cmp_eq_u32 s38, s60
    s_cselect_b32 s38, 8, 0
    s_or_b32 s58, s58, s38
    s_cbranch_scc0 MEND
    v_and_b32 v28, 15, v1
    v_and_b32 v11, 1, v1
    v_lshlrev_b32 v11, 4, v11
    v_mov_b32 v12, 0x3f80
    v_lshlrev_b32 v11, v11, v12
    v_lshrrev_b32 v12, 1, v28
    v_cmp_eq_u32 vcc, 0, v12
    s_nop 1
    v_cndmask_b32 v24, 0, v11, vcc
    v_cmp_eq_u32 vcc, 1, v12
    s_nop 1
    v_cndmask_b32 v25, 0, v11, vcc
    v_cmp_eq_u32 vcc, 2, v12
    s_nop 1
    v_cndmask_b32 v26, 0, v11, vcc
    v_cmp_eq_u32 vcc, 3, v12
    s_nop 1
    v_cndmask_b32 v27, 0, v11, vcc
    v_and_b32 v11, 3, v1
    v_bfe_u32 v12, v1, 4, 1
    v_lshl_add_u32 v11, v11, 1, v12
    v_lshlrev_b32 v29, 4, v11
    v_lshlrev_b32 v30, 3, v11
    s_barrier
    s_barrier
ROLE:
    s_ff1_i32_b32 s61, s58
    s_bitset0_b32 s58, s61
    s_bitcmp1_b32 s61, 0
    s_cselect_b32 s62, s51, s50
    s_cselect_b32 s64, 32, 0
    s_sub_u32 s46, 31, s59
    s_bitcmp1_b32 s61, 1
    s_cselect_b32 s46, s46, s59
    s_add_u32 s64, s64, s46
    s_mul_i32 s64, s64, 7168
    s_add_u32 s64, s64, 2490368
    s_add_u32 s47, s64, 4096
    s_and_b32 s63, s62, 0x7ff
    s_lshl_b32 s63, s63, 11
    s_lshl_b32 s46, s46, 6
    s_add_u32 s63, s63, s46
    s_lshl_b32 s38, s61, 7
    v_add_u32 v11, s38, v29
    s_mov_b32 s45, 0
    v_mov_b32 v31, s62
    v_ashrrev_i32 v12, 31, v31
    v_not_b32 v12, v12
    v_or_b32 v12, 0x80000000, v12
    v_xor_b32 v31, v31, v12
    v_mul_f32 v31, 0xbfb8aa3b, v31
    v_exp_f32 v31, v31
    s_nop 0
    v_add_f32 v31, 1.0, v31
    v_rcp_f32 v31, v31
RPOLL:
    buffer_load_dwordx4 v[34:37], v15, s[8:11], s64 offen offset:0 sc1
    buffer_load_dwordx4 v[38:41], v15, s[8:11], s64 offen offset:1024 sc1
    buffer_load_dwordx4 v[42:45], v15, s[8:11], s64 offen offset:2048 sc1
    buffer_load_dwordx4 v[46:49], v15, s[8:11], s64 offen offset:3072 sc1
    buffer_load_dwordx4 v[50:53], v15, s[8:11], s47 offen offset:0 sc1
    buffer_load_dwordx4 v[54:57], v15, s[8:11], s47 offen offset:1024 sc1
    buffer_load_dwordx4 v[58:61], v15, s[8:11], s47 offen offset:2048 sc1
    s_add_u32 s45, s45, 1
    s_waitcnt vmcnt(6)
    v_mfma_f32_16x16x32_bf16 v[62:65], v[24:27], v[34:37], 0
    s_waitcnt vmcnt(5)
    v_mfma_f32_16x16x32_bf16 v[62:65], v[24:27], v[38:41], v[62:65]
    s_waitcnt vmcnt(4)
    v_mfma_f32_16x16x32_bf16 v[62:65], v[24:27], v[42:45], v[62:65]
    s_waitcnt vmcnt(3)
    v_mfma_f32_16x16x32_bf16 v[62:65], v[24:27], v[46:49], v[62:65]
    s_waitcnt vmcnt(2)
    v_mfma_f32_16x16x32_bf16 v[62:65], v[24:27], v[50:53], v[62:65]
    s_waitcnt vmcnt(1)
    v_mfma_f32_16x16x32_bf16 v[62:65], v[24:27], v[54:57], v[62:65]
    s_waitcnt vmcnt(0)
    v_mfma_f32_16x16x32_bf16 v[62:65], v[24:27], v[58:61], v[62:65]
    ds_read_b128 v[66:69], v11 offset:60416
    s_cmp_ge_u32 s45, 4096
    s_cbranch_scc1 RGOT
    s_nop 4
    v_cmp_u_f32 vcc, v62, v62
    s_cbranch_vccnz RPOLL
RGOT:
    s_nop 4
    v_add_f32_dpp v62, v62, v62 row_ror:4 row_mask:0xf bank_mask:0xf
    v_add_f32_dpp v63, v63, v63 row_ror:4 row_mask:0xf bank_mask:0xf
    v_add_f32_dpp v64, v64, v64 row_ror:4 row_mask:0xf bank_mask:0xf
    v_add_f32_dpp v65, v65, v65 row_ror:4 row_mask:0xf bank_mask:0xf
    v_add_f32_dpp v62, v62, v62 row_ror:8 row_mask:0xf bank_mask:0xf
    v_add_f32_dpp v63, v63, v63 row_ror:8 row_mask:0xf bank_mask:0xf
    v_add_f32_dpp v64, v64, v64 row_ror:8 row_mask:0xf bank_mask:0xf
    v_add_f32_dpp v65, v65, v65 row_ror:8 row_mask:0xf bank_mask:0xf
FCHK:
    s_waitcnt lgkmcnt(0)
    v_max3_u32 v12, v66, v67, v68
    v_max_u32 v12, v12, v69
    v_cmp_eq_u32 vcc, -1, v12
    s_cbranch_vccnz FRETRY
FOK:
    v_fmac_f32 v66, v62, v31
    v_fmac_f32 v67, v63, v31
    v_fmac_f32 v68, v64, v31
    v_fmac_f32 v69, v65, v31
    v_cvt_pk_bf16_f32 v66, v66, v67
    v_cvt_pk_bf16_f32 v67, v68, v69
    s_mov_b64 exec, 0x000f000f
    buffer_store_dwordx2 v[66:67], v30, s[24:27], s63 offen
    s_mov_b64 exec, -1
    s_cmp_lg_u32 s58, 0
    s_nop 0
    s_cbranch_scc1 ROLE
MEND:
    s_endpgm
FRETRY:
    s_add_u32 s45, s45, 1
    s_cmp_ge_u32 s45, 65536
    s_cbranch_scc1 FOK
    ds_read_b128 v[66:69], v11 offset:60416
    s_branch FCHK
NOTALL:
    s_cmp_ge_u32 s45, 4096
    s_cbranch_scc1 FINAL
    s_cmp_eq_u64 s[50:51], s[52:53]
    s_cselect_b64 vcc, s[54:55], 0
    s_cmp_eq_u64 vcc, -1
    s_cbranch_scc0 POLLA
    buffer_load_dwordx4 v[34:37], v15, s[8:11], s44 offen offset:0 sc1
    buffer_load_dwordx4 v[38:41], v15, s[8:11], s44 offen offset:1024 sc1
    buffer_load_dwordx4 v[42:45], v15, s[8:11], s44 offen offset:2048 sc1
    buffer_load_dwordx4 v[46:49], v15, s[8:11], s44 offen offset:3072 sc1
    s_nop 0
    s_branch REDUCE
POLLA:
    v_mov_b32 v11, s50
    v_mov_b32 v12, s51
    s_mov_b64 s[52:53], s[50:51]
    v_cndmask_b32 v11, v11, v12, s[56:57]
    v_and_b32 v32, 0x7ff, v11
    v_lshl_add_u32 v33, v32, 11, v16
    buffer_load_dwordx4 v[24:27], v33, s[4:7], 0 offen
    v_and_b32 v12, 7, v11
    v_and_b32 v11, 0x7f8, v11
    v_lshl_add_u32 v11, v12, 11, v11
    buffer_load_dwordx2 v[20:21], v11, s[8:11], s42 offen sc1
    buffer_load_dwordx4 v[34:37], v15, s[8:11], s44 offen offset:0 sc1
    buffer_load_dwordx4 v[38:41], v15, s[8:11], s44 offen offset:1024 sc1
    buffer_load_dwordx4 v[42:45], v15, s[8:11], s44 offen offset:2048 sc1
    buffer_load_dwordx4 v[46:49], v15, s[8:11], s44 offen offset:3072 sc1
    s_mov_b64 exec, 3
    ds_write_b32 v18, v32 offset:58240
    s_mov_b64 exec, -1
    s_waitcnt vmcnt(5)
    v_lshlrev_b32 v50, 16, v24
    v_and_b32 v51, 0xffff0000, v24
    v_lshlrev_b32 v52, 16, v25
    v_and_b32 v53, 0xffff0000, v25
    v_lshlrev_b32 v54, 16, v26
    v_and_b32 v55, 0xffff0000, v26
    v_lshlrev_b32 v56, 16, v27
    v_and_b32 v57, 0xffff0000, v27
    s_waitcnt vmcnt(4)
    v_max_u32 v11, v20, v21
    v_mul_f32 v21, -v20, v21
    v_cmp_ne_u32 s[54:55], -1, v11
    v_fma_f32 v50, v50, v20, v21
    v_fma_f32 v51, v51, v20, v21
    v_fma_f32 v52, v52, v20, v21
    v_fma_f32 v53, v53, v20, v21
    v_fma_f32 v54, v54, v20, v21
    v_fma_f32 v55, v55, v20, v21
    v_fma_f32 v56, v56, v20, v21
    v_fma_f32 v57, v57, v20, v21
    v_cvt_pk_bf16_f32 v24, v50, v51
    v_cvt_pk_bf16_f32 v25, v52, v53
    v_cvt_pk_bf16_f32 v26, v54, v55
    v_cvt_pk_bf16_f32 v27, v56, v57
    ds_write_b128 v15, v[24:27] offset:58368
    s_nop 0
    s_branch REDUCE
SAME:
    s_cmp_eq_u64 s[54:55], -1
    s_cbranch_scc0 FINAL
    s_barrier
    s_branch GOT
SRETRY:
    s_add_u32 s45, s45, 1
    s_cmp_ge_u32 s45, 8192
    s_cbranch_scc1 SOK
    buffer_load_dwordx2 v[20:21], v11, s[8:11], s42 offen sc1
    s_branch SCHK
LOAD:
    s_lshl_b32 s14, 7, 20
    s_mov_b32 s15, s7
    s_mov_b64 s[18:19], s[14:15]
    s_lshr_b32 s41, s40, 2
    s_and_b32 s42, s40, 3
    s_mul_i32 s43, s42, 1835008
    s_lshl_b32 s38, s41, 7
    s_add_u32 s43, s43, s38
    v_bfe_u32 v10, v1, 1, 2
    v_bfe_u32 v11, v1, 4, 1
    v_xor_b32 v10, v10, v11
    v_and_b32 v11, 1, v1
    v_lshlrev_b32 v11, 4, v11
    v_lshl_add_u32 v10, v10, 5, v11
    v_lshrrev_b32 v11, 3, v1
    v_mul_u32_u24 v2, 7168, v11
    v_add_u32 v2, v10, v2
    v_xor_b32 v3, 64, v2
    v_add_u32 v4, 112640, v2
    v_add_u32 v5, 168960, v3
    v_add_u32 v3, 56320, v3
    s_cmp_eq_u32 s35, 0
    s_cselect_b32 s46, s37, s36
    s_cselect_b32 s47, -1, 1
    s_cselect_b32 s48, 16384, 0
    s_lshl_b32 s47, s47, 19
    s_lshl_b32 s46, s46, 11
    v_and_b32 v12, 32, v1
    v_lshlrev_b32 v6, 4, v1
    v_xor_b32 v12, v12, v6
    s_waitcnt lgkmcnt(0)
    s_add_u32 m0, s48, 0
    s_nop 0
    buffer_load_dwordx4 v12, s[4:7], s46 offen offset:0 lds
    buffer_load_dwordx4 v12, s[4:7], s46 offen offset:1024 lds
    s_add_u32 m0, s48, 2048
    s_add_u32 s46, s46, s47
    buffer_load_dwordx4 v12, s[4:7], s46 offen offset:0 lds
    buffer_load_dwordx4 v12, s[4:7], s46 offen offset:1024 lds
    s_add_u32 m0, s48, 4096
    s_add_u32 s46, s46, s47
    buffer_load_dwordx4 v12, s[4:7], s46 offen offset:0 lds
    buffer_load_dwordx4 v12, s[4:7], s46 offen offset:1024 lds
    s_add_u32 m0, s48, 6144
    s_add_u32 s46, s46, s47
    buffer_load_dwordx4 v12, s[4:7], s46 offen offset:0 lds
    buffer_load_dwordx4 v12, s[4:7], s46 offen offset:1024 lds
    s_add_u32 m0, s48, 8192
    s_add_u32 s46, s46, s47
    buffer_load_dwordx4 v12, s[4:7], s46 offen offset:0 lds
    buffer_load_dwordx4 v12, s[4:7], s46 offen offset:1024 lds
    s_add_u32 m0, s48, 10240
    s_add_u32 s46, s46, s47
    buffer_load_dwordx4 v12, s[4:7], s46 offen offset:0 lds
    buffer_load_dwordx4 v12, s[4:7], s46 offen offset:1024 lds
    s_add_u32 m0, s48, 12288
    s_add_u32 s46, s46, s47
    buffer_load_dwordx4 v12, s[4:7], s46 offen offset:0 lds
    buffer_load_dwordx4 v12, s[4:7], s46 offen offset:1024 lds
    s_add_u32 m0, s48, 14336
    s_add_u32 s46, s46, s47
    buffer_load_dwordx4 v12, s[4:7], s46 offen offset:0 lds
    buffer_load_dwordx4 v12, s[4:7], s46 offen offset:1024 lds
    s_mov_b32 m0, 61440
    s_add_u32 s45, s43, 0
    buffer_load_dwordx4 v2, s[12:15], s45 offen offset:0 nt lds
    buffer_load_dwordx4 v3, s[12:15], s45 offen offset:1024 nt lds
    buffer_load_dwordx4 v4, s[12:15], s45 offen offset:2048 nt lds
    buffer_load_dwordx4 v5, s[12:15], s45 offen offset:3072 nt lds
    s_mov_b32 m0, 94208
    s_nop 0
    buffer_load_dwordx4 v2, s[16:19], s45 offen offset:0 nt lds
    buffer_load_dwordx4 v3, s[16:19], s45 offen offset:1024 nt lds
    buffer_load_dwordx4 v4, s[16:19], s45 offen offset:2048 nt lds
    buffer_load_dwordx4 v5, s[16:19], s45 offen offset:3072 nt lds
    s_mov_b32 m0, 65536
    s_add_u32 s45, s43, 229376
    buffer_load_dwordx4 v2, s[12:15], s45 offen offset:0 nt lds
    buffer_load_dwordx4 v3, s[12:15], s45 offen offset:1024 nt lds
    buffer_load_dwordx4 v4, s[12:15], s45 offen offset:2048 nt lds
    buffer_load_dwordx4 v5, s[12:15], s45 offen offset:3072 nt lds
    v_mov_b32 v12, 256
    s_mov_b64 s[22:23], s[14:15]
    s_lshl_b32 s44, s41, 17
    s_lshl_b32 s38, s42, 9
    s_add_u32 s44, s44, s38
    v_lshl_add_u32 v6, v11, 11, v10
    v_xor_b32 v7, 64, v6
    v_add_u32 v8, 30720, v6
    v_add_u32 v9, 46080, v7
    v_add_u32 v7, 15360, v7
    v_mov_b32 v10, -1
    v_mov_b32 v11, 0
    ds_write_b32 v11, v10 offset:58252
    s_waitcnt vmcnt(12)
    s_mov_b64 exec, 1
    ds_add_u32 v11, v12 offset:58260
    s_mov_b64 exec, -1
    s_mov_b32 m0, 98304
    s_nop 0
    buffer_load_dwordx4 v2, s[16:19], s45 offen offset:0 nt lds
    buffer_load_dwordx4 v3, s[16:19], s45 offen offset:1024 nt lds
    buffer_load_dwordx4 v4, s[16:19], s45 offen offset:2048 nt lds
    buffer_load_dwordx4 v5, s[16:19], s45 offen offset:3072 nt lds
    s_mov_b32 m0, 69632
    s_add_u32 s45, s43, 458752
    buffer_load_dwordx4 v2, s[12:15], s45 offen offset:0 nt lds
    buffer_load_dwordx4 v3, s[12:15], s45 offen offset:1024 nt lds
    buffer_load_dwordx4 v4, s[12:15], s45 offen offset:2048 nt lds
    buffer_load_dwordx4 v5, s[12:15], s45 offen offset:3072 nt lds
    s_mov_b32 m0, 102400
    s_waitcnt vmcnt(19)
    buffer_load_dwordx4 v2, s[16:19], s45 offen offset:0 nt lds
    s_waitcnt vmcnt(19)
    buffer_load_dwordx4 v3, s[16:19], s45 offen offset:1024 nt lds
    s_waitcnt vmcnt(19)
    buffer_load_dwordx4 v4, s[16:19], s45 offen offset:2048 nt lds
    s_waitcnt vmcnt(19)
    buffer_load_dwordx4 v5, s[16:19], s45 offen offset:3072 nt lds
    s_mov_b32 m0, 73728
    s_add_u32 s45, s43, 688128
    s_waitcnt vmcnt(19)
    buffer_load_dwordx4 v2, s[12:15], s45 offen offset:0 nt lds
    s_waitcnt vmcnt(19)
    buffer_load_dwordx4 v3, s[12:15], s45 offen offset:1024 nt lds
    s_waitcnt vmcnt(19)
    buffer_load_dwordx4 v4, s[12:15], s45 offen offset:2048 nt lds
    s_waitcnt vmcnt(19)
    buffer_load_dwordx4 v5, s[12:15], s45 offen offset:3072 nt lds
    s_mov_b32 m0, 106496
    s_waitcnt vmcnt(19)
    buffer_load_dwordx4 v2, s[16:19], s45 offen offset:0 nt lds
    s_waitcnt vmcnt(19)
    buffer_load_dwordx4 v3, s[16:19], s45 offen offset:1024 nt lds
    s_waitcnt vmcnt(19)
    buffer_load_dwordx4 v4, s[16:19], s45 offen offset:2048 nt lds
    s_waitcnt vmcnt(19)
    buffer_load_dwordx4 v5, s[16:19], s45 offen offset:3072 nt lds
    s_mov_b32 m0, 77824
    s_add_u32 s45, s43, 917504
    s_waitcnt vmcnt(19)
    buffer_load_dwordx4 v2, s[12:15], s45 offen offset:0 nt lds
    s_waitcnt vmcnt(19)
    buffer_load_dwordx4 v3, s[12:15], s45 offen offset:1024 nt lds
    s_waitcnt vmcnt(19)
    buffer_load_dwordx4 v4, s[12:15], s45 offen offset:2048 nt lds
    s_waitcnt vmcnt(19)
    buffer_load_dwordx4 v5, s[12:15], s45 offen offset:3072 nt lds
    s_mov_b32 m0, 110592
    s_waitcnt vmcnt(19)
    buffer_load_dwordx4 v2, s[16:19], s45 offen offset:0 nt lds
    s_waitcnt vmcnt(19)
    buffer_load_dwordx4 v3, s[16:19], s45 offen offset:1024 nt lds
    s_waitcnt vmcnt(19)
    buffer_load_dwordx4 v4, s[16:19], s45 offen offset:2048 nt lds
    s_waitcnt vmcnt(19)
    buffer_load_dwordx4 v5, s[16:19], s45 offen offset:3072 nt lds
    s_mov_b32 m0, 81920
    s_add_u32 s45, s43, 1146880
PAD10:
    s_cbranch_execz RET_A_1
    s_waitcnt vmcnt(19)
    buffer_load_dwordx4 v2, s[12:15], s45 offen offset:0 nt lds
    s_waitcnt vmcnt(19)
    buffer_load_dwordx4 v3, s[12:15], s45 offen offset:1024 nt lds
    s_waitcnt vmcnt(19)
    buffer_load_dwordx4 v4, s[12:15], s45 offen offset:2048 nt lds
    s_waitcnt vmcnt(19)
    buffer_load_dwordx4 v5, s[12:15], s45 offen offset:3072 nt lds
    s_mov_b32 m0, 114688
    s_waitcnt vmcnt(19)
    buffer_load_dwordx4 v2, s[16:19], s45 offen offset:0 nt lds
    s_waitcnt vmcnt(19)
    buffer_load_dwordx4 v3, s[16:19], s45 offen offset:1024 nt lds
    s_waitcnt vmcnt(19)
    buffer_load_dwordx4 v4, s[16:19], s45 offen offset:2048 nt lds
    s_waitcnt vmcnt(19)
    buffer_load_dwordx4 v5, s[16:19], s45 offen offset:3072 nt lds
    s_mov_b32 m0, 86016
    s_add_u32 s45, s43, 1376256
    s_waitcnt vmcnt(19)
    buffer_load_dwordx4 v2, s[12:15], s45 offen offset:0 nt lds
    s_waitcnt vmcnt(19)
    buffer_load_dwordx4 v3, s[12:15], s45 offen offset:1024 nt lds
    s_waitcnt vmcnt(19)
    buffer_load_dwordx4 v4, s[12:15], s45 offen offset:2048 nt lds
    s_waitcnt vmcnt(19)
    buffer_load_dwordx4 v5, s[12:15], s45 offen offset:3072 nt lds
    s_mov_b32 m0, 118784
    s_waitcnt vmcnt(19)
    buffer_load_dwordx4 v2, s[16:19], s45 offen offset:0 nt lds
    s_waitcnt vmcnt(19)
    buffer_load_dwordx4 v3, s[16:19], s45 offen offset:1024 nt lds
    s_waitcnt vmcnt(19)
    buffer_load_dwordx4 v4, s[16:19], s45 offen offset:2048 nt lds
    s_waitcnt vmcnt(19)
    buffer_load_dwordx4 v5, s[16:19], s45 offen offset:3072 nt lds
    s_waitcnt lgkmcnt(0)
    s_barrier
    s_mov_b32 m0, 90112
    s_add_u32 s45, s43, 1605632
    s_waitcnt vmcnt(19)
PAD11:
    s_cbranch_execz RET_A_2
    buffer_load_dwordx4 v2, s[12:15], s45 offen offset:0 nt lds
    s_waitcnt vmcnt(19)
    buffer_load_dwordx4 v3, s[12:15], s45 offen offset:1024 nt lds
    s_waitcnt vmcnt(19)
    buffer_load_dwordx4 v4, s[12:15], s45 offen offset:2048 nt lds
    s_waitcnt vmcnt(19)
    buffer_load_dwordx4 v5, s[12:15], s45 offen offset:3072 nt lds
    s_mov_b32 m0, 122880
    s_waitcnt vmcnt(19)
    buffer_load_dwordx4 v2, s[16:19], s45 offen offset:0 nt lds
    s_waitcnt vmcnt(19)
    buffer_load_dwordx4 v3, s[16:19], s45 offen offset:1024 nt lds
    s_waitcnt vmcnt(19)
    buffer_load_dwordx4 v4, s[16:19], s45 offen offset:2048 nt lds
    s_waitcnt vmcnt(19)
    buffer_load_dwordx4 v5, s[16:19], s45 offen offset:3072 nt lds
    s_barrier
    s_mov_b32 m0, 126976
    s_add_u32 s45, s44, 0
    buffer_load_dwordx4 v6, s[20:23], s45 offen offset:0 nt lds
    buffer_load_dwordx4 v7, s[20:23], s45 offen offset:1024 nt lds
    buffer_load_dwordx4 v8, s[20:23], s45 offen offset:2048 nt lds
    buffer_load_dwordx4 v9, s[20:23], s45 offen offset:3072 nt lds
    s_mov_b32 m0, 131072
    s_add_u32 s45, s44, 128
    buffer_load_dwordx4 v6, s[20:23], s45 offen offset:0 nt lds
    buffer_load_dwordx4 v7, s[20:23], s45 offen offset:1024 nt lds
    buffer_load_dwordx4 v8, s[20:23], s45 offen offset:2048 nt lds
    buffer_load_dwordx4 v9, s[20:23], s45 offen offset:3072 nt lds
    s_mov_b32 m0, 135168
    s_add_u32 s45, s44, 256
    buffer_load_dwordx4 v6, s[20:23], s45 offen offset:0 nt lds
    buffer_load_dwordx4 v7, s[20:23], s45 offen offset:1024 nt lds
    buffer_load_dwordx4 v8, s[20:23], s45 offen offset:2048 nt lds
    buffer_load_dwordx4 v9, s[20:23], s45 offen offset:3072 nt lds
    s_mov_b32 m0, 139264
    s_add_u32 s45, s44, 384
    buffer_load_dwordx4 v6, s[20:23], s45 offen offset:0 nt lds
    buffer_load_dwordx4 v7, s[20:23], s45 offen offset:1024 nt lds
    buffer_load_dwordx4 v8, s[20:23], s45 offen offset:2048 nt lds
    buffer_load_dwordx4 v9, s[20:23], s45 offen offset:3072 nt lds
    s_mov_b32 m0, 143360
    s_add_u32 s45, s44, 65536
    buffer_load_dwordx4 v6, s[20:23], s45 offen offset:0 nt lds
    buffer_load_dwordx4 v7, s[20:23], s45 offen offset:1024 nt lds
    buffer_load_dwordx4 v8, s[20:23], s45 offen offset:2048 nt lds
    buffer_load_dwordx4 v9, s[20:23], s45 offen offset:3072 nt lds
    s_mov_b32 m0, 147456
    s_add_u32 s45, s44, 65664
    buffer_load_dwordx4 v6, s[20:23], s45 offen offset:0 nt lds
    buffer_load_dwordx4 v7, s[20:23], s45 offen offset:1024 nt lds
    buffer_load_dwordx4 v8, s[20:23], s45 offen offset:2048 nt lds
    buffer_load_dwordx4 v9, s[20:23], s45 offen offset:3072 nt lds
    s_waitcnt vmcnt(24)
    s_barrier
    s_barrier
    s_mov_b32 m0, 151552
    s_add_u32 s45, s44, 65792
    buffer_load_dwordx4 v6, s[20:23], s45 offen offset:0 nt lds
    buffer_load_dwordx4 v7, s[20:23], s45 offen offset:1024 nt lds
    buffer_load_dwordx4 v8, s[20:23], s45 offen offset:2048 nt lds
    buffer_load_dwordx4 v9, s[20:23], s45 offen offset:3072 nt lds
    s_mov_b32 m0, 155648
    s_add_u32 s45, s44, 65920
    buffer_load_dwordx4 v6, s[20:23], s45 offen offset:0 nt lds
    buffer_load_dwordx4 v7, s[20:23], s45 offen offset:1024 nt lds
    buffer_load_dwordx4 v8, s[20:23], s45 offen offset:2048 nt lds
    buffer_load_dwordx4 v9, s[20:23], s45 offen offset:3072 nt lds
    s_waitcnt vmcnt(0)
    ds_write_b32 v11, v11 offset:58252
    s_endpgm
.section .rodata,"a"
.p2align 6
.amdhsa_kernel parallel_sum__spectral_fnet__moe_arch_mod__prompt_kernel
  .amdhsa_next_free_vgpr 156
  .amdhsa_next_free_sgpr 102
  .amdhsa_accum_offset 156
  .amdhsa_group_segment_fixed_size 0
  .amdhsa_kernarg_size 104
  .amdhsa_user_sgpr_count 2
  .amdhsa_user_sgpr_kernarg_segment_ptr 1
  .amdhsa_system_sgpr_workgroup_id_x 1
.end_amdhsa_kernel
```

```asm
; @launch grid=(256,1,1) block=(640,1,1) lds=159744
.amdgcn_target "amdgcn-amd-amdhsa--gfx950"
.text
.globl parallel_sum__spectral_fnet__moe_arch_mod__prompt_kernel
.p2align 12
.type parallel_sum__spectral_fnet__moe_arch_mod__prompt_kernel,@function
parallel_sum__spectral_fnet__moe_arch_mod__prompt_kernel:
    s_cmpk_ge_u32 s2, 256
    s_cbranch_scc1 END
    v_lshrrev_b32 v2, 6, v0
    s_load_dwordx2 s[4:5], s[0:1], 0
    s_load_dwordx2 s[28:29], s[0:1], 48
    s_load_dwordx2 s[8:9], s[0:1], 96
    s_load_dwordx2 s[12:13], s[0:1], 56
    s_load_dwordx2 s[16:17], s[0:1], 64
    s_load_dwordx2 s[20:21], s[0:1], 72
    s_load_dwordx2 s[24:25], s[0:1], 80
    v_readfirstlane_b32 s32, v2
    s_lshr_b32 s34, s2, 3
    v_and_b32 v1, 63, v0
    s_lshl_b32 s38, s32, 5
    s_add_u32 s38, s38, s34
    s_cmpk_lt_u32 s38, 316
    s_cbranch_scc1 BUSY
    s_mov_b64 exec, 0
    s_cmp_eq_u32 s34, 28
    s_cbranch_scc1 PAD0
    s_cmp_eq_u32 s34, 29
    s_cbranch_scc1 PAD1
    s_cmp_eq_u32 s34, 30
    s_cbranch_scc1 PAD8
    s_branch PAD2
BUSY:
    s_and_b32 s33, s2, 7
    s_lshr_b32 s38, s2, 4
    s_lshl3_add_u32 s36, s38, s33
    s_and_b32 s35, s34, 1
    s_cmp_eq_u32 s36, 0
    s_cselect_b32 s38, 128, s36
    s_sub_u32 s37, 2048, s38
    s_mul_i32 s40, s33, 28
    s_add_u32 s40, s40, s34
    s_lshl_b32 s6, 1, 22
    s_lshl_b32 s7, 1, 17
    s_lshl_b32 s10, 27, 17
    s_mov_b32 s11, s7
    s_cmp_eq_u32 s32, 9
    s_cbranch_scc1 LOADB
    s_cmp_eq_u32 s32, 8
    s_cbranch_scc1 COMM0
    s_lshl_b32 s38, s32, 8
    s_add_u32 s41, s36, s38
    s_sub_u32 s38, s37, s38
    s_cmp_eq_u32 s35, 0
    s_cselect_b32 s42, s38, s41
    s_cselect_b32 s41, s41, s38
    s_lshl_b32 s43, s32, 11
    s_lshl_b32 s38, s35, 14
    s_add_u32 s43, s43, s38
    v_and_b32 v9, 32, v1
    v_lshlrev_b32 v8, 4, v1
    v_lshrrev_b32 v5, 2, v1
    v_xor_b32 v2, v8, v9
    s_lshl_b32 s47, s32, 8
    s_add_u32 m0, s47, 49408
    s_and_b32 s39, s32, 2
    s_lshl_b32 s39, s39, 4
    v_lshrrev_b32 v11, 2, v8
    s_movk_i32 s30, 2048
    s_mov_b32 s31, s7
    v_xor_b32 v11, s39, v11
    s_lshl_b32 s39, s41, 11
    s_lshl_b32 s42, s42, 11
    v_and_b32 v6, 3, v1
    v_and_b32 v3, 15, v1
    v_lshrrev_b32 v4, 4, v1
    v_and_b32 v5, 3, v5
    v_and_b32 v7, 1, v4
    s_lshl_b32 s48, s35, 3
    s_cmp_eq_u32 s35, 0
    s_cselect_b32 s38, 1, 63
    v_lshrrev_b32 v9, 1, v3
    v_add_u32 v9, s48, v9
    v_and_b32 v10, 1, v3
    v_cmp_ne_u32 vcc, s38, v3
    v_cvt_f32_u32 v24, v4
    s_nop 0
    v_cndmask_b32 v9, 16, v9, vcc
    v_mul_f32 v26, 4.0, v24
    v_cndmask_b32 v10, 0, v10, vcc
    v_cvt_f32_u32 v9, v9
    v_cvt_f32_u32 v10, v10
    v_add_f32 v24, v26, v26
    v_mul_f32 v9, 0x3d000000, v9
    v_mul_f32 v10, 0x3e800000, v10
    v_cos_f32 v25, v9
    v_fma_f32 v16, v9, v24, v10
    v_add_f32 v17, v16, v9
    s_waitcnt lgkmcnt(0)
    buffer_load_dword v11, s[28:31], s47 offen lds
    s_xor_b32 m0, s43, 16384
    buffer_load_dwordx4 v[28:31], v2, s[4:7], s39 offen
    buffer_load_dwordx4 v[32:35], v2, s[4:7], s39 offen offset:1024
    s_cmpk_ge_u32 s2, 224
    s_cbranch_scc1 BI0
    s_barrier
BI0:
    s_branch CMP2
COMM0:
    s_setprio 3
    v_mov_b32 v10, 0
    s_mov_b32 s41, 2392064
    v_mov_b32 v6, -1
    v_mov_b32 v7, -1
    v_mov_b32 v8, -1
    v_mov_b32 v9, -1
    s_lshr_b32 s46, s40, 2
    s_and_b32 s47, s40, 3
    v_lshlrev_b32 v15, 4, v1
    v_lshrrev_b32 v11, 5, v1
    v_and_b32 v12, 0x1f0, v15
    v_lshl_add_u32 v19, v11, 11, v12
    s_lshl3_add_u32 s58, s46, s47
    s_lshl_b32 s58, s58, 9
    s_add_u32 s58, s58, 2949120
    s_mul_i32 s59, s47, 57344
    s_lshl_b32 s43, s46, 7
    s_add_u32 s59, s59, s43
    s_add_u32 s59, s59, 2490368
    s_cmpk_lt_u32 s2, 224
    s_cselect_b32 s58, s58, 117440512
    s_cselect_b32 s59, s59, 117440512
    v_lshrrev_b32 v11, 3, v1
    v_and_b32 v12, 0x70, v15
    v_mul_u32_u24 v11, 7168, v11
    v_add_u32 v20, v11, v12
    v_lshlrev_b32 v12, 8, v1
    v_add_u32 v11, s36, v12
    v_sub_u32 v12, s37, v12
    s_cmp_eq_u32 s35, 0
    s_cselect_b64 vcc, 0, -1
    v_cndmask_b32 v13, v11, v12, vcc
    v_and_b32 v11, 7, v13
    v_and_b32 v12, 0x7f8, v13
    v_lshl_add_u32 v13, v11, 11, v12
    s_mov_b32 s42, 2359296
    v_mov_b32 v22, 0
    v_mov_b32 v23, 0
    v_mov_b32 v24, 0
    v_mov_b32 v25, 0
    ds_write_b128 v10, v[22:25] offset:58256
    s_waitcnt lgkmcnt(0)
    buffer_load_dwordx2 v[4:5], v10, s[8:11], s41 offen sc1
    s_cmpk_ge_u32 s2, 224
    s_cbranch_scc1 BI1
    s_barrier
BI1:
    s_mul_i32 s60, s36, 16384
    s_lshl_b32 s61, s35, 13
    s_add_u32 s60, s60, s61
    s_add_u32 s61, s60, 4096
    buffer_store_dwordx4 v[6:9], v15, s[8:11], s60 offen offset:0 sc1
    buffer_store_dwordx4 v[6:9], v15, s[8:11], s60 offen offset:1024 sc1
    buffer_store_dwordx4 v[6:9], v15, s[8:11], s60 offen offset:2048 sc1
    buffer_store_dwordx4 v[6:9], v15, s[8:11], s60 offen offset:3072 sc1
    buffer_store_dwordx4 v[6:9], v15, s[8:11], s61 offen offset:0 sc1
    buffer_store_dwordx4 v[6:9], v15, s[8:11], s61 offen offset:1024 sc1
    buffer_store_dwordx4 v[6:9], v15, s[8:11], s61 offen offset:2048 sc1
    buffer_store_dwordx4 v[6:9], v15, s[8:11], s61 offen offset:3072 sc1
    buffer_store_dwordx4 v[6:9], v19, s[8:11], s58 offen sc1
    buffer_store_dwordx4 v[6:9], v20, s[8:11], s59 offen sc1
    s_add_u32 s59, s59, 229376
    buffer_store_dwordx4 v[6:9], v20, s[8:11], s59 offen sc1
    s_mov_b64 exec, 0xff
    buffer_store_dwordx2 v[6:7], v13, s[8:11], s42 offen sc1
    s_mov_b64 exec, -1
    s_branch COMM
LOADB:
    s_barrier
    s_branch LOAD
RET_A_0:
    s_cmp_eq_u32 s34, 28
    s_cbranch_scc1 PAD10
    s_cmp_eq_u32 s34, 29
    s_cbranch_scc1 PAD3
    s_cmp_eq_u32 s34, 30
    s_cbranch_scc1 PAD4
    s_cmp_eq_u32 s34, 31
    s_cbranch_scc1 PAD11
RET_A_1:
    s_mov_b64 exec, -1
    s_branch PREF
CMP2:
    v_cos_f32 v16, v16
    v_cos_f32 v17, v17
    v_add_f32 v25, v25, v25
    s_add_u32 s38, s38, -1
    v_cmp_ne_u32 vcc, s38, v3
    v_mov_b32 v11, 0xc2000000
    v_mov_b32 v27, 0x3a800000
    v_fma_f32 v18, v25, v17, -v16
    v_fma_f32 v19, v25, v18, -v17
    v_fma_f32 v20, v25, v19, -v18
    v_fma_f32 v21, v25, v20, -v19
    v_fma_f32 v22, v25, v21, -v20
    v_fma_f32 v23, v25, v22, -v21
    v_cndmask_b32 v11, v11, 0, vcc
    v_cvt_pk_bf16_f32 v12, v16, v17
    v_cvt_pk_bf16_f32 v13, v18, v19
    v_cvt_pk_bf16_f32 v14, v20, v21
    v_cvt_pk_bf16_f32 v15, v22, v23
PAD0:
    s_cbranch_execz RET_A_0
    s_mul_i32 s44, s36, 16384
    s_lshl3_add_u32 s38, s35, s32
    s_lshl_b32 s38, s38, 10
    s_add_u32 s44, s44, s38
    s_lshr_b32 s46, s40, 2
    s_and_b32 s45, s40, 3
    s_add_u32 s48, s48, s32
    v_lshl_add_u32 v9, v3, 5, s48
    v_mov_b32 v24, 512
    v_cmp_eq_u32 vcc, 0, v9
    s_nop 1
    v_cndmask_b32 v9, v9, v24, vcc
    v_cvt_f32_u32 v9, v9
    v_bfrev_b32 v10, 1
    v_mul_f32 v9, v27, v9
    v_mul_f32 v16, v9, v26
    v_cos_f32 v25, v9
    v_fmamk_f32 v20, v9, 0x41800000, v16
    v_add_f32 v17, v16, v9
    v_add_f32 v21, v20, v9
    v_add_f32 v25, v25, v25
    v_sin_f32 v68, v16
    v_cos_f32 v16, v16
    v_sin_f32 v69, v17
    v_cos_f32 v17, v17
    v_sin_f32 v72, v20
    v_cos_f32 v20, v20
    v_sin_f32 v73, v21
    v_cos_f32 v21, v21
    v_fma_f32 v70, v25, v69, -v68
    v_fma_f32 v18, v25, v17, -v16
    v_fma_f32 v74, v25, v73, -v72
    v_fma_f32 v22, v25, v21, -v20
    v_fma_f32 v71, v25, v70, -v69
    v_fma_f32 v19, v25, v18, -v17
    v_fma_f32 v75, v25, v74, -v73
    v_fma_f32 v23, v25, v22, -v21
    v_cvt_pk_bf16_f32 v48, v68, v69
    v_cvt_pk_bf16_f32 v44, v16, v17
    v_cvt_pk_bf16_f32 v49, v70, v71
    v_cvt_pk_bf16_f32 v45, v18, v19
    v_cvt_pk_bf16_f32 v50, v72, v73
    v_cvt_pk_bf16_f32 v46, v20, v21
    v_cvt_pk_bf16_f32 v51, v74, v75
    v_cvt_pk_bf16_f32 v47, v22, v23
    v_xor_b32_dpp v60, v48, v10 row_mirror row_mask:0xf bank_mask:0xf
    v_xor_b32 v52, 0x80008000, v48
    v_xor_b32_dpp v61, v49, v10 row_mirror row_mask:0xf bank_mask:0xf
    v_xor_b32 v53, 0x80008000, v49
    v_xor_b32_dpp v62, v50, v10 row_mirror row_mask:0xf bank_mask:0xf
    v_xor_b32 v54, 0x80008000, v50
    v_xor_b32_dpp v63, v51, v10 row_mirror row_mask:0xf bank_mask:0xf
    v_xor_b32 v55, 0x80008000, v51
    v_xor_b32_dpp v56, v44, v10 row_mirror row_mask:0xf bank_mask:0xf
    v_xor_b32_dpp v57, v45, v10 row_mirror row_mask:0xf bank_mask:0xf
    v_xor_b32_dpp v58, v46, v10 row_mirror row_mask:0xf bank_mask:0xf
    v_xor_b32_dpp v59, v47, v10 row_mirror row_mask:0xf bank_mask:0xf
    s_cmpk_lt_u32 s2, 224
    s_cbranch_scc1 NOOTH
    buffer_load_dwordx4 v2, s[4:7], s42 offen lds
    buffer_load_dwordx4 v2, s[4:7], s42 offen offset:1024 lds
NOOTH:
    s_cmp_eq_u32 s48, 0
    s_cbranch_scc0 SPEKD
    v_lshlrev_b32 v9, 5, v3
    v_sub_u32 v9, 1008, v9
    v_cvt_f32_u32 v9, v9
    v_mul_f32 v9, v27, v9
    v_mul_f32 v16, v9, v26
    v_cos_f32 v25, v9
    v_fmamk_f32 v20, v9, 0x41800000, v16
    v_add_f32 v17, v16, v9
    v_add_f32 v21, v20, v9
    v_add_f32 v25, v25, v25
    v_sin_f32 v68, v16
    v_cos_f32 v16, v16
    v_sin_f32 v69, v17
    v_cos_f32 v17, v17
    v_sin_f32 v72, v20
    v_cos_f32 v20, v20
    v_sin_f32 v73, v21
    v_cos_f32 v21, v21
    v_fma_f32 v70, v25, v69, -v68
    v_fma_f32 v18, v25, v17, -v16
    v_fma_f32 v74, v25, v73, -v72
    v_fma_f32 v22, v25, v21, -v20
    v_fma_f32 v71, v25, v70, -v69
    v_fma_f32 v19, v25, v18, -v17
    v_fma_f32 v75, v25, v74, -v73
    v_fma_f32 v23, v25, v22, -v21
    v_cvt_pk_bf16_f32 v60, v68, v69
    v_cvt_pk_bf16_f32 v56, v16, v17
    v_cvt_pk_bf16_f32 v61, v70, v71
    v_cvt_pk_bf16_f32 v57, v18, v19
    v_cvt_pk_bf16_f32 v62, v72, v73
    v_cvt_pk_bf16_f32 v58, v20, v21
    v_cvt_pk_bf16_f32 v63, v74, v75
    v_cvt_pk_bf16_f32 v59, v22, v23
SPEKD:
    v_xor_b32 v64, 0x80008000, v56
    v_xor_b32 v65, 0x80008000, v57
    v_xor_b32 v66, 0x80008000, v58
    v_xor_b32 v67, 0x80008000, v59
    v_lshrrev_b32 v9, 1, v3
    v_and_b32 v10, 1, v3
    v_cvt_f32_u32 v9, v9
    v_cvt_f32_u32 v24, v10
    v_cmp_gt_u32 vcc, 32, v1
    v_mov_b32 v68, 0xbe800000
    v_mul_f32 v9, 0x3e000000, v9
    s_cmp_eq_u32 s36, 0
    s_cbranch_scc0 BFQN
    v_lshrrev_b32 v24, 5, v1
    v_cmp_eq_u32 s[100:101], v24, v10
    v_mul_f32 v10, 0x40f00000, v9
    v_cndmask_b32 v10, v10, 0, vcc
    v_cndmask_b32 v9, -v9, v9, vcc
    v_cndmask_b32 v10, -v68, v10, s[100:101]
    v_cndmask_b32 v9, 0, v9, s[100:101]
    v_cndmask_b32 v68, 0, v68, s[100:101]
    s_branch BFGO
BFQN:
    v_mul_f32 v10, 0x3e800000, v24
    v_cndmask_b32 v68, -v68, v68, vcc
BFGO:
    v_cvt_f32_u32 v24, v7
    v_cos_f32 v25, v9
    v_mul_f32 v24, 4.0, v24
    v_fma_f32 v16, v9, v24, v10
    v_add_f32 v25, v25, v25
    v_add_f32 v17, v16, v9
    v_add_f32 v20, v16, v68
    v_add_f32 v21, v17, v68
    v_cos_f32 v16, v16
    v_cos_f32 v17, v17
    v_cos_f32 v20, v20
    v_cos_f32 v21, v21
    v_add_u32 v68, s43, v8
    v_fma_f32 v18, v25, v17, -v16
    v_fma_f32 v22, v25, v21, -v20
    v_fma_f32 v19, v25, v18, -v17
    v_fma_f32 v23, v25, v22, -v21
    v_xor_b32 v69, 16384, v68
    s_lshl_b32 s38, s32, 11
    v_lshl_add_u32 v24, v4, 9, s38
    v_lshl_add_u32 v24, v5, 6, v24
    v_lshl_add_u32 v24, v7, 5, v24
    v_lshl_add_u32 v70, v6, 3, v24
    v_xor_b32 v71, 32, v70
    s_cmp_lt_u32 s32, 4
    s_cselect_b32 s38, 0, 3
    s_lshl_b32 s39, s32, 6
    s_add_u32 s39, s39, 32768
    v_mul_u32_u24 v9, 1040, v3
    v_xor_b32 v24, s38, v4
    v_add_u32 v9, s39, v9
    v_lshl_add_u32 v72, v24, 4, v9
    v_xor_b32 v24, 2, v24
    v_lshl_add_u32 v73, v24, 4, v9
    s_lshl_b32 s38, s32, 2
    s_add_u32 s38, s38, 58112
    v_mov_b32 v74, s38
    s_lshl_b32 s39, s35, 5
    v_add_u32 v75, s39, v74
    s_mul_i32 s38, s32, 2080
    s_add_u32 s38, s38, 32768
    v_sub_u32 v24, 4, v5
    v_and_b32 v24, 3, v24
    v_xor_b32 v24, v24, v4
    v_lshl_add_u32 v9, v3, 6, s38
    v_lshl_add_u32 v76, v24, 4, v9
    v_lshlrev_b32 v80, 4, v4
PAD1:
    s_cbranch_execz RET_A_0
    v_lshlrev_b32 v24, 8, v4
    v_lshl_add_u32 v24, v3, 3, v24
    s_mul_i32 s38, s32, 1088
    s_add_u32 s38, s38, 49408
    v_add_u32 v77, s38, v24
    s_sub_u32 s38, 8, s32
    s_and_b32 s38, s38, 7
    s_mul_i32 s38, s38, 1088
    s_add_u32 s38, s38, 49412
    v_add_u32 v78, s38, v24
    s_lshl_b32 s38, s32, 7
    s_add_u32 s38, s38, 49408
    v_mul_u32_u24 v24, 1088, v5
    v_lshl_add_u32 v9, v4, 2, v6
    v_add_u32 v24, s38, v24
    v_lshl_add_u32 v79, v9, 3, v24
    v_mov_b32 v9, 0
    v_mov_b32 v10, 0
    v_mov_b32 v24, 0
    v_mov_b32 v25, 0
    v_mov_b32 v81, 0
    v_mov_b32 v82, 0
    v_mov_b32 v83, 1
    v_mov_b32 v84, 0
    s_cmpk_lt_u32 s2, 224
    s_cselect_b32 s47, 263, 7
    s_waitcnt vmcnt(0)
    ds_write_b128 v68, v[28:31]
    ds_write_b128 v68, v[32:35] offset:1024
    v_dot2c_f32_bf16 v9, 0x3f803f80, v28
    v_dot2c_f32_bf16 v10, v28, v28
    v_dot2c_f32_bf16 v9, 0x3f803f80, v29
    v_dot2c_f32_bf16 v10, v29, v29
    s_cmpk_ge_u32 s2, 224
    s_cbranch_scc1 MEETB
    s_mov_b64 exec, 1
    ds_add_rtn_u32 v85, v84, v83 offset:58256
    s_mov_b64 exec, -1
    s_waitcnt lgkmcnt(0)
    v_readfirstlane_b32 s38, v85
    s_cmp_eq_u32 s38, 7
    s_cbranch_scc1 GO0
SPIN0:
    ds_read_b32 v85, v84 offset:58256
    s_waitcnt lgkmcnt(0)
    v_cmp_eq_u32 vcc, 8, v85
    s_cbranch_vccz SPIN0
GO0:
    ds_read_b128 v[36:39], v8 offset:49408
    ds_read_b128 v[40:43], v8 offset:50432
    v_dot2c_f32_bf16 v9, 0x3f803f80, v30
    v_dot2c_f32_bf16 v10, v30, v30
    v_dot2c_f32_bf16 v9, 0x3f803f80, v31
    v_dot2c_f32_bf16 v10, v31, v31
    v_dot2c_f32_bf16 v9, 0x3f803f80, v32
    v_dot2c_f32_bf16 v10, v32, v32
    v_dot2c_f32_bf16 v9, 0x3f803f80, v33
    v_dot2c_f32_bf16 v10, v33, v33
    v_dot2c_f32_bf16 v9, 0x3f803f80, v34
    v_dot2c_f32_bf16 v10, v34, v34
    v_dot2c_f32_bf16 v9, 0x3f803f80, v35
    v_dot2c_f32_bf16 v10, v35, v35
    s_waitcnt lgkmcnt(1)
    v_dot2c_f32_bf16 v25, 0x3f803f80, v36
    v_dot2c_f32_bf16 v24, v28, v36
    v_dot2c_f32_bf16 v25, 0x3f803f80, v37
    v_dot2c_f32_bf16 v24, v29, v37
    v_dot2c_f32_bf16 v25, 0x3f803f80, v38
    v_dot2c_f32_bf16 v24, v30, v38
    v_dot2c_f32_bf16 v25, 0x3f803f80, v39
    v_dot2c_f32_bf16 v24, v31, v39
    s_waitcnt lgkmcnt(0)
    v_dot2c_f32_bf16 v25, 0x3f803f80, v40
    v_dot2c_f32_bf16 v24, v32, v40
    v_dot2c_f32_bf16 v25, 0x3f803f80, v41
    v_dot2c_f32_bf16 v24, v33, v41
    v_dot2c_f32_bf16 v25, 0x3f803f80, v42
    v_dot2c_f32_bf16 v24, v34, v42
    v_dot2c_f32_bf16 v25, 0x3f803f80, v43
    v_dot2c_f32_bf16 v24, v35, v43
    v_permlane32_swap_b32 v9, v10
    s_nop 1
    v_permlane32_swap_b32 v24, v25
    v_add_f32 v9, v9, v10
    v_add_f32 v24, v24, v25
    s_nop 1
    v_permlane16_swap_b32 v9, v24
    v_add_f32 v9, v9, v24
    s_nop 1
    v_add_f32_dpp v9, v9, v9 row_ror:8 row_mask:0xf bank_mask:0xf
    s_nop 1
    v_add_f32_dpp v9, v9, v9 row_ror:4 row_mask:0xf bank_mask:0xf
    s_nop 1
    v_add_f32_dpp v9, v9, v9 row_ror:2 row_mask:0xf bank_mask:0xf
    s_nop 1
    v_add_f32_dpp v9, v9, v9 row_ror:1 row_mask:0xf bank_mask:0xf
    s_nop 0
    v_readlane_b32 s49, v9, 0
    v_readlane_b32 s50, v9, 32
    v_readlane_b32 s51, v9, 16
    v_readlane_b32 s52, v9, 48
    v_mul_f32 v2, s49, v27
    v_mul_f32 v10, s50, v27
    v_mov_b32 v24, s51
    v_fma_f32 v10, -v2, v2, v10
    v_fma_f32 v24, -v2, s52, v24
    v_max_f32 v10, 0, v10
    v_add_f32 v10, 0x3727c5ac, v10
    v_rsq_f32 v110, v10
    s_nop 0
    v_mul_f32 v24, v24, v110
    v_ashrrev_i32 v10, 31, v24
    v_or_b32 v10, 0x80000000, v10
    v_xor_b32 v10, v24, v10
    v_and_b32 v10, 0xfffff800, v10
    v_or_b32 v10, s41, v10
    s_mov_b64 exec, 1
    ds_write2_b32 v74, v10, v2 offset0:16 offset1:40
    ds_write_b32 v75, v110
    s_mov_b64 exec, -1
    s_mov_b64 exec, 1
    ds_add_rtn_u32 v85, v84, v83 offset:58260
    s_mov_b64 exec, -1
    s_waitcnt lgkmcnt(0)
    v_readfirstlane_b32 s38, v85
    s_cmp_eq_u32 s38, s47
    s_cbranch_scc1 GO1
    s_add_u32 s47, s47, 1
SPIN1:
    ds_read_b32 v85, v84 offset:58260
    s_waitcnt lgkmcnt(0)
    v_cmp_eq_u32 vcc, s47, v85
    s_cbranch_vccz SPIN1
GO1:
    s_waitcnt vmcnt(0)
    ds_read_b128 v[86:89], v69
    ds_read_b128 v[90:93], v69 offset:1024
    ds_read_b64_tr_b16 v[94:95], v70 offset:0
    ds_read_b64_tr_b16 v[96:97], v70 offset:256
    ds_read_b64_tr_b16 v[98:99], v71 offset:0
    ds_read_b64_tr_b16 v[100:101], v71 offset:256
    ds_read_b64_tr_b16 v[102:103], v70 offset:16384
    ds_read_b64_tr_b16 v[104:105], v70 offset:16640
    ds_read_b64_tr_b16 v[106:107], v71 offset:16384
    ds_read_b64_tr_b16 v[108:109], v71 offset:16640
    s_waitcnt lgkmcnt(8)
    v_dot2c_f32_bf16 v81, 0x3f803f80, v86
    v_dot2c_f32_bf16 v82, v86, v86
    v_dot2c_f32_bf16 v81, 0x3f803f80, v87
    v_dot2c_f32_bf16 v82, v87, v87
    v_dot2c_f32_bf16 v81, 0x3f803f80, v88
    v_dot2c_f32_bf16 v82, v88, v88
    v_dot2c_f32_bf16 v81, 0x3f803f80, v89
    v_dot2c_f32_bf16 v82, v89, v89
    v_dot2c_f32_bf16 v81, 0x3f803f80, v90
    v_dot2c_f32_bf16 v82, v90, v90
    v_dot2c_f32_bf16 v81, 0x3f803f80, v91
    v_dot2c_f32_bf16 v82, v91, v91
    v_dot2c_f32_bf16 v81, 0x3f803f80, v92
    v_dot2c_f32_bf16 v82, v92, v92
    v_dot2c_f32_bf16 v81, 0x3f803f80, v93
    v_dot2c_f32_bf16 v82, v93, v93
    s_nop 2
    v_permlane32_swap_b32 v81, v82
    v_mul_f32 v112, v11, v2
    v_mul_f32 v113, v11, v2
    v_mul_f32 v114, v11, v2
    v_mul_f32 v115, v11, v2
    v_add_f32 v81, v81, v82
    v_mov_b32 v82, v81
    s_waitcnt lgkmcnt(4)
    v_mfma_f32_16x16x32_bf16 v[120:123], v[94:97], v[12:15], v[112:115]
    v_permlane16_swap_b32 v81, v82
    v_mfma_f32_16x16x32_bf16 v[124:127], v[98:101], v[12:15], v[112:115]
    v_add_f32 v81, v81, v82
    s_nop 1
    v_add_f32_dpp v81, v81, v81 row_ror:8 row_mask:0xf bank_mask:0xf
    s_nop 1
    v_add_f32_dpp v81, v81, v81 row_ror:4 row_mask:0xf bank_mask:0xf
    s_nop 1
    v_add_f32_dpp v81, v81, v81 row_ror:2 row_mask:0xf bank_mask:0xf
    s_nop 1
    v_add_f32_dpp v81, v81, v81 row_ror:1 row_mask:0xf bank_mask:0xf
    s_nop 0
    v_readlane_b32 s49, v81, 0
PAD2:
    s_cbranch_execz RET_A_0
    v_readlane_b32 s50, v81, 32
    v_cvt_pk_bf16_f32 v136, v120, v121
    v_cvt_pk_bf16_f32 v137, v122, v123
    v_cvt_pk_bf16_f32 v138, v124, v125
    v_cvt_pk_bf16_f32 v139, v126, v127
    v_mul_f32 v81, s49, v27
    v_mul_f32 v82, s50, v27
    ds_write_b128 v72, v[136:139]
    v_mul_f32 v116, v11, v81
    v_mul_f32 v117, v11, v81
    v_mul_f32 v118, v11, v81
    v_mul_f32 v119, v11, v81
    v_fma_f32 v82, -v81, v81, v82
    s_waitcnt lgkmcnt(1)
    v_mfma_f32_16x16x32_bf16 v[128:131], v[102:105], v[12:15], v[116:119]
    v_mfma_f32_16x16x32_bf16 v[132:135], v[106:109], v[12:15], v[116:119]
    v_max_f32 v82, 0, v82
    v_add_f32 v82, 0x3727c5ac, v82
    v_rsq_f32 v82, v82
    v_xor_b32 v75, 32, v75
    s_mov_b64 exec, 1
    ds_write_b32 v75, v82
    s_mov_b64 exec, -1
    v_cvt_pk_bf16_f32 v140, v128, v129
    v_cvt_pk_bf16_f32 v141, v130, v131
    v_cvt_pk_bf16_f32 v142, v132, v133
    v_cvt_pk_bf16_f32 v143, v134, v135
    ds_write_b128 v73, v[140:143] offset:512
    s_mov_b64 exec, 1
    ds_add_rtn_u32 v85, v84, v83 offset:58264
    s_mov_b64 exec, -1
    ds_read_b128 v[144:147], v76
    ds_read_b128 v[148:151], v76 offset:1040
    ds_read_b128 v[152:155], v80 offset:58112
    s_waitcnt lgkmcnt(3)
    v_readfirstlane_b32 s38, v85
    s_cmp_eq_u32 s38, 7
    s_cbranch_scc1 GO2
SPIN2:
    ds_read_b32 v85, v84 offset:58264
    ds_read_b128 v[144:147], v76
    ds_read_b128 v[148:151], v76 offset:1040
PAD3:
    s_cbranch_execz RET_A_1
    ds_read_b128 v[152:155], v80 offset:58112
    s_waitcnt lgkmcnt(3)
    v_cmp_eq_u32 vcc, 8, v85
    s_cbranch_vccz SPIN2
GO2:
    s_waitcnt lgkmcnt(1)
    s_cmp_eq_u32 s48, 0
    v_mfma_f32_16x16x32_bf16 v[10:13], v[144:147], v[44:47], 0
    v_mfma_f32_16x16x32_bf16 v[24:27], v[144:147], v[52:55], 0
    s_cbranch_scc0 SPECN
    v_mfma_f32_16x16x32_bf16 v[28:31], v[148:151], v[56:59], 0
    v_mfma_f32_16x16x32_bf16 v[32:35], v[148:151], v[60:63], 0
    s_branch SPECD
SPECN:
    v_mfma_f32_16x16x32_bf16 v[28:31], v[144:147], v[56:59], 0
    v_mfma_f32_16x16x32_bf16 v[32:35], v[144:147], v[60:63], 0
    v_mfma_f32_16x16x32_bf16 v[10:13], v[148:151], v[48:51], v[10:13]
    v_mfma_f32_16x16x32_bf16 v[24:27], v[148:151], v[44:47], v[24:27]
    v_mfma_f32_16x16x32_bf16 v[28:31], v[148:151], v[60:63], v[28:31]
    v_mfma_f32_16x16x32_bf16 v[32:35], v[148:151], v[64:67], v[32:35]
SPECD:
    s_waitcnt lgkmcnt(0)
    v_mul_f32 v16, v16, v152
    v_mul_f32 v17, v17, v153
    v_mul_f32 v18, v18, v154
    v_mul_f32 v19, v19, v155
    v_mul_f32 v20, v20, v152
    v_mul_f32 v21, v21, v153
    v_mul_f32 v22, v22, v154
    v_mul_f32 v23, v23, v155
    v_cvt_pk_bf16_f32 v36, v16, v17
    v_cvt_pk_bf16_f32 v37, v18, v19
    v_cvt_pk_bf16_f32 v38, v20, v21
    v_cvt_pk_bf16_f32 v39, v22, v23
    v_cvt_pk_bf16_f32 v40, v10, v11
    v_cvt_pk_bf16_f32 v41, v12, v13
    v_cvt_pk_bf16_f32 v42, v24, v25
    v_cvt_pk_bf16_f32 v43, v26, v27
    s_nop 1
    v_mfma_f32_16x16x32_bf16 v[144:147], v[36:39], v[40:43], 0
    v_cvt_pk_bf16_f32 v68, v28, v29
    v_cvt_pk_bf16_f32 v69, v30, v31
    v_cvt_pk_bf16_f32 v70, v32, v33
    v_cvt_pk_bf16_f32 v71, v34, v35
    s_nop 1
    v_mfma_f32_16x16x32_bf16 v[148:151], v[36:39], v[68:71], 0
    s_nop 0
    v_cvt_pk_bf16_f32 v40, v144, v145
    v_cvt_pk_bf16_f32 v41, v146, v147
    ds_write2_b32 v77, v40, v41 offset1:32
    s_nop 3
    v_cvt_pk_bf16_f32 v68, v148, v149
    v_cvt_pk_bf16_f32 v69, v150, v151
    ds_write2_b32 v78, v68, v69 offset1:32
    s_mov_b64 exec, 1
    ds_add_rtn_u32 v85, v84, v83 offset:58268
    s_mov_b64 exec, -1
    ds_read_b64_tr_b16 v[36:37], v79
    ds_read_b64_tr_b16 v[38:39], v79 offset:4352
    s_waitcnt lgkmcnt(2)
    v_readfirstlane_b32 s38, v85
    s_cmp_eq_u32 s38, 7
    s_cbranch_scc1 GO3
SPIN3:
    ds_read_b32 v85, v84 offset:58268
    ds_read_b64_tr_b16 v[36:37], v79
    ds_read_b64_tr_b16 v[38:39], v79 offset:4352
    s_waitcnt lgkmcnt(2)
    v_cmp_eq_u32 vcc, 8, v85
    s_cbranch_vccz SPIN3
GO3:
    s_and_b32 s47, s34, 15
    s_lshr_b32 s53, s34, 4
    s_lshl3_add_u32 s38, s53, s32
    s_lshl_b32 s38, s38, 7
    s_add_u32 s38, s38, s33
    v_lshl_add_u32 v2, v3, 3, s38
    v_sub_u32 v9, 2048, v2
    v_and_b32 v9, 2047, v9
    s_waitcnt lgkmcnt(0)
    buffer_store_dwordx4 v[36:39], v8, s[8:11], s44 offen sc1
    s_lshl_b32 s38, s47, 6
    v_lshl_add_u32 v73, v4, 4, s38
    v_lshl_add_u32 v81, v2, 11, v73
    v_sub_u32 v73, 2032, v73
    v_lshl_add_u32 v14, v9, 11, v73
    v_and_b32 v73, 7, v2
    v_and_b32 v74, 0x7f8, v2
    v_lshl_add_u32 v15, v73, 11, v74
    v_and_b32 v73, 7, v9
    v_and_b32 v74, 0x7f8, v9
    v_lshl_add_u32 v72, v73, 11, v74
    v_cvt_f32_u32 v75, v2
    v_lshrrev_b32 v73, 5, v1
    v_add_u32 v74, v7, v7
    v_lshl_add_u32 v73, v73, 3, v74
    v_mul_f32 v75, 0x3a000000, v75
    v_cvt_f32_u32 v73, v73
    v_mul_f32 v74, 0x41800000, v75
    v_mul_f32 v10, v75, v73
    v_cos_f32 v80, v74
    v_add_f32 v11, v10, v75
    v_fma_f32 v12, v75, 4.0, v10
    v_fma_f32 v13, v75, 4.0, v11
    v_add_f32 v80, v80, v80
    v_add_f32 v20, v10, v74
    v_add_f32 v21, v11, v74
    v_add_f32 v22, v12, v74
    v_add_f32 v23, v13, v74
    v_sin_f32 v16, v10
    v_cos_f32 v10, v10
    v_sin_f32 v17, v11
    v_cos_f32 v11, v11
    v_sin_f32 v18, v12
    v_cos_f32 v12, v12
    v_sin_f32 v19, v13
    v_cos_f32 v13, v13
    v_sin_f32 v24, v20
    v_cos_f32 v20, v20
    v_sin_f32 v25, v21
    v_cos_f32 v21, v21
    v_sin_f32 v26, v22
    v_cos_f32 v22, v22
    v_sin_f32 v27, v23
    v_cos_f32 v23, v23
    v_cvt_pk_bf16_f32 v40, v10, v16
    v_fma_f32 v10, v80, v20, -v10
    v_fma_f32 v16, v80, v24, -v16
    v_cvt_pk_bf16_f32 v41, v11, v17
    v_fma_f32 v11, v80, v21, -v11
    v_fma_f32 v17, v80, v25, -v17
    v_cvt_pk_bf16_f32 v42, v12, v18
    v_fma_f32 v12, v80, v22, -v12
    v_fma_f32 v18, v80, v26, -v18
    v_cvt_pk_bf16_f32 v43, v13, v19
    v_fma_f32 v13, v80, v23, -v13
    v_fma_f32 v19, v80, v27, -v19
    v_cvt_pk_bf16_f32 v44, v20, v24
    v_fma_f32 v20, v80, v10, -v20
    v_fma_f32 v24, v80, v16, -v24
    v_cvt_pk_bf16_f32 v45, v21, v25
    v_fma_f32 v21, v80, v11, -v21
    v_fma_f32 v25, v80, v17, -v25
    v_cvt_pk_bf16_f32 v46, v22, v26
    v_fma_f32 v22, v80, v12, -v22
    v_fma_f32 v26, v80, v18, -v26
    v_cvt_pk_bf16_f32 v47, v23, v27
    v_fma_f32 v23, v80, v13, -v23
    v_fma_f32 v27, v80, v19, -v27
    v_cvt_pk_bf16_f32 v48, v10, v16
    v_fma_f32 v10, v80, v20, -v10
    v_fma_f32 v16, v80, v24, -v16
    v_cvt_pk_bf16_f32 v49, v11, v17
    v_fma_f32 v11, v80, v21, -v11
    v_fma_f32 v17, v80, v25, -v17
    v_cvt_pk_bf16_f32 v50, v12, v18
    v_fma_f32 v12, v80, v22, -v12
    v_fma_f32 v18, v80, v26, -v18
    v_cvt_pk_bf16_f32 v51, v13, v19
    v_fma_f32 v13, v80, v23, -v13
    v_fma_f32 v19, v80, v27, -v19
    v_cvt_pk_bf16_f32 v52, v20, v24
    v_fma_f32 v20, v80, v10, -v20
    v_fma_f32 v24, v80, v16, -v24
    v_cvt_pk_bf16_f32 v53, v21, v25
PAD4:
    s_cbranch_execz RET_A_1
    v_fma_f32 v21, v80, v11, -v21
    v_fma_f32 v25, v80, v17, -v25
    v_cvt_pk_bf16_f32 v54, v22, v26
    v_fma_f32 v22, v80, v12, -v22
    v_fma_f32 v26, v80, v18, -v26
    v_cvt_pk_bf16_f32 v55, v23, v27
    v_fma_f32 v23, v80, v13, -v23
    v_fma_f32 v27, v80, v19, -v27
    v_cvt_pk_bf16_f32 v56, v10, v16
    v_fma_f32 v10, v80, v20, -v10
    v_fma_f32 v16, v80, v24, -v16
    v_cvt_pk_bf16_f32 v57, v11, v17
    v_fma_f32 v11, v80, v21, -v11
    v_fma_f32 v17, v80, v25, -v17
    v_cvt_pk_bf16_f32 v58, v12, v18
    v_fma_f32 v12, v80, v22, -v12
    v_fma_f32 v18, v80, v26, -v18
    v_cvt_pk_bf16_f32 v59, v13, v19
    v_fma_f32 v13, v80, v23, -v13
    v_fma_f32 v19, v80, v27, -v19
    v_cvt_pk_bf16_f32 v60, v20, v24
    v_fma_f32 v20, v80, v10, -v20
    v_fma_f32 v24, v80, v16, -v24
    v_cvt_pk_bf16_f32 v61, v21, v25
    v_fma_f32 v21, v80, v11, -v21
    v_fma_f32 v25, v80, v17, -v25
    v_cvt_pk_bf16_f32 v62, v22, v26
    v_fma_f32 v22, v80, v12, -v22
    v_fma_f32 v26, v80, v18, -v26
    v_cvt_pk_bf16_f32 v63, v23, v27
    v_fma_f32 v23, v80, v13, -v23
    v_fma_f32 v27, v80, v19, -v27
    v_cvt_pk_bf16_f32 v64, v10, v16
    v_cvt_pk_bf16_f32 v65, v11, v17
    v_cvt_pk_bf16_f32 v66, v12, v18
    v_cvt_pk_bf16_f32 v67, v13, v19
    v_cvt_pk_bf16_f32 v68, v20, v24
    v_cvt_pk_bf16_f32 v69, v21, v25
    v_cvt_pk_bf16_f32 v70, v22, v26
    v_cvt_pk_bf16_f32 v71, v23, v27
    v_and_b32 v73, 1, v3
    v_cmp_gt_u32 vcc, 16, v1
    v_lshlrev_b32 v73, 31, v73
    v_or_b32 v73, 0x3f803f80, v73
    v_cndmask_b32 v40, v40, v73, vcc
    s_barrier
    s_lshl_b32 s38, s33, 10
    s_mul_i32 s39, s32, 262144
    s_add_u32 s38, s38, s39
    s_lshl_b32 s54, s47, 6
    s_add_u32 s55, s54, 64
    s_add_u32 s54, s54, s38
    s_and_b32 s55, s55, 1023
    s_add_u32 s41, s54, 8192
    s_add_u32 s55, s55, s38
    v_lshrrev_b32 v18, 2, v1
    v_and_b32 v19, 1, v1
    v_bfe_u32 v20, v1, 1, 1
    v_mul_u32_u24 v73, 16384, v18
    v_lshl_add_u32 v75, v6, 4, v73
    v_lshl_add_u32 v80, v19, 4, v73
    s_mul_i32 s38, s32, 3072
    v_lshl_add_u32 v73, v18, 1, v19
    v_mul_u32_u24 v73, 96, v73
    v_add_u32 v12, s38, v73
    v_mad_u32_u24 v10, v20, 24, v12
    v_lshl_add_u32 v11, v20, 3, v12
    v_lshrrev_b32 v73, 5, v1
    v_lshl_add_u32 v74, v7, 2, v5
    v_lshl_add_u32 v73, v73, 4, v74
    v_mul_u32_u24 v73, 96, v73
    v_lshl_add_u32 v13, v6, 3, v73
    s_cmp_eq_u32 s47, 0
    s_cselect_b32 s38, 0x0908, 0
    s_xor_b32 s38, s38, 0x07060504
    v_cmp_eq_u32 vcc, 1, v20
    v_mov_b32 v73, 0x07060100
    v_mov_b32 v17, 0x07060504
    v_mov_b32 v16, s38
    v_cndmask_b32 v17, v17, v73, vcc
    v_cndmask_b32 v16, v16, v73, vcc
    v_lshrrev_b32 v73, 1, v5
    v_lshl_add_u32 v73, v7, 1, v73
    v_lshlrev_b32 v74, 10, v4
    v_lshl_add_u32 v74, v5, 7, v74
    v_lshl_add_u32 v74, v6, 3, v74
    v_lshl_add_u32 v74, v73, 5, v74
    s_lshl_b32 s38, s32, 12
    s_add_u32 s38, s38, 126976
    v_add_u32 v22, s38, v74
    s_and_b32 s38, s32, 3
    s_lshl_b32 s38, s38, 5
    v_xor_b32 v74, s38, v74
    s_lshr_b32 s39, s32, 2
    s_lshl_b32 s38, s39, 15
    s_add_u32 s38, s38, 61440
    v_add_u32 v21, s38, v74
    v_lshlrev_b32 v73, 4, v19
    v_lshl_add_u32 v23, v4, 5, v73
    s_lshl_b32 s52, s46, 12
    s_add_u32 s52, s52, 2949120
    s_lshl_b32 s38, s45, 9
    s_add_u32 s44, s52, s38
    s_lshl_b32 s38, s39, 8
    s_add_u32 s44, s44, s38
    s_bfe_u32 s38, s32, 0x10001
    s_lshl_b32 s38, s38, 11
    s_add_u32 s44, s44, s38
    s_and_b32 s38, s32, 1
    s_lshl_b32 s38, s38, 7
    s_add_u32 s44, s44, s38
    s_cmp_lt_u32 s2, 224
    s_cselect_b32 s44, s44, 117440512
    s_lshl_b32 s38, s39, 11
    s_add_u32 s52, s52, s38
    v_lshl_add_u32 v73, v20, 8, v73
    v_lshl_add_u32 v73, v4, 6, v73
    v_and_b32 v74, 1, v5
    v_lshl_add_u32 v73, v74, 5, v73
    v_lshrrev_b32 v74, 1, v5
    v_lshl_add_u32 v24, v74, 10, v73
    v_mul_u32_u24 v73, 229376, v19
    v_lshl_add_u32 v73, v7, 5, v73
    v_lshrrev_b32 v74, 5, v1
    v_lshl_add_u32 v25, v74, 4, v73
    s_and_b32 s38, s32, 3
    s_lshl2_add_u32 s38, s45, s38
    s_mul_i32 s42, s38, 14336
    s_lshl1_add_u32 s38, s46, s39
    s_lshl_b32 s38, s38, 6
    s_add_u32 s42, s42, s38
    s_add_u32 s42, s42, 2490368
    s_mov_b32 s50, 0x00030003
    s_mov_b32 s51, 0x00030003
    s_mov_b32 s43, 2359296
    s_mov_b32 s48, 0
    s_mov_b32 s26, s6
    s_mov_b32 s27, s7
    v_mov_b32 v73, 0
    s_mov_b64 exec, 0
    s_cmp_eq_u32 s32, 0
    s_cbranch_scc1 PAD5
    s_cmp_eq_u32 s32, 1
    s_cbranch_scc1 PAD6
    s_cmp_eq_u32 s32, 2
    s_cbranch_scc1 PAD7
    s_cmp_eq_u32 s32, 3
    s_cbranch_scc1 PAD9
RET_B_0:
    s_mov_b64 exec, -1
    s_barrier
    s_barrier
    ds_read_b128 v[90:93], v8 offset:58368
    ds_read_b64_tr_b16 v[76:77], v21 offset:0
    ds_read_b64_tr_b16 v[78:79], v21 offset:512
    ds_read_b64 v[36:37], v73 offset:58240
    ds_read_b64_tr_b16 v[122:123], v21 offset:4096
    ds_read_b64_tr_b16 v[124:125], v21 offset:4608
    ds_read_b64_tr_b16 v[126:127], v21 offset:8192
    ds_read_b64_tr_b16 v[128:129], v21 offset:8704
    ds_read_b64_tr_b16 v[130:131], v21 offset:12288
    ds_read_b64_tr_b16 v[132:133], v21 offset:12800
PAD5:
    s_cbranch_execz RET_B_0
    s_waitcnt lgkmcnt(9)
    v_mov_b32_dpp v94, v90 row_shl:2 row_mask:0xf bank_mask:0xf
    v_mov_b32_dpp v95, v91 row_shl:2 row_mask:0xf bank_mask:0xf
    v_mov_b32_dpp v96, v92 row_shl:2 row_mask:0xf bank_mask:0xf
    v_mov_b32_dpp v97, v93 row_shl:2 row_mask:0xf bank_mask:0xf
    s_waitcnt lgkmcnt(7)
    v_mfma_f32_16x16x32_bf16 v[134:137], v[76:79], v[90:93], 0
    ds_read_b64_tr_b16 v[76:77], v21 offset:16384
    ds_read_b64_tr_b16 v[78:79], v21 offset:16896
    v_mov_b32_dpp v98, v90 row_shl:4 row_mask:0xf bank_mask:0xf
    v_mov_b32_dpp v99, v91 row_shl:4 row_mask:0xf bank_mask:0xf
    v_mov_b32_dpp v100, v92 row_shl:4 row_mask:0xf bank_mask:0xf
    v_mov_b32_dpp v101, v93 row_shl:4 row_mask:0xf bank_mask:0xf
    s_waitcnt lgkmcnt(6)
    v_mfma_f32_16x16x32_bf16 v[138:141], v[122:125], v[94:97], 0
    ds_read_b64_tr_b16 v[122:123], v21 offset:20480
    ds_read_b64_tr_b16 v[124:125], v21 offset:20992
    v_mov_b32_dpp v102, v90 row_shl:6 row_mask:0xf bank_mask:0xf
    v_mov_b32_dpp v103, v91 row_shl:6 row_mask:0xf bank_mask:0xf
    v_mov_b32_dpp v104, v92 row_shl:6 row_mask:0xf bank_mask:0xf
    v_mov_b32_dpp v105, v93 row_shl:6 row_mask:0xf bank_mask:0xf
    s_waitcnt lgkmcnt(6)
    v_mfma_f32_16x16x32_bf16 v[134:137], v[126:129], v[98:101], v[134:137]
    ds_read_b64_tr_b16 v[126:127], v21 offset:24576
    ds_read_b64_tr_b16 v[128:129], v21 offset:25088
    v_mov_b32_dpp v106, v90 row_shl:8 row_mask:0xf bank_mask:0xf
    v_mov_b32_dpp v107, v91 row_shl:8 row_mask:0xf bank_mask:0xf
    v_mov_b32_dpp v108, v92 row_shl:8 row_mask:0xf bank_mask:0xf
    v_mov_b32_dpp v109, v93 row_shl:8 row_mask:0xf bank_mask:0xf
    s_waitcnt lgkmcnt(6)
    v_mfma_f32_16x16x32_bf16 v[138:141], v[130:133], v[102:105], v[138:141]
    ds_read_b64_tr_b16 v[130:131], v21 offset:28672
    ds_read_b64_tr_b16 v[132:133], v21 offset:29184
    v_mov_b32_dpp v110, v90 row_shl:10 row_mask:0xf bank_mask:0xf
    v_mov_b32_dpp v111, v91 row_shl:10 row_mask:0xf bank_mask:0xf
    v_mov_b32_dpp v112, v92 row_shl:10 row_mask:0xf bank_mask:0xf
    v_mov_b32_dpp v113, v93 row_shl:10 row_mask:0xf bank_mask:0xf
    s_waitcnt lgkmcnt(6)
    v_mfma_f32_16x16x32_bf16 v[134:137], v[76:79], v[106:109], v[134:137]
    v_mov_b32_dpp v114, v90 row_shl:12 row_mask:0xf bank_mask:0xf
    v_mov_b32_dpp v115, v91 row_shl:12 row_mask:0xf bank_mask:0xf
    v_mov_b32_dpp v116, v92 row_shl:12 row_mask:0xf bank_mask:0xf
    v_mov_b32_dpp v117, v93 row_shl:12 row_mask:0xf bank_mask:0xf
    s_waitcnt lgkmcnt(4)
    v_mfma_f32_16x16x32_bf16 v[138:141], v[122:125], v[110:113], v[138:141]
    v_mov_b32_dpp v118, v90 row_shl:14 row_mask:0xf bank_mask:0xf
    v_mov_b32_dpp v119, v91 row_shl:14 row_mask:0xf bank_mask:0xf
    v_mov_b32_dpp v120, v92 row_shl:14 row_mask:0xf bank_mask:0xf
    v_mov_b32_dpp v121, v93 row_shl:14 row_mask:0xf bank_mask:0xf
    s_waitcnt lgkmcnt(2)
    v_mfma_f32_16x16x32_bf16 v[134:137], v[126:129], v[114:117], v[134:137]
    s_waitcnt lgkmcnt(0)
    v_mfma_f32_16x16x32_bf16 v[138:141], v[130:133], v[118:121], v[138:141]
    v_cmp_eq_u32 s[34:35], v2, v36
    v_cmp_eq_u32 vcc, v2, v37
    v_cmp_eq_u32 s[36:37], v9, v36
    v_cmp_eq_u32 s[46:47], v9, v37
    v_lshlrev_b32 v74, 5, v4
    v_cndmask_b32 v2, 0, 64, vcc
    v_cndmask_b32 v9, 0, 64, s[46:47]
    s_nop 0
    v_add_f32 v134, v134, v138
    v_add_f32 v135, v135, v139
    v_add_f32 v136, v136, v140
    v_add_f32 v137, v137, v141
    s_mov_b64 exec, s[50:51]
    buffer_store_dwordx4 v[134:137], v23, s[8:11], s44 offen sc1
    s_mov_b64 exec, -1
    s_barrier
    buffer_load_dwordx4 v[26:29], v75, s[8:11], s54 offen
    buffer_load_dwordx4 v[30:33], v75, s[8:11], s41 offen
    buffer_load_dword v20, v80, s[8:11], s55 offen
    buffer_load_dwordx2 v[18:19], v15, s[8:11], s43 offen sc1
    buffer_load_dwordx2 v[34:35], v72, s[8:11], s43 offen sc1
    s_cmpk_lt_u32 s2, 224
    s_cbranch_scc1 NORES
    buffer_load_dwordx4 v[82:85], v81, s[4:7], 0 offen
    buffer_load_dwordx4 v[86:89], v14, s[4:7], 0 offen
NORES:
    s_or_b64 s[34:35], s[34:35], vcc
    s_or_b64 s[36:37], s[36:37], s[46:47]
    v_lshl_add_u32 v2, v2, 1, v74
    v_sub_u32 v74, 96, v74
    v_lshl_add_u32 v9, v9, 1, v74
    s_waitcnt vmcnt(0)
UCHK:
    v_max3_u32 v73, v26, v27, v28
    v_max3_u32 v74, v30, v31, v32
    v_max3_u32 v73, v73, v29, v33
    v_max3_u32 v74, v74, v20, v18
    v_max3_u32 v73, v73, v19, v34
    v_max3_u32 v73, v73, v74, v35
    v_cmp_eq_u32 vcc, -1, v73
    s_cbranch_vccnz URETRY
UOK:
    s_cmpk_ge_u32 s2, 224
    s_cbranch_scc1 NOHX
    buffer_load_dwordx4 v[90:93], v24, s[8:11], s52 offen
    buffer_load_dwordx4 v[94:97], v24, s[8:11], s52 offen offset:512
NOHX:
    v_perm_b32 v73, v26, v30, v16
    v_perm_b32 v30, v30, v26, v17
    ds_write_b32 v12, v20 offset:32
    v_mov_b32 v26, v73
    ds_write_b64 v10, v[28:29] offset:40
    ds_write_b64 v11, v[32:33] offset:48
    ds_write_b64 v11, v[30:31] offset:8
    ds_write_b64 v10, v[26:27]
    s_cbranch_scc1 NODN
    v_mov_b32 v106, 0
    v_xor_b32 v107, 32, v22
    v_xor_b32 v108, 64, v22
    v_xor_b32 v109, 96, v22
    ds_read_b32 v8, v106 offset:58252
    ds_read_b64_tr_b16 v[36:37], v22 offset:0
    ds_read_b64_tr_b16 v[38:39], v22 offset:512
    ds_read_b64_tr_b16 v[76:77], v107 offset:0
    ds_read_b64_tr_b16 v[78:79], v107 offset:512
    ds_read_b64_tr_b16 v[98:99], v108 offset:0
    ds_read_b64_tr_b16 v[100:101], v108 offset:512
    ds_read_b64_tr_b16 v[102:103], v109 offset:0
    ds_read_b64_tr_b16 v[104:105], v109 offset:512
    s_mov_b32 s48, 0
    s_waitcnt vmcnt(0)
HCHK:
    v_add_f32 v90, v90, v94
    v_add_f32 v91, v91, v95
    v_add_f32 v92, v92, v96
    v_add_f32 v93, v93, v97
    v_add_f32_dpp v90, v90, v90 row_ror:8 row_mask:0xf bank_mask:0xf
    v_add_f32_dpp v91, v91, v91 row_ror:8 row_mask:0xf bank_mask:0xf
    v_add_f32_dpp v92, v92, v92 row_ror:8 row_mask:0xf bank_mask:0xf
    v_add_f32_dpp v93, v93, v93 row_ror:8 row_mask:0xf bank_mask:0xf
    v_cmp_u_f32 vcc, v90, v91
    v_cmp_u_f32 s[46:47], v92, v93
    v_mov_b32_dpp v130, v90 quad_perm:[0,1,0,1] row_mask:0xf bank_mask:0xf
    v_mov_b32_dpp v131, v91 quad_perm:[0,1,0,1] row_mask:0xf bank_mask:0xf
    v_mov_b32_dpp v132, v92 quad_perm:[0,1,0,1] row_mask:0xf bank_mask:0xf
    v_mov_b32_dpp v133, v93 quad_perm:[0,1,0,1] row_mask:0xf bank_mask:0xf
    s_or_b64 vcc, vcc, s[46:47]
    s_cbranch_scc1 HRETRY
HOK:
    buffer_load_dwordx4 v[82:85], v81, s[4:7], 0 offen
    buffer_load_dwordx4 v[86:89], v14, s[4:7], 0 offen
    v_mul_f32 v126, 0xbfb8aa3b, v130
    v_mul_f32 v127, 0xbfb8aa3b, v131
    v_mul_f32 v128, 0xbfb8aa3b, v132
    v_mul_f32 v129, 0xbfb8aa3b, v133
    v_exp_f32 v126, v126
    v_mul_f32_dpp v130, v90, v130 quad_perm:[2,3,2,3] row_mask:0xf bank_mask:0xf
    v_exp_f32 v127, v127
    v_mul_f32_dpp v131, v91, v131 quad_perm:[2,3,2,3] row_mask:0xf bank_mask:0xf
    v_exp_f32 v128, v128
    v_mul_f32_dpp v132, v92, v132 quad_perm:[2,3,2,3] row_mask:0xf bank_mask:0xf
    v_exp_f32 v129, v129
    v_mul_f32_dpp v133, v93, v133 quad_perm:[2,3,2,3] row_mask:0xf bank_mask:0xf
    v_add_f32 v126, 1.0, v126
PAD6:
    s_cbranch_execz RET_B_0
    v_add_f32 v127, 1.0, v127
    v_add_f32 v128, 1.0, v128
    v_add_f32 v129, 1.0, v129
    v_rcp_f32 v126, v126
    v_rcp_f32 v127, v127
    v_rcp_f32 v128, v128
    v_rcp_f32 v129, v129
    s_mov_b32 s48, 0
    s_waitcnt lgkmcnt(8)
DCHK:
    v_cmp_eq_u32 vcc, -1, v8
    s_cbranch_vccnz DRETRY
DOK:
    v_mul_f32 v130, v130, v126
    v_mul_f32 v131, v131, v127
    v_mul_f32 v132, v132, v128
    v_mul_f32 v133, v133, v129
    v_cvt_pk_bf16_f32 v138, v130, v131
    v_cvt_pk_bf16_f32 v139, v132, v133
    s_add_u32 s52, s42, 7168
    v_mov_b32_dpp v140, v138 row_shl:4 row_mask:0xf bank_mask:0xf
    v_mov_b32_dpp v141, v139 row_shl:4 row_mask:0xf bank_mask:0xf
    s_waitcnt lgkmcnt(6)
    s_nop 0
    v_mfma_f32_16x16x32_bf16 v[110:113], v[36:39], v[138:141], 0
    s_waitcnt lgkmcnt(4)
    v_mfma_f32_16x16x32_bf16 v[114:117], v[76:79], v[138:141], 0
    s_waitcnt lgkmcnt(2)
    v_mfma_f32_16x16x32_bf16 v[118:121], v[98:101], v[138:141], 0
    s_waitcnt lgkmcnt(0)
    v_mfma_f32_16x16x32_bf16 v[122:125], v[102:105], v[138:141], 0
    s_nop 1
    v_cvt_pk_bf16_f32 v126, v110, v111
    v_cvt_pk_bf16_f32 v127, v112, v113
    v_cvt_pk_bf16_f32 v128, v114, v115
    v_cvt_pk_bf16_f32 v129, v116, v117
    s_nop 0
    v_permlane16_swap_b32 v126, v128
    v_permlane16_swap_b32 v127, v129
    s_mov_b64 exec, s[50:51]
    buffer_store_dwordx4 v[126:129], v25, s[8:11], s42 offen sc1
    s_mov_b64 exec, -1
    v_cvt_pk_bf16_f32 v130, v118, v119
    v_cvt_pk_bf16_f32 v131, v120, v121
    v_cvt_pk_bf16_f32 v132, v122, v123
    v_cvt_pk_bf16_f32 v133, v124, v125
    s_nop 0
    v_permlane16_swap_b32 v130, v132
    v_permlane16_swap_b32 v131, v133
    s_mov_b64 exec, s[50:51]
    buffer_store_dwordx4 v[130:133], v25, s[8:11], s52 offen sc1
    s_mov_b64 exec, -1
DNJ:
    s_barrier
    ds_read_b64_tr_b16 v[76:77], v13 offset:0
    ds_read_b64_tr_b16 v[78:79], v13 offset:768
    ds_read_b64_tr_b16 v[90:91], v13 offset:40
    ds_read_b64_tr_b16 v[92:93], v13 offset:808
    ds_read_b64_tr_b16 v[94:95], v13 offset:8
    ds_read_b64_tr_b16 v[96:97], v13 offset:776
    ds_read_b64_tr_b16 v[98:99], v13 offset:3072
    ds_read_b64_tr_b16 v[100:101], v13 offset:3840
    ds_read_b64_tr_b16 v[102:103], v13 offset:3112
    ds_read_b64_tr_b16 v[104:105], v13 offset:3880
    ds_read_b64_tr_b16 v[106:107], v13 offset:3080
    ds_read_b64_tr_b16 v[108:109], v13 offset:3848
    s_waitcnt lgkmcnt(10)
    v_mfma_f32_16x16x32_bf16 v[26:29], v[76:79], v[40:43], 0
    s_waitcnt lgkmcnt(8)
    v_mfma_f32_16x16x32_bf16 v[30:33], v[90:93], v[40:43], 0
    s_waitcnt lgkmcnt(6)
    v_mfma_f32_16x16x32_bf16 v[36:39], v[94:97], v[40:43], 0
    ds_read_b64_tr_b16 v[76:77], v13 offset:6144
    ds_read_b64_tr_b16 v[78:79], v13 offset:6912
    ds_read_b64_tr_b16 v[90:91], v13 offset:6184
    ds_read_b64_tr_b16 v[92:93], v13 offset:6952
    ds_read_b64_tr_b16 v[94:95], v13 offset:6152
    ds_read_b64_tr_b16 v[96:97], v13 offset:6920
    s_waitcnt lgkmcnt(10)
    v_mfma_f32_16x16x32_bf16 v[26:29], v[98:101], v[44:47], v[26:29]
    s_waitcnt lgkmcnt(8)
    v_mfma_f32_16x16x32_bf16 v[30:33], v[102:105], v[44:47], v[30:33]
    s_waitcnt lgkmcnt(6)
    v_mfma_f32_16x16x32_bf16 v[36:39], v[106:109], v[44:47], v[36:39]
    ds_read_b64_tr_b16 v[98:99], v13 offset:9216
    ds_read_b64_tr_b16 v[100:101], v13 offset:9984
    ds_read_b64_tr_b16 v[102:103], v13 offset:9256
    ds_read_b64_tr_b16 v[104:105], v13 offset:10024
    ds_read_b64_tr_b16 v[106:107], v13 offset:9224
    ds_read_b64_tr_b16 v[108:109], v13 offset:9992
    s_waitcnt lgkmcnt(10)
    v_mfma_f32_16x16x32_bf16 v[26:29], v[76:79], v[48:51], v[26:29]
    s_waitcnt lgkmcnt(8)
    v_mfma_f32_16x16x32_bf16 v[30:33], v[90:93], v[48:51], v[30:33]
    s_waitcnt lgkmcnt(6)
    v_mfma_f32_16x16x32_bf16 v[36:39], v[94:97], v[48:51], v[36:39]
    ds_read_b64_tr_b16 v[76:77], v13 offset:12288
    ds_read_b64_tr_b16 v[78:79], v13 offset:13056
    ds_read_b64_tr_b16 v[90:91], v13 offset:12328
    ds_read_b64_tr_b16 v[92:93], v13 offset:13096
    ds_read_b64_tr_b16 v[94:95], v13 offset:12296
    ds_read_b64_tr_b16 v[96:97], v13 offset:13064
    s_waitcnt lgkmcnt(10)
    v_mfma_f32_16x16x32_bf16 v[26:29], v[98:101], v[52:55], v[26:29]
    s_waitcnt lgkmcnt(8)
    v_mfma_f32_16x16x32_bf16 v[30:33], v[102:105], v[52:55], v[30:33]
    s_waitcnt lgkmcnt(6)
    v_mfma_f32_16x16x32_bf16 v[36:39], v[106:109], v[52:55], v[36:39]
    ds_read_b64_tr_b16 v[98:99], v13 offset:15360
    ds_read_b64_tr_b16 v[100:101], v13 offset:16128
    ds_read_b64_tr_b16 v[102:103], v13 offset:15400
    ds_read_b64_tr_b16 v[104:105], v13 offset:16168
    ds_read_b64_tr_b16 v[106:107], v13 offset:15368
    ds_read_b64_tr_b16 v[108:109], v13 offset:16136
    s_waitcnt lgkmcnt(10)
    v_mfma_f32_16x16x32_bf16 v[26:29], v[76:79], v[56:59], v[26:29]
    s_waitcnt lgkmcnt(8)
    v_mfma_f32_16x16x32_bf16 v[30:33], v[90:93], v[56:59], v[30:33]
    s_waitcnt lgkmcnt(6)
    v_mfma_f32_16x16x32_bf16 v[36:39], v[94:97], v[56:59], v[36:39]
    ds_read_b64_tr_b16 v[76:77], v13 offset:18432
    ds_read_b64_tr_b16 v[78:79], v13 offset:19200
    ds_read_b64_tr_b16 v[90:91], v13 offset:18472
    ds_read_b64_tr_b16 v[92:93], v13 offset:19240
    ds_read_b64_tr_b16 v[94:95], v13 offset:18440
    ds_read_b64_tr_b16 v[96:97], v13 offset:19208
    s_waitcnt lgkmcnt(10)
    v_mfma_f32_16x16x32_bf16 v[26:29], v[98:101], v[60:63], v[26:29]
    s_waitcnt lgkmcnt(8)
    v_mfma_f32_16x16x32_bf16 v[30:33], v[102:105], v[60:63], v[30:33]
    s_waitcnt lgkmcnt(6)
    v_mfma_f32_16x16x32_bf16 v[36:39], v[106:109], v[60:63], v[36:39]
    ds_read_b64_tr_b16 v[98:99], v13 offset:21504
    ds_read_b64_tr_b16 v[100:101], v13 offset:22272
    ds_read_b64_tr_b16 v[102:103], v13 offset:21544
    ds_read_b64_tr_b16 v[104:105], v13 offset:22312
    ds_read_b64_tr_b16 v[106:107], v13 offset:21512
    ds_read_b64_tr_b16 v[108:109], v13 offset:22280
    s_waitcnt vmcnt(2)
    v_lshlrev_b32 v40, 16, v82
    v_and_b32 v41, 0xffff0000, v82
    v_lshlrev_b32 v42, 16, v83
    v_and_b32 v43, 0xffff0000, v83
    v_lshlrev_b32 v44, 16, v84
    v_and_b32 v45, 0xffff0000, v84
    v_lshlrev_b32 v46, 16, v85
    v_and_b32 v47, 0xffff0000, v85
    v_lshlrev_b32 v48, 16, v86
    v_and_b32 v49, 0xffff0000, v86
    v_lshlrev_b32 v50, 16, v87
    v_and_b32 v51, 0xffff0000, v87
    v_lshlrev_b32 v52, 16, v88
    v_and_b32 v53, 0xffff0000, v88
    v_lshlrev_b32 v54, 16, v89
    v_and_b32 v55, 0xffff0000, v89
    v_mul_f32 v19, -v18, v19
    v_add_f32 v18, 1.0, v18
    v_mul_f32 v35, -v34, v35
    v_add_f32 v34, 1.0, v34
    v_fma_f32 v40, v40, v18, v19
    v_fma_f32 v41, v41, v18, v19
PAD7:
    s_cbranch_execz RET_B_0
    v_fma_f32 v42, v42, v18, v19
    v_fma_f32 v43, v43, v18, v19
    v_fma_f32 v44, v44, v18, v19
    v_fma_f32 v45, v45, v18, v19
    v_fma_f32 v46, v46, v18, v19
    v_fma_f32 v47, v47, v18, v19
    v_fma_f32 v48, v48, v34, v35
    v_fma_f32 v49, v49, v34, v35
    v_fma_f32 v50, v50, v34, v35
    v_fma_f32 v51, v51, v34, v35
    v_fma_f32 v52, v52, v34, v35
    v_fma_f32 v53, v53, v34, v35
    v_fma_f32 v54, v54, v34, v35
    v_fma_f32 v55, v55, v34, v35
    s_waitcnt lgkmcnt(10)
    v_mfma_f32_16x16x32_bf16 v[26:29], v[76:79], v[64:67], v[26:29]
    s_waitcnt lgkmcnt(8)
    v_mfma_f32_16x16x32_bf16 v[30:33], v[90:93], v[64:67], v[30:33]
    s_waitcnt lgkmcnt(6)
    v_mfma_f32_16x16x32_bf16 v[36:39], v[94:97], v[64:67], v[36:39]
    s_waitcnt lgkmcnt(4)
    v_mfma_f32_16x16x32_bf16 v[26:29], v[98:101], v[68:71], v[26:29]
    s_waitcnt lgkmcnt(2)
    v_mfma_f32_16x16x32_bf16 v[30:33], v[102:105], v[68:71], v[30:33]
    s_waitcnt lgkmcnt(0)
    v_mfma_f32_16x16x32_bf16 v[36:39], v[106:109], v[68:71], v[36:39]
    v_bfrev_b32 v73, 1
    v_cndmask_b32 v81, v81, v73, s[34:35]
    v_cndmask_b32 v14, v14, v73, s[36:37]
    s_nop 0
    v_add_f32 v40, v40, v26
    v_add_f32 v41, v41, v27
    v_add_f32 v42, v42, v28
    v_add_f32 v43, v43, v29
    v_add_f32 v53, v53, v29
    v_add_f32 v54, v54, v28
    v_add_f32 v55, v55, v27
    v_add_f32 v44, v44, v30
    v_add_f32 v49, v49, v33
    v_add_f32 v45, v45, v31
    v_add_f32 v50, v50, v32
    v_add_f32 v46, v46, v32
    v_add_f32 v51, v51, v31
    v_add_f32 v47, v47, v33
    v_add_f32 v52, v52, v30
    v_add_f32 v48, v48, v36
    v_cvt_pk_bf16_f32 v16, v40, v41
    v_cvt_pk_bf16_f32 v17, v42, v43
    v_cvt_pk_bf16_f32 v18, v44, v45
    v_cvt_pk_bf16_f32 v19, v46, v47
    v_cvt_pk_bf16_f32 v56, v48, v49
    v_cvt_pk_bf16_f32 v57, v50, v51
    v_cvt_pk_bf16_f32 v58, v52, v53
    v_cvt_pk_bf16_f32 v59, v54, v55
    s_or_b64 vcc, s[34:35], s[36:37]
    s_cbranch_scc1 FINW
FIND:
COUT:
    buffer_store_dwordx4 v[16:19], v81, s[24:27], 0 offen sc1 nt
    buffer_store_dwordx4 v[56:59], v14, s[24:27], 0 offen sc1 nt
END:
    s_endpgm
URETRY:
    s_add_u32 s48, s48, 1
    s_cmp_ge_u32 s48, 4096
    s_cbranch_scc1 UOK
    buffer_load_dwordx4 v[26:29], v75, s[8:11], s54 offen sc1
    buffer_load_dwordx4 v[30:33], v75, s[8:11], s41 offen sc1
    buffer_load_dword v20, v80, s[8:11], s55 offen sc1
    buffer_load_dwordx2 v[18:19], v15, s[8:11], s43 offen sc1
    buffer_load_dwordx2 v[34:35], v72, s[8:11], s43 offen sc1
    s_waitcnt vmcnt(0)
    s_branch UCHK
HRETRY:
    s_add_u32 s48, s48, 1
    s_cmp_ge_u32 s48, 4096
    s_cbranch_scc1 HOK
    buffer_load_dwordx4 v[90:93], v24, s[8:11], s52 offen sc1
    buffer_load_dwordx4 v[94:97], v24, s[8:11], s52 offen offset:512 sc1
    s_waitcnt vmcnt(0)
    s_branch HCHK
DRETRY:
    s_add_u32 s48, s48, 1
    s_cmp_ge_u32 s48, 65536
    s_nop 1
    s_cbranch_scc1 DOK
    ds_read_b32 v8, v106 offset:58252
    ds_read_b64_tr_b16 v[36:37], v22 offset:0
    ds_read_b64_tr_b16 v[38:39], v22 offset:512
    ds_read_b64_tr_b16 v[76:77], v107 offset:0
    ds_read_b64_tr_b16 v[78:79], v107 offset:512
    ds_read_b64_tr_b16 v[98:99], v108 offset:0
    ds_read_b64_tr_b16 v[100:101], v108 offset:512
    ds_read_b64_tr_b16 v[102:103], v109 offset:0
    ds_read_b64_tr_b16 v[104:105], v109 offset:512
    s_waitcnt lgkmcnt(0)
    s_branch DCHK
NODN:
    s_waitcnt vmcnt(0) lgkmcnt(0)
    s_branch DNJ
MEETB:
    s_barrier
    s_nop 1
    s_branch GO0
FINW:
    s_mov_b64 exec, s[34:35]
    ds_write_b128 v2, v[40:43] offset:60416
    ds_write_b128 v2, v[44:47] offset:60432
    s_mov_b64 exec, s[36:37]
    ds_write_b128 v9, v[48:51] offset:60672
    ds_write_b128 v9, v[52:55] offset:60688
    s_mov_b64 exec, -1
    s_waitcnt lgkmcnt(0)
    s_branch FIND
COMM:
PAD8:
    s_cbranch_execz RET_A_0
    v_lshlrev_b32 v11, 3, v1
    ds_write_b64 v11, v[6:7] offset:60416
    s_mov_b32 s26, s6
    s_mov_b32 s27, s7
    v_lshlrev_b32 v14, 12, v1
    s_and_b32 s3, s2, 3
    s_lshl_b32 s43, s3, 10
    s_and_b32 s3, s2, 0xfc
    s_lshl2_add_u32 s43, s3, s43
    s_add_u32 s43, s43, 3407872
    s_lshl_b32 s44, s33, 12
    s_add_u32 s44, s44, 3407872
    s_mov_b32 s45, 0
    s_lshl_b32 s38, s35, 5
    v_lshlrev_b32 v18, 2, v1
    v_add_u32 v17, s38, v18
    v_lshrrev_b32 v11, 4, v1
    v_bfe_u32 v12, v1, 1, 3
    v_lshl_add_u32 v11, v12, 2, v11
    s_lshl_b32 s38, s47, 9
    v_lshl_add_u32 v16, v11, 4, s38
    s_mov_b32 s56, 0xaaaaaaaa
    s_mov_b32 s57, 0xaaaaaaaa
    s_cmpk_lt_u32 s2, 224
    s_cbranch_scc1 CB0
    s_barrier
CB0:
    s_waitcnt vmcnt(12)
    v_add_u32 v4, 2, v4
    v_or_b32 v4, 1, v4
    v_readfirstlane_b32 s49, v5
    v_readfirstlane_b32 s48, v4
    s_waitcnt lgkmcnt(0)
CSPIN:
    ds_read_b32 v12, v10 offset:58260
    ds_read_b128 v[24:27], v10 offset:58176
    ds_read_b128 v[28:31], v10 offset:58192
    ds_read_b32 v20, v17 offset:58112
    ds_read_b32 v21, v18 offset:58272
    s_waitcnt lgkmcnt(4)
    v_and_b32 v12, 0xff, v12
    v_cmp_eq_u32 vcc, 8, v12
    s_cbranch_vccz CSPIN
    s_waitcnt lgkmcnt(3)
    v_max3_u32 v19, v24, v25, v26
    v_med3_u32 v23, v24, v25, v26
    s_waitcnt lgkmcnt(2)
    v_max3_u32 v32, v27, v28, v29
    v_med3_u32 v33, v27, v28, v29
    v_med3_u32 v12, v19, v32, v30
    v_max3_u32 v19, v19, v32, v30
    v_max3_u32 v12, v12, v23, v33
    v_max_u32 v2, v19, v31
    v_med3_u32 v3, v19, v12, v31
    s_mov_b64 exec, 0xff
    s_waitcnt vmcnt(0)
    buffer_store_dwordx4 v[2:5], v14, s[8:11], s43 offen sc1
    s_waitcnt lgkmcnt(0)
    buffer_store_dwordx2 v[20:21], v13, s[8:11], s42 offen sc1
    s_mov_b64 exec, -1
    v_readfirstlane_b32 s50, v2
    v_readfirstlane_b32 s51, v3
    s_barrier
    buffer_load_dwordx4 v[34:37], v15, s[8:11], s44 offen offset:0 sc1
    buffer_load_dwordx4 v[38:41], v15, s[8:11], s44 offen offset:1024 sc1
    buffer_load_dwordx4 v[42:45], v15, s[8:11], s44 offen offset:2048 sc1
    buffer_load_dwordx4 v[46:49], v15, s[8:11], s44 offen offset:3072 sc1
    s_mov_b64 s[54:55], 0
    s_mov_b64 s[52:53], -1
REDUCE:
    s_add_u32 s45, s45, 1
    s_waitcnt vmcnt(3)
    v_cmp_eq_u64 vcc, s[48:49], v[36:37]
    s_waitcnt vmcnt(2)
    v_cmp_eq_u64 s[58:59], s[48:49], v[40:41]
    v_max_u32 v23, v35, v39
    v_max_u32 v19, v34, v38
    v_med3_u32 v23, v34, v38, v23
    s_waitcnt vmcnt(1)
    v_cmp_eq_u64 s[60:61], s[48:49], v[44:45]
    s_and_b64 vcc, vcc, s[58:59]
    s_waitcnt vmcnt(0)
    v_cmp_eq_u64 s[62:63], s[48:49], v[48:49]
    v_max_u32 v33, v43, v47
    v_max_u32 v32, v42, v46
    v_med3_u32 v33, v42, v46, v33
    s_and_b64 vcc, vcc, s[60:61]
    v_max_u32 v23, v23, v33
    s_and_b64 vcc, vcc, s[62:63]
    v_med3_u32 v23, v19, v32, v23
    v_max_u32 v19, v19, v32
    v_cndmask_b32 v23, 0, v23, vcc
    v_cndmask_b32 v19, 0, v19, vcc
    s_nop 0
    v_max_u32_dpp v33, v23, v23 row_ror:8 row_mask:0xf bank_mask:0xf
    v_mov_b32_dpp v32, v19 row_ror:8 row_mask:0xf bank_mask:0xf
    v_med3_u32 v23, v19, v32, v33
    v_max_u32 v19, v19, v32
    s_nop 0
    v_max_u32_dpp v33, v23, v23 row_ror:4 row_mask:0xf bank_mask:0xf
    v_mov_b32_dpp v32, v19 row_ror:4 row_mask:0xf bank_mask:0xf
    v_med3_u32 v23, v19, v32, v33
    v_max_u32 v19, v19, v32
    s_nop 0
    v_max_u32_dpp v33, v23, v23 row_ror:2 row_mask:0xf bank_mask:0xf
    v_mov_b32_dpp v32, v19 row_ror:2 row_mask:0xf bank_mask:0xf
    v_med3_u32 v23, v19, v32, v33
    v_max_u32 v19, v19, v32
    s_nop 0
    v_max_u32_dpp v33, v23, v23 row_ror:1 row_mask:0xf bank_mask:0xf
    v_mov_b32_dpp v32, v19 row_ror:1 row_mask:0xf bank_mask:0xf
    v_med3_u32 v23, v19, v32, v33
    v_max_u32 v19, v19, v32
    s_nop 0
    v_max_u32_dpp v33, v23, v23 row_bcast:15 row_mask:0xa bank_mask:0xf
    v_mov_b32_dpp v32, v19 row_bcast:15 row_mask:0xa bank_mask:0xf
    v_med3_u32 v23, v19, v32, v33
    v_max_u32 v19, v19, v32
    s_nop 0
    v_max_u32_dpp v33, v23, v23 row_bcast:31 row_mask:0xc bank_mask:0xf
    v_mov_b32_dpp v32, v19 row_bcast:31 row_mask:0xc bank_mask:0xf
    v_med3_u32 v23, v19, v32, v33
    v_max_u32 v19, v19, v32
    s_nop 0
    v_readlane_b32 s50, v19, 63
    v_readlane_b32 s51, v23, 63
    s_cmp_eq_u64 vcc, -1
    s_cbranch_scc0 NOTALL
    s_cmp_eq_u64 s[50:51], s[52:53]
    s_cbranch_scc1 SAME
FINAL:
    v_mov_b32 v11, s50
    v_mov_b32 v12, s51
    v_cndmask_b32 v11, v11, v12, s[56:57]
    v_and_b32 v32, 0x7ff, v11
    v_lshl_add_u32 v33, v32, 11, v16
    buffer_load_dwordx4 v[24:27], v33, s[4:7], 0 offen
    v_and_b32 v12, 7, v11
    v_and_b32 v11, 0x7f8, v11
    v_lshl_add_u32 v11, v12, 11, v11
    buffer_load_dwordx2 v[20:21], v11, s[8:11], s42 offen sc1
    s_barrier
    s_mov_b64 exec, 3
    ds_write_b32 v18, v32 offset:58240
    s_mov_b64 exec, -1
    s_waitcnt vmcnt(1)
    v_lshlrev_b32 v50, 16, v24
    v_and_b32 v51, 0xffff0000, v24
    v_lshlrev_b32 v52, 16, v25
    v_and_b32 v53, 0xffff0000, v25
    v_lshlrev_b32 v54, 16, v26
    v_and_b32 v55, 0xffff0000, v26
    v_lshlrev_b32 v56, 16, v27
    v_and_b32 v57, 0xffff0000, v27
SCHK:
    s_waitcnt vmcnt(0)
    v_max_u32 v12, v20, v21
    v_mul_f32 v21, -v20, v21
    v_cmp_eq_u32 vcc, -1, v12
    s_cbranch_vccnz SRETRY
SOK:
    v_fma_f32 v50, v50, v20, v21
    v_fma_f32 v51, v51, v20, v21
    v_fma_f32 v52, v52, v20, v21
    v_fma_f32 v53, v53, v20, v21
    v_fma_f32 v54, v54, v20, v21
    v_fma_f32 v55, v55, v20, v21
    v_fma_f32 v56, v56, v20, v21
    v_fma_f32 v57, v57, v20, v21
    v_cvt_pk_bf16_f32 v24, v50, v51
    v_cvt_pk_bf16_f32 v25, v52, v53
    v_cvt_pk_bf16_f32 v26, v54, v55
    v_cvt_pk_bf16_f32 v27, v56, v57
    ds_write_b128 v15, v[24:27] offset:58368
GOT:
    s_waitcnt lgkmcnt(0)
    s_barrier
    s_cmp_lg_u32 s2, 0
    s_cbranch_scc1 NOEP
PAD9:
    s_cbranch_execz RET_B_0
    s_mov_b64 exec, 1
    buffer_store_dword v4, v10, s[8:11], s41 offen sc1
    s_mov_b64 exec, -1
NOEP:
    s_and_b32 s59, s34, 15
    s_lshr_b32 s60, s34, 4
    s_lshl_b32 s60, s60, 10
    s_or_b32 s60, s60, s33
    s_mov_b32 s58, 0
    s_and_b32 s38, s50, 0x407
    s_cmp_eq_u32 s38, s60
    s_cselect_b32 s38, 1, 0
    s_or_b32 s58, s58, s38
    s_and_b32 s38, s51, 0x407
    s_cmp_eq_u32 s38, s60
    s_cselect_b32 s38, 2, 0
    s_or_b32 s58, s58, s38
    s_sub_u32 s38, 0, s50
    s_and_b32 s38, s38, 0x407
    s_cmp_eq_u32 s38, s60
    s_cselect_b32 s38, 4, 0
    s_or_b32 s58, s58, s38
    s_sub_u32 s38, 0, s51
    s_and_b32 s38, s38, 0x407
    s_cmp_eq_u32 s38, s60
    s_cselect_b32 s38, 8, 0
    s_or_b32 s58, s58, s38
    s_cbranch_scc0 MEND
    v_and_b32 v28, 15, v1
    v_and_b32 v11, 1, v1
    v_lshlrev_b32 v11, 4, v11
    v_mov_b32 v12, 0x3f80
    v_lshlrev_b32 v11, v11, v12
    v_lshrrev_b32 v12, 1, v28
    v_cmp_eq_u32 vcc, 0, v12
    s_nop 1
    v_cndmask_b32 v24, 0, v11, vcc
    v_cmp_eq_u32 vcc, 1, v12
    s_nop 1
    v_cndmask_b32 v25, 0, v11, vcc
    v_cmp_eq_u32 vcc, 2, v12
    s_nop 1
    v_cndmask_b32 v26, 0, v11, vcc
    v_cmp_eq_u32 vcc, 3, v12
    s_nop 1
    v_cndmask_b32 v27, 0, v11, vcc
    v_and_b32 v11, 3, v1
    v_bfe_u32 v12, v1, 4, 1
    v_lshl_add_u32 v11, v11, 1, v12
    v_lshlrev_b32 v29, 4, v11
    v_lshlrev_b32 v30, 3, v11
    s_barrier
    s_barrier
ROLE:
    s_ff1_i32_b32 s61, s58
    s_bitset0_b32 s58, s61
    s_bitcmp1_b32 s61, 0
    s_cselect_b32 s62, s51, s50
    s_cselect_b32 s64, 32, 0
    s_sub_u32 s46, 31, s59
    s_bitcmp1_b32 s61, 1
    s_cselect_b32 s46, s46, s59
    s_add_u32 s64, s64, s46
    s_mul_i32 s64, s64, 7168
    s_add_u32 s64, s64, 2490368
    s_add_u32 s47, s64, 4096
    s_and_b32 s63, s62, 0x7ff
    s_lshl_b32 s63, s63, 11
    s_lshl_b32 s46, s46, 6
    s_add_u32 s63, s63, s46
    s_lshl_b32 s38, s61, 7
    v_add_u32 v11, s38, v29
    s_mov_b32 s45, 0
    v_mov_b32 v31, s62
    v_ashrrev_i32 v12, 31, v31
    v_not_b32 v12, v12
    v_or_b32 v12, 0x80000000, v12
    v_xor_b32 v31, v31, v12
    v_mul_f32 v31, 0xbfb8aa3b, v31
    v_exp_f32 v31, v31
    s_nop 0
    v_add_f32 v31, 1.0, v31
    v_rcp_f32 v31, v31
RPOLL:
    buffer_load_dwordx4 v[34:37], v15, s[8:11], s64 offen offset:0 sc1
    buffer_load_dwordx4 v[38:41], v15, s[8:11], s64 offen offset:1024 sc1
    buffer_load_dwordx4 v[42:45], v15, s[8:11], s64 offen offset:2048 sc1
    buffer_load_dwordx4 v[46:49], v15, s[8:11], s64 offen offset:3072 sc1
    buffer_load_dwordx4 v[50:53], v15, s[8:11], s47 offen offset:0 sc1
    buffer_load_dwordx4 v[54:57], v15, s[8:11], s47 offen offset:1024 sc1
    buffer_load_dwordx4 v[58:61], v15, s[8:11], s47 offen offset:2048 sc1
    s_add_u32 s45, s45, 1
    s_waitcnt vmcnt(6)
    v_mfma_f32_16x16x32_bf16 v[62:65], v[24:27], v[34:37], 0
    s_waitcnt vmcnt(5)
    v_mfma_f32_16x16x32_bf16 v[62:65], v[24:27], v[38:41], v[62:65]
    s_waitcnt vmcnt(4)
    v_mfma_f32_16x16x32_bf16 v[62:65], v[24:27], v[42:45], v[62:65]
    s_waitcnt vmcnt(3)
    v_mfma_f32_16x16x32_bf16 v[62:65], v[24:27], v[46:49], v[62:65]
    s_waitcnt vmcnt(2)
    v_mfma_f32_16x16x32_bf16 v[62:65], v[24:27], v[50:53], v[62:65]
    s_waitcnt vmcnt(1)
    v_mfma_f32_16x16x32_bf16 v[62:65], v[24:27], v[54:57], v[62:65]
    s_waitcnt vmcnt(0)
    v_mfma_f32_16x16x32_bf16 v[62:65], v[24:27], v[58:61], v[62:65]
    ds_read_b128 v[66:69], v11 offset:60416
    s_cmp_ge_u32 s45, 4096
    s_cbranch_scc1 RGOT
    s_nop 4
    v_cmp_u_f32 vcc, v62, v62
    s_cbranch_vccnz RPOLL
RGOT:
    s_nop 4
    v_add_f32_dpp v62, v62, v62 row_ror:4 row_mask:0xf bank_mask:0xf
    v_add_f32_dpp v63, v63, v63 row_ror:4 row_mask:0xf bank_mask:0xf
    v_add_f32_dpp v64, v64, v64 row_ror:4 row_mask:0xf bank_mask:0xf
    v_add_f32_dpp v65, v65, v65 row_ror:4 row_mask:0xf bank_mask:0xf
    v_add_f32_dpp v62, v62, v62 row_ror:8 row_mask:0xf bank_mask:0xf
    v_add_f32_dpp v63, v63, v63 row_ror:8 row_mask:0xf bank_mask:0xf
    v_add_f32_dpp v64, v64, v64 row_ror:8 row_mask:0xf bank_mask:0xf
    v_add_f32_dpp v65, v65, v65 row_ror:8 row_mask:0xf bank_mask:0xf
FCHK:
    s_waitcnt lgkmcnt(0)
    v_max3_u32 v12, v66, v67, v68
    v_max_u32 v12, v12, v69
    v_cmp_eq_u32 vcc, -1, v12
    s_cbranch_vccnz FRETRY
FOK:
    v_fmac_f32 v66, v62, v31
    v_fmac_f32 v67, v63, v31
    v_fmac_f32 v68, v64, v31
    v_fmac_f32 v69, v65, v31
    v_cvt_pk_bf16_f32 v66, v66, v67
    v_cvt_pk_bf16_f32 v67, v68, v69
    s_mov_b64 exec, 0x000f000f
    buffer_store_dwordx2 v[66:67], v30, s[24:27], s63 offen sc1 nt
    s_mov_b64 exec, -1
    s_cmp_lg_u32 s58, 0
    s_nop 0
    s_cbranch_scc1 ROLE
MEND:
    s_endpgm
FRETRY:
    s_add_u32 s45, s45, 1
    s_cmp_ge_u32 s45, 65536
    s_cbranch_scc1 FOK
    ds_read_b128 v[66:69], v11 offset:60416
    s_branch FCHK
NOTALL:
    s_cmp_ge_u32 s45, 4096
    s_cbranch_scc1 FINAL
    s_cmp_eq_u64 s[50:51], s[52:53]
    s_cselect_b64 vcc, s[54:55], 0
    s_cmp_eq_u64 vcc, -1
    s_cbranch_scc0 POLLA
    buffer_load_dwordx4 v[34:37], v15, s[8:11], s44 offen offset:0 sc1
    buffer_load_dwordx4 v[38:41], v15, s[8:11], s44 offen offset:1024 sc1
    buffer_load_dwordx4 v[42:45], v15, s[8:11], s44 offen offset:2048 sc1
    buffer_load_dwordx4 v[46:49], v15, s[8:11], s44 offen offset:3072 sc1
    s_nop 0
    s_branch REDUCE
POLLA:
    v_mov_b32 v11, s50
    v_mov_b32 v12, s51
    s_mov_b64 s[52:53], s[50:51]
    v_cndmask_b32 v11, v11, v12, s[56:57]
    v_and_b32 v32, 0x7ff, v11
    v_lshl_add_u32 v33, v32, 11, v16
    buffer_load_dwordx4 v[24:27], v33, s[4:7], 0 offen
    v_and_b32 v12, 7, v11
    v_and_b32 v11, 0x7f8, v11
    v_lshl_add_u32 v11, v12, 11, v11
    buffer_load_dwordx2 v[20:21], v11, s[8:11], s42 offen sc1
    buffer_load_dwordx4 v[34:37], v15, s[8:11], s44 offen offset:0 sc1
    buffer_load_dwordx4 v[38:41], v15, s[8:11], s44 offen offset:1024 sc1
    buffer_load_dwordx4 v[42:45], v15, s[8:11], s44 offen offset:2048 sc1
    buffer_load_dwordx4 v[46:49], v15, s[8:11], s44 offen offset:3072 sc1
    s_mov_b64 exec, 3
    ds_write_b32 v18, v32 offset:58240
    s_mov_b64 exec, -1
    s_waitcnt vmcnt(5)
    v_lshlrev_b32 v50, 16, v24
    v_and_b32 v51, 0xffff0000, v24
    v_lshlrev_b32 v52, 16, v25
    v_and_b32 v53, 0xffff0000, v25
    v_lshlrev_b32 v54, 16, v26
    v_and_b32 v55, 0xffff0000, v26
    v_lshlrev_b32 v56, 16, v27
    v_and_b32 v57, 0xffff0000, v27
    s_waitcnt vmcnt(4)
    v_max_u32 v11, v20, v21
    v_mul_f32 v21, -v20, v21
    v_cmp_ne_u32 s[54:55], -1, v11
    v_fma_f32 v50, v50, v20, v21
    v_fma_f32 v51, v51, v20, v21
    v_fma_f32 v52, v52, v20, v21
    v_fma_f32 v53, v53, v20, v21
    v_fma_f32 v54, v54, v20, v21
    v_fma_f32 v55, v55, v20, v21
    v_fma_f32 v56, v56, v20, v21
    v_fma_f32 v57, v57, v20, v21
    v_cvt_pk_bf16_f32 v24, v50, v51
    v_cvt_pk_bf16_f32 v25, v52, v53
    v_cvt_pk_bf16_f32 v26, v54, v55
    v_cvt_pk_bf16_f32 v27, v56, v57
    ds_write_b128 v15, v[24:27] offset:58368
    s_nop 0
    s_branch REDUCE
SAME:
    s_cmp_eq_u64 s[54:55], -1
    s_cbranch_scc0 FINAL
    s_barrier
    s_branch GOT
SRETRY:
    s_add_u32 s45, s45, 1
    s_cmp_ge_u32 s45, 8192
    s_cbranch_scc1 SOK
    buffer_load_dwordx2 v[20:21], v11, s[8:11], s42 offen sc1
    s_branch SCHK
LOAD:
    s_lshl_b32 s14, 7, 20
    s_mov_b32 s15, s7
    s_mov_b64 s[18:19], s[14:15]
    s_lshr_b32 s41, s40, 2
    s_and_b32 s42, s40, 3
    s_mul_i32 s43, s42, 1835008
    s_lshl_b32 s38, s41, 7
    s_add_u32 s43, s43, s38
    v_bfe_u32 v10, v1, 1, 2
    v_bfe_u32 v11, v1, 4, 1
    v_xor_b32 v10, v10, v11
    v_and_b32 v11, 1, v1
    v_lshlrev_b32 v11, 4, v11
    v_lshl_add_u32 v10, v10, 5, v11
    v_lshrrev_b32 v11, 3, v1
    v_mul_u32_u24 v2, 7168, v11
    v_add_u32 v2, v10, v2
    v_xor_b32 v3, 64, v2
    v_add_u32 v4, 112640, v2
    v_add_u32 v5, 168960, v3
    v_add_u32 v3, 56320, v3
    s_cmp_eq_u32 s35, 0
    s_cselect_b32 s46, s37, s36
    s_cselect_b32 s47, -1, 1
    s_cselect_b32 s48, 16384, 0
    s_lshl_b32 s47, s47, 19
    s_lshl_b32 s46, s46, 11
    v_and_b32 v12, 32, v1
    v_lshlrev_b32 v6, 4, v1
    v_xor_b32 v12, v12, v6
    s_waitcnt lgkmcnt(0)
    s_add_u32 m0, s48, 0
    s_nop 0
    buffer_load_dwordx4 v12, s[4:7], s46 offen offset:0 lds
    buffer_load_dwordx4 v12, s[4:7], s46 offen offset:1024 lds
    s_add_u32 m0, s48, 2048
    s_add_u32 s46, s46, s47
    buffer_load_dwordx4 v12, s[4:7], s46 offen offset:0 lds
    buffer_load_dwordx4 v12, s[4:7], s46 offen offset:1024 lds
    s_add_u32 m0, s48, 4096
    s_add_u32 s46, s46, s47
    buffer_load_dwordx4 v12, s[4:7], s46 offen offset:0 lds
    buffer_load_dwordx4 v12, s[4:7], s46 offen offset:1024 lds
    s_add_u32 m0, s48, 6144
    s_add_u32 s46, s46, s47
    buffer_load_dwordx4 v12, s[4:7], s46 offen offset:0 lds
    buffer_load_dwordx4 v12, s[4:7], s46 offen offset:1024 lds
    s_add_u32 m0, s48, 8192
    s_add_u32 s46, s46, s47
    buffer_load_dwordx4 v12, s[4:7], s46 offen offset:0 lds
    buffer_load_dwordx4 v12, s[4:7], s46 offen offset:1024 lds
    s_add_u32 m0, s48, 10240
    s_add_u32 s46, s46, s47
    buffer_load_dwordx4 v12, s[4:7], s46 offen offset:0 lds
    buffer_load_dwordx4 v12, s[4:7], s46 offen offset:1024 lds
    s_add_u32 m0, s48, 12288
    s_add_u32 s46, s46, s47
    buffer_load_dwordx4 v12, s[4:7], s46 offen offset:0 lds
    buffer_load_dwordx4 v12, s[4:7], s46 offen offset:1024 lds
    s_add_u32 m0, s48, 14336
    s_add_u32 s46, s46, s47
    buffer_load_dwordx4 v12, s[4:7], s46 offen offset:0 lds
    buffer_load_dwordx4 v12, s[4:7], s46 offen offset:1024 lds
    s_mov_b32 m0, 61440
    s_add_u32 s45, s43, 0
    buffer_load_dwordx4 v2, s[12:15], s45 offen offset:0 nt lds
    buffer_load_dwordx4 v3, s[12:15], s45 offen offset:1024 nt lds
    buffer_load_dwordx4 v4, s[12:15], s45 offen offset:2048 nt lds
    buffer_load_dwordx4 v5, s[12:15], s45 offen offset:3072 nt lds
    s_mov_b32 m0, 94208
    s_nop 0
    buffer_load_dwordx4 v2, s[16:19], s45 offen offset:0 nt lds
    buffer_load_dwordx4 v3, s[16:19], s45 offen offset:1024 nt lds
    buffer_load_dwordx4 v4, s[16:19], s45 offen offset:2048 nt lds
    buffer_load_dwordx4 v5, s[16:19], s45 offen offset:3072 nt lds
    s_mov_b32 m0, 65536
    s_add_u32 s45, s43, 229376
    buffer_load_dwordx4 v2, s[12:15], s45 offen offset:0 nt lds
    buffer_load_dwordx4 v3, s[12:15], s45 offen offset:1024 nt lds
    buffer_load_dwordx4 v4, s[12:15], s45 offen offset:2048 nt lds
    buffer_load_dwordx4 v5, s[12:15], s45 offen offset:3072 nt lds
    v_mov_b32 v12, 256
    s_mov_b64 s[22:23], s[14:15]
    s_lshl_b32 s44, s41, 17
    s_lshl_b32 s38, s42, 9
    s_add_u32 s44, s44, s38
    v_lshl_add_u32 v6, v11, 11, v10
    v_xor_b32 v7, 64, v6
    v_add_u32 v8, 30720, v6
    v_add_u32 v9, 46080, v7
    v_add_u32 v7, 15360, v7
    v_mov_b32 v10, -1
    v_mov_b32 v11, 0
    ds_write_b32 v11, v10 offset:58252
    s_waitcnt vmcnt(12)
    s_mov_b64 exec, 1
    ds_add_u32 v11, v12 offset:58260
    s_mov_b64 exec, -1
    s_mov_b32 m0, 98304
    s_nop 0
    buffer_load_dwordx4 v2, s[16:19], s45 offen offset:0 nt lds
    buffer_load_dwordx4 v3, s[16:19], s45 offen offset:1024 nt lds
    buffer_load_dwordx4 v4, s[16:19], s45 offen offset:2048 nt lds
    buffer_load_dwordx4 v5, s[16:19], s45 offen offset:3072 nt lds
    s_mov_b32 m0, 69632
    s_add_u32 s45, s43, 458752
    buffer_load_dwordx4 v2, s[12:15], s45 offen offset:0 nt lds
    buffer_load_dwordx4 v3, s[12:15], s45 offen offset:1024 nt lds
    buffer_load_dwordx4 v4, s[12:15], s45 offen offset:2048 nt lds
    buffer_load_dwordx4 v5, s[12:15], s45 offen offset:3072 nt lds
    s_mov_b32 m0, 102400
    s_waitcnt vmcnt(19)
    buffer_load_dwordx4 v2, s[16:19], s45 offen offset:0 nt lds
    s_waitcnt vmcnt(19)
    buffer_load_dwordx4 v3, s[16:19], s45 offen offset:1024 nt lds
    s_waitcnt vmcnt(19)
    buffer_load_dwordx4 v4, s[16:19], s45 offen offset:2048 nt lds
    s_waitcnt vmcnt(19)
    buffer_load_dwordx4 v5, s[16:19], s45 offen offset:3072 nt lds
    s_mov_b32 m0, 73728
    s_add_u32 s45, s43, 688128
    s_waitcnt vmcnt(19)
    buffer_load_dwordx4 v2, s[12:15], s45 offen offset:0 nt lds
    s_waitcnt vmcnt(19)
    buffer_load_dwordx4 v3, s[12:15], s45 offen offset:1024 nt lds
    s_waitcnt vmcnt(19)
    buffer_load_dwordx4 v4, s[12:15], s45 offen offset:2048 nt lds
    s_waitcnt vmcnt(19)
    buffer_load_dwordx4 v5, s[12:15], s45 offen offset:3072 nt lds
    s_mov_b32 m0, 106496
    s_waitcnt vmcnt(19)
    buffer_load_dwordx4 v2, s[16:19], s45 offen offset:0 nt lds
    s_waitcnt vmcnt(19)
    buffer_load_dwordx4 v3, s[16:19], s45 offen offset:1024 nt lds
    s_waitcnt vmcnt(19)
    buffer_load_dwordx4 v4, s[16:19], s45 offen offset:2048 nt lds
    s_waitcnt vmcnt(19)
    buffer_load_dwordx4 v5, s[16:19], s45 offen offset:3072 nt lds
    s_mov_b32 m0, 77824
    s_add_u32 s45, s43, 917504
    s_waitcnt vmcnt(19)
    buffer_load_dwordx4 v2, s[12:15], s45 offen offset:0 nt lds
    s_waitcnt vmcnt(19)
    buffer_load_dwordx4 v3, s[12:15], s45 offen offset:1024 nt lds
    s_waitcnt vmcnt(19)
    buffer_load_dwordx4 v4, s[12:15], s45 offen offset:2048 nt lds
    s_waitcnt vmcnt(19)
    buffer_load_dwordx4 v5, s[12:15], s45 offen offset:3072 nt lds
    s_mov_b32 m0, 110592
    s_waitcnt vmcnt(19)
    buffer_load_dwordx4 v2, s[16:19], s45 offen offset:0 nt lds
    s_waitcnt vmcnt(19)
    buffer_load_dwordx4 v3, s[16:19], s45 offen offset:1024 nt lds
    s_waitcnt vmcnt(19)
    buffer_load_dwordx4 v4, s[16:19], s45 offen offset:2048 nt lds
    s_waitcnt vmcnt(19)
    buffer_load_dwordx4 v5, s[16:19], s45 offen offset:3072 nt lds
    s_mov_b32 m0, 81920
PAD10:
    s_cbranch_execz RET_A_1
    s_add_u32 s45, s43, 1146880
    s_waitcnt vmcnt(19)
    buffer_load_dwordx4 v2, s[12:15], s45 offen offset:0 nt lds
    s_waitcnt vmcnt(19)
    buffer_load_dwordx4 v3, s[12:15], s45 offen offset:1024 nt lds
    s_waitcnt vmcnt(19)
    buffer_load_dwordx4 v4, s[12:15], s45 offen offset:2048 nt lds
    s_waitcnt vmcnt(19)
    buffer_load_dwordx4 v5, s[12:15], s45 offen offset:3072 nt lds
    s_mov_b32 m0, 114688
    s_waitcnt vmcnt(19)
    buffer_load_dwordx4 v2, s[16:19], s45 offen offset:0 nt lds
    s_waitcnt vmcnt(19)
    buffer_load_dwordx4 v3, s[16:19], s45 offen offset:1024 nt lds
    s_waitcnt vmcnt(19)
    buffer_load_dwordx4 v4, s[16:19], s45 offen offset:2048 nt lds
    s_waitcnt vmcnt(19)
    buffer_load_dwordx4 v5, s[16:19], s45 offen offset:3072 nt lds
    s_mov_b32 m0, 86016
    s_add_u32 s45, s43, 1376256
    s_waitcnt vmcnt(19)
    buffer_load_dwordx4 v2, s[12:15], s45 offen offset:0 nt lds
    s_waitcnt vmcnt(19)
    buffer_load_dwordx4 v3, s[12:15], s45 offen offset:1024 nt lds
    s_waitcnt vmcnt(19)
    buffer_load_dwordx4 v4, s[12:15], s45 offen offset:2048 nt lds
    s_waitcnt vmcnt(19)
    buffer_load_dwordx4 v5, s[12:15], s45 offen offset:3072 nt lds
    s_mov_b32 m0, 118784
    s_waitcnt vmcnt(19)
    buffer_load_dwordx4 v2, s[16:19], s45 offen offset:0 nt lds
    s_waitcnt vmcnt(19)
    buffer_load_dwordx4 v3, s[16:19], s45 offen offset:1024 nt lds
    s_waitcnt vmcnt(19)
    buffer_load_dwordx4 v4, s[16:19], s45 offen offset:2048 nt lds
    s_waitcnt vmcnt(19)
    buffer_load_dwordx4 v5, s[16:19], s45 offen offset:3072 nt lds
    s_waitcnt lgkmcnt(0)
    s_barrier
    s_mov_b32 m0, 90112
    s_add_u32 s45, s43, 1605632
PAD11:
    s_cbranch_execz RET_A_1
    s_waitcnt vmcnt(19)
    buffer_load_dwordx4 v2, s[12:15], s45 offen offset:0 nt lds
    s_waitcnt vmcnt(19)
    buffer_load_dwordx4 v3, s[12:15], s45 offen offset:1024 nt lds
    s_waitcnt vmcnt(19)
    buffer_load_dwordx4 v4, s[12:15], s45 offen offset:2048 nt lds
    s_waitcnt vmcnt(19)
    buffer_load_dwordx4 v5, s[12:15], s45 offen offset:3072 nt lds
    s_mov_b32 m0, 122880
    s_waitcnt vmcnt(19)
    buffer_load_dwordx4 v2, s[16:19], s45 offen offset:0 nt lds
    s_waitcnt vmcnt(19)
    buffer_load_dwordx4 v3, s[16:19], s45 offen offset:1024 nt lds
    s_waitcnt vmcnt(19)
    buffer_load_dwordx4 v4, s[16:19], s45 offen offset:2048 nt lds
    s_waitcnt vmcnt(19)
    buffer_load_dwordx4 v5, s[16:19], s45 offen offset:3072 nt lds
    s_barrier
    s_mov_b32 m0, 126976
    s_add_u32 s45, s44, 0
    buffer_load_dwordx4 v6, s[20:23], s45 offen offset:0 nt lds
    buffer_load_dwordx4 v7, s[20:23], s45 offen offset:1024 nt lds
    buffer_load_dwordx4 v8, s[20:23], s45 offen offset:2048 nt lds
    buffer_load_dwordx4 v9, s[20:23], s45 offen offset:3072 nt lds
    s_mov_b32 m0, 131072
    s_add_u32 s45, s44, 128
    buffer_load_dwordx4 v6, s[20:23], s45 offen offset:0 nt lds
    buffer_load_dwordx4 v7, s[20:23], s45 offen offset:1024 nt lds
    buffer_load_dwordx4 v8, s[20:23], s45 offen offset:2048 nt lds
    buffer_load_dwordx4 v9, s[20:23], s45 offen offset:3072 nt lds
    s_mov_b32 m0, 135168
    s_add_u32 s45, s44, 256
    buffer_load_dwordx4 v6, s[20:23], s45 offen offset:0 nt lds
    buffer_load_dwordx4 v7, s[20:23], s45 offen offset:1024 nt lds
    buffer_load_dwordx4 v8, s[20:23], s45 offen offset:2048 nt lds
    buffer_load_dwordx4 v9, s[20:23], s45 offen offset:3072 nt lds
    s_mov_b32 m0, 139264
    s_add_u32 s45, s44, 384
    buffer_load_dwordx4 v6, s[20:23], s45 offen offset:0 nt lds
    buffer_load_dwordx4 v7, s[20:23], s45 offen offset:1024 nt lds
    buffer_load_dwordx4 v8, s[20:23], s45 offen offset:2048 nt lds
    buffer_load_dwordx4 v9, s[20:23], s45 offen offset:3072 nt lds
    s_mov_b32 m0, 143360
    s_add_u32 s45, s44, 65536
    buffer_load_dwordx4 v6, s[20:23], s45 offen offset:0 nt lds
    buffer_load_dwordx4 v7, s[20:23], s45 offen offset:1024 nt lds
    buffer_load_dwordx4 v8, s[20:23], s45 offen offset:2048 nt lds
    buffer_load_dwordx4 v9, s[20:23], s45 offen offset:3072 nt lds
    s_mov_b32 m0, 147456
    s_add_u32 s45, s44, 65664
    buffer_load_dwordx4 v6, s[20:23], s45 offen offset:0 nt lds
    buffer_load_dwordx4 v7, s[20:23], s45 offen offset:1024 nt lds
    buffer_load_dwordx4 v8, s[20:23], s45 offen offset:2048 nt lds
    buffer_load_dwordx4 v9, s[20:23], s45 offen offset:3072 nt lds
    s_mov_b32 m0, 151552
    s_add_u32 s45, s44, 65792
    buffer_load_dwordx4 v6, s[20:23], s45 offen offset:0 nt lds
    buffer_load_dwordx4 v7, s[20:23], s45 offen offset:1024 nt lds
    buffer_load_dwordx4 v8, s[20:23], s45 offen offset:2048 nt lds
    buffer_load_dwordx4 v9, s[20:23], s45 offen offset:3072 nt lds
    s_mov_b32 m0, 155648
    s_add_u32 s45, s44, 65920
    buffer_load_dwordx4 v6, s[20:23], s45 offen offset:0 nt lds
    buffer_load_dwordx4 v7, s[20:23], s45 offen offset:1024 nt lds
    buffer_load_dwordx4 v8, s[20:23], s45 offen offset:2048 nt lds
    buffer_load_dwordx4 v9, s[20:23], s45 offen offset:3072 nt lds
    s_waitcnt vmcnt(32)
    s_barrier
    s_barrier
    s_waitcnt vmcnt(0)
    ds_write_b32 v11, v11 offset:58252
    s_endpgm
PREF:
    s_lshl_b32 s22, 7, 20
    s_lshl_b32 s23, 1, 17
    s_and_b32 s3, s2, 7
    s_mul_i32 s3, s3, 28
    s_sub_u32 s38, s34, 28
    s_mul_i32 s38, s38, 7
    s_add_u32 s3, s3, s38
    v_lshrrev_b32 v2, 1, v1
    v_and_b32 v3, 1, v1
    v_lshlrev_b32 v3, 7, v3
    v_lshl_add_u32 v2, v2, 11, v3
    s_waitcnt lgkmcnt(0)
    s_barrier
    s_add_u32 s38, s3, 0
    s_and_b32 s39, s38, 3
    s_lshr_b32 s38, s38, 2
    s_lshl_b32 s39, s39, 9
    s_lshl_b32 s38, s38, 17
    s_add_u32 s39, s39, 65536
    s_add_u32 s38, s38, s39
    buffer_load_dword v4, v2, s[20:23], s38 offen offset:256
    s_add_u32 s38, s3, 1
    s_and_b32 s39, s38, 3
    s_lshr_b32 s38, s38, 2
    s_lshl_b32 s39, s39, 9
    s_lshl_b32 s38, s38, 17
    s_add_u32 s39, s39, 65536
    s_add_u32 s38, s38, s39
    buffer_load_dword v4, v2, s[20:23], s38 offen offset:256
    s_add_u32 s38, s3, 2
    s_and_b32 s39, s38, 3
    s_lshr_b32 s38, s38, 2
    s_lshl_b32 s39, s39, 9
    s_lshl_b32 s38, s38, 17
    s_add_u32 s39, s39, 65536
    s_add_u32 s38, s38, s39
    buffer_load_dword v4, v2, s[20:23], s38 offen offset:256
    s_add_u32 s38, s3, 3
    s_and_b32 s39, s38, 3
    s_lshr_b32 s38, s38, 2
    s_lshl_b32 s39, s39, 9
    s_lshl_b32 s38, s38, 17
    s_add_u32 s39, s39, 65536
    s_add_u32 s38, s38, s39
    s_waitcnt vmcnt(2)
    buffer_load_dword v4, v2, s[20:23], s38 offen offset:256
    s_add_u32 s38, s3, 4
    s_and_b32 s39, s38, 3
    s_lshr_b32 s38, s38, 2
    s_lshl_b32 s39, s39, 9
    s_lshl_b32 s38, s38, 17
    s_add_u32 s39, s39, 65536
    s_add_u32 s38, s38, s39
    s_waitcnt vmcnt(2)
    buffer_load_dword v4, v2, s[20:23], s38 offen offset:256
    s_add_u32 s38, s3, 5
    s_and_b32 s39, s38, 3
    s_lshr_b32 s38, s38, 2
    s_lshl_b32 s39, s39, 9
    s_lshl_b32 s38, s38, 17
    s_add_u32 s39, s39, 65536
    s_add_u32 s38, s38, s39
    s_waitcnt vmcnt(2)
    buffer_load_dword v4, v2, s[20:23], s38 offen offset:256
    s_add_u32 s38, s3, 6
    s_and_b32 s39, s38, 3
    s_lshr_b32 s38, s38, 2
    s_lshl_b32 s39, s39, 9
    s_lshl_b32 s38, s38, 17
    s_add_u32 s39, s39, 65536
    s_add_u32 s38, s38, s39
    s_waitcnt vmcnt(2)
    buffer_load_dword v4, v2, s[20:23], s38 offen offset:256
    s_waitcnt vmcnt(0)
    s_endpgm
.section .rodata,"a"
.p2align 6
.amdhsa_kernel parallel_sum__spectral_fnet__moe_arch_mod__prompt_kernel
  .amdhsa_next_free_vgpr 156
  .amdhsa_next_free_sgpr 102
  .amdhsa_accum_offset 156
  .amdhsa_group_segment_fixed_size 0
  .amdhsa_kernarg_size 104
  .amdhsa_user_sgpr_count 2
  .amdhsa_user_sgpr_kernarg_segment_ptr 1
  .amdhsa_system_sgpr_workgroup_id_x 1
.end_amdhsa_kernel
```

```asm
; @launch grid=(256,1,1) block=(640,1,1) lds=159744
.amdgcn_target "amdgcn-amd-amdhsa--gfx950"
.text
.globl parallel_sum__spectral_fnet__moe_arch_mod__prompt_kernel
.p2align 12
.type parallel_sum__spectral_fnet__moe_arch_mod__prompt_kernel,@function
parallel_sum__spectral_fnet__moe_arch_mod__prompt_kernel:
    s_cmpk_ge_u32 s2, 256
    s_cbranch_scc1 END
    v_lshrrev_b32 v2, 6, v0
    s_load_dwordx2 s[4:5], s[0:1], 0
    s_load_dwordx2 s[28:29], s[0:1], 48
    s_load_dwordx2 s[8:9], s[0:1], 96
    s_load_dwordx2 s[12:13], s[0:1], 56
    s_load_dwordx2 s[16:17], s[0:1], 64
    s_load_dwordx2 s[20:21], s[0:1], 72
    s_load_dwordx2 s[24:25], s[0:1], 80
    v_readfirstlane_b32 s32, v2
    s_lshr_b32 s34, s2, 3
    v_and_b32 v1, 63, v0
    s_lshl_b32 s38, s32, 5
    s_add_u32 s38, s38, s34
    s_cmpk_lt_u32 s38, 316
    s_cbranch_scc1 BUSY
    s_mov_b64 exec, 0
    s_cmp_eq_u32 s34, 28
    s_cbranch_scc1 PAD0
    s_cmp_eq_u32 s34, 29
    s_cbranch_scc1 PAD1
    s_cmp_eq_u32 s34, 30
    s_cbranch_scc1 PAD8
    s_branch PAD2
BUSY:
    s_and_b32 s33, s2, 7
    s_lshr_b32 s38, s2, 4
    s_lshl3_add_u32 s36, s38, s33
    s_and_b32 s35, s34, 1
    s_cmp_eq_u32 s36, 0
    s_cselect_b32 s38, 128, s36
    s_sub_u32 s37, 2048, s38
    s_mul_i32 s40, s33, 28
    s_add_u32 s40, s40, s34
    s_lshl_b32 s6, 1, 22
    s_lshl_b32 s7, 1, 17
    s_lshl_b32 s10, 27, 17
    s_mov_b32 s11, s7
    s_cmp_eq_u32 s32, 9
    s_cbranch_scc1 LOADB
    s_cmp_eq_u32 s32, 8
    s_cbranch_scc1 COMM0
    s_lshl_b32 s38, s32, 8
    s_add_u32 s41, s36, s38
    s_sub_u32 s38, s37, s38
    s_cmp_eq_u32 s35, 0
    s_cselect_b32 s42, s38, s41
    s_cselect_b32 s41, s41, s38
    s_lshl_b32 s43, s32, 11
    s_lshl_b32 s38, s35, 14
    s_add_u32 s43, s43, s38
    v_and_b32 v9, 32, v1
    v_lshlrev_b32 v8, 4, v1
    v_lshrrev_b32 v5, 2, v1
    v_xor_b32 v2, v8, v9
    s_lshl_b32 s47, s32, 8
    s_add_u32 m0, s47, 49408
    s_and_b32 s39, s32, 2
    s_lshl_b32 s39, s39, 4
    v_lshrrev_b32 v11, 2, v8
    s_movk_i32 s30, 2048
    s_mov_b32 s31, s7
    v_xor_b32 v11, s39, v11
    s_lshl_b32 s39, s41, 11
    s_lshl_b32 s42, s42, 11
    v_and_b32 v6, 3, v1
    v_and_b32 v3, 15, v1
    v_lshrrev_b32 v4, 4, v1
    v_and_b32 v5, 3, v5
    v_and_b32 v7, 1, v4
    s_lshl_b32 s48, s35, 3
    s_cmp_eq_u32 s35, 0
    s_cselect_b32 s38, 1, 63
    v_lshrrev_b32 v9, 1, v3
    v_add_u32 v9, s48, v9
    v_and_b32 v10, 1, v3
    v_cmp_ne_u32 vcc, s38, v3
    v_cvt_f32_u32 v24, v4
    s_nop 0
    v_cndmask_b32 v9, 16, v9, vcc
    v_mul_f32 v26, 4.0, v24
    v_cndmask_b32 v10, 0, v10, vcc
    v_cvt_f32_u32 v9, v9
    v_cvt_f32_u32 v10, v10
    v_add_f32 v24, v26, v26
    v_mul_f32 v9, 0x3d000000, v9
    v_mul_f32 v10, 0x3e800000, v10
    v_cos_f32 v25, v9
    v_fma_f32 v16, v9, v24, v10
    v_add_f32 v17, v16, v9
    s_waitcnt lgkmcnt(0)
    buffer_load_dword v11, s[28:31], s47 offen lds
    s_xor_b32 m0, s43, 16384
    buffer_load_dwordx4 v[28:31], v2, s[4:7], s39 offen
    buffer_load_dwordx4 v[32:35], v2, s[4:7], s39 offen offset:1024
    s_cmpk_ge_u32 s2, 224
    s_cbranch_scc1 BI0
    s_barrier
BI0:
    s_branch CMP2
COMM0:
    s_setprio 3
    v_mov_b32 v10, 0
    s_mov_b32 s41, 2392064
    v_mov_b32 v6, -1
    v_mov_b32 v7, -1
    v_mov_b32 v8, -1
    v_mov_b32 v9, -1
    s_lshr_b32 s46, s40, 2
    s_and_b32 s47, s40, 3
    v_lshlrev_b32 v15, 4, v1
    v_lshrrev_b32 v11, 5, v1
    v_and_b32 v12, 0x1f0, v15
    v_lshl_add_u32 v19, v11, 11, v12
    s_lshl3_add_u32 s58, s46, s47
    s_lshl_b32 s58, s58, 9
    s_add_u32 s58, s58, 2949120
    s_mul_i32 s59, s47, 57344
    s_lshl_b32 s43, s46, 7
    s_add_u32 s59, s59, s43
    s_add_u32 s59, s59, 2490368
    s_cmpk_lt_u32 s2, 224
    s_cselect_b32 s58, s58, 117440512
    s_cselect_b32 s59, s59, 117440512
    v_lshrrev_b32 v11, 3, v1
    v_and_b32 v12, 0x70, v15
    v_mul_u32_u24 v11, 7168, v11
    v_add_u32 v20, v11, v12
    v_lshlrev_b32 v12, 8, v1
    v_add_u32 v11, s36, v12
    v_sub_u32 v12, s37, v12
    s_cmp_eq_u32 s35, 0
    s_cselect_b64 vcc, 0, -1
    v_cndmask_b32 v13, v11, v12, vcc
    v_and_b32 v11, 7, v13
    v_and_b32 v12, 0x7f8, v13
    v_lshl_add_u32 v13, v11, 11, v12
    s_mov_b32 s42, 2359296
    v_mov_b32 v22, 0
    v_mov_b32 v23, 0
    v_mov_b32 v24, 0
    v_mov_b32 v25, 0
    ds_write_b128 v10, v[22:25] offset:58256
    s_waitcnt lgkmcnt(0)
    buffer_load_dwordx2 v[4:5], v10, s[8:11], s41 offen sc1
    s_cmpk_ge_u32 s2, 224
    s_cbranch_scc1 BI1
    s_barrier
BI1:
    s_mul_i32 s60, s36, 16384
    s_lshl_b32 s61, s35, 13
    s_add_u32 s60, s60, s61
    s_add_u32 s61, s60, 4096
    buffer_store_dwordx4 v[6:9], v15, s[8:11], s60 offen offset:0 sc1
    buffer_store_dwordx4 v[6:9], v15, s[8:11], s60 offen offset:1024 sc1
    buffer_store_dwordx4 v[6:9], v15, s[8:11], s60 offen offset:2048 sc1
    buffer_store_dwordx4 v[6:9], v15, s[8:11], s60 offen offset:3072 sc1
    buffer_store_dwordx4 v[6:9], v15, s[8:11], s61 offen offset:0 sc1
    buffer_store_dwordx4 v[6:9], v15, s[8:11], s61 offen offset:1024 sc1
    buffer_store_dwordx4 v[6:9], v15, s[8:11], s61 offen offset:2048 sc1
    buffer_store_dwordx4 v[6:9], v15, s[8:11], s61 offen offset:3072 sc1
    buffer_store_dwordx4 v[6:9], v19, s[8:11], s58 offen sc1
    buffer_store_dwordx4 v[6:9], v20, s[8:11], s59 offen sc1
    s_add_u32 s59, s59, 229376
    buffer_store_dwordx4 v[6:9], v20, s[8:11], s59 offen sc1
    s_mov_b64 exec, 0xff
    buffer_store_dwordx2 v[6:7], v13, s[8:11], s42 offen sc1
    s_mov_b64 exec, -1
    s_branch COMM
LOADB:
    s_barrier
    s_branch LOAD
RET_A_0:
    s_cmp_eq_u32 s34, 28
    s_cbranch_scc1 PAD10
    s_cmp_eq_u32 s34, 29
    s_cbranch_scc1 PAD3
    s_cmp_eq_u32 s34, 30
    s_cbranch_scc1 PAD4
    s_cmp_eq_u32 s34, 31
    s_cbranch_scc1 PAD5
RET_A_1:
    s_cmp_eq_u32 s34, 28
    s_cbranch_scc1 PAD11
RET_A_2:
    s_mov_b64 exec, -1
    s_branch PREF
CMP2:
    v_cos_f32 v16, v16
    v_cos_f32 v17, v17
    v_add_f32 v25, v25, v25
    s_add_u32 s38, s38, -1
    v_cmp_ne_u32 vcc, s38, v3
    v_mov_b32 v11, 0xc2000000
    v_mov_b32 v27, 0x3a800000
    v_fma_f32 v18, v25, v17, -v16
    v_fma_f32 v19, v25, v18, -v17
    v_fma_f32 v20, v25, v19, -v18
    v_fma_f32 v21, v25, v20, -v19
    v_fma_f32 v22, v25, v21, -v20
    v_fma_f32 v23, v25, v22, -v21
    v_cndmask_b32 v11, v11, 0, vcc
    v_cvt_pk_bf16_f32 v12, v16, v17
    v_cvt_pk_bf16_f32 v13, v18, v19
    v_cvt_pk_bf16_f32 v14, v20, v21
PAD0:
    s_cbranch_execz RET_A_0
    v_cvt_pk_bf16_f32 v15, v22, v23
    s_mul_i32 s44, s36, 16384
    s_lshl3_add_u32 s38, s35, s32
    s_lshl_b32 s38, s38, 10
    s_add_u32 s44, s44, s38
    s_lshr_b32 s46, s40, 2
    s_and_b32 s45, s40, 3
    s_add_u32 s48, s48, s32
    v_lshl_add_u32 v9, v3, 5, s48
    v_mov_b32 v24, 512
    v_cmp_eq_u32 vcc, 0, v9
    s_nop 1
    v_cndmask_b32 v9, v9, v24, vcc
    v_cvt_f32_u32 v9, v9
    v_bfrev_b32 v10, 1
    v_mul_f32 v9, v27, v9
    v_mul_f32 v16, v9, v26
    v_cos_f32 v25, v9
    v_fmamk_f32 v20, v9, 0x41800000, v16
    v_add_f32 v17, v16, v9
    v_add_f32 v21, v20, v9
    v_add_f32 v25, v25, v25
    v_sin_f32 v68, v16
    v_cos_f32 v16, v16
    v_sin_f32 v69, v17
    v_cos_f32 v17, v17
    v_sin_f32 v72, v20
    v_cos_f32 v20, v20
    v_sin_f32 v73, v21
    v_cos_f32 v21, v21
    v_fma_f32 v70, v25, v69, -v68
    v_fma_f32 v18, v25, v17, -v16
    v_fma_f32 v74, v25, v73, -v72
    v_fma_f32 v22, v25, v21, -v20
    v_fma_f32 v71, v25, v70, -v69
    v_fma_f32 v19, v25, v18, -v17
    v_fma_f32 v75, v25, v74, -v73
    v_fma_f32 v23, v25, v22, -v21
    v_cvt_pk_bf16_f32 v48, v68, v69
    v_cvt_pk_bf16_f32 v44, v16, v17
    v_cvt_pk_bf16_f32 v49, v70, v71
    v_cvt_pk_bf16_f32 v45, v18, v19
    v_cvt_pk_bf16_f32 v50, v72, v73
    v_cvt_pk_bf16_f32 v46, v20, v21
    v_cvt_pk_bf16_f32 v51, v74, v75
    v_cvt_pk_bf16_f32 v47, v22, v23
    v_xor_b32_dpp v60, v48, v10 row_mirror row_mask:0xf bank_mask:0xf
    v_xor_b32 v52, 0x80008000, v48
    v_xor_b32_dpp v61, v49, v10 row_mirror row_mask:0xf bank_mask:0xf
    v_xor_b32 v53, 0x80008000, v49
    v_xor_b32_dpp v62, v50, v10 row_mirror row_mask:0xf bank_mask:0xf
    v_xor_b32 v54, 0x80008000, v50
    v_xor_b32_dpp v63, v51, v10 row_mirror row_mask:0xf bank_mask:0xf
    v_xor_b32 v55, 0x80008000, v51
    v_xor_b32_dpp v56, v44, v10 row_mirror row_mask:0xf bank_mask:0xf
    v_xor_b32_dpp v57, v45, v10 row_mirror row_mask:0xf bank_mask:0xf
    v_xor_b32_dpp v58, v46, v10 row_mirror row_mask:0xf bank_mask:0xf
    v_xor_b32_dpp v59, v47, v10 row_mirror row_mask:0xf bank_mask:0xf
    s_cmpk_lt_u32 s2, 224
    s_cbranch_scc1 NOOTH
    buffer_load_dwordx4 v2, s[4:7], s42 offen lds
    buffer_load_dwordx4 v2, s[4:7], s42 offen offset:1024 lds
NOOTH:
    s_cmp_eq_u32 s48, 0
    s_cbranch_scc0 SPEKD
    v_lshlrev_b32 v9, 5, v3
    v_sub_u32 v9, 1008, v9
    v_cvt_f32_u32 v9, v9
    v_mul_f32 v9, v27, v9
    v_mul_f32 v16, v9, v26
    v_cos_f32 v25, v9
    v_fmamk_f32 v20, v9, 0x41800000, v16
    v_add_f32 v17, v16, v9
    v_add_f32 v21, v20, v9
    v_add_f32 v25, v25, v25
    v_sin_f32 v68, v16
    v_cos_f32 v16, v16
    v_sin_f32 v69, v17
    v_cos_f32 v17, v17
    v_sin_f32 v72, v20
    v_cos_f32 v20, v20
    v_sin_f32 v73, v21
    v_cos_f32 v21, v21
    v_fma_f32 v70, v25, v69, -v68
    v_fma_f32 v18, v25, v17, -v16
    v_fma_f32 v74, v25, v73, -v72
    v_fma_f32 v22, v25, v21, -v20
    v_fma_f32 v71, v25, v70, -v69
    v_fma_f32 v19, v25, v18, -v17
    v_fma_f32 v75, v25, v74, -v73
    v_fma_f32 v23, v25, v22, -v21
    v_cvt_pk_bf16_f32 v60, v68, v69
    v_cvt_pk_bf16_f32 v56, v16, v17
    v_cvt_pk_bf16_f32 v61, v70, v71
    v_cvt_pk_bf16_f32 v57, v18, v19
    v_cvt_pk_bf16_f32 v62, v72, v73
    v_cvt_pk_bf16_f32 v58, v20, v21
    v_cvt_pk_bf16_f32 v63, v74, v75
    v_cvt_pk_bf16_f32 v59, v22, v23
SPEKD:
    v_xor_b32 v64, 0x80008000, v56
    v_xor_b32 v65, 0x80008000, v57
    v_xor_b32 v66, 0x80008000, v58
    v_xor_b32 v67, 0x80008000, v59
    v_lshrrev_b32 v9, 1, v3
    v_and_b32 v10, 1, v3
    v_cvt_f32_u32 v9, v9
    v_cvt_f32_u32 v24, v10
    v_cmp_gt_u32 vcc, 32, v1
    v_mov_b32 v68, 0xbe800000
    v_mul_f32 v9, 0x3e000000, v9
    s_cmp_eq_u32 s36, 0
    s_cbranch_scc0 BFQN
    v_lshrrev_b32 v24, 5, v1
    v_cmp_eq_u32 s[100:101], v24, v10
    v_mul_f32 v10, 0x40f00000, v9
    v_cndmask_b32 v10, v10, 0, vcc
    v_cndmask_b32 v9, -v9, v9, vcc
    v_cndmask_b32 v10, -v68, v10, s[100:101]
    v_cndmask_b32 v9, 0, v9, s[100:101]
    v_cndmask_b32 v68, 0, v68, s[100:101]
    s_branch BFGO
BFQN:
    v_mul_f32 v10, 0x3e800000, v24
    v_cndmask_b32 v68, -v68, v68, vcc
BFGO:
    v_cvt_f32_u32 v24, v7
    v_cos_f32 v25, v9
    v_mul_f32 v24, 4.0, v24
    v_fma_f32 v16, v9, v24, v10
    v_add_f32 v25, v25, v25
    v_add_f32 v17, v16, v9
    v_add_f32 v20, v16, v68
    v_add_f32 v21, v17, v68
    v_cos_f32 v16, v16
    v_cos_f32 v17, v17
    v_cos_f32 v20, v20
    v_cos_f32 v21, v21
    v_add_u32 v68, s43, v8
    v_fma_f32 v18, v25, v17, -v16
    v_fma_f32 v22, v25, v21, -v20
    v_fma_f32 v19, v25, v18, -v17
    v_fma_f32 v23, v25, v22, -v21
    v_xor_b32 v69, 16384, v68
    s_lshl_b32 s38, s32, 11
    v_lshl_add_u32 v24, v4, 9, s38
    v_lshl_add_u32 v24, v5, 6, v24
    v_lshl_add_u32 v24, v7, 5, v24
    v_lshl_add_u32 v70, v6, 3, v24
    v_xor_b32 v71, 32, v70
    s_cmp_lt_u32 s32, 4
    s_cselect_b32 s38, 0, 3
    s_lshl_b32 s39, s32, 6
    s_add_u32 s39, s39, 32768
    v_mul_u32_u24 v9, 1040, v3
    v_xor_b32 v24, s38, v4
    v_add_u32 v9, s39, v9
    v_lshl_add_u32 v72, v24, 4, v9
    v_xor_b32 v24, 2, v24
    v_lshl_add_u32 v73, v24, 4, v9
    s_lshl_b32 s38, s32, 2
    s_add_u32 s38, s38, 58112
    v_mov_b32 v74, s38
    s_lshl_b32 s39, s35, 5
    v_add_u32 v75, s39, v74
    s_mul_i32 s38, s32, 2080
    s_add_u32 s38, s38, 32768
    v_sub_u32 v24, 4, v5
    v_and_b32 v24, 3, v24
    v_xor_b32 v24, v24, v4
    v_lshl_add_u32 v9, v3, 6, s38
    v_lshl_add_u32 v76, v24, 4, v9
PAD1:
    s_cbranch_execz RET_A_0
    v_lshlrev_b32 v80, 4, v4
    v_lshlrev_b32 v24, 8, v4
    v_lshl_add_u32 v24, v3, 3, v24
    s_mul_i32 s38, s32, 1088
    s_add_u32 s38, s38, 49408
    v_add_u32 v77, s38, v24
    s_sub_u32 s38, 8, s32
    s_and_b32 s38, s38, 7
    s_mul_i32 s38, s38, 1088
    s_add_u32 s38, s38, 49412
    v_add_u32 v78, s38, v24
    s_lshl_b32 s38, s32, 7
    s_add_u32 s38, s38, 49408
    v_mul_u32_u24 v24, 1088, v5
    v_lshl_add_u32 v9, v4, 2, v6
    v_add_u32 v24, s38, v24
    v_lshl_add_u32 v79, v9, 3, v24
    v_mov_b32 v9, 0
    v_mov_b32 v10, 0
    v_mov_b32 v24, 0
    v_mov_b32 v25, 0
    v_mov_b32 v81, 0
    v_mov_b32 v82, 0
    v_mov_b32 v83, 1
    v_mov_b32 v84, 0
    s_cmpk_lt_u32 s2, 224
    s_cselect_b32 s47, 263, 7
    s_waitcnt vmcnt(0)
    ds_write_b128 v68, v[28:31]
    ds_write_b128 v68, v[32:35] offset:1024
    v_dot2c_f32_bf16 v9, 0x3f803f80, v28
    v_dot2c_f32_bf16 v10, v28, v28
    v_dot2c_f32_bf16 v9, 0x3f803f80, v29
    v_dot2c_f32_bf16 v10, v29, v29
    s_cmpk_ge_u32 s2, 224
    s_cbranch_scc1 MEETB
    s_mov_b64 exec, 1
    ds_add_rtn_u32 v85, v84, v83 offset:58256
    s_mov_b64 exec, -1
    s_waitcnt lgkmcnt(0)
    v_readfirstlane_b32 s38, v85
    s_cmp_eq_u32 s38, 7
    s_cbranch_scc1 GO0
SPIN0:
    ds_read_b32 v85, v84 offset:58256
    s_waitcnt lgkmcnt(0)
    v_cmp_eq_u32 vcc, 8, v85
    s_cbranch_vccz SPIN0
GO0:
    ds_read_b128 v[36:39], v8 offset:49408
    ds_read_b128 v[40:43], v8 offset:50432
    v_dot2c_f32_bf16 v9, 0x3f803f80, v30
    v_dot2c_f32_bf16 v10, v30, v30
    v_dot2c_f32_bf16 v9, 0x3f803f80, v31
    v_dot2c_f32_bf16 v10, v31, v31
    v_dot2c_f32_bf16 v9, 0x3f803f80, v32
    v_dot2c_f32_bf16 v10, v32, v32
    v_dot2c_f32_bf16 v9, 0x3f803f80, v33
    v_dot2c_f32_bf16 v10, v33, v33
    v_dot2c_f32_bf16 v9, 0x3f803f80, v34
    v_dot2c_f32_bf16 v10, v34, v34
    v_dot2c_f32_bf16 v9, 0x3f803f80, v35
    v_dot2c_f32_bf16 v10, v35, v35
    s_waitcnt lgkmcnt(1)
    v_dot2c_f32_bf16 v25, 0x3f803f80, v36
    v_dot2c_f32_bf16 v24, v28, v36
    v_dot2c_f32_bf16 v25, 0x3f803f80, v37
    v_dot2c_f32_bf16 v24, v29, v37
    v_dot2c_f32_bf16 v25, 0x3f803f80, v38
    v_dot2c_f32_bf16 v24, v30, v38
    v_dot2c_f32_bf16 v25, 0x3f803f80, v39
    v_dot2c_f32_bf16 v24, v31, v39
    s_waitcnt lgkmcnt(0)
    v_dot2c_f32_bf16 v25, 0x3f803f80, v40
    v_dot2c_f32_bf16 v24, v32, v40
    v_dot2c_f32_bf16 v25, 0x3f803f80, v41
    v_dot2c_f32_bf16 v24, v33, v41
    v_dot2c_f32_bf16 v25, 0x3f803f80, v42
    v_dot2c_f32_bf16 v24, v34, v42
    v_dot2c_f32_bf16 v25, 0x3f803f80, v43
    v_dot2c_f32_bf16 v24, v35, v43
    v_permlane32_swap_b32 v9, v10
    s_nop 1
    v_permlane32_swap_b32 v24, v25
    v_add_f32 v9, v9, v10
    v_add_f32 v24, v24, v25
    s_nop 1
    v_permlane16_swap_b32 v9, v24
    v_add_f32 v9, v9, v24
    s_nop 1
    v_add_f32_dpp v9, v9, v9 row_ror:8 row_mask:0xf bank_mask:0xf
    s_nop 1
    v_add_f32_dpp v9, v9, v9 row_ror:4 row_mask:0xf bank_mask:0xf
    s_nop 1
    v_add_f32_dpp v9, v9, v9 row_ror:2 row_mask:0xf bank_mask:0xf
    s_nop 1
    v_add_f32_dpp v9, v9, v9 row_ror:1 row_mask:0xf bank_mask:0xf
    s_nop 0
    v_readlane_b32 s49, v9, 0
    v_readlane_b32 s50, v9, 32
    v_readlane_b32 s51, v9, 16
    v_readlane_b32 s52, v9, 48
    v_mul_f32 v2, s49, v27
    v_mul_f32 v10, s50, v27
    v_mov_b32 v24, s51
    v_fma_f32 v10, -v2, v2, v10
    v_fma_f32 v24, -v2, s52, v24
    v_max_f32 v10, 0, v10
    v_add_f32 v10, 0x3727c5ac, v10
    v_rsq_f32 v110, v10
    s_nop 0
    v_mul_f32 v24, v24, v110
    v_ashrrev_i32 v10, 31, v24
    v_or_b32 v10, 0x80000000, v10
    v_xor_b32 v10, v24, v10
    v_and_b32 v10, 0xfffff800, v10
    v_or_b32 v10, s41, v10
    s_mov_b64 exec, 1
    ds_write2_b32 v74, v10, v2 offset0:16 offset1:40
    ds_write_b32 v75, v110
    s_mov_b64 exec, -1
    s_mov_b64 exec, 1
    ds_add_rtn_u32 v85, v84, v83 offset:58260
    s_mov_b64 exec, -1
    s_waitcnt lgkmcnt(0)
    v_readfirstlane_b32 s38, v85
    s_cmp_eq_u32 s38, s47
    s_cbranch_scc1 GO1
    s_add_u32 s47, s47, 1
SPIN1:
    ds_read_b32 v85, v84 offset:58260
    s_waitcnt lgkmcnt(0)
    v_cmp_eq_u32 vcc, s47, v85
    s_cbranch_vccz SPIN1
GO1:
    s_waitcnt vmcnt(0)
    ds_read_b128 v[86:89], v69
    ds_read_b128 v[90:93], v69 offset:1024
    ds_read_b64_tr_b16 v[94:95], v70 offset:0
    ds_read_b64_tr_b16 v[96:97], v70 offset:256
    ds_read_b64_tr_b16 v[98:99], v71 offset:0
    ds_read_b64_tr_b16 v[100:101], v71 offset:256
    ds_read_b64_tr_b16 v[102:103], v70 offset:16384
    ds_read_b64_tr_b16 v[104:105], v70 offset:16640
    ds_read_b64_tr_b16 v[106:107], v71 offset:16384
    ds_read_b64_tr_b16 v[108:109], v71 offset:16640
    s_waitcnt lgkmcnt(8)
    v_dot2c_f32_bf16 v81, 0x3f803f80, v86
    v_dot2c_f32_bf16 v82, v86, v86
    v_dot2c_f32_bf16 v81, 0x3f803f80, v87
    v_dot2c_f32_bf16 v82, v87, v87
    v_dot2c_f32_bf16 v81, 0x3f803f80, v88
    v_dot2c_f32_bf16 v82, v88, v88
    v_dot2c_f32_bf16 v81, 0x3f803f80, v89
    v_dot2c_f32_bf16 v82, v89, v89
    v_dot2c_f32_bf16 v81, 0x3f803f80, v90
    v_dot2c_f32_bf16 v82, v90, v90
    v_dot2c_f32_bf16 v81, 0x3f803f80, v91
    v_dot2c_f32_bf16 v82, v91, v91
    v_dot2c_f32_bf16 v81, 0x3f803f80, v92
    v_dot2c_f32_bf16 v82, v92, v92
    v_dot2c_f32_bf16 v81, 0x3f803f80, v93
    v_dot2c_f32_bf16 v82, v93, v93
    s_nop 2
    v_permlane32_swap_b32 v81, v82
    v_mul_f32 v112, v11, v2
    v_mul_f32 v113, v11, v2
    v_mul_f32 v114, v11, v2
    v_mul_f32 v115, v11, v2
    v_add_f32 v81, v81, v82
    v_mov_b32 v82, v81
    s_waitcnt lgkmcnt(4)
    v_mfma_f32_16x16x32_bf16 v[120:123], v[94:97], v[12:15], v[112:115]
    v_permlane16_swap_b32 v81, v82
    v_mfma_f32_16x16x32_bf16 v[124:127], v[98:101], v[12:15], v[112:115]
    v_add_f32 v81, v81, v82
    s_nop 1
    v_add_f32_dpp v81, v81, v81 row_ror:8 row_mask:0xf bank_mask:0xf
    s_nop 1
    v_add_f32_dpp v81, v81, v81 row_ror:4 row_mask:0xf bank_mask:0xf
    s_nop 1
    v_add_f32_dpp v81, v81, v81 row_ror:2 row_mask:0xf bank_mask:0xf
    s_nop 1
    v_add_f32_dpp v81, v81, v81 row_ror:1 row_mask:0xf bank_mask:0xf
    s_nop 0
PAD2:
    s_cbranch_execz RET_A_0
    v_readlane_b32 s49, v81, 0
    v_readlane_b32 s50, v81, 32
    v_cvt_pk_bf16_f32 v136, v120, v121
    v_cvt_pk_bf16_f32 v137, v122, v123
    v_cvt_pk_bf16_f32 v138, v124, v125
    v_cvt_pk_bf16_f32 v139, v126, v127
    v_mul_f32 v81, s49, v27
    v_mul_f32 v82, s50, v27
    ds_write_b128 v72, v[136:139]
    v_mul_f32 v116, v11, v81
    v_mul_f32 v117, v11, v81
    v_mul_f32 v118, v11, v81
    v_mul_f32 v119, v11, v81
    v_fma_f32 v82, -v81, v81, v82
    s_waitcnt lgkmcnt(1)
    v_mfma_f32_16x16x32_bf16 v[128:131], v[102:105], v[12:15], v[116:119]
    v_mfma_f32_16x16x32_bf16 v[132:135], v[106:109], v[12:15], v[116:119]
    v_max_f32 v82, 0, v82
    v_add_f32 v82, 0x3727c5ac, v82
    v_rsq_f32 v82, v82
    v_xor_b32 v75, 32, v75
    s_mov_b64 exec, 1
    ds_write_b32 v75, v82
    s_mov_b64 exec, -1
    v_cvt_pk_bf16_f32 v140, v128, v129
    v_cvt_pk_bf16_f32 v141, v130, v131
    v_cvt_pk_bf16_f32 v142, v132, v133
    v_cvt_pk_bf16_f32 v143, v134, v135
    ds_write_b128 v73, v[140:143] offset:512
    s_mov_b64 exec, 1
    ds_add_rtn_u32 v85, v84, v83 offset:58264
    s_mov_b64 exec, -1
    ds_read_b128 v[144:147], v76
    ds_read_b128 v[148:151], v76 offset:1040
    ds_read_b128 v[152:155], v80 offset:58112
    s_waitcnt lgkmcnt(3)
    v_readfirstlane_b32 s38, v85
    s_cmp_eq_u32 s38, 7
    s_cbranch_scc1 GO2
SPIN2:
    ds_read_b32 v85, v84 offset:58264
    ds_read_b128 v[144:147], v76
PAD3:
    s_cbranch_execz RET_A_1
    ds_read_b128 v[148:151], v76 offset:1040
    ds_read_b128 v[152:155], v80 offset:58112
    s_waitcnt lgkmcnt(3)
    v_cmp_eq_u32 vcc, 8, v85
    s_cbranch_vccz SPIN2
GO2:
    s_waitcnt lgkmcnt(1)
    s_cmp_eq_u32 s48, 0
    v_mfma_f32_16x16x32_bf16 v[10:13], v[144:147], v[44:47], 0
    v_mfma_f32_16x16x32_bf16 v[24:27], v[144:147], v[52:55], 0
    s_cbranch_scc0 SPECN
    v_mfma_f32_16x16x32_bf16 v[28:31], v[148:151], v[56:59], 0
    v_mfma_f32_16x16x32_bf16 v[32:35], v[148:151], v[60:63], 0
    s_branch SPECD
SPECN:
    v_mfma_f32_16x16x32_bf16 v[28:31], v[144:147], v[56:59], 0
    v_mfma_f32_16x16x32_bf16 v[32:35], v[144:147], v[60:63], 0
    v_mfma_f32_16x16x32_bf16 v[10:13], v[148:151], v[48:51], v[10:13]
    v_mfma_f32_16x16x32_bf16 v[24:27], v[148:151], v[44:47], v[24:27]
    v_mfma_f32_16x16x32_bf16 v[28:31], v[148:151], v[60:63], v[28:31]
    v_mfma_f32_16x16x32_bf16 v[32:35], v[148:151], v[64:67], v[32:35]
SPECD:
    s_waitcnt lgkmcnt(0)
    v_mul_f32 v16, v16, v152
    v_mul_f32 v17, v17, v153
    v_mul_f32 v18, v18, v154
    v_mul_f32 v19, v19, v155
    v_mul_f32 v20, v20, v152
    v_mul_f32 v21, v21, v153
    v_mul_f32 v22, v22, v154
    v_mul_f32 v23, v23, v155
    v_cvt_pk_bf16_f32 v36, v16, v17
    v_cvt_pk_bf16_f32 v37, v18, v19
    v_cvt_pk_bf16_f32 v38, v20, v21
    v_cvt_pk_bf16_f32 v39, v22, v23
    v_cvt_pk_bf16_f32 v40, v10, v11
    v_cvt_pk_bf16_f32 v41, v12, v13
    v_cvt_pk_bf16_f32 v42, v24, v25
    v_cvt_pk_bf16_f32 v43, v26, v27
    s_nop 1
    v_mfma_f32_16x16x32_bf16 v[144:147], v[36:39], v[40:43], 0
    v_cvt_pk_bf16_f32 v68, v28, v29
    v_cvt_pk_bf16_f32 v69, v30, v31
    v_cvt_pk_bf16_f32 v70, v32, v33
    v_cvt_pk_bf16_f32 v71, v34, v35
    s_nop 1
    v_mfma_f32_16x16x32_bf16 v[148:151], v[36:39], v[68:71], 0
    s_nop 0
    v_cvt_pk_bf16_f32 v40, v144, v145
    v_cvt_pk_bf16_f32 v41, v146, v147
    ds_write2_b32 v77, v40, v41 offset1:32
    s_nop 3
    v_cvt_pk_bf16_f32 v68, v148, v149
    v_cvt_pk_bf16_f32 v69, v150, v151
    ds_write2_b32 v78, v68, v69 offset1:32
    s_mov_b64 exec, 1
    ds_add_rtn_u32 v85, v84, v83 offset:58268
    s_mov_b64 exec, -1
    ds_read_b64_tr_b16 v[36:37], v79
    ds_read_b64_tr_b16 v[38:39], v79 offset:4352
    s_waitcnt lgkmcnt(2)
    v_readfirstlane_b32 s38, v85
    s_cmp_eq_u32 s38, 7
    s_cbranch_scc1 GO3
SPIN3:
    ds_read_b32 v85, v84 offset:58268
    ds_read_b64_tr_b16 v[36:37], v79
    ds_read_b64_tr_b16 v[38:39], v79 offset:4352
    s_waitcnt lgkmcnt(2)
    v_cmp_eq_u32 vcc, 8, v85
    s_cbranch_vccz SPIN3
GO3:
    s_and_b32 s47, s34, 15
    s_lshr_b32 s53, s34, 4
    s_lshl3_add_u32 s38, s53, s32
    s_lshl_b32 s38, s38, 7
    s_add_u32 s38, s38, s33
    v_lshl_add_u32 v2, v3, 3, s38
    v_sub_u32 v9, 2048, v2
    v_and_b32 v9, 2047, v9
    s_waitcnt lgkmcnt(0)
    buffer_store_dwordx4 v[36:39], v8, s[8:11], s44 offen sc1
    s_lshl_b32 s38, s47, 6
    v_lshl_add_u32 v73, v4, 4, s38
    v_lshl_add_u32 v81, v2, 11, v73
    v_sub_u32 v73, 2032, v73
    v_lshl_add_u32 v14, v9, 11, v73
    v_and_b32 v73, 7, v2
    v_and_b32 v74, 0x7f8, v2
    v_lshl_add_u32 v15, v73, 11, v74
    v_and_b32 v73, 7, v9
    v_and_b32 v74, 0x7f8, v9
    v_lshl_add_u32 v72, v73, 11, v74
    v_cvt_f32_u32 v75, v2
    v_lshrrev_b32 v73, 5, v1
    v_add_u32 v74, v7, v7
    v_lshl_add_u32 v73, v73, 3, v74
    v_mul_f32 v75, 0x3a000000, v75
    v_cvt_f32_u32 v73, v73
    v_mul_f32 v74, 0x41800000, v75
    v_mul_f32 v10, v75, v73
    v_cos_f32 v80, v74
    v_add_f32 v11, v10, v75
    v_fma_f32 v12, v75, 4.0, v10
    v_fma_f32 v13, v75, 4.0, v11
    v_add_f32 v80, v80, v80
    v_add_f32 v20, v10, v74
    v_add_f32 v21, v11, v74
    v_add_f32 v22, v12, v74
    v_add_f32 v23, v13, v74
    v_sin_f32 v16, v10
    v_cos_f32 v10, v10
    v_sin_f32 v17, v11
    v_cos_f32 v11, v11
    v_sin_f32 v18, v12
    v_cos_f32 v12, v12
    v_sin_f32 v19, v13
    v_cos_f32 v13, v13
    v_sin_f32 v24, v20
    v_cos_f32 v20, v20
    v_sin_f32 v25, v21
    v_cos_f32 v21, v21
    v_sin_f32 v26, v22
    v_cos_f32 v22, v22
    v_sin_f32 v27, v23
    v_cos_f32 v23, v23
    v_cvt_pk_bf16_f32 v40, v10, v16
    v_fma_f32 v10, v80, v20, -v10
    v_fma_f32 v16, v80, v24, -v16
    v_cvt_pk_bf16_f32 v41, v11, v17
    v_fma_f32 v11, v80, v21, -v11
    v_fma_f32 v17, v80, v25, -v17
    v_cvt_pk_bf16_f32 v42, v12, v18
    v_fma_f32 v12, v80, v22, -v12
    v_fma_f32 v18, v80, v26, -v18
    v_cvt_pk_bf16_f32 v43, v13, v19
    v_fma_f32 v13, v80, v23, -v13
    v_fma_f32 v19, v80, v27, -v19
    v_cvt_pk_bf16_f32 v44, v20, v24
    v_fma_f32 v20, v80, v10, -v20
    v_fma_f32 v24, v80, v16, -v24
    v_cvt_pk_bf16_f32 v45, v21, v25
    v_fma_f32 v21, v80, v11, -v21
    v_fma_f32 v25, v80, v17, -v25
    v_cvt_pk_bf16_f32 v46, v22, v26
    v_fma_f32 v22, v80, v12, -v22
    v_fma_f32 v26, v80, v18, -v26
    v_cvt_pk_bf16_f32 v47, v23, v27
    v_fma_f32 v23, v80, v13, -v23
    v_fma_f32 v27, v80, v19, -v27
    v_cvt_pk_bf16_f32 v48, v10, v16
    v_fma_f32 v10, v80, v20, -v10
    v_fma_f32 v16, v80, v24, -v16
    v_cvt_pk_bf16_f32 v49, v11, v17
    v_fma_f32 v11, v80, v21, -v11
    v_fma_f32 v17, v80, v25, -v17
    v_cvt_pk_bf16_f32 v50, v12, v18
    v_fma_f32 v12, v80, v22, -v12
    v_fma_f32 v18, v80, v26, -v18
    v_cvt_pk_bf16_f32 v51, v13, v19
    v_fma_f32 v13, v80, v23, -v13
    v_fma_f32 v19, v80, v27, -v19
    v_cvt_pk_bf16_f32 v52, v20, v24
    v_fma_f32 v20, v80, v10, -v20
    v_fma_f32 v24, v80, v16, -v24
PAD4:
    s_cbranch_execz RET_A_1
    v_cvt_pk_bf16_f32 v53, v21, v25
    v_fma_f32 v21, v80, v11, -v21
    v_fma_f32 v25, v80, v17, -v25
    v_cvt_pk_bf16_f32 v54, v22, v26
    v_fma_f32 v22, v80, v12, -v22
    v_fma_f32 v26, v80, v18, -v26
    v_cvt_pk_bf16_f32 v55, v23, v27
    v_fma_f32 v23, v80, v13, -v23
    v_fma_f32 v27, v80, v19, -v27
    v_cvt_pk_bf16_f32 v56, v10, v16
    v_fma_f32 v10, v80, v20, -v10
    v_fma_f32 v16, v80, v24, -v16
    v_cvt_pk_bf16_f32 v57, v11, v17
    v_fma_f32 v11, v80, v21, -v11
    v_fma_f32 v17, v80, v25, -v17
    v_cvt_pk_bf16_f32 v58, v12, v18
    v_fma_f32 v12, v80, v22, -v12
    v_fma_f32 v18, v80, v26, -v18
    v_cvt_pk_bf16_f32 v59, v13, v19
    v_fma_f32 v13, v80, v23, -v13
    v_fma_f32 v19, v80, v27, -v19
    v_cvt_pk_bf16_f32 v60, v20, v24
    v_fma_f32 v20, v80, v10, -v20
    v_fma_f32 v24, v80, v16, -v24
    v_cvt_pk_bf16_f32 v61, v21, v25
    v_fma_f32 v21, v80, v11, -v21
    v_fma_f32 v25, v80, v17, -v25
    v_cvt_pk_bf16_f32 v62, v22, v26
    v_fma_f32 v22, v80, v12, -v22
    v_fma_f32 v26, v80, v18, -v26
    v_cvt_pk_bf16_f32 v63, v23, v27
    v_fma_f32 v23, v80, v13, -v23
    v_fma_f32 v27, v80, v19, -v27
    v_cvt_pk_bf16_f32 v64, v10, v16
    v_cvt_pk_bf16_f32 v65, v11, v17
    v_cvt_pk_bf16_f32 v66, v12, v18
    v_cvt_pk_bf16_f32 v67, v13, v19
    v_cvt_pk_bf16_f32 v68, v20, v24
    v_cvt_pk_bf16_f32 v69, v21, v25
    v_cvt_pk_bf16_f32 v70, v22, v26
    v_cvt_pk_bf16_f32 v71, v23, v27
    v_and_b32 v73, 1, v3
    v_cmp_gt_u32 vcc, 16, v1
    v_lshlrev_b32 v73, 31, v73
    v_or_b32 v73, 0x3f803f80, v73
    v_cndmask_b32 v40, v40, v73, vcc
    s_barrier
    s_lshl_b32 s38, s33, 10
    s_mul_i32 s39, s32, 262144
    s_add_u32 s38, s38, s39
    s_lshl_b32 s54, s47, 6
    s_add_u32 s55, s54, 64
    s_add_u32 s54, s54, s38
    s_and_b32 s55, s55, 1023
    s_add_u32 s41, s54, 8192
    s_add_u32 s55, s55, s38
    v_lshrrev_b32 v18, 2, v1
    v_and_b32 v19, 1, v1
    v_bfe_u32 v20, v1, 1, 1
    v_mul_u32_u24 v73, 16384, v18
    v_lshl_add_u32 v75, v6, 4, v73
    v_lshl_add_u32 v80, v19, 4, v73
    s_mul_i32 s38, s32, 3072
    v_lshl_add_u32 v73, v18, 1, v19
    v_mul_u32_u24 v73, 96, v73
    v_add_u32 v12, s38, v73
    v_mad_u32_u24 v10, v20, 24, v12
    v_lshl_add_u32 v11, v20, 3, v12
    s_lshl_b32 s38, s32, 4
    v_and_b32 v73, 1, v18
    v_lshl_add_u32 v73, v73, 1, v19
    v_lshl_add_u32 v73, v7, 2, v73
    v_lshl_add_u32 v12, v73, 1, s38
    v_bfe_u32 v73, v1, 3, 1
    v_lshrrev_b32 v74, 5, v1
    v_lshl_add_u32 v73, v74, 1, v73
    v_lshl_add_u32 v12, v73, 7, v12
    v_sub_u32 v73, 15, v3
    v_lshlrev_b32 v73, 4, v73
    v_lshl_add_u32 v21, v4, 7, v73
    v_lshrrev_b32 v73, 5, v1
    v_lshl_add_u32 v74, v7, 2, v5
    v_lshl_add_u32 v73, v73, 4, v74
    v_mul_u32_u24 v73, 96, v73
    v_lshl_add_u32 v13, v6, 3, v73
    s_cmp_eq_u32 s47, 0
    s_cselect_b32 s38, 0x0908, 0
    s_xor_b32 s38, s38, 0x07060504
    v_cmp_eq_u32 vcc, 1, v20
    v_mov_b32 v73, 0x07060100
    v_mov_b32 v17, 0x07060504
    v_mov_b32 v16, s38
    v_cndmask_b32 v17, v17, v73, vcc
    v_cndmask_b32 v16, v16, v73, vcc
    v_lshrrev_b32 v73, 1, v5
    v_lshl_add_u32 v73, v7, 1, v73
    v_lshlrev_b32 v74, 10, v4
    v_lshl_add_u32 v74, v5, 7, v74
    v_lshl_add_u32 v74, v6, 3, v74
    v_lshl_add_u32 v74, v73, 5, v74
    s_lshl_b32 s38, s32, 12
    s_add_u32 s38, s38, 126976
    v_add_u32 v23, s38, v74
    s_and_b32 s38, s32, 3
    s_lshl_b32 s38, s38, 5
    v_xor_b32 v74, s38, v74
    s_lshr_b32 s39, s32, 2
    s_lshl_b32 s38, s39, 15
    s_add_u32 s38, s38, 61440
    v_add_u32 v22, s38, v74
    v_lshlrev_b32 v73, 4, v19
    v_lshl_add_u32 v24, v4, 5, v73
    s_lshl_b32 s52, s46, 12
    s_add_u32 s52, s52, 2949120
    s_lshl_b32 s38, s45, 9
    s_add_u32 s44, s52, s38
    s_lshl_b32 s38, s39, 8
    s_add_u32 s44, s44, s38
    s_bfe_u32 s38, s32, 0x10001
    s_lshl_b32 s38, s38, 11
    s_add_u32 s44, s44, s38
    s_and_b32 s38, s32, 1
    s_lshl_b32 s38, s38, 7
    s_add_u32 s44, s44, s38
    s_cmpk_ge_u32 s2, 192
    s_cselect_b32 s38, -6, 1
    s_mul_i32 s38, s38, s39
    s_lshl_b32 s38, s38, 12
    s_add_u32 s44, s44, s38
    s_cmp_lt_u32 s2, 224
    s_cselect_b32 s44, s44, 117440512
    s_lshl_b32 s38, s39, 11
    s_add_u32 s52, s52, s38
    v_lshl_add_u32 v73, v20, 8, v73
    v_lshl_add_u32 v73, v4, 6, v73
    v_and_b32 v74, 1, v5
    v_lshl_add_u32 v73, v74, 5, v73
    v_lshrrev_b32 v74, 1, v5
    v_lshl_add_u32 v25, v74, 10, v73
    v_mul_u32_u24 v73, 229376, v19
    v_lshl_add_u32 v73, v7, 5, v73
    v_lshrrev_b32 v74, 5, v1
    v_lshl_add_u32 v26, v74, 4, v73
    s_and_b32 s38, s32, 3
    s_lshl2_add_u32 s38, s45, s38
    s_mul_i32 s42, s38, 14336
    s_lshl1_add_u32 s38, s46, s39
    s_lshl_b32 s38, s38, 6
    s_add_u32 s42, s42, s38
    s_add_u32 s42, s42, 2490368
    s_mov_b32 s50, 0x00030003
    s_mov_b32 s51, 0x00030003
    s_mov_b32 s43, 2359296
    s_mov_b32 s48, 0
    s_mov_b32 s26, s6
    s_mov_b32 s27, s7
    v_mov_b32 v73, 0
    s_mov_b64 exec, 0
    s_cmp_eq_u32 s32, 0
    s_cbranch_scc1 PAD6
    s_cmp_eq_u32 s32, 1
    s_cbranch_scc1 PAD7
    s_cmp_eq_u32 s32, 2
    s_cbranch_scc1 PAD9
RET_B_0:
    s_mov_b64 exec, -1
PAD5:
    s_cbranch_execz RET_A_1
    s_barrier
    s_barrier
    ds_read_b128 v[90:93], v8 offset:58368
    ds_read_b64_tr_b16 v[76:77], v22 offset:0
    ds_read_b64_tr_b16 v[78:79], v22 offset:512
    ds_read_b64 v[38:39], v73 offset:58240
    ds_read_b64_tr_b16 v[122:123], v22 offset:4096
    ds_read_b64_tr_b16 v[124:125], v22 offset:4608
    ds_read_b64_tr_b16 v[126:127], v22 offset:8192
    ds_read_b64_tr_b16 v[128:129], v22 offset:8704
    ds_read_b64_tr_b16 v[130:131], v22 offset:12288
    ds_read_b64_tr_b16 v[132:133], v22 offset:12800
    s_waitcnt lgkmcnt(9)
    v_mov_b32_dpp v94, v90 row_shl:2 row_mask:0xf bank_mask:0xf
    v_mov_b32_dpp v95, v91 row_shl:2 row_mask:0xf bank_mask:0xf
    v_mov_b32_dpp v96, v92 row_shl:2 row_mask:0xf bank_mask:0xf
    v_mov_b32_dpp v97, v93 row_shl:2 row_mask:0xf bank_mask:0xf
    s_waitcnt lgkmcnt(7)
    v_mfma_f32_16x16x32_bf16 v[134:137], v[76:79], v[90:93], 0
    ds_read_b64_tr_b16 v[76:77], v22 offset:16384
    ds_read_b64_tr_b16 v[78:79], v22 offset:16896
    v_mov_b32_dpp v98, v90 row_shl:4 row_mask:0xf bank_mask:0xf
    v_mov_b32_dpp v99, v91 row_shl:4 row_mask:0xf bank_mask:0xf
    v_mov_b32_dpp v100, v92 row_shl:4 row_mask:0xf bank_mask:0xf
    v_mov_b32_dpp v101, v93 row_shl:4 row_mask:0xf bank_mask:0xf
    s_waitcnt lgkmcnt(6)
    v_mfma_f32_16x16x32_bf16 v[138:141], v[122:125], v[94:97], 0
    ds_read_b64_tr_b16 v[122:123], v22 offset:20480
    ds_read_b64_tr_b16 v[124:125], v22 offset:20992
    v_mov_b32_dpp v102, v90 row_shl:6 row_mask:0xf bank_mask:0xf
    v_mov_b32_dpp v103, v91 row_shl:6 row_mask:0xf bank_mask:0xf
    v_mov_b32_dpp v104, v92 row_shl:6 row_mask:0xf bank_mask:0xf
    v_mov_b32_dpp v105, v93 row_shl:6 row_mask:0xf bank_mask:0xf
    s_waitcnt lgkmcnt(6)
    v_mfma_f32_16x16x32_bf16 v[134:137], v[126:129], v[98:101], v[134:137]
    ds_read_b64_tr_b16 v[126:127], v22 offset:24576
    ds_read_b64_tr_b16 v[128:129], v22 offset:25088
    v_mov_b32_dpp v106, v90 row_shl:8 row_mask:0xf bank_mask:0xf
    v_mov_b32_dpp v107, v91 row_shl:8 row_mask:0xf bank_mask:0xf
    v_mov_b32_dpp v108, v92 row_shl:8 row_mask:0xf bank_mask:0xf
    v_mov_b32_dpp v109, v93 row_shl:8 row_mask:0xf bank_mask:0xf
    s_waitcnt lgkmcnt(6)
    v_mfma_f32_16x16x32_bf16 v[138:141], v[130:133], v[102:105], v[138:141]
    ds_read_b64_tr_b16 v[130:131], v22 offset:28672
    ds_read_b64_tr_b16 v[132:133], v22 offset:29184
    v_mov_b32_dpp v110, v90 row_shl:10 row_mask:0xf bank_mask:0xf
    v_mov_b32_dpp v111, v91 row_shl:10 row_mask:0xf bank_mask:0xf
    v_mov_b32_dpp v112, v92 row_shl:10 row_mask:0xf bank_mask:0xf
    v_mov_b32_dpp v113, v93 row_shl:10 row_mask:0xf bank_mask:0xf
    s_waitcnt lgkmcnt(6)
    v_mfma_f32_16x16x32_bf16 v[134:137], v[76:79], v[106:109], v[134:137]
    v_mov_b32_dpp v114, v90 row_shl:12 row_mask:0xf bank_mask:0xf
    v_mov_b32_dpp v115, v91 row_shl:12 row_mask:0xf bank_mask:0xf
    v_mov_b32_dpp v116, v92 row_shl:12 row_mask:0xf bank_mask:0xf
    v_mov_b32_dpp v117, v93 row_shl:12 row_mask:0xf bank_mask:0xf
    s_waitcnt lgkmcnt(4)
    v_mfma_f32_16x16x32_bf16 v[138:141], v[122:125], v[110:113], v[138:141]
    v_mov_b32_dpp v118, v90 row_shl:14 row_mask:0xf bank_mask:0xf
    v_mov_b32_dpp v119, v91 row_shl:14 row_mask:0xf bank_mask:0xf
    v_mov_b32_dpp v120, v92 row_shl:14 row_mask:0xf bank_mask:0xf
    v_mov_b32_dpp v121, v93 row_shl:14 row_mask:0xf bank_mask:0xf
    s_waitcnt lgkmcnt(2)
    v_mfma_f32_16x16x32_bf16 v[134:137], v[126:129], v[114:117], v[134:137]
    s_waitcnt lgkmcnt(0)
    v_mfma_f32_16x16x32_bf16 v[138:141], v[130:133], v[118:121], v[138:141]
    v_cmp_eq_u32 s[34:35], v2, v38
    v_cmp_eq_u32 vcc, v2, v39
    v_cmp_eq_u32 s[36:37], v9, v38
    v_cmp_eq_u32 s[46:47], v9, v39
    v_lshlrev_b32 v74, 5, v4
    v_cndmask_b32 v2, 0, 64, vcc
    v_cndmask_b32 v9, 0, 64, s[46:47]
    s_nop 0
    v_add_f32 v134, v134, v138
    v_add_f32 v135, v135, v139
    v_add_f32 v136, v136, v140
    v_add_f32 v137, v137, v141
    s_mov_b64 exec, s[50:51]
    buffer_store_dwordx4 v[134:137], v24, s[8:11], s44 offen sc1
    s_mov_b64 exec, -1
    s_barrier
    buffer_load_dwordx4 v[28:31], v75, s[8:11], s54 offen
    buffer_load_dwordx4 v[32:35], v75, s[8:11], s41 offen
    buffer_load_dword v20, v80, s[8:11], s55 offen
    buffer_load_dwordx2 v[18:19], v15, s[8:11], s43 offen sc1
    buffer_load_dwordx2 v[36:37], v72, s[8:11], s43 offen sc1
    s_cmpk_lt_u32 s2, 224
    s_cbranch_scc1 NORES
    buffer_load_dwordx4 v[82:85], v81, s[4:7], 0 offen
    buffer_load_dwordx4 v[86:89], v14, s[4:7], 0 offen
NORES:
    s_or_b64 s[34:35], s[34:35], vcc
    s_or_b64 s[36:37], s[36:37], s[46:47]
    v_lshl_add_u32 v2, v2, 1, v74
    v_sub_u32 v74, 96, v74
    v_lshl_add_u32 v9, v9, 1, v74
    s_waitcnt vmcnt(0)
UCHK:
    v_max3_u32 v73, v28, v29, v30
    v_max3_u32 v74, v32, v33, v34
    v_max3_u32 v73, v73, v31, v35
    v_max3_u32 v74, v74, v20, v18
    v_max3_u32 v73, v73, v19, v36
    v_max3_u32 v73, v73, v74, v37
    v_cmp_eq_u32 vcc, -1, v73
    s_cbranch_vccnz URETRY
UOK:
    s_cmpk_ge_u32 s2, 224
    s_cbranch_scc1 NOHX
    buffer_load_dwordx4 v[90:93], v25, s[8:11], s52 offen
    buffer_load_dwordx4 v[94:97], v25, s[8:11], s52 offen offset:512
NOHX:
    v_perm_b32 v73, v28, v32, v16
    v_perm_b32 v32, v32, v28, v17
    ds_write_b16 v12, v20 offset:24640
    v_mov_b32 v28, v73
    ds_write_b64 v10, v[30:31] offset:40
    ds_write_b64 v11, v[34:35] offset:48
    ds_write_b64 v11, v[32:33] offset:8
    ds_write_b64 v10, v[28:29]
    s_cbranch_scc1 NODN
    v_mov_b32 v110, 0
    v_xor_b32 v111, 32, v23
    v_xor_b32 v112, 64, v23
    v_xor_b32 v113, 96, v23
    ds_read_b32 v8, v110 offset:58252
    ds_read_b64_tr_b16 v[76:77], v23 offset:0
    ds_read_b64_tr_b16 v[78:79], v23 offset:512
    ds_read_b64_tr_b16 v[98:99], v111 offset:0
    ds_read_b64_tr_b16 v[100:101], v111 offset:512
    ds_read_b64_tr_b16 v[102:103], v112 offset:0
    ds_read_b64_tr_b16 v[104:105], v112 offset:512
    ds_read_b64_tr_b16 v[106:107], v113 offset:0
    ds_read_b64_tr_b16 v[108:109], v113 offset:512
    s_mov_b32 s48, 0
    s_waitcnt vmcnt(0)
HCHK:
    v_add_f32 v90, v90, v94
    v_add_f32 v91, v91, v95
    v_add_f32 v92, v92, v96
    v_add_f32 v93, v93, v97
    v_add_f32_dpp v90, v90, v90 row_ror:8 row_mask:0xf bank_mask:0xf
    v_add_f32_dpp v91, v91, v91 row_ror:8 row_mask:0xf bank_mask:0xf
    v_add_f32_dpp v92, v92, v92 row_ror:8 row_mask:0xf bank_mask:0xf
    v_add_f32_dpp v93, v93, v93 row_ror:8 row_mask:0xf bank_mask:0xf
    v_cmp_u_f32 vcc, v90, v91
    v_cmp_u_f32 s[46:47], v92, v93
    v_mov_b32_dpp v138, v90 quad_perm:[0,1,0,1] row_mask:0xf bank_mask:0xf
    v_mov_b32_dpp v139, v91 quad_perm:[0,1,0,1] row_mask:0xf bank_mask:0xf
    v_mov_b32_dpp v140, v92 quad_perm:[0,1,0,1] row_mask:0xf bank_mask:0xf
    v_mov_b32_dpp v141, v93 quad_perm:[0,1,0,1] row_mask:0xf bank_mask:0xf
    s_or_b64 vcc, vcc, s[46:47]
    s_cbranch_scc1 HRETRY
HOK:
    buffer_load_dwordx4 v[82:85], v81, s[4:7], 0 offen
PAD6:
    s_cbranch_execz RET_B_0
    buffer_load_dwordx4 v[86:89], v14, s[4:7], 0 offen
    v_mul_f32 v130, 0xbfb8aa3b, v138
    v_mul_f32 v131, 0xbfb8aa3b, v139
    v_mul_f32 v132, 0xbfb8aa3b, v140
    v_mul_f32 v133, 0xbfb8aa3b, v141
    v_exp_f32 v130, v130
    v_mul_f32_dpp v138, v90, v138 quad_perm:[2,3,2,3] row_mask:0xf bank_mask:0xf
    v_exp_f32 v131, v131
    v_mul_f32_dpp v139, v91, v139 quad_perm:[2,3,2,3] row_mask:0xf bank_mask:0xf
    v_exp_f32 v132, v132
    v_mul_f32_dpp v140, v92, v140 quad_perm:[2,3,2,3] row_mask:0xf bank_mask:0xf
    v_exp_f32 v133, v133
    v_mul_f32_dpp v141, v93, v141 quad_perm:[2,3,2,3] row_mask:0xf bank_mask:0xf
    v_add_f32 v130, 1.0, v130
    v_add_f32 v131, 1.0, v131
    v_add_f32 v132, 1.0, v132
    v_add_f32 v133, 1.0, v133
    v_rcp_f32 v130, v130
    v_rcp_f32 v131, v131
    v_rcp_f32 v132, v132
    v_rcp_f32 v133, v133
    s_mov_b32 s48, 0
    s_waitcnt lgkmcnt(8)
DCHK:
    v_cmp_eq_u32 vcc, -1, v8
    s_cbranch_vccnz DRETRY
DOK:
    v_mul_f32 v138, v138, v130
    v_mul_f32 v139, v139, v131
    v_mul_f32 v140, v140, v132
    v_mul_f32 v141, v141, v133
    v_cvt_pk_bf16_f32 v142, v138, v139
    v_cvt_pk_bf16_f32 v143, v140, v141
    s_add_u32 s52, s42, 7168
    v_mov_b32_dpp v144, v142 row_shl:4 row_mask:0xf bank_mask:0xf
    v_mov_b32_dpp v145, v143 row_shl:4 row_mask:0xf bank_mask:0xf
    s_waitcnt lgkmcnt(6)
    s_nop 0
    v_mfma_f32_16x16x32_bf16 v[114:117], v[76:79], v[142:145], 0
    s_waitcnt lgkmcnt(4)
    v_mfma_f32_16x16x32_bf16 v[118:121], v[98:101], v[142:145], 0
    s_waitcnt lgkmcnt(2)
    v_mfma_f32_16x16x32_bf16 v[122:125], v[102:105], v[142:145], 0
    s_waitcnt lgkmcnt(0)
    v_mfma_f32_16x16x32_bf16 v[126:129], v[106:109], v[142:145], 0
    s_nop 1
    v_cvt_pk_bf16_f32 v130, v114, v115
    v_cvt_pk_bf16_f32 v131, v116, v117
    v_cvt_pk_bf16_f32 v132, v118, v119
    v_cvt_pk_bf16_f32 v133, v120, v121
    s_nop 0
    v_permlane16_swap_b32 v130, v132
    v_permlane16_swap_b32 v131, v133
    s_mov_b64 exec, s[50:51]
    buffer_store_dwordx4 v[130:133], v26, s[8:11], s42 offen sc1
    s_mov_b64 exec, -1
    v_cvt_pk_bf16_f32 v138, v122, v123
    v_cvt_pk_bf16_f32 v139, v124, v125
    v_cvt_pk_bf16_f32 v140, v126, v127
    v_cvt_pk_bf16_f32 v141, v128, v129
    s_nop 0
    v_permlane16_swap_b32 v138, v140
    v_permlane16_swap_b32 v139, v141
    s_mov_b64 exec, s[50:51]
    buffer_store_dwordx4 v[138:141], v26, s[8:11], s52 offen sc1
    s_mov_b64 exec, -1
DNJ:
    s_barrier
    ds_read_b64_tr_b16 v[90:91], v13 offset:0
    ds_read_b64_tr_b16 v[92:93], v13 offset:768
    ds_read_b64_tr_b16 v[94:95], v13 offset:40
    ds_read_b64_tr_b16 v[96:97], v13 offset:808
    ds_read_b128 v[114:117], v21 offset:24592
    ds_read_b64_tr_b16 v[102:103], v13 offset:3072
    ds_read_b64_tr_b16 v[104:105], v13 offset:3840
    ds_read_b64_tr_b16 v[106:107], v13 offset:3112
    ds_read_b64_tr_b16 v[108:109], v13 offset:3880
    s_waitcnt lgkmcnt(7)
    v_mfma_f32_16x16x32_bf16 v[28:31], v[90:93], v[40:43], 0
    s_waitcnt lgkmcnt(5)
    v_mfma_f32_16x16x32_bf16 v[32:35], v[94:97], v[40:43], 0
    ds_read_b64_tr_b16 v[90:91], v13 offset:6144
    ds_read_b64_tr_b16 v[92:93], v13 offset:6912
    ds_read_b64_tr_b16 v[94:95], v13 offset:6184
    ds_read_b64_tr_b16 v[96:97], v13 offset:6952
    s_waitcnt lgkmcnt(8)
    v_mfma_f32_16x16x32_bf16 v[76:79], v[114:117], v[40:43], 0
    v_mov_b32_dpp v110, v114 row_shr:1 row_mask:0xf bank_mask:0xf
    v_mov_b32_dpp v111, v115 row_shr:1 row_mask:0xf bank_mask:0xf
    v_mov_b32_dpp v112, v116 row_shr:1 row_mask:0xf bank_mask:0xf
    v_mov_b32_dpp v113, v117 row_shr:1 row_mask:0xf bank_mask:0xf
    s_waitcnt lgkmcnt(6)
    v_mfma_f32_16x16x32_bf16 v[28:31], v[102:105], v[44:47], v[28:31]
    s_waitcnt lgkmcnt(4)
    v_mfma_f32_16x16x32_bf16 v[32:35], v[106:109], v[44:47], v[32:35]
    ds_read_b64_tr_b16 v[102:103], v13 offset:9216
    ds_read_b64_tr_b16 v[104:105], v13 offset:9984
    ds_read_b64_tr_b16 v[106:107], v13 offset:9256
    ds_read_b64_tr_b16 v[108:109], v13 offset:10024
    v_mfma_f32_16x16x32_bf16 v[76:79], v[110:113], v[44:47], v[76:79]
    v_mov_b32_dpp v98, v114 row_shr:2 row_mask:0xf bank_mask:0xf
    v_mov_b32_dpp v99, v115 row_shr:2 row_mask:0xf bank_mask:0xf
    v_mov_b32_dpp v100, v116 row_shr:2 row_mask:0xf bank_mask:0xf
    v_mov_b32_dpp v101, v117 row_shr:2 row_mask:0xf bank_mask:0xf
    s_waitcnt lgkmcnt(6)
    v_mfma_f32_16x16x32_bf16 v[28:31], v[90:93], v[48:51], v[28:31]
    s_waitcnt lgkmcnt(4)
    v_mfma_f32_16x16x32_bf16 v[32:35], v[94:97], v[48:51], v[32:35]
    ds_read_b64_tr_b16 v[90:91], v13 offset:12288
    ds_read_b64_tr_b16 v[92:93], v13 offset:13056
    ds_read_b64_tr_b16 v[94:95], v13 offset:12328
    ds_read_b64_tr_b16 v[96:97], v13 offset:13096
    v_mfma_f32_16x16x32_bf16 v[76:79], v[98:101], v[48:51], v[76:79]
    v_mov_b32_dpp v110, v114 row_shr:3 row_mask:0xf bank_mask:0xf
    v_mov_b32_dpp v111, v115 row_shr:3 row_mask:0xf bank_mask:0xf
    v_mov_b32_dpp v112, v116 row_shr:3 row_mask:0xf bank_mask:0xf
    v_mov_b32_dpp v113, v117 row_shr:3 row_mask:0xf bank_mask:0xf
    s_waitcnt lgkmcnt(6)
    v_mfma_f32_16x16x32_bf16 v[28:31], v[102:105], v[52:55], v[28:31]
    s_waitcnt lgkmcnt(4)
    v_mfma_f32_16x16x32_bf16 v[32:35], v[106:109], v[52:55], v[32:35]
    ds_read_b64_tr_b16 v[102:103], v13 offset:15360
    ds_read_b64_tr_b16 v[104:105], v13 offset:16128
    ds_read_b64_tr_b16 v[106:107], v13 offset:15400
    ds_read_b64_tr_b16 v[108:109], v13 offset:16168
    v_mfma_f32_16x16x32_bf16 v[76:79], v[110:113], v[52:55], v[76:79]
    v_mov_b32_dpp v98, v114 row_shr:4 row_mask:0xf bank_mask:0xf
    v_mov_b32_dpp v99, v115 row_shr:4 row_mask:0xf bank_mask:0xf
    v_mov_b32_dpp v100, v116 row_shr:4 row_mask:0xf bank_mask:0xf
    v_mov_b32_dpp v101, v117 row_shr:4 row_mask:0xf bank_mask:0xf
    s_waitcnt lgkmcnt(6)
    v_mfma_f32_16x16x32_bf16 v[28:31], v[90:93], v[56:59], v[28:31]
    s_waitcnt lgkmcnt(4)
    v_mfma_f32_16x16x32_bf16 v[32:35], v[94:97], v[56:59], v[32:35]
    ds_read_b64_tr_b16 v[90:91], v13 offset:18432
    ds_read_b64_tr_b16 v[92:93], v13 offset:19200
    ds_read_b64_tr_b16 v[94:95], v13 offset:18472
    ds_read_b64_tr_b16 v[96:97], v13 offset:19240
    v_mfma_f32_16x16x32_bf16 v[76:79], v[98:101], v[56:59], v[76:79]
    v_mov_b32_dpp v110, v114 row_shr:5 row_mask:0xf bank_mask:0xf
    v_mov_b32_dpp v111, v115 row_shr:5 row_mask:0xf bank_mask:0xf
    v_mov_b32_dpp v112, v116 row_shr:5 row_mask:0xf bank_mask:0xf
    v_mov_b32_dpp v113, v117 row_shr:5 row_mask:0xf bank_mask:0xf
    s_waitcnt lgkmcnt(6)
    v_mfma_f32_16x16x32_bf16 v[28:31], v[102:105], v[60:63], v[28:31]
    s_waitcnt lgkmcnt(4)
    v_mfma_f32_16x16x32_bf16 v[32:35], v[106:109], v[60:63], v[32:35]
    ds_read_b64_tr_b16 v[102:103], v13 offset:21504
    ds_read_b64_tr_b16 v[104:105], v13 offset:22272
    ds_read_b64_tr_b16 v[106:107], v13 offset:21544
    ds_read_b64_tr_b16 v[108:109], v13 offset:22312
    v_mfma_f32_16x16x32_bf16 v[76:79], v[110:113], v[60:63], v[76:79]
    v_mov_b32_dpp v98, v114 row_shr:6 row_mask:0xf bank_mask:0xf
    v_mov_b32_dpp v99, v115 row_shr:6 row_mask:0xf bank_mask:0xf
    v_mov_b32_dpp v100, v116 row_shr:6 row_mask:0xf bank_mask:0xf
PAD7:
    s_cbranch_execz RET_B_0
    v_mov_b32_dpp v101, v117 row_shr:6 row_mask:0xf bank_mask:0xf
    s_waitcnt lgkmcnt(6)
    v_mfma_f32_16x16x32_bf16 v[28:31], v[90:93], v[64:67], v[28:31]
    s_waitcnt lgkmcnt(4)
    v_mfma_f32_16x16x32_bf16 v[32:35], v[94:97], v[64:67], v[32:35]
    v_mfma_f32_16x16x32_bf16 v[76:79], v[98:101], v[64:67], v[76:79]
    v_mov_b32_dpp v110, v114 row_shr:7 row_mask:0xf bank_mask:0xf
    v_mov_b32_dpp v111, v115 row_shr:7 row_mask:0xf bank_mask:0xf
    v_mov_b32_dpp v112, v116 row_shr:7 row_mask:0xf bank_mask:0xf
    v_mov_b32_dpp v113, v117 row_shr:7 row_mask:0xf bank_mask:0xf
    s_waitcnt lgkmcnt(2)
    v_mfma_f32_16x16x32_bf16 v[28:31], v[102:105], v[68:71], v[28:31]
    s_waitcnt lgkmcnt(0)
    v_mfma_f32_16x16x32_bf16 v[32:35], v[106:109], v[68:71], v[32:35]
    v_mfma_f32_16x16x32_bf16 v[76:79], v[110:113], v[68:71], v[76:79]
    v_mul_f32 v19, -v18, v19
    v_add_f32 v18, 1.0, v18
    v_mul_f32 v37, -v36, v37
    v_add_f32 v36, 1.0, v36
    v_bfrev_b32 v73, 1
    v_cndmask_b32 v81, v81, v73, s[34:35]
    v_cndmask_b32 v14, v14, v73, s[36:37]
    v_mov_b32 v114, v28
    v_add_f32 v38, v19, v28
    v_add_f32 v39, v19, v29
    v_add_f32 v40, v19, v30
    v_add_f32 v41, v19, v31
    v_permlane16_swap_b32 v28, v114
    v_add_f32 v51, v37, v31
    v_add_f32 v52, v37, v30
    v_add_f32 v53, v37, v29
    v_add_f32 v42, v19, v32
    v_add_f32 v47, v37, v35
    v_add_f32 v43, v19, v33
    v_add_f32 v48, v37, v34
    v_add_f32 v44, v19, v34
    v_add_f32 v49, v37, v33
    v_permlane32_swap_b32 v28, v76
    v_add_f32 v45, v19, v35
    v_add_f32 v50, v37, v32
    v_add_f32_dpp v46, v114, v37 quad_perm:[0,1,2,3] row_mask:0x5 bank_mask:0xf
    s_nop 1
    v_add_f32_dpp v46, v76, v37 quad_perm:[0,1,2,3] row_mask:0xa bank_mask:0xf
    s_or_b64 vcc, s[34:35], s[36:37]
    s_waitcnt vmcnt(3)
    v_lshlrev_b32 v62, 16, v82
    v_and_b32 v63, 0xffff0000, v82
    v_lshlrev_b32 v64, 16, v83
    v_and_b32 v65, 0xffff0000, v83
    v_lshlrev_b32 v66, 16, v84
    v_and_b32 v67, 0xffff0000, v84
    v_lshlrev_b32 v68, 16, v85
    v_and_b32 v69, 0xffff0000, v85
    v_fmac_f32 v38, v62, v18
    v_fmac_f32 v39, v63, v18
    v_fmac_f32 v40, v64, v18
    v_fmac_f32 v41, v65, v18
    v_fmac_f32 v42, v66, v18
    v_fmac_f32 v43, v67, v18
    v_fmac_f32 v44, v68, v18
    v_fmac_f32 v45, v69, v18
    v_cvt_pk_bf16_f32 v54, v38, v39
    v_cvt_pk_bf16_f32 v55, v40, v41
    v_cvt_pk_bf16_f32 v56, v42, v43
    v_cvt_pk_bf16_f32 v57, v44, v45
    buffer_store_dwordx4 v[54:57], v81, s[24:27], 0 offen sc1 nt
    s_waitcnt vmcnt(3)
    v_lshlrev_b32 v62, 16, v86
    v_and_b32 v63, 0xffff0000, v86
    v_lshlrev_b32 v64, 16, v87
    v_and_b32 v65, 0xffff0000, v87
    v_lshlrev_b32 v66, 16, v88
    v_and_b32 v67, 0xffff0000, v88
    v_lshlrev_b32 v68, 16, v89
    v_and_b32 v69, 0xffff0000, v89
    v_fmac_f32 v46, v62, v36
    v_fmac_f32 v47, v63, v36
    v_fmac_f32 v48, v64, v36
    v_fmac_f32 v49, v65, v36
    v_fmac_f32 v50, v66, v36
    v_fmac_f32 v51, v67, v36
    v_fmac_f32 v52, v68, v36
    v_fmac_f32 v53, v69, v36
    s_cbranch_scc1 FINW
FIND:
    v_cvt_pk_bf16_f32 v58, v46, v47
    v_cvt_pk_bf16_f32 v59, v48, v49
    v_cvt_pk_bf16_f32 v60, v50, v51
    v_cvt_pk_bf16_f32 v61, v52, v53
COUT:
    buffer_store_dwordx4 v[58:61], v14, s[24:27], 0 offen sc1 nt
END:
    s_endpgm
URETRY:
    s_add_u32 s48, s48, 1
    s_cmp_ge_u32 s48, 4096
    s_cbranch_scc1 UOK
    buffer_load_dwordx4 v[28:31], v75, s[8:11], s54 offen sc1
    buffer_load_dwordx4 v[32:35], v75, s[8:11], s41 offen sc1
    buffer_load_dword v20, v80, s[8:11], s55 offen sc1
    buffer_load_dwordx2 v[18:19], v15, s[8:11], s43 offen sc1
    buffer_load_dwordx2 v[36:37], v72, s[8:11], s43 offen sc1
    s_waitcnt vmcnt(0)
    s_branch UCHK
HRETRY:
    s_add_u32 s48, s48, 1
    s_cmp_ge_u32 s48, 4096
    s_cbranch_scc1 HOK
    buffer_load_dwordx4 v[90:93], v25, s[8:11], s52 offen sc1
    buffer_load_dwordx4 v[94:97], v25, s[8:11], s52 offen offset:512 sc1
    s_waitcnt vmcnt(0)
    s_branch HCHK
DRETRY:
    s_add_u32 s48, s48, 1
    s_cmp_ge_u32 s48, 65536
    s_nop 1
    s_cbranch_scc1 DOK
    ds_read_b32 v8, v110 offset:58252
    ds_read_b64_tr_b16 v[76:77], v23 offset:0
    ds_read_b64_tr_b16 v[78:79], v23 offset:512
    ds_read_b64_tr_b16 v[98:99], v111 offset:0
    ds_read_b64_tr_b16 v[100:101], v111 offset:512
    ds_read_b64_tr_b16 v[102:103], v112 offset:0
    ds_read_b64_tr_b16 v[104:105], v112 offset:512
    ds_read_b64_tr_b16 v[106:107], v113 offset:0
    ds_read_b64_tr_b16 v[108:109], v113 offset:512
    s_waitcnt lgkmcnt(0)
    s_branch DCHK
NODN:
    s_waitcnt vmcnt(0) lgkmcnt(0)
    s_branch DNJ
MEETB:
    s_barrier
    s_nop 1
    s_branch GO0
FINW:
    s_mov_b64 exec, s[34:35]
    ds_write_b128 v2, v[38:41] offset:60416
    ds_write_b128 v2, v[42:45] offset:60432
    s_mov_b64 exec, s[36:37]
    ds_write_b128 v9, v[46:49] offset:60672
    ds_write_b128 v9, v[50:53] offset:60688
    s_mov_b64 exec, -1
    s_waitcnt lgkmcnt(0)
    s_branch FIND
COMM:
PAD8:
    s_cbranch_execz RET_A_0
    v_lshlrev_b32 v11, 3, v1
    ds_write_b64 v11, v[6:7] offset:60416
    s_mov_b32 s26, s6
    s_mov_b32 s27, s7
    v_lshlrev_b32 v14, 12, v1
    s_and_b32 s3, s2, 3
    s_lshl_b32 s43, s3, 10
    s_and_b32 s3, s2, 0xfc
    s_lshl2_add_u32 s43, s3, s43
    s_add_u32 s43, s43, 3407872
    s_lshl_b32 s44, s33, 12
    s_add_u32 s44, s44, 3407872
    s_mov_b32 s45, 0
    s_lshl_b32 s38, s35, 5
    v_lshlrev_b32 v18, 2, v1
    v_add_u32 v17, s38, v18
    v_lshrrev_b32 v11, 4, v1
    v_bfe_u32 v12, v1, 1, 3
    v_lshl_add_u32 v11, v12, 2, v11
    s_lshl_b32 s38, s47, 9
    v_lshl_add_u32 v16, v11, 4, s38
    s_mov_b32 s56, 0xaaaaaaaa
    s_mov_b32 s57, 0xaaaaaaaa
    s_cmpk_lt_u32 s2, 224
    s_cbranch_scc1 CB0
    s_barrier
CB0:
    s_waitcnt vmcnt(12)
    v_add_u32 v4, 2, v4
    v_or_b32 v4, 1, v4
    v_readfirstlane_b32 s49, v5
    v_readfirstlane_b32 s48, v4
    s_waitcnt lgkmcnt(0)
CSPIN:
    ds_read_b32 v12, v10 offset:58260
    ds_read_b128 v[24:27], v10 offset:58176
    ds_read_b128 v[28:31], v10 offset:58192
    ds_read_b32 v20, v17 offset:58112
    ds_read_b32 v21, v18 offset:58272
    s_waitcnt lgkmcnt(4)
    v_and_b32 v12, 0xff, v12
    v_cmp_eq_u32 vcc, 8, v12
    s_cbranch_vccz CSPIN
    s_waitcnt lgkmcnt(3)
    v_max3_u32 v19, v24, v25, v26
    v_med3_u32 v23, v24, v25, v26
    s_waitcnt lgkmcnt(2)
    v_max3_u32 v32, v27, v28, v29
    v_med3_u32 v33, v27, v28, v29
    v_med3_u32 v12, v19, v32, v30
    v_max3_u32 v19, v19, v32, v30
    v_max3_u32 v12, v12, v23, v33
    v_max_u32 v2, v19, v31
    v_med3_u32 v3, v19, v12, v31
    s_mov_b64 exec, 0xff
    s_waitcnt vmcnt(0)
    buffer_store_dwordx4 v[2:5], v14, s[8:11], s43 offen sc1
    s_waitcnt lgkmcnt(0)
    buffer_store_dwordx2 v[20:21], v13, s[8:11], s42 offen sc1
    s_mov_b64 exec, -1
    v_readfirstlane_b32 s50, v2
    v_readfirstlane_b32 s51, v3
    s_barrier
    buffer_load_dwordx4 v[34:37], v15, s[8:11], s44 offen offset:0 sc1
    buffer_load_dwordx4 v[38:41], v15, s[8:11], s44 offen offset:1024 sc1
    buffer_load_dwordx4 v[42:45], v15, s[8:11], s44 offen offset:2048 sc1
    buffer_load_dwordx4 v[46:49], v15, s[8:11], s44 offen offset:3072 sc1
    s_mov_b64 s[54:55], 0
    s_mov_b64 s[52:53], -1
REDUCE:
    s_add_u32 s45, s45, 1
    s_waitcnt vmcnt(3)
    v_cmp_eq_u64 vcc, s[48:49], v[36:37]
    s_waitcnt vmcnt(2)
    v_cmp_eq_u64 s[58:59], s[48:49], v[40:41]
    v_max_u32 v23, v35, v39
    v_max_u32 v19, v34, v38
    v_med3_u32 v23, v34, v38, v23
    s_waitcnt vmcnt(1)
    v_cmp_eq_u64 s[60:61], s[48:49], v[44:45]
    s_and_b64 vcc, vcc, s[58:59]
    s_waitcnt vmcnt(0)
    v_cmp_eq_u64 s[62:63], s[48:49], v[48:49]
    v_max_u32 v33, v43, v47
    v_max_u32 v32, v42, v46
    v_med3_u32 v33, v42, v46, v33
    s_and_b64 vcc, vcc, s[60:61]
    v_max_u32 v23, v23, v33
    s_and_b64 vcc, vcc, s[62:63]
    v_med3_u32 v23, v19, v32, v23
    v_max_u32 v19, v19, v32
    v_cndmask_b32 v23, 0, v23, vcc
    v_cndmask_b32 v19, 0, v19, vcc
    s_nop 0
    v_max_u32_dpp v33, v23, v23 row_ror:8 row_mask:0xf bank_mask:0xf
    v_mov_b32_dpp v32, v19 row_ror:8 row_mask:0xf bank_mask:0xf
    v_med3_u32 v23, v19, v32, v33
    v_max_u32 v19, v19, v32
    s_nop 0
    v_max_u32_dpp v33, v23, v23 row_ror:4 row_mask:0xf bank_mask:0xf
    v_mov_b32_dpp v32, v19 row_ror:4 row_mask:0xf bank_mask:0xf
    v_med3_u32 v23, v19, v32, v33
    v_max_u32 v19, v19, v32
    s_nop 0
    v_max_u32_dpp v33, v23, v23 row_ror:2 row_mask:0xf bank_mask:0xf
    v_mov_b32_dpp v32, v19 row_ror:2 row_mask:0xf bank_mask:0xf
    v_med3_u32 v23, v19, v32, v33
    v_max_u32 v19, v19, v32
    s_nop 0
    v_max_u32_dpp v33, v23, v23 row_ror:1 row_mask:0xf bank_mask:0xf
    v_mov_b32_dpp v32, v19 row_ror:1 row_mask:0xf bank_mask:0xf
    v_med3_u32 v23, v19, v32, v33
    v_max_u32 v19, v19, v32
    s_nop 0
    v_max_u32_dpp v33, v23, v23 row_bcast:15 row_mask:0xa bank_mask:0xf
    v_mov_b32_dpp v32, v19 row_bcast:15 row_mask:0xa bank_mask:0xf
    v_med3_u32 v23, v19, v32, v33
    v_max_u32 v19, v19, v32
    s_nop 0
    v_max_u32_dpp v33, v23, v23 row_bcast:31 row_mask:0xc bank_mask:0xf
    v_mov_b32_dpp v32, v19 row_bcast:31 row_mask:0xc bank_mask:0xf
    v_med3_u32 v23, v19, v32, v33
    v_max_u32 v19, v19, v32
    s_nop 0
    v_readlane_b32 s50, v19, 63
    v_readlane_b32 s51, v23, 63
    s_cmp_eq_u64 vcc, -1
    s_cbranch_scc0 NOTALL
    s_cmp_eq_u64 s[50:51], s[52:53]
    s_cbranch_scc1 SAME
FINAL:
    v_mov_b32 v11, s50
    v_mov_b32 v12, s51
    v_cndmask_b32 v11, v11, v12, s[56:57]
    v_and_b32 v32, 0x7ff, v11
    v_lshl_add_u32 v33, v32, 11, v16
    buffer_load_dwordx4 v[24:27], v33, s[4:7], 0 offen
    v_and_b32 v12, 7, v11
    v_and_b32 v11, 0x7f8, v11
    v_lshl_add_u32 v11, v12, 11, v11
    buffer_load_dwordx2 v[20:21], v11, s[8:11], s42 offen sc1
    s_barrier
    s_mov_b64 exec, 3
    ds_write_b32 v18, v32 offset:58240
    s_mov_b64 exec, -1
    s_waitcnt vmcnt(1)
    v_lshlrev_b32 v50, 16, v24
    v_and_b32 v51, 0xffff0000, v24
    v_lshlrev_b32 v52, 16, v25
    v_and_b32 v53, 0xffff0000, v25
    v_lshlrev_b32 v54, 16, v26
    v_and_b32 v55, 0xffff0000, v26
    v_lshlrev_b32 v56, 16, v27
    v_and_b32 v57, 0xffff0000, v27
SCHK:
    s_waitcnt vmcnt(0)
    v_max_u32 v12, v20, v21
    v_mul_f32 v21, -v20, v21
    v_cmp_eq_u32 vcc, -1, v12
    s_cbranch_vccnz SRETRY
SOK:
    v_fma_f32 v50, v50, v20, v21
    v_fma_f32 v51, v51, v20, v21
    v_fma_f32 v52, v52, v20, v21
    v_fma_f32 v53, v53, v20, v21
    v_fma_f32 v54, v54, v20, v21
    v_fma_f32 v55, v55, v20, v21
    v_fma_f32 v56, v56, v20, v21
    v_fma_f32 v57, v57, v20, v21
    v_cvt_pk_bf16_f32 v24, v50, v51
    v_cvt_pk_bf16_f32 v25, v52, v53
    v_cvt_pk_bf16_f32 v26, v54, v55
    v_cvt_pk_bf16_f32 v27, v56, v57
    ds_write_b128 v15, v[24:27] offset:58368
GOT:
    s_waitcnt lgkmcnt(0)
    s_barrier
PAD9:
    s_cbranch_execz RET_B_0
    s_cmp_lg_u32 s2, 0
    s_cbranch_scc1 NOEP
    s_mov_b64 exec, 1
    buffer_store_dword v4, v10, s[8:11], s41 offen sc1
    s_mov_b64 exec, -1
NOEP:
    s_and_b32 s59, s34, 15
    s_lshr_b32 s60, s34, 4
    s_lshl_b32 s60, s60, 10
    s_or_b32 s60, s60, s33
    s_mov_b32 s58, 0
    s_and_b32 s38, s50, 0x407
    s_cmp_eq_u32 s38, s60
    s_cselect_b32 s38, 1, 0
    s_or_b32 s58, s58, s38
    s_and_b32 s38, s51, 0x407
    s_cmp_eq_u32 s38, s60
    s_cselect_b32 s38, 2, 0
    s_or_b32 s58, s58, s38
    s_sub_u32 s38, 0, s50
    s_and_b32 s38, s38, 0x407
    s_cmp_eq_u32 s38, s60
    s_cselect_b32 s38, 4, 0
    s_or_b32 s58, s58, s38
    s_sub_u32 s38, 0, s51
    s_and_b32 s38, s38, 0x407
    s_cmp_eq_u32 s38, s60
    s_cselect_b32 s38, 8, 0
    s_or_b32 s58, s58, s38
    s_cbranch_scc0 MEND
    v_and_b32 v28, 15, v1
    v_and_b32 v11, 1, v1
    v_lshlrev_b32 v11, 4, v11
    v_mov_b32 v12, 0x3f80
    v_lshlrev_b32 v11, v11, v12
    v_lshrrev_b32 v12, 1, v28
    v_cmp_eq_u32 vcc, 0, v12
    s_nop 1
    v_cndmask_b32 v24, 0, v11, vcc
    v_cmp_eq_u32 vcc, 1, v12
    s_nop 1
    v_cndmask_b32 v25, 0, v11, vcc
    v_cmp_eq_u32 vcc, 2, v12
    s_nop 1
    v_cndmask_b32 v26, 0, v11, vcc
    v_cmp_eq_u32 vcc, 3, v12
    s_nop 1
    v_cndmask_b32 v27, 0, v11, vcc
    v_and_b32 v11, 3, v1
    v_bfe_u32 v12, v1, 4, 1
    v_lshl_add_u32 v11, v11, 1, v12
    v_lshlrev_b32 v29, 4, v11
    v_lshlrev_b32 v30, 3, v11
    s_barrier
    s_barrier
ROLE:
    s_ff1_i32_b32 s61, s58
    s_bitset0_b32 s58, s61
    s_bitcmp1_b32 s61, 0
    s_cselect_b32 s62, s51, s50
    s_cselect_b32 s64, 32, 0
    s_sub_u32 s46, 31, s59
    s_bitcmp1_b32 s61, 1
    s_cselect_b32 s46, s46, s59
    s_add_u32 s64, s64, s46
    s_mul_i32 s64, s64, 7168
    s_add_u32 s64, s64, 2490368
    s_add_u32 s47, s64, 4096
    s_and_b32 s63, s62, 0x7ff
    s_lshl_b32 s63, s63, 11
    s_lshl_b32 s46, s46, 6
    s_add_u32 s63, s63, s46
    s_lshl_b32 s38, s61, 7
    v_add_u32 v11, s38, v29
    s_mov_b32 s45, 0
    v_mov_b32 v31, s62
    v_ashrrev_i32 v12, 31, v31
    v_not_b32 v12, v12
    v_or_b32 v12, 0x80000000, v12
    v_xor_b32 v31, v31, v12
    v_mul_f32 v31, 0xbfb8aa3b, v31
    v_exp_f32 v31, v31
    s_nop 0
    v_add_f32 v31, 1.0, v31
    v_rcp_f32 v31, v31
RPOLL:
    buffer_load_dwordx4 v[34:37], v15, s[8:11], s64 offen offset:0 sc1
    buffer_load_dwordx4 v[38:41], v15, s[8:11], s64 offen offset:1024 sc1
    buffer_load_dwordx4 v[42:45], v15, s[8:11], s64 offen offset:2048 sc1
    buffer_load_dwordx4 v[46:49], v15, s[8:11], s64 offen offset:3072 sc1
    buffer_load_dwordx4 v[50:53], v15, s[8:11], s47 offen offset:0 sc1
    buffer_load_dwordx4 v[54:57], v15, s[8:11], s47 offen offset:1024 sc1
    buffer_load_dwordx4 v[58:61], v15, s[8:11], s47 offen offset:2048 sc1
    s_add_u32 s45, s45, 1
    s_waitcnt vmcnt(6)
    v_mfma_f32_16x16x32_bf16 v[62:65], v[24:27], v[34:37], 0
    s_waitcnt vmcnt(5)
    v_mfma_f32_16x16x32_bf16 v[62:65], v[24:27], v[38:41], v[62:65]
    s_waitcnt vmcnt(4)
    v_mfma_f32_16x16x32_bf16 v[62:65], v[24:27], v[42:45], v[62:65]
    s_waitcnt vmcnt(3)
    v_mfma_f32_16x16x32_bf16 v[62:65], v[24:27], v[46:49], v[62:65]
    s_waitcnt vmcnt(2)
    v_mfma_f32_16x16x32_bf16 v[62:65], v[24:27], v[50:53], v[62:65]
    s_waitcnt vmcnt(1)
    v_mfma_f32_16x16x32_bf16 v[62:65], v[24:27], v[54:57], v[62:65]
    s_waitcnt vmcnt(0)
    v_mfma_f32_16x16x32_bf16 v[62:65], v[24:27], v[58:61], v[62:65]
    ds_read_b128 v[66:69], v11 offset:60416
    s_cmp_ge_u32 s45, 4096
    s_cbranch_scc1 RGOT
    s_nop 4
    v_cmp_u_f32 vcc, v62, v62
    s_cbranch_vccnz RPOLL
RGOT:
    s_nop 4
    v_add_f32_dpp v62, v62, v62 row_ror:4 row_mask:0xf bank_mask:0xf
    v_add_f32_dpp v63, v63, v63 row_ror:4 row_mask:0xf bank_mask:0xf
    v_add_f32_dpp v64, v64, v64 row_ror:4 row_mask:0xf bank_mask:0xf
    v_add_f32_dpp v65, v65, v65 row_ror:4 row_mask:0xf bank_mask:0xf
    v_add_f32_dpp v62, v62, v62 row_ror:8 row_mask:0xf bank_mask:0xf
    v_add_f32_dpp v63, v63, v63 row_ror:8 row_mask:0xf bank_mask:0xf
    v_add_f32_dpp v64, v64, v64 row_ror:8 row_mask:0xf bank_mask:0xf
    v_add_f32_dpp v65, v65, v65 row_ror:8 row_mask:0xf bank_mask:0xf
FCHK:
    s_waitcnt lgkmcnt(0)
    v_max3_u32 v12, v66, v67, v68
    v_max_u32 v12, v12, v69
    v_cmp_eq_u32 vcc, -1, v12
    s_cbranch_vccnz FRETRY
FOK:
    v_fmac_f32 v66, v62, v31
    v_fmac_f32 v67, v63, v31
    v_fmac_f32 v68, v64, v31
    v_fmac_f32 v69, v65, v31
    v_cvt_pk_bf16_f32 v66, v66, v67
    v_cvt_pk_bf16_f32 v67, v68, v69
    s_mov_b64 exec, 0x000f000f
    buffer_store_dwordx2 v[66:67], v30, s[24:27], s63 offen sc1 nt
    s_mov_b64 exec, -1
    s_cmp_lg_u32 s58, 0
    s_nop 0
    s_cbranch_scc1 ROLE
MEND:
    s_endpgm
FRETRY:
    s_add_u32 s45, s45, 1
    s_cmp_ge_u32 s45, 65536
    s_cbranch_scc1 FOK
    ds_read_b128 v[66:69], v11 offset:60416
    s_branch FCHK
NOTALL:
    s_cmp_ge_u32 s45, 4096
    s_cbranch_scc1 FINAL
    s_cmp_eq_u64 s[50:51], s[52:53]
    s_cselect_b64 vcc, s[54:55], 0
    s_cmp_eq_u64 vcc, -1
    s_cbranch_scc0 POLLA
    buffer_load_dwordx4 v[34:37], v15, s[8:11], s44 offen offset:0 sc1
    buffer_load_dwordx4 v[38:41], v15, s[8:11], s44 offen offset:1024 sc1
    buffer_load_dwordx4 v[42:45], v15, s[8:11], s44 offen offset:2048 sc1
    buffer_load_dwordx4 v[46:49], v15, s[8:11], s44 offen offset:3072 sc1
    s_nop 0
    s_branch REDUCE
POLLA:
    v_mov_b32 v11, s50
    v_mov_b32 v12, s51
    s_mov_b64 s[52:53], s[50:51]
    v_cndmask_b32 v11, v11, v12, s[56:57]
    v_and_b32 v32, 0x7ff, v11
    v_lshl_add_u32 v33, v32, 11, v16
    buffer_load_dwordx4 v[24:27], v33, s[4:7], 0 offen
    v_and_b32 v12, 7, v11
    v_and_b32 v11, 0x7f8, v11
    v_lshl_add_u32 v11, v12, 11, v11
    buffer_load_dwordx2 v[20:21], v11, s[8:11], s42 offen sc1
    buffer_load_dwordx4 v[34:37], v15, s[8:11], s44 offen offset:0 sc1
    buffer_load_dwordx4 v[38:41], v15, s[8:11], s44 offen offset:1024 sc1
    buffer_load_dwordx4 v[42:45], v15, s[8:11], s44 offen offset:2048 sc1
    buffer_load_dwordx4 v[46:49], v15, s[8:11], s44 offen offset:3072 sc1
    s_mov_b64 exec, 3
    ds_write_b32 v18, v32 offset:58240
    s_mov_b64 exec, -1
    s_waitcnt vmcnt(5)
    v_lshlrev_b32 v50, 16, v24
    v_and_b32 v51, 0xffff0000, v24
    v_lshlrev_b32 v52, 16, v25
    v_and_b32 v53, 0xffff0000, v25
    v_lshlrev_b32 v54, 16, v26
    v_and_b32 v55, 0xffff0000, v26
    v_lshlrev_b32 v56, 16, v27
    v_and_b32 v57, 0xffff0000, v27
    s_waitcnt vmcnt(4)
    v_max_u32 v11, v20, v21
    v_mul_f32 v21, -v20, v21
    v_cmp_ne_u32 s[54:55], -1, v11
    v_fma_f32 v50, v50, v20, v21
    v_fma_f32 v51, v51, v20, v21
    v_fma_f32 v52, v52, v20, v21
    v_fma_f32 v53, v53, v20, v21
    v_fma_f32 v54, v54, v20, v21
    v_fma_f32 v55, v55, v20, v21
    v_fma_f32 v56, v56, v20, v21
    v_fma_f32 v57, v57, v20, v21
    v_cvt_pk_bf16_f32 v24, v50, v51
    v_cvt_pk_bf16_f32 v25, v52, v53
    v_cvt_pk_bf16_f32 v26, v54, v55
    v_cvt_pk_bf16_f32 v27, v56, v57
    ds_write_b128 v15, v[24:27] offset:58368
    s_nop 0
    s_branch REDUCE
SAME:
    s_cmp_eq_u64 s[54:55], -1
    s_cbranch_scc0 FINAL
    s_barrier
    s_branch GOT
SRETRY:
    s_add_u32 s45, s45, 1
    s_cmp_ge_u32 s45, 8192
    s_cbranch_scc1 SOK
    buffer_load_dwordx2 v[20:21], v11, s[8:11], s42 offen sc1
    s_branch SCHK
LOAD:
    s_lshl_b32 s14, 7, 20
    s_mov_b32 s15, s7
    s_mov_b64 s[18:19], s[14:15]
    s_lshr_b32 s41, s40, 2
    s_and_b32 s42, s40, 3
    s_mul_i32 s43, s42, 1835008
    s_lshl_b32 s38, s41, 7
    s_add_u32 s43, s43, s38
    s_cmpk_ge_u32 s2, 192
    s_cselect_b32 s46, -6, 1
    s_lshl_b32 s46, s46, 7
    s_add_u32 s46, s46, s43
    v_bfe_u32 v10, v1, 1, 2
    v_bfe_u32 v11, v1, 4, 1
    v_xor_b32 v10, v10, v11
    v_and_b32 v11, 1, v1
    v_lshlrev_b32 v11, 4, v11
    v_lshl_add_u32 v10, v10, 5, v11
    v_lshrrev_b32 v11, 3, v1
    v_mul_u32_u24 v2, 7168, v11
    v_add_u32 v2, v10, v2
    v_xor_b32 v3, 64, v2
    v_add_u32 v4, 112640, v2
    v_add_u32 v5, 168960, v3
    v_add_u32 v3, 56320, v3
    s_cmp_eq_u32 s35, 0
    s_cselect_b32 s47, s37, s36
    s_cselect_b32 s48, -1, 1
    s_cselect_b32 s49, 16384, 0
    s_lshl_b32 s48, s48, 19
    s_lshl_b32 s47, s47, 11
    v_and_b32 v12, 32, v1
    v_lshlrev_b32 v6, 4, v1
    v_xor_b32 v12, v12, v6
    s_waitcnt lgkmcnt(0)
    s_add_u32 m0, s49, 0
    s_nop 0
    buffer_load_dwordx4 v12, s[4:7], s47 offen offset:0 lds
    buffer_load_dwordx4 v12, s[4:7], s47 offen offset:1024 lds
    s_add_u32 m0, s49, 2048
    s_add_u32 s47, s47, s48
    buffer_load_dwordx4 v12, s[4:7], s47 offen offset:0 lds
    buffer_load_dwordx4 v12, s[4:7], s47 offen offset:1024 lds
    s_add_u32 m0, s49, 4096
    s_add_u32 s47, s47, s48
    buffer_load_dwordx4 v12, s[4:7], s47 offen offset:0 lds
    buffer_load_dwordx4 v12, s[4:7], s47 offen offset:1024 lds
    s_add_u32 m0, s49, 6144
    s_add_u32 s47, s47, s48
    buffer_load_dwordx4 v12, s[4:7], s47 offen offset:0 lds
    buffer_load_dwordx4 v12, s[4:7], s47 offen offset:1024 lds
    s_add_u32 m0, s49, 8192
    s_add_u32 s47, s47, s48
    buffer_load_dwordx4 v12, s[4:7], s47 offen offset:0 lds
    buffer_load_dwordx4 v12, s[4:7], s47 offen offset:1024 lds
    s_add_u32 m0, s49, 10240
    s_add_u32 s47, s47, s48
    buffer_load_dwordx4 v12, s[4:7], s47 offen offset:0 lds
    buffer_load_dwordx4 v12, s[4:7], s47 offen offset:1024 lds
    s_add_u32 m0, s49, 12288
    s_add_u32 s47, s47, s48
    buffer_load_dwordx4 v12, s[4:7], s47 offen offset:0 lds
    buffer_load_dwordx4 v12, s[4:7], s47 offen offset:1024 lds
    s_add_u32 m0, s49, 14336
    s_add_u32 s47, s47, s48
    buffer_load_dwordx4 v12, s[4:7], s47 offen offset:0 lds
    buffer_load_dwordx4 v12, s[4:7], s47 offen offset:1024 lds
    s_mov_b32 m0, 61440
    s_add_u32 s45, s43, 0
    buffer_load_dwordx4 v2, s[12:15], s45 offen offset:0 nt lds
    buffer_load_dwordx4 v3, s[12:15], s45 offen offset:1024 nt lds
    buffer_load_dwordx4 v4, s[12:15], s45 offen offset:2048 nt lds
    buffer_load_dwordx4 v5, s[12:15], s45 offen offset:3072 nt lds
    s_mov_b32 m0, 94208
    s_add_u32 s45, s46, 0
    buffer_load_dwordx4 v2, s[16:19], s45 offen offset:0 nt lds
    buffer_load_dwordx4 v3, s[16:19], s45 offen offset:1024 nt lds
    buffer_load_dwordx4 v4, s[16:19], s45 offen offset:2048 nt lds
    buffer_load_dwordx4 v5, s[16:19], s45 offen offset:3072 nt lds
    s_mov_b32 m0, 65536
    s_add_u32 s45, s43, 229376
    buffer_load_dwordx4 v2, s[12:15], s45 offen offset:0 nt lds
    buffer_load_dwordx4 v3, s[12:15], s45 offen offset:1024 nt lds
    buffer_load_dwordx4 v4, s[12:15], s45 offen offset:2048 nt lds
    buffer_load_dwordx4 v5, s[12:15], s45 offen offset:3072 nt lds
    v_mov_b32 v12, 256
    s_mov_b64 s[22:23], s[14:15]
    s_lshl_b32 s44, s41, 17
    s_lshl_b32 s38, s42, 9
    s_add_u32 s44, s44, s38
    v_lshl_add_u32 v6, v11, 11, v10
    v_xor_b32 v7, 64, v6
    v_add_u32 v8, 30720, v6
    v_add_u32 v9, 46080, v7
    v_add_u32 v7, 15360, v7
    v_mov_b32 v10, -1
    v_mov_b32 v11, 0
    ds_write_b32 v11, v10 offset:58252
    s_waitcnt vmcnt(12)
    s_mov_b64 exec, 1
    ds_add_u32 v11, v12 offset:58260
    s_mov_b64 exec, -1
    s_mov_b32 m0, 98304
    s_add_u32 s45, s46, 229376
    buffer_load_dwordx4 v2, s[16:19], s45 offen offset:0 nt lds
    buffer_load_dwordx4 v3, s[16:19], s45 offen offset:1024 nt lds
    buffer_load_dwordx4 v4, s[16:19], s45 offen offset:2048 nt lds
    buffer_load_dwordx4 v5, s[16:19], s45 offen offset:3072 nt lds
    s_mov_b32 m0, 69632
    s_add_u32 s45, s43, 458752
    buffer_load_dwordx4 v2, s[12:15], s45 offen offset:0 nt lds
    buffer_load_dwordx4 v3, s[12:15], s45 offen offset:1024 nt lds
    buffer_load_dwordx4 v4, s[12:15], s45 offen offset:2048 nt lds
    buffer_load_dwordx4 v5, s[12:15], s45 offen offset:3072 nt lds
    s_mov_b32 m0, 102400
    s_add_u32 s45, s46, 458752
    s_waitcnt vmcnt(19)
    buffer_load_dwordx4 v2, s[16:19], s45 offen offset:0 nt lds
    s_waitcnt vmcnt(19)
    buffer_load_dwordx4 v3, s[16:19], s45 offen offset:1024 nt lds
    s_waitcnt vmcnt(19)
    buffer_load_dwordx4 v4, s[16:19], s45 offen offset:2048 nt lds
    s_waitcnt vmcnt(19)
    buffer_load_dwordx4 v5, s[16:19], s45 offen offset:3072 nt lds
    s_mov_b32 m0, 73728
    s_add_u32 s45, s43, 688128
    s_waitcnt vmcnt(19)
    buffer_load_dwordx4 v2, s[12:15], s45 offen offset:0 nt lds
    s_waitcnt vmcnt(19)
    buffer_load_dwordx4 v3, s[12:15], s45 offen offset:1024 nt lds
    s_waitcnt vmcnt(19)
    buffer_load_dwordx4 v4, s[12:15], s45 offen offset:2048 nt lds
    s_waitcnt vmcnt(19)
    buffer_load_dwordx4 v5, s[12:15], s45 offen offset:3072 nt lds
    s_mov_b32 m0, 106496
    s_add_u32 s45, s46, 688128
    s_waitcnt vmcnt(19)
    buffer_load_dwordx4 v2, s[16:19], s45 offen offset:0 nt lds
    s_waitcnt vmcnt(19)
    buffer_load_dwordx4 v3, s[16:19], s45 offen offset:1024 nt lds
    s_waitcnt vmcnt(19)
    buffer_load_dwordx4 v4, s[16:19], s45 offen offset:2048 nt lds
    s_waitcnt vmcnt(19)
    buffer_load_dwordx4 v5, s[16:19], s45 offen offset:3072 nt lds
    s_mov_b32 m0, 77824
    s_add_u32 s45, s43, 917504
    s_waitcnt vmcnt(19)
    buffer_load_dwordx4 v2, s[12:15], s45 offen offset:0 nt lds
    s_waitcnt vmcnt(19)
    buffer_load_dwordx4 v3, s[12:15], s45 offen offset:1024 nt lds
    s_waitcnt vmcnt(19)
    buffer_load_dwordx4 v4, s[12:15], s45 offen offset:2048 nt lds
    s_waitcnt vmcnt(19)
    buffer_load_dwordx4 v5, s[12:15], s45 offen offset:3072 nt lds
    s_mov_b32 m0, 110592
    s_add_u32 s45, s46, 917504
    s_waitcnt vmcnt(19)
PAD10:
    s_cbranch_execz RET_A_1
    buffer_load_dwordx4 v2, s[16:19], s45 offen offset:0 nt lds
    s_waitcnt vmcnt(19)
    buffer_load_dwordx4 v3, s[16:19], s45 offen offset:1024 nt lds
    s_waitcnt vmcnt(19)
    buffer_load_dwordx4 v4, s[16:19], s45 offen offset:2048 nt lds
    s_waitcnt vmcnt(19)
    buffer_load_dwordx4 v5, s[16:19], s45 offen offset:3072 nt lds
    s_mov_b32 m0, 81920
    s_add_u32 s45, s43, 1146880
    s_waitcnt vmcnt(19)
    buffer_load_dwordx4 v2, s[12:15], s45 offen offset:0 nt lds
    s_waitcnt vmcnt(19)
    buffer_load_dwordx4 v3, s[12:15], s45 offen offset:1024 nt lds
    s_waitcnt vmcnt(19)
    buffer_load_dwordx4 v4, s[12:15], s45 offen offset:2048 nt lds
    s_waitcnt vmcnt(19)
    buffer_load_dwordx4 v5, s[12:15], s45 offen offset:3072 nt lds
    s_mov_b32 m0, 114688
    s_add_u32 s45, s46, 1146880
PAD11:
    s_cbranch_execz RET_A_2
    s_waitcnt vmcnt(19)
    buffer_load_dwordx4 v2, s[16:19], s45 offen offset:0 nt lds
    s_waitcnt vmcnt(19)
    buffer_load_dwordx4 v3, s[16:19], s45 offen offset:1024 nt lds
    s_waitcnt vmcnt(19)
    buffer_load_dwordx4 v4, s[16:19], s45 offen offset:2048 nt lds
    s_waitcnt vmcnt(19)
    buffer_load_dwordx4 v5, s[16:19], s45 offen offset:3072 nt lds
    s_mov_b32 m0, 86016
    s_add_u32 s45, s43, 1376256
    s_waitcnt vmcnt(19)
    buffer_load_dwordx4 v2, s[12:15], s45 offen offset:0 nt lds
    s_waitcnt vmcnt(19)
    buffer_load_dwordx4 v3, s[12:15], s45 offen offset:1024 nt lds
    s_waitcnt vmcnt(19)
    buffer_load_dwordx4 v4, s[12:15], s45 offen offset:2048 nt lds
    s_waitcnt vmcnt(19)
    buffer_load_dwordx4 v5, s[12:15], s45 offen offset:3072 nt lds
    s_mov_b32 m0, 118784
    s_add_u32 s45, s46, 1376256
    s_waitcnt vmcnt(19)
    buffer_load_dwordx4 v2, s[16:19], s45 offen offset:0 nt lds
    s_waitcnt vmcnt(19)
    buffer_load_dwordx4 v3, s[16:19], s45 offen offset:1024 nt lds
    s_waitcnt vmcnt(19)
    buffer_load_dwordx4 v4, s[16:19], s45 offen offset:2048 nt lds
    s_waitcnt vmcnt(19)
    buffer_load_dwordx4 v5, s[16:19], s45 offen offset:3072 nt lds
    s_waitcnt lgkmcnt(0)
    s_barrier
    s_mov_b32 m0, 90112
    s_add_u32 s45, s43, 1605632
    s_waitcnt vmcnt(19)
    buffer_load_dwordx4 v2, s[12:15], s45 offen offset:0 nt lds
    s_waitcnt vmcnt(19)
    buffer_load_dwordx4 v3, s[12:15], s45 offen offset:1024 nt lds
    s_waitcnt vmcnt(19)
    buffer_load_dwordx4 v4, s[12:15], s45 offen offset:2048 nt lds
    s_waitcnt vmcnt(19)
    buffer_load_dwordx4 v5, s[12:15], s45 offen offset:3072 nt lds
    s_mov_b32 m0, 122880
    s_add_u32 s45, s46, 1605632
    s_waitcnt vmcnt(19)
    buffer_load_dwordx4 v2, s[16:19], s45 offen offset:0 nt lds
    s_waitcnt vmcnt(19)
    buffer_load_dwordx4 v3, s[16:19], s45 offen offset:1024 nt lds
    s_waitcnt vmcnt(19)
    buffer_load_dwordx4 v4, s[16:19], s45 offen offset:2048 nt lds
    s_waitcnt vmcnt(19)
    buffer_load_dwordx4 v5, s[16:19], s45 offen offset:3072 nt lds
    s_barrier
    s_mov_b32 m0, 126976
    s_add_u32 s45, s44, 0
    buffer_load_dwordx4 v6, s[20:23], s45 offen offset:0 nt lds
    buffer_load_dwordx4 v7, s[20:23], s45 offen offset:1024 nt lds
    buffer_load_dwordx4 v8, s[20:23], s45 offen offset:2048 nt lds
    buffer_load_dwordx4 v9, s[20:23], s45 offen offset:3072 nt lds
    s_mov_b32 m0, 131072
    s_add_u32 s45, s44, 128
    buffer_load_dwordx4 v6, s[20:23], s45 offen offset:0 nt lds
    buffer_load_dwordx4 v7, s[20:23], s45 offen offset:1024 nt lds
    buffer_load_dwordx4 v8, s[20:23], s45 offen offset:2048 nt lds
    buffer_load_dwordx4 v9, s[20:23], s45 offen offset:3072 nt lds
    s_mov_b32 m0, 135168
    s_add_u32 s45, s44, 256
    buffer_load_dwordx4 v6, s[20:23], s45 offen offset:0 nt lds
    buffer_load_dwordx4 v7, s[20:23], s45 offen offset:1024 nt lds
    buffer_load_dwordx4 v8, s[20:23], s45 offen offset:2048 nt lds
    buffer_load_dwordx4 v9, s[20:23], s45 offen offset:3072 nt lds
    s_mov_b32 m0, 139264
    s_add_u32 s45, s44, 384
    buffer_load_dwordx4 v6, s[20:23], s45 offen offset:0 nt lds
    buffer_load_dwordx4 v7, s[20:23], s45 offen offset:1024 nt lds
    buffer_load_dwordx4 v8, s[20:23], s45 offen offset:2048 nt lds
    buffer_load_dwordx4 v9, s[20:23], s45 offen offset:3072 nt lds
    s_mov_b32 m0, 143360
    s_add_u32 s45, s44, 65536
    buffer_load_dwordx4 v6, s[20:23], s45 offen offset:0 nt lds
    buffer_load_dwordx4 v7, s[20:23], s45 offen offset:1024 nt lds
    buffer_load_dwordx4 v8, s[20:23], s45 offen offset:2048 nt lds
    buffer_load_dwordx4 v9, s[20:23], s45 offen offset:3072 nt lds
    s_mov_b32 m0, 147456
    s_add_u32 s45, s44, 65664
    buffer_load_dwordx4 v6, s[20:23], s45 offen offset:0 nt lds
    buffer_load_dwordx4 v7, s[20:23], s45 offen offset:1024 nt lds
    buffer_load_dwordx4 v8, s[20:23], s45 offen offset:2048 nt lds
    buffer_load_dwordx4 v9, s[20:23], s45 offen offset:3072 nt lds
    s_mov_b32 m0, 151552
    s_add_u32 s45, s44, 65792
    buffer_load_dwordx4 v6, s[20:23], s45 offen offset:0 nt lds
    buffer_load_dwordx4 v7, s[20:23], s45 offen offset:1024 nt lds
    buffer_load_dwordx4 v8, s[20:23], s45 offen offset:2048 nt lds
    buffer_load_dwordx4 v9, s[20:23], s45 offen offset:3072 nt lds
    s_mov_b32 m0, 155648
    s_add_u32 s45, s44, 65920
    buffer_load_dwordx4 v6, s[20:23], s45 offen offset:0 nt lds
    buffer_load_dwordx4 v7, s[20:23], s45 offen offset:1024 nt lds
    buffer_load_dwordx4 v8, s[20:23], s45 offen offset:2048 nt lds
    buffer_load_dwordx4 v9, s[20:23], s45 offen offset:3072 nt lds
    s_waitcnt vmcnt(32)
    s_barrier
    s_barrier
    s_waitcnt vmcnt(0)
    ds_write_b32 v11, v11 offset:58252
    s_endpgm
PREF:
    s_lshl_b32 s22, 7, 20
    s_lshl_b32 s23, 1, 17
    s_and_b32 s3, s2, 7
    s_mul_i32 s3, s3, 28
    s_sub_u32 s38, s34, 28
    s_mul_i32 s38, s38, 7
    s_add_u32 s3, s3, s38
    v_lshrrev_b32 v2, 1, v1
    v_and_b32 v3, 1, v1
    v_lshlrev_b32 v3, 7, v3
    v_lshl_add_u32 v2, v2, 11, v3
    s_waitcnt lgkmcnt(0)
    s_barrier
    s_add_u32 s38, s3, 0
    s_and_b32 s39, s38, 3
    s_lshr_b32 s38, s38, 2
    s_lshl_b32 s39, s39, 9
    s_lshl_b32 s38, s38, 17
    s_add_u32 s39, s39, 65536
    s_add_u32 s38, s38, s39
    buffer_load_dword v4, v2, s[20:23], s38 offen offset:256
    s_add_u32 s38, s3, 1
    s_and_b32 s39, s38, 3
    s_lshr_b32 s38, s38, 2
    s_lshl_b32 s39, s39, 9
    s_lshl_b32 s38, s38, 17
    s_add_u32 s39, s39, 65536
    s_add_u32 s38, s38, s39
    buffer_load_dword v4, v2, s[20:23], s38 offen offset:256
    s_add_u32 s38, s3, 2
    s_and_b32 s39, s38, 3
    s_lshr_b32 s38, s38, 2
    s_lshl_b32 s39, s39, 9
    s_lshl_b32 s38, s38, 17
    s_add_u32 s39, s39, 65536
    s_add_u32 s38, s38, s39
    buffer_load_dword v4, v2, s[20:23], s38 offen offset:256
    s_add_u32 s38, s3, 3
    s_and_b32 s39, s38, 3
    s_lshr_b32 s38, s38, 2
    s_lshl_b32 s39, s39, 9
    s_lshl_b32 s38, s38, 17
    s_add_u32 s39, s39, 65536
    s_add_u32 s38, s38, s39
    s_waitcnt vmcnt(2)
    buffer_load_dword v4, v2, s[20:23], s38 offen offset:256
    s_add_u32 s38, s3, 4
    s_and_b32 s39, s38, 3
    s_lshr_b32 s38, s38, 2
    s_lshl_b32 s39, s39, 9
    s_lshl_b32 s38, s38, 17
    s_add_u32 s39, s39, 65536
    s_add_u32 s38, s38, s39
    s_waitcnt vmcnt(2)
    buffer_load_dword v4, v2, s[20:23], s38 offen offset:256
    s_add_u32 s38, s3, 5
    s_and_b32 s39, s38, 3
    s_lshr_b32 s38, s38, 2
    s_lshl_b32 s39, s39, 9
    s_lshl_b32 s38, s38, 17
    s_add_u32 s39, s39, 65536
    s_add_u32 s38, s38, s39
    s_waitcnt vmcnt(2)
    buffer_load_dword v4, v2, s[20:23], s38 offen offset:256
    s_add_u32 s38, s3, 6
    s_and_b32 s39, s38, 3
    s_lshr_b32 s38, s38, 2
    s_lshl_b32 s39, s39, 9
    s_lshl_b32 s38, s38, 17
    s_add_u32 s39, s39, 65536
    s_add_u32 s38, s38, s39
    s_waitcnt vmcnt(2)
    buffer_load_dword v4, v2, s[20:23], s38 offen offset:256
    s_waitcnt vmcnt(0)
    s_endpgm
.section .rodata,"a"
.p2align 6
.amdhsa_kernel parallel_sum__spectral_fnet__moe_arch_mod__prompt_kernel
  .amdhsa_next_free_vgpr 156
  .amdhsa_next_free_sgpr 102
  .amdhsa_accum_offset 156
  .amdhsa_group_segment_fixed_size 0
  .amdhsa_kernarg_size 104
  .amdhsa_user_sgpr_count 2
  .amdhsa_user_sgpr_kernarg_segment_ptr 1
  .amdhsa_system_sgpr_workgroup_id_x 1
.end_amdhsa_kernel
```
